```python
import torch

def _softmax(x, axis=-1):
    return torch.softmax(x, dim=axis)
def _gelu(x):
    return torch.nn.functional.gelu(x, approximate="tanh")
def _silu(x):
    return torch.nn.functional.silu(x)
def _sigmoid(x):
    return torch.sigmoid(x)
def _layernorm(x, axis=-1, eps=1e-5):
    m = x.mean(dim=axis, keepdim=True)
    v = x.var(dim=axis, keepdim=True, unbiased=False)
    return (x - m) / torch.sqrt(v + eps)
def _scatter_add(tgt, idx, src, axis=0):
    return tgt.clone().index_add_(axis, idx, src)
def _segment_sum(src, seg, n):
    out = torch.zeros((n,) + src.shape[1:], dtype=src.dtype)
    return out.index_add_(0, seg, src)
def _pad(x, pw):
    flat = tuple(v for pair in reversed(pw) for v in pair)
    return torch.nn.functional.pad(x, flat)

kernel_name = 'parallel_sum__ssm_conv_s5__swiglu_ffn__prompt'

def setup_inputs():

    _w = (lambda a: (lambda t: t.to(torch.bfloat16) if t.is_floating_point() else t)(torch.as_tensor(a)))
    def _A_setup():
        B, S, D = 1, 2048, 1024
        P = D
        Lambda_re = -0.5 * (lambda _x: torch.exp(torch.as_tensor(_x)))((lambda *s: torch.randn(*s, dtype=torch.bfloat16) * 0.8)(P))
        Lambda_im = (lambda *s: torch.randn(*s, dtype=torch.bfloat16) * 0.8)(P) * 1.0
        B_re = (lambda *s: torch.randn(*s, dtype=torch.bfloat16) * 1.6)(P, D) * (D ** -0.5)
        B_im = (lambda *s: torch.randn(*s, dtype=torch.bfloat16) * 1.6)(P, D) * (D ** -0.5)
        C_re = (lambda *s: torch.randn(*s, dtype=torch.bfloat16) * 1.6)(D, P) * (P ** -0.5)
        C_im = (lambda *s: torch.randn(*s, dtype=torch.bfloat16) * 1.6)(D, P) * (P ** -0.5)
        log_dt = (lambda *s: torch.randn(*s, dtype=torch.bfloat16) * 0.8)(P) * 0.3 - 2.0
        Dskip = (lambda *s: torch.randn(*s, dtype=torch.bfloat16) * 0.4)(D)
        return {
            "x": _w((lambda *s: torch.randn(*s, dtype=torch.bfloat16) * 0.05)(B, S, D)),
            "Lambda_re": _w(Lambda_re),
            "Lambda_im": _w(Lambda_im),
            "B_re": _w(B_re),
            "B_im": _w(B_im),
            "C_re": _w(C_re),
            "C_im": _w(C_im),
            "log_dt": _w(log_dt),
            "Dskip": _w(Dskip),
        }
    _A_in = _A_setup()

    def _B_setup():
        B, S, D, F = 1, 2048, 1024, 3584
        return {
            "x": _w((lambda *s: torch.randn(*s, dtype=torch.bfloat16) * 0.05)(B, S, D)),
            "w_gate": _w((lambda *s: torch.randn(*s, dtype=torch.bfloat16) * 0.05)(D, F)),
            "w_up": _w((lambda *s: torch.randn(*s, dtype=torch.bfloat16) * 0.05)(D, F)),
            "w_down": _w((lambda *s: torch.randn(*s, dtype=torch.bfloat16) * 0.05)(F, D)),
        }
    _B_in = _B_setup()

    return {
        "A_x": _A_in["x"],
        "A_Lambda_re": _A_in["Lambda_re"],
        "A_Lambda_im": _A_in["Lambda_im"],
        "A_B_re": _A_in["B_re"],
        "A_B_im": _A_in["B_im"],
        "A_C_re": _A_in["C_re"],
        "A_C_im": _A_in["C_im"],
        "A_log_dt": _A_in["log_dt"],
        "A_Dskip": _A_in["Dskip"],
        "B_x": _B_in["x"],
        "B_w_gate": _B_in["w_gate"],
        "B_w_up": _B_in["w_up"],
        "B_w_down": _B_in["w_down"],
    }

def reference(A_x, A_Lambda_re, A_Lambda_im, A_B_re, A_B_im, A_C_re, A_C_im, A_log_dt, A_Dskip, B_x, B_w_gate, B_w_up, B_w_down):
    def _A_ref(x, Lambda_re, Lambda_im, B_re, B_im, C_re, C_im, log_dt, Dskip):
        Bsz, L, H = x.shape
        Lam = Lambda_re + 1j * Lambda_im
        Bmat = B_re + 1j * B_im
        Cmat = C_re + 1j * C_im
        dt = torch.exp(log_dt)
        Lam_bar = torch.exp(dt * Lam)
        B_bar = ((Lam_bar - 1.0) / Lam)[:, None] * Bmat
        Bu = torch.einsum("bld,pd->blp", x + 0j, B_bar)
        h = torch.zeros_like(Bu[:, 0, :])
        hs = []
        for t in range(L):
            h = Lam_bar[None, :] * h + Bu[:, t, :]
            hs.append(h)
        hseq = torch.stack(hs, 1)
        y = 2.0 * torch.einsum("blp,dp->bld", hseq, Cmat).real + x * Dskip[None, None, :]
        return y

    def _B_ref(x, w_gate, w_up, w_down):
        g = _silu(x @ w_gate)
        u = x @ w_up
        return (g * u) @ w_down

    x = A_x
    xn = _layernorm(x, axis=-1)
    return x + _A_ref(xn, A_Lambda_re, A_Lambda_im, A_B_re, A_B_im, A_C_re, A_C_im, A_log_dt, A_Dskip) + _B_ref(xn, B_w_gate, B_w_up, B_w_down)
```

```asm
; @launch grid=(256,1,1) block=(256,1,1) lds=163840
.amdgcn_target "amdgcn-amd-amdhsa--gfx950"
.text
.globl parallel_sum__ssm_conv_s5__swiglu_ffn__prompt_kernel
.p2align 8
.type parallel_sum__ssm_conv_s5__swiglu_ffn__prompt_kernel,@function
parallel_sum__ssm_conv_s5__swiglu_ffn__prompt_kernel:
    s_cmp_ge_u32 s2, 256
    s_cbranch_scc1 K_END
    s_load_dwordx2 s[36:37], s[0:1], 0
    s_load_dwordx2 s[4:5], s[0:1], 120
    s_load_dwordx4 s[64:67], s[0:1], 80
    s_load_dwordx4 s[68:71], s[0:1], 24
    s_load_dwordx4 s[72:75], s[0:1], 8
    s_load_dwordx2 s[76:77], s[0:1], 56
    s_load_dwordx2 s[20:21], s[0:1], 40
    s_load_dwordx2 s[24:25], s[0:1], 48
    s_load_dwordx2 s[28:29], s[0:1], 96
    s_load_dwordx2 s[32:33], s[0:1], 104
    s_load_dwordx2 s[40:41], s[0:1], 64
    v_mov_b32 v176, v0
    v_lshrrev_b32 v1, 6, v0
    v_and_b32 v0, 63, v0
    v_readfirstlane_b32 s16, v1
    v_lshlrev_b32 v1, 4, v0
    s_mov_b32 s38, 0x400000
    s_mov_b32 s39, 0x20000
    s_mov_b32 s6, 0xa000000
    s_mov_b32 s7, 0x20000
    s_mov_b32 s10, 0x700000
    s_mov_b32 s11, 0x20000
    s_mov_b32 s14, 0x200000
    s_mov_b32 s15, 0x20000
    s_and_b32 s60, s2, 4
    s_bfe_u32 s61, s2, 0x20003
    s_add_u32 s17, s60, s61
    s_and_b32 s49, s2, 3
    s_lshr_b32 s50, s2, 5
    s_lshl3_add_u32 s18, s49, s50
    s_lshl2_add_u32 s63, s17, s49
    s_and_b32 s60, s50, 1
    s_lshl1_add_u32 s60, s63, s60
    s_lshl_b32 s60, s60, 5
    s_and_b32 s61, s50, 6
    s_add_u32 s60, s60, s61
    s_lshl4_add_u32 s60, s60, s16
    s_lshl_b32 s60, s60, 7
    v_and_b32 v67, 7, v0
    v_lshrrev_b32 v66, 2, v0
    v_and_b32 v66, 14, v66
    v_lshrrev_b32 v68, 2, v67
    v_lshlrev_b32 v68, 4, v68
    v_and_b32 v69, 1, v67
    v_lshl_add_u32 v68, v69, 3, v68
    v_bfe_u32 v69, v67, 1, 1
    v_add_u32 v68, v68, v69
    v_lshlrev_b32 v68, 11, v68
    v_lshl_add_u32 v70, v66, 3, v68
    v_mov_b32 v178, 29884416
    s_cmp_ge_u32 s16, 2
    s_waitcnt lgkmcnt(0)
    buffer_load_dwordx4 v[80:83], v70, s[36:39], s60 offen offset:0
    buffer_load_dwordx4 v[84:87], v70, s[36:39], s60 offen offset:512
    buffer_load_dwordx4 v[88:91], v70, s[36:39], s60 offen offset:1024
    buffer_load_dwordx4 v[92:95], v70, s[36:39], s60 offen offset:1536
    s_cselect_b32 s8, s66, s64
    s_cselect_b32 s9, s67, s65
    s_cselect_b32 s12, s70, s68
    s_cselect_b32 s13, s71, s69
    buffer_load_dword v178, v178, s[4:7], 0 offen
    s_lshl2_add_u32 s19, s17, s16
    s_lshl2_add_u32 s60, s19, s49
    s_lshl_b32 s60, s60, 19
    s_add_u32 s60, s60, 33554432
    s_lshr_b32 s62, s50, 1
    s_and_b32 s61, s50, 1
    s_lshl2_add_u32 s61, s62, s61
    s_lshl_b32 s61, s61, 12
    s_add_u32 s69, s60, s61
    s_lshl_b32 s60, s19, 16
    s_xor_b32 s69, s69, s60
    s_lshr_b32 s62, s16, 1
    s_and_b32 s61, s16, 1
    s_lshl2_add_u32 s61, s62, s61
    s_lshl_b32 s61, s61, 12
    s_xor_b32 s69, s69, s61
    s_getpc_b64 s[64:65]
K_PC0:
    s_lshr_b32 s60, s2, 3
    s_lshl2_add_u32 s61, s60, s16
    s_lshl_b32 s61, s61, 7
    v_lshlrev_b32 v66, 14, v0
    v_add_u32 v66, s61, v66
    v_min_u32 v66, CODE_END-K_PC0-4, v66
    global_load_dword a216, v66, s[64:65]
    s_and_b32 s61, s16, 1
    s_lshl1_add_u32 s60, s60, s61
    s_mul_i32 s61, s60, 14336
    s_mul_i32 s62, s49, 1792
    s_add_u32 s61, s61, s62
    v_bfe_u32 v66, v0, 4, 1
    v_and_b32 v12, 15, v0
    v_min_u32 v67, 13, v12
    v_lshlrev_b32 v67, 7, v67
    v_mul_u32_u24 v66, 7168, v66
    v_add3_u32 v73, v66, v67, s61
    s_lshl_b32 s61, s49, 6
    s_add_u32 s61, s61, s60
    s_lshl_b32 s61, s61, 13
    v_bfe_u32 v66, v0, 4, 2
    v_lshlrev_b32 v66, 11, v66
    v_min_u32 v67, 1, v12
    v_lshl_add_u32 v66, v67, 7, v66
    v_add_u32 v71, s61, v66
    s_lshl_b32 s60, s18, 5
    v_add_u32 v72, s60, v12
    v_lshlrev_b32 v72, 1, v72
    v_lshlrev_b32 v12, 7, v12
    v_and_b32 v179, 7, v0
    v_lshlrev_b32 v179, 4, v179
    v_add_u32 v179, 131072, v179
    s_lshl_b32 s60, s16, 2
    v_add_u32 v177, s60, v179
    v_lshrrev_b32 v66, 3, v176
    s_and_b32 s60, s63, 7
    v_lshrrev_b32 v180, 2, v66
    v_xor_b32 v180, s60, v180
    v_lshlrev_b32 v180, 12, v180
    v_and_b32 v66, 3, v66
    v_lshl_add_u32 v180, v66, 8, v180
    v_and_b32 v66, 7, v0
    v_lshl_add_u32 v180, v66, 4, v180
    s_lshl3_add_u32 s60, s63, s50
    s_lshl_b32 s60, s60, 7
    s_add_u32 s60, s60, 29556736
    v_lshrrev_b32 v66, 3, v176
    v_min_u32 v66, 1, v66
    v_lshl_add_u32 v182, v66, 28, v1
    v_add_u32 v182, s60, v182
    s_lshl_b32 s60, s63, 17
    s_lshr_b32 s61, s50, 1
    s_lshl_b32 s61, s61, 10
    s_add_u32 s60, s60, s61
    s_and_b32 s61, s50, 1
    s_lshl_b32 s61, s61, 7
    s_add_u32 s60, s60, s61
    v_add_u32 v180, s60, v180
    s_mov_b32 s61, 0xffff0000
    buffer_load_dword a216, v182, s[4:7], 0 offen
    s_mov_b32 s71, 0
    s_waitcnt vmcnt(6)
    v_lshlrev_b32 v96, 16, v80
    v_and_b32 v97, s61, v80
    v_lshlrev_b32 v98, 16, v81
    v_and_b32 v99, s61, v81
    v_lshlrev_b32 v100, 16, v82
    v_and_b32 v101, s61, v82
    v_lshlrev_b32 v102, 16, v83
    v_and_b32 v103, s61, v83
    v_pk_add_f32 v[128:129], v[96:97], v[98:99]
    v_pk_add_f32 v[130:131], v[100:101], v[102:103]
    s_waitcnt vmcnt(5)
    v_lshlrev_b32 v104, 16, v84
    v_and_b32 v105, s61, v84
    v_lshlrev_b32 v106, 16, v85
    v_and_b32 v107, s61, v85
    v_lshlrev_b32 v108, 16, v86
    v_and_b32 v109, s61, v86
    v_lshlrev_b32 v110, 16, v87
    v_and_b32 v111, s61, v87
    v_pk_add_f32 v[132:133], v[104:105], v[106:107]
    v_pk_add_f32 v[134:135], v[108:109], v[110:111]
    v_pk_add_f32 v[128:129], v[128:129], v[132:133]
    v_pk_add_f32 v[130:131], v[130:131], v[134:135]
    s_waitcnt vmcnt(4)
    v_lshlrev_b32 v112, 16, v88
    v_and_b32 v113, s61, v88
    v_lshlrev_b32 v114, 16, v89
    v_and_b32 v115, s61, v89
    v_lshlrev_b32 v116, 16, v90
    v_and_b32 v117, s61, v90
    v_lshlrev_b32 v118, 16, v91
    v_and_b32 v119, s61, v91
    v_pk_add_f32 v[136:137], v[112:113], v[114:115]
    v_pk_add_f32 v[138:139], v[116:117], v[118:119]
    v_pk_add_f32 v[128:129], v[128:129], v[136:137]
    v_pk_add_f32 v[130:131], v[130:131], v[138:139]
    s_waitcnt vmcnt(3)
    buffer_load_dword a216, v73, s[8:11], 0 offen
    buffer_load_dword a216, v71, s[12:15], 0 offen
    v_lshlrev_b32 v120, 16, v92
    v_and_b32 v121, s61, v92
    v_lshlrev_b32 v122, 16, v93
    v_and_b32 v123, s61, v93
    v_lshlrev_b32 v124, 16, v94
    v_and_b32 v125, s61, v94
    v_lshlrev_b32 v126, 16, v95
    v_and_b32 v127, s61, v95
    v_pk_add_f32 v[140:141], v[120:121], v[122:123]
    v_pk_add_f32 v[142:143], v[124:125], v[126:127]
    v_pk_add_f32 v[128:129], v[128:129], v[140:141]
    v_pk_add_f32 v[130:131], v[130:131], v[142:143]
    v_pk_add_f32 v[128:129], v[128:129], v[130:131]
    v_add_f32 v160, v128, v129
    s_nop 1
    v_add_f32_dpp v160, v160, v160 row_ror:8 row_mask:0xf bank_mask:0xf
    v_mov_b32 v161, v160
    s_nop 1
    v_permlane16_swap_b32 v160, v161
    v_add_f32 v160, v160, v161
    v_mov_b32 v161, v160
    s_nop 1
    v_permlane32_swap_b32 v160, v161
    v_add_f32 v160, v160, v161
    ds_write_b32 v177, v160
    s_waitcnt lgkmcnt(0)
    s_barrier
    ds_read_b128 v[168:171], v179
    global_load_ushort v74, v72, s[72:73] offset:0
    global_load_ushort v75, v72, s[74:75] offset:0
    global_load_ushort v76, v72, s[76:77] offset:0
    global_load_ushort v77, v72, s[72:73] offset:32
    global_load_ushort v78, v72, s[74:75] offset:32
    global_load_ushort v79, v72, s[76:77] offset:32
    s_waitcnt lgkmcnt(0)
    v_pk_add_f32 v[168:169], v[168:169], v[170:171]
    v_add_f32 v160, v168, v169
    v_mul_f32 v160, 0x3a800000, v160
    v_pk_add_f32 v[128:129], v[96:97], v[160:161] op_sel_hi:[1,0] neg_lo:[0,1] neg_hi:[0,1]
    v_pk_add_f32 v[130:131], v[98:99], v[160:161] op_sel_hi:[1,0] neg_lo:[0,1] neg_hi:[0,1]
    v_pk_add_f32 v[132:133], v[100:101], v[160:161] op_sel_hi:[1,0] neg_lo:[0,1] neg_hi:[0,1]
    v_pk_add_f32 v[134:135], v[102:103], v[160:161] op_sel_hi:[1,0] neg_lo:[0,1] neg_hi:[0,1]
    v_pk_add_f32 v[136:137], v[104:105], v[160:161] op_sel_hi:[1,0] neg_lo:[0,1] neg_hi:[0,1]
    v_pk_add_f32 v[138:139], v[106:107], v[160:161] op_sel_hi:[1,0] neg_lo:[0,1] neg_hi:[0,1]
    v_pk_add_f32 v[140:141], v[108:109], v[160:161] op_sel_hi:[1,0] neg_lo:[0,1] neg_hi:[0,1]
    v_pk_add_f32 v[142:143], v[110:111], v[160:161] op_sel_hi:[1,0] neg_lo:[0,1] neg_hi:[0,1]
    v_pk_add_f32 v[144:145], v[112:113], v[160:161] op_sel_hi:[1,0] neg_lo:[0,1] neg_hi:[0,1]
    v_pk_add_f32 v[146:147], v[114:115], v[160:161] op_sel_hi:[1,0] neg_lo:[0,1] neg_hi:[0,1]
    v_pk_add_f32 v[148:149], v[116:117], v[160:161] op_sel_hi:[1,0] neg_lo:[0,1] neg_hi:[0,1]
    v_pk_add_f32 v[150:151], v[118:119], v[160:161] op_sel_hi:[1,0] neg_lo:[0,1] neg_hi:[0,1]
    v_pk_add_f32 v[152:153], v[120:121], v[160:161] op_sel_hi:[1,0] neg_lo:[0,1] neg_hi:[0,1]
    v_pk_add_f32 v[154:155], v[122:123], v[160:161] op_sel_hi:[1,0] neg_lo:[0,1] neg_hi:[0,1]
    v_pk_add_f32 v[156:157], v[124:125], v[160:161] op_sel_hi:[1,0] neg_lo:[0,1] neg_hi:[0,1]
    v_pk_add_f32 v[158:159], v[126:127], v[160:161] op_sel_hi:[1,0] neg_lo:[0,1] neg_hi:[0,1]
    v_pk_mul_f32 v[162:163], v[128:129], v[128:129]
    v_pk_mul_f32 v[164:165], v[130:131], v[130:131]
    v_pk_fma_f32 v[162:163], v[132:133], v[132:133], v[162:163]
    v_pk_fma_f32 v[164:165], v[134:135], v[134:135], v[164:165]
    v_pk_fma_f32 v[162:163], v[136:137], v[136:137], v[162:163]
    v_pk_fma_f32 v[164:165], v[138:139], v[138:139], v[164:165]
    v_pk_fma_f32 v[162:163], v[140:141], v[140:141], v[162:163]
    v_pk_fma_f32 v[164:165], v[142:143], v[142:143], v[164:165]
    v_pk_fma_f32 v[162:163], v[144:145], v[144:145], v[162:163]
    v_pk_fma_f32 v[164:165], v[146:147], v[146:147], v[164:165]
    v_pk_fma_f32 v[162:163], v[148:149], v[148:149], v[162:163]
    v_pk_fma_f32 v[164:165], v[150:151], v[150:151], v[164:165]
    v_pk_fma_f32 v[162:163], v[152:153], v[152:153], v[162:163]
    v_pk_fma_f32 v[164:165], v[154:155], v[154:155], v[164:165]
    v_pk_fma_f32 v[162:163], v[156:157], v[156:157], v[162:163]
    v_pk_fma_f32 v[164:165], v[158:159], v[158:159], v[164:165]
    v_pk_add_f32 v[162:163], v[162:163], v[164:165]
    v_add_f32 v162, v162, v163
    v_cvt_pk_bf16_f32 v160, v160, v160
    v_lshlrev_b32 v160, 16, v160
    v_add_f32_dpp v162, v162, v162 row_ror:8 row_mask:0xf bank_mask:0xf
    v_pk_add_f32 v[128:129], v[96:97], v[160:161] op_sel_hi:[1,0] neg_lo:[0,1] neg_hi:[0,1]
    v_pk_add_f32 v[130:131], v[98:99], v[160:161] op_sel_hi:[1,0] neg_lo:[0,1] neg_hi:[0,1]
    v_mov_b32 v163, v162
    v_pk_add_f32 v[132:133], v[100:101], v[160:161] op_sel_hi:[1,0] neg_lo:[0,1] neg_hi:[0,1]
    v_pk_add_f32 v[134:135], v[102:103], v[160:161] op_sel_hi:[1,0] neg_lo:[0,1] neg_hi:[0,1]
    v_permlane16_swap_b32 v162, v163
    v_pk_add_f32 v[136:137], v[104:105], v[160:161] op_sel_hi:[1,0] neg_lo:[0,1] neg_hi:[0,1]
    v_pk_add_f32 v[138:139], v[106:107], v[160:161] op_sel_hi:[1,0] neg_lo:[0,1] neg_hi:[0,1]
    v_add_f32 v162, v162, v163
    v_pk_add_f32 v[140:141], v[108:109], v[160:161] op_sel_hi:[1,0] neg_lo:[0,1] neg_hi:[0,1]
    v_mov_b32 v163, v162
    v_pk_add_f32 v[142:143], v[110:111], v[160:161] op_sel_hi:[1,0] neg_lo:[0,1] neg_hi:[0,1]
    v_pk_add_f32 v[144:145], v[112:113], v[160:161] op_sel_hi:[1,0] neg_lo:[0,1] neg_hi:[0,1]
    v_permlane32_swap_b32 v162, v163
    v_pk_add_f32 v[146:147], v[114:115], v[160:161] op_sel_hi:[1,0] neg_lo:[0,1] neg_hi:[0,1]
    v_pk_add_f32 v[148:149], v[116:117], v[160:161] op_sel_hi:[1,0] neg_lo:[0,1] neg_hi:[0,1]
    v_add_f32 v162, v162, v163
    v_pk_add_f32 v[150:151], v[118:119], v[160:161] op_sel_hi:[1,0] neg_lo:[0,1] neg_hi:[0,1]
    ds_write_b32 v177, v162 offset:128
    v_pk_add_f32 v[152:153], v[120:121], v[160:161] op_sel_hi:[1,0] neg_lo:[0,1] neg_hi:[0,1]
    v_pk_add_f32 v[154:155], v[122:123], v[160:161] op_sel_hi:[1,0] neg_lo:[0,1] neg_hi:[0,1]
    v_pk_add_f32 v[156:157], v[124:125], v[160:161] op_sel_hi:[1,0] neg_lo:[0,1] neg_hi:[0,1]
    v_pk_add_f32 v[158:159], v[126:127], v[160:161] op_sel_hi:[1,0] neg_lo:[0,1] neg_hi:[0,1]
    v_cvt_pk_bf16_f32 v80, v128, v129
    v_cvt_pk_bf16_f32 v81, v130, v131
    v_cvt_pk_bf16_f32 v82, v132, v133
    v_cvt_pk_bf16_f32 v83, v134, v135
    v_cvt_pk_bf16_f32 v84, v136, v137
    v_cvt_pk_bf16_f32 v85, v138, v139
    s_waitcnt lgkmcnt(0)
    s_barrier
    ds_read_b128 v[168:171], v179 offset:128
    v_cvt_pk_bf16_f32 v86, v140, v141
    v_cvt_pk_bf16_f32 v87, v142, v143
    v_cvt_pk_bf16_f32 v88, v144, v145
    v_cvt_pk_bf16_f32 v89, v146, v147
    v_cvt_pk_bf16_f32 v90, v148, v149
    v_cvt_pk_bf16_f32 v91, v150, v151
    v_cvt_pk_bf16_f32 v92, v152, v153
    v_cvt_pk_bf16_f32 v93, v154, v155
    v_cvt_pk_bf16_f32 v94, v156, v157
    v_cvt_pk_bf16_f32 v95, v158, v159
    v_lshlrev_b32 v96, 16, v80
    v_and_b32 v97, s61, v80
    v_lshlrev_b32 v98, 16, v81
    v_and_b32 v99, s61, v81
    v_lshlrev_b32 v100, 16, v82
    v_and_b32 v101, s61, v82
    v_lshlrev_b32 v102, 16, v83
    v_and_b32 v103, s61, v83
    v_lshlrev_b32 v104, 16, v84
    v_and_b32 v105, s61, v84
    v_lshlrev_b32 v106, 16, v85
    v_and_b32 v107, s61, v85
    s_waitcnt lgkmcnt(0)
    v_pk_add_f32 v[168:169], v[168:169], v[170:171]
    v_lshlrev_b32 v108, 16, v86
    v_and_b32 v109, s61, v86
    v_add_f32 v162, v168, v169
    v_lshlrev_b32 v110, 16, v87
    v_and_b32 v111, s61, v87
    v_mul_f32 v162, 0x3a800000, v162
    v_lshlrev_b32 v112, 16, v88
    v_cvt_pk_bf16_f32 v162, v162, v162
    v_and_b32 v113, s61, v88
    v_lshlrev_b32 v114, 16, v89
    v_lshlrev_b32 v162, 16, v162
    v_and_b32 v115, s61, v89
    v_lshlrev_b32 v116, 16, v90
    v_add_f32 v162, 0x3727c5ac, v162
    v_and_b32 v117, s61, v90
    v_cvt_pk_bf16_f32 v162, v162, v162
    v_lshlrev_b32 v118, 16, v91
    v_and_b32 v119, s61, v91
    v_lshlrev_b32 v162, 16, v162
    v_lshlrev_b32 v120, 16, v92
    v_and_b32 v121, s61, v92
    v_sqrt_f32 v162, v162
    v_lshlrev_b32 v122, 16, v93
    v_cvt_pk_bf16_f32 v162, v162, v162
    v_and_b32 v123, s61, v93
    v_lshlrev_b32 v124, 16, v94
    v_lshlrev_b32 v162, 16, v162
    v_and_b32 v125, s61, v94
    v_lshlrev_b32 v126, 16, v95
    v_rcp_f32 v162, v162
    v_and_b32 v127, s61, v95
    v_pk_mul_f32 v[96:97], v[96:97], v[162:163] op_sel_hi:[1,0]
    v_pk_mul_f32 v[98:99], v[98:99], v[162:163] op_sel_hi:[1,0]
    v_pk_mul_f32 v[100:101], v[100:101], v[162:163] op_sel_hi:[1,0]
    v_pk_mul_f32 v[102:103], v[102:103], v[162:163] op_sel_hi:[1,0]
    v_cvt_pk_bf16_f32 v80, v96, v97
    v_cvt_pk_bf16_f32 v81, v98, v99
    v_cvt_pk_bf16_f32 v82, v100, v101
    v_cvt_pk_bf16_f32 v83, v102, v103
    s_mov_b32 s78, 0
    buffer_store_dwordx4 v[80:83], v180, s[4:7], s78 offen sc1
    v_pk_mul_f32 v[104:105], v[104:105], v[162:163] op_sel_hi:[1,0]
    v_pk_mul_f32 v[106:107], v[106:107], v[162:163] op_sel_hi:[1,0]
    v_pk_mul_f32 v[108:109], v[108:109], v[162:163] op_sel_hi:[1,0]
    v_pk_mul_f32 v[110:111], v[110:111], v[162:163] op_sel_hi:[1,0]
    v_cvt_pk_bf16_f32 v84, v104, v105
    v_cvt_pk_bf16_f32 v85, v106, v107
    v_cvt_pk_bf16_f32 v86, v108, v109
    v_cvt_pk_bf16_f32 v87, v110, v111
    v_pk_mul_f32 v[112:113], v[112:113], v[162:163] op_sel_hi:[1,0]
    v_pk_mul_f32 v[114:115], v[114:115], v[162:163] op_sel_hi:[1,0]
    v_pk_mul_f32 v[116:117], v[116:117], v[162:163] op_sel_hi:[1,0]
    v_pk_mul_f32 v[118:119], v[118:119], v[162:163] op_sel_hi:[1,0]
    v_cvt_pk_bf16_f32 v88, v112, v113
    v_cvt_pk_bf16_f32 v89, v114, v115
    v_cvt_pk_bf16_f32 v90, v116, v117
    v_cvt_pk_bf16_f32 v91, v118, v119
    v_pk_mul_f32 v[120:121], v[120:121], v[162:163] op_sel_hi:[1,0]
    v_pk_mul_f32 v[122:123], v[122:123], v[162:163] op_sel_hi:[1,0]
    v_pk_mul_f32 v[124:125], v[124:125], v[162:163] op_sel_hi:[1,0]
    v_pk_mul_f32 v[126:127], v[126:127], v[162:163] op_sel_hi:[1,0]
    v_cvt_pk_bf16_f32 v92, v120, v121
    v_cvt_pk_bf16_f32 v93, v122, v123
    v_cvt_pk_bf16_f32 v94, v124, v125
    v_cvt_pk_bf16_f32 v95, v126, v127
    s_waitcnt vmcnt(11)
    v_readfirstlane_b32 s79, v178
    s_nop 0
    s_add_u32 s79, s79, 256
    v_mov_b32 v188, s79
    v_mov_b32 v189, s79
    v_mov_b32 v190, s79
    v_mov_b32 v191, s79
    s_lshl_b32 s44, s19, 5
    s_and_b32 s60, s19, 7
    s_add_u32 s44, s44, s60
    s_lshl_b32 s44, s44, 12
    s_and_b32 s62, s18, 1
    s_lshl_b32 s62, s62, 1
    s_and_b32 s60, s16, 1
    s_mul_i32 s45, s60, 229376
    s_mul_i32 s61, s18, 224
    s_add_u32 s45, s45, s61
    s_lshl1_add_u32 s61, s18, s60
    s_lshl_b32 s46, s61, 15
    s_mul_i32 s47, s16, 7168
    s_lshl_b32 s48, s16, 11
    s_add_u32 s48, s48, 28672
    s_lshr_b32 s61, s2, 3
    s_lshl1_add_u32 s60, s61, s60
    s_bfe_u32 s61, s2, 0x10002
    s_lshl1_add_u32 s60, s60, s61
    s_lshl2_add_u32 s61, s60, s49
    s_mul_i32 s3, s61, 1792
    s_lshl_b32 s61, s49, 7
    s_add_u32 s61, s61, s60
    s_lshl_b32 s68, s61, 12
    s_add_u32 s3, s3, 0
    v_add_u32 v66, 0, v0
    v_mul_u32_u24 v67, 4682, v66
    v_lshrrev_b32 v67, 16, v67
    v_mad_i32_i24 v68, v67, -14, v66
    v_add_u32 v68, s62, v68
    v_subrev_u32 v69, 14, v68
    v_min_u32 v68, v68, v69
    v_and_b32 v69, 12, v67
    v_add_u32 v69, v69, v67
    v_lshrrev_b32 v70, 4, v67
    v_mad_i32_i24 v69, v70, -12, v69
    v_mul_u32_u24 v69, 7168, v69
    v_lshl_add_u32 v2, v68, 4, v69
    v_add_u32 v66, 64, v0
    v_mul_u32_u24 v67, 4682, v66
    v_lshrrev_b32 v67, 16, v67
    v_mad_i32_i24 v68, v67, -14, v66
    v_add_u32 v68, s62, v68
    v_subrev_u32 v69, 14, v68
    v_min_u32 v68, v68, v69
    v_and_b32 v69, 12, v67
    v_add_u32 v69, v69, v67
    v_lshrrev_b32 v70, 4, v67
    v_mad_i32_i24 v69, v70, -12, v69
    v_mul_u32_u24 v69, 7168, v69
    v_lshl_add_u32 v3, v68, 4, v69
    v_subrev_u32 v3, 1024, v3
    v_add_u32 v66, 128, v0
    v_mul_u32_u24 v67, 4682, v66
    v_lshrrev_b32 v67, 16, v67
    v_mad_i32_i24 v68, v67, -14, v66
    v_add_u32 v68, s62, v68
    v_subrev_u32 v69, 14, v68
    v_min_u32 v68, v68, v69
    v_and_b32 v69, 12, v67
    v_add_u32 v69, v69, v67
    v_lshrrev_b32 v70, 4, v67
    v_mad_i32_i24 v69, v70, -12, v69
    v_mul_u32_u24 v69, 7168, v69
    v_lshl_add_u32 v4, v68, 4, v69
    v_subrev_u32 v4, 2048, v4
    v_add_u32 v66, 192, v0
    v_mul_u32_u24 v67, 4682, v66
    v_lshrrev_b32 v67, 16, v67
    v_mad_i32_i24 v68, v67, -14, v66
    v_add_u32 v68, s62, v68
    v_subrev_u32 v69, 14, v68
    v_min_u32 v68, v68, v69
    v_and_b32 v69, 12, v67
    v_add_u32 v69, v69, v67
    v_lshrrev_b32 v70, 4, v67
    v_mad_i32_i24 v69, v70, -12, v69
    v_mul_u32_u24 v69, 7168, v69
    v_lshl_add_u32 v5, v68, 4, v69
    v_subrev_u32 v5, 3072, v5
    v_lshrrev_b32 v66, 3, v0
    v_add_u32 v66, 0, v66
    v_lshrrev_b32 v67, 1, v66
    v_xor_b32 v67, v67, v0
    v_and_b32 v67, 7, v67
    v_lshlrev_b32 v67, 4, v67
    v_lshl_add_u32 v9, v66, 11, v67
    v_lshrrev_b32 v66, 3, v0
    v_add_u32 v66, 8, v66
    v_lshrrev_b32 v67, 1, v66
    v_xor_b32 v67, v67, v0
    v_and_b32 v67, 7, v67
    v_lshlrev_b32 v67, 4, v67
    v_lshl_add_u32 v10, v66, 11, v67
    v_subrev_u32 v10, 1024, v10
    v_add_u32 v66, 256, v0
    v_mul_u32_u24 v67, 4682, v66
    v_lshrrev_b32 v67, 16, v67
    v_mad_i32_i24 v68, v67, -14, v66
    v_add_u32 v68, s62, v68
    v_subrev_u32 v69, 14, v68
    v_min_u32 v68, v68, v69
    v_and_b32 v69, 12, v67
    v_add_u32 v69, v69, v67
    v_lshrrev_b32 v70, 4, v67
    v_mad_i32_i24 v69, v70, -12, v69
    v_mul_u32_u24 v69, 7168, v69
    v_lshl_add_u32 v6, v68, 4, v69
    v_add_u32 v66, 320, v0
    v_mul_u32_u24 v67, 4682, v66
    v_lshrrev_b32 v67, 16, v67
    v_mad_i32_i24 v68, v67, -14, v66
    v_add_u32 v68, s62, v68
    v_subrev_u32 v69, 14, v68
    v_min_u32 v68, v68, v69
    v_and_b32 v69, 12, v67
    v_add_u32 v69, v69, v67
    v_lshrrev_b32 v70, 4, v67
    v_mad_i32_i24 v69, v70, -12, v69
    v_mul_u32_u24 v69, 7168, v69
    v_lshl_add_u32 v7, v68, 4, v69
    v_subrev_u32 v7, 1024, v7
    v_add_u32 v66, 384, v0
    v_mul_u32_u24 v67, 4682, v66
    v_lshrrev_b32 v67, 16, v67
    v_mad_i32_i24 v68, v67, -14, v66
    v_add_u32 v68, s62, v68
    v_subrev_u32 v69, 14, v68
    v_min_u32 v68, v68, v69
    v_and_b32 v69, 12, v67
    v_add_u32 v69, v69, v67
    v_lshrrev_b32 v70, 4, v67
    v_mad_i32_i24 v69, v70, -12, v69
    v_mul_u32_u24 v69, 7168, v69
    v_lshl_add_u32 v8, v68, 4, v69
    v_subrev_u32 v8, 2048, v8
    v_lshrrev_b32 v66, 2, v0
    v_mul_u32_u24 v66, 224, v66
    v_and_b32 v67, 3, v0
    v_lshl_add_u32 v11, v67, 3, v66
    v_add_u32 v17, 73728, v11
    v_and_b32 v66, 15, v0
    v_lshrrev_b32 v67, 4, v0
    v_lshrrev_b32 v68, 1, v66
    v_xor_b32 v67, v67, v68
    v_lshlrev_b32 v67, 4, v67
    v_lshl_add_u32 v67, v66, 7, v67
    v_add_u32 v13, 28672, v67
    v_xor_b32 v14, 64, v13
    v_add_u32 v15, 73728, v13
    v_add_u32 v16, 73728, v14
    s_mov_b32 s22, 0x200000
    s_mov_b32 s23, 0x20000
    s_mov_b32 s26, 0x200000
    s_mov_b32 s27, 0x20000
    s_mov_b32 s30, 0x700000
    s_mov_b32 s31, 0x20000
    s_mov_b32 s34, 0x800000
    s_mov_b32 s35, 0x20000
    s_mov_b32 s42, 0x800
    s_mov_b32 s43, 0x20000
    s_waitcnt vmcnt(0)
    s_barrier
    buffer_store_dwordx4 v[188:191], v182, s[4:7], 0 offen sc1
    s_add_u32 m0, s47, 0
    s_nop 0
    buffer_load_dwordx4 v2, s[8:11], s45 offen offset:0  lds
    v_mov_b32 v66, 0
    v_mov_b32 v67, 0
    v_mov_b32 v68, 0
    v_mov_b32 v69, 0
    v_add_u32 v70, 147456, v1
    buffer_load_dwordx4 v3, s[8:11], s45 offen offset:1024  lds
    ds_write_b128 v70, v[66:69]
    s_lshl3_add_u32 s60, s19, s50
    s_lshl_b32 s60, s60, 8
    s_add_u32 s1, s60, 29425664
    v_accvgpr_write_b32 a212, -1
    buffer_load_dwordx4 v4, s[8:11], s45 offen offset:2048  lds
    v_accvgpr_write_b32 a213, -1
    v_accvgpr_write_b32 a214, -1
    v_accvgpr_write_b32 a215, -1
    s_waitcnt lgkmcnt(0)
    s_lshl2_add_u32 s60, s2, s16
    buffer_load_dwordx4 v5, s[8:11], s45 offen offset:3072  lds
    s_mul_i32 s76, s60, 1792
    s_lshl_b32 s77, s60, 11
    s_getpc_b64 s[74:75]
K_PC:
    v_and_b32 v66, 16, v0
    s_add_u32 m0, s48, 0
    s_nop 0
    buffer_load_dwordx4 v9, s[12:15], s46 offen offset:0  lds
    v_cmp_ne_u32 s[52:53], 0, v66
    v_and_b32 v66, 32, v0
    v_cmp_ne_u32 s[54:55], 0, v66
    s_and_b32 s60, s16, 1
    v_mov_b32 v66, s60
    buffer_load_dwordx4 v10, s[12:15], s46 offen offset:1024  lds
    v_cmp_ne_u32 s[56:57], 0, v66
    s_and_b32 s60, s16, 2
    v_mov_b32 v66, s60
    v_cmp_ne_u32 s[58:59], 0, v66
    v_lshlrev_b32 v74, 16, v74
    s_add_u32 m0, s47, 4096
    s_nop 0
    buffer_load_dwordx4 v6, s[8:11], s45 offen offset:0  lds
    v_lshlrev_b32 v75, 16, v75
    v_lshlrev_b32 v76, 16, v76
    v_mul_f32 v76, 0x3fb8aa3b, v76
    v_exp_f32 v76, v76
    s_nop 0
    v_cvt_pk_bf16_f32 v76, v76, v76
    buffer_load_dwordx4 v7, s[8:11], s45 offen offset:1024  lds
    v_lshlrev_b32 v76, 16, v76
    v_mul_f32 v66, v76, v74
    v_mul_f32 v67, v76, v75
    v_mul_f32 v66, 0x3fb8aa3b, v66
    v_exp_f32 v66, v66
    buffer_load_dwordx4 v8, s[8:11], s45 offen offset:2048  lds
    v_mul_f32 v67, 0.15915494, v67
    v_rndne_f32 v68, v67
    v_sub_f32 v67, v67, v68
    v_cos_f32 v68, v67
    v_sin_f32 v69, v67
    v_and_b32 v184, 7, v0
    s_lshl_b32 s78, s19, 10
    s_add_u32 s78, s78, 29556736
    v_lshlrev_b32 v183, 7, v184
    v_add_u32 v183, s78, v183
    s_lshl3_add_u32 s78, s18, s17
    s_lshl_b32 s78, s78, 8
    s_add_u32 s78, s78, 29360128
    v_lshrrev_b32 v184, 4, v176
    v_min_u32 v184, 1, v184
    v_lshl_add_u32 v181, v184, 28, v1
    v_add_u32 v181, s78, v181
    v_mov_b32 v184, -1
    v_mov_b32 v185, -1
    v_mov_b32 v186, -1
    v_mov_b32 v187, -1
    buffer_load_dword v192, v183, s[4:7], 0 offen sc1
    v_mul_f32 v34, v66, v68
    v_mul_f32 v35, v66, v69
    v_add_f32 v66, -1.0, v34
    v_mul_f32 v67, v74, v74
    v_fmac_f32 v67, v75, v75
    v_rcp_f32 v67, v67
    v_mul_f32 v62, v66, v74
    v_fmac_f32 v62, v35, v75
    v_mul_f32 v63, v35, v74
    v_fma_f32 v63, -v66, v75, v63
    v_add_f32 v67, v67, v67
    v_mul_f32 v62, v62, v67
    v_mul_f32 v63, v63, v67
    v_mul_f32 v66, v34, v34
    v_mul_f32 v67, v34, v35
    v_fma_f32 v66, -v35, v35, v66
    v_fmac_f32 v67, v35, v34
    v_mul_f32 v68, v66, v66
    v_mul_f32 v69, v66, v67
    v_fma_f32 v68, -v67, v67, v68
    v_fmac_f32 v69, v67, v66
    v_mul_f32 v38, v68, v68
    v_mul_f32 v39, v68, v69
    v_fma_f32 v38, -v69, v69, v38
    v_fmac_f32 v39, v69, v68
    v_mul_f32 v18, v38, v38
    v_mul_f32 v19, v38, v39
    v_fma_f32 v18, -v39, v39, v18
    v_fmac_f32 v19, v39, v38
    v_mul_f32 v22, v18, v18
    v_mul_f32 v23, v18, v19
    v_fma_f32 v22, -v19, v19, v22
    v_fmac_f32 v23, v19, v18
    v_mul_f32 v26, v22, v22
    v_mul_f32 v27, v22, v23
    v_fma_f32 v26, -v23, v23, v26
    v_fmac_f32 v27, v23, v22
    v_mul_f32 v70, v26, v26
    v_mul_f32 v71, v26, v27
    v_fma_f32 v70, -v27, v27, v70
    v_fmac_f32 v71, v27, v26
    v_mul_f32 v42, v70, v70
    v_mul_f32 v43, v70, v71
    v_fma_f32 v42, -v71, v71, v42
    v_fmac_f32 v43, v71, v70
    v_mul_f32 v46, v42, v42
    v_mul_f32 v47, v42, v43
    v_fma_f32 v46, -v43, v43, v46
    v_fmac_f32 v47, v43, v42
    v_mul_f32 v50, v46, v46
    v_mul_f32 v51, v46, v47
    v_fma_f32 v50, -v47, v47, v50
    v_fmac_f32 v51, v47, v46
    v_cndmask_b32 v66, 1.0, v18, s[52:53]
    v_cndmask_b32 v67, 0, v19, s[52:53]
    v_cndmask_b32 v68, 1.0, v22, s[54:55]
    v_cndmask_b32 v69, 0, v23, s[54:55]
    v_mul_f32 v54, v66, v68
    v_mul_f32 v55, v66, v69
    v_fma_f32 v54, -v67, v69, v54
    v_fmac_f32 v55, v67, v68
    v_cndmask_b32 v30, 0, v66, s[54:55]
    v_cndmask_b32 v31, 0, v67, s[54:55]
    v_cndmask_b32 v66, 1.0, v26, s[56:57]
    v_cndmask_b32 v67, 0, v27, s[56:57]
    v_cndmask_b32 v68, 1.0, v70, s[58:59]
    v_cndmask_b32 v69, 0, v71, s[58:59]
    v_mul_f32 v58, v66, v68
    v_mul_f32 v59, v66, v69
    v_fma_f32 v58, -v67, v69, v58
    v_fmac_f32 v59, v67, v68
    v_lshlrev_b32 v77, 16, v77
    v_lshlrev_b32 v78, 16, v78
    v_lshlrev_b32 v79, 16, v79
    v_mul_f32 v79, 0x3fb8aa3b, v79
    v_exp_f32 v79, v79
    s_nop 0
    v_cvt_pk_bf16_f32 v79, v79, v79
    v_lshlrev_b32 v79, 16, v79
    v_mul_f32 v66, v79, v77
    v_mul_f32 v67, v79, v78
    v_mul_f32 v66, 0x3fb8aa3b, v66
    v_exp_f32 v66, v66
    v_mul_f32 v67, 0.15915494, v67
    v_rndne_f32 v68, v67
    v_sub_f32 v67, v67, v68
    v_cos_f32 v68, v67
    v_sin_f32 v69, v67
    v_mul_f32 v36, v66, v68
    v_mul_f32 v37, v66, v69
    v_add_f32 v66, -1.0, v36
    v_mul_f32 v67, v77, v77
    v_fmac_f32 v67, v78, v78
    v_rcp_f32 v67, v67
    v_mul_f32 v64, v66, v77
    v_fmac_f32 v64, v37, v78
    v_mul_f32 v65, v37, v77
    v_fma_f32 v65, -v66, v78, v65
    v_add_f32 v67, v67, v67
    v_mul_f32 v64, v64, v67
    v_mul_f32 v65, v65, v67
    s_waitcnt vmcnt(1)
    s_barrier
    ds_read_b128 a[232:235], v13 offset:0
    ds_read_b128 a[236:239], v14 offset:0
    ds_read_b128 a[240:243], v13 offset:4096
    ds_read_b128 a[244:247], v14 offset:4096
    s_waitcnt vmcnt(0)
    v_cmp_ne_u32 vcc, s79, v192
    s_cbranch_vccnz SLOW_XN
BACK_XN:
    buffer_load_dwordx4 a[112:115], v1, s[4:7], s44 offen offset:0 sc1
    buffer_load_dwordx4 a[116:119], v1, s[4:7], s44 offen offset:1024 sc1
    buffer_load_dwordx4 a[120:123], v1, s[4:7], s44 offen offset:2048 sc1
    buffer_load_dwordx4 a[124:127], v1, s[4:7], s44 offen offset:3072 sc1
    s_xor_b32 s44, s44, 4096
    buffer_load_dwordx4 a[128:131], v1, s[4:7], s44 offen offset:0 sc1
    buffer_load_dwordx4 a[132:135], v1, s[4:7], s44 offen offset:1024 sc1
    buffer_load_dwordx4 a[136:139], v1, s[4:7], s44 offen offset:2048 sc1
    buffer_load_dwordx4 a[140:143], v1, s[4:7], s44 offen offset:3072 sc1
    s_mov_b32 s78, 32768
    buffer_store_dwordx4 v[84:87], v180, s[4:7], s78 offen sc1
    s_mov_b32 s78, 65536
    buffer_store_dwordx4 v[88:91], v180, s[4:7], s78 offen sc1
    s_mov_b32 s78, 98304
    buffer_store_dwordx4 v[92:95], v180, s[4:7], s78 offen sc1
    buffer_store_dwordx4 v[184:187], v181, s[4:7], 0 offen sc1
    s_waitcnt vmcnt(4) lgkmcnt(2)
    v_mfma_f32_16x16x32_bf16 v[80:83], a[112:115], a[232:235], 0
    s_add_u32 s45, s45, 458752
    ds_read_b128 a[248:251], v13 offset:2048
    v_mfma_f32_16x16x32_bf16 v[80:83], a[128:131], a[236:239], v[80:83]
    s_add_u32 m0, s47, 36864
    v_mfma_f32_16x16x32_bf16 v[84:87], a[132:135], a[236:239], 0
    buffer_load_dwordx4 v2, s[8:11], s45 offen offset:0  lds
    v_mfma_f32_16x16x32_bf16 v[84:87], a[116:119], a[232:235], v[84:87]
    v_mfma_f32_16x16x32_bf16 v[88:91], a[120:123], a[232:235], 0
    ds_read_b128 a[252:255], v14 offset:2048
    v_mfma_f32_16x16x32_bf16 v[88:91], a[136:139], a[236:239], v[88:91]
    v_mfma_f32_16x16x32_bf16 v[92:95], a[140:143], a[236:239], 0
    buffer_load_dwordx4 v3, s[8:11], s45 offen offset:1024  lds
    v_mfma_f32_16x16x32_bf16 v[92:95], a[124:127], a[232:235], v[92:95]
    s_waitcnt lgkmcnt(2)
    v_mfma_f32_16x16x32_bf16 v[108:111], a[124:127], a[240:243], 0
    ds_read_b128 a[232:235], v13 offset:6144
    v_mul_f32 v66, v36, v36
    v_mfma_f32_16x16x32_bf16 v[108:111], a[140:143], a[244:247], v[108:111]
    v_mul_f32 v67, v36, v37
    v_fma_f32 v66, -v37, v37, v66
    v_mfma_f32_16x16x32_bf16 v[104:107], a[136:139], a[244:247], 0
    buffer_load_dwordx4 v4, s[8:11], s45 offen offset:2048  lds
    v_mfma_f32_16x16x32_bf16 v[104:107], a[120:123], a[240:243], v[104:107]
    v_fmac_f32 v67, v37, v36
    v_mul_f32 v68, v66, v66
    v_mfma_f32_16x16x32_bf16 v[100:103], a[116:119], a[240:243], 0
    ds_read_b128 a[236:239], v14 offset:6144
    v_mul_f32 v69, v66, v67
    v_mfma_f32_16x16x32_bf16 v[100:103], a[132:135], a[244:247], v[100:103]
    v_fma_f32 v68, -v67, v67, v68
    v_fmac_f32 v69, v67, v66
    v_mfma_f32_16x16x32_bf16 v[96:99], a[128:131], a[244:247], 0
    buffer_load_dwordx4 v5, s[8:11], s45 offen offset:3072  lds
    v_mfma_f32_16x16x32_bf16 v[96:99], a[112:115], a[240:243], v[96:99]
    s_waitcnt lgkmcnt(2)
    v_mul_f32 v40, v68, v68
    v_mul_f32 v41, v68, v69
    v_mfma_f32_16x16x32_bf16 v[112:115], a[112:115], a[248:251], 0
    s_add_u32 s46, s46, 128
    ds_read_b64_tr_b16 a[240:241], v11 offset:0
    ds_read_b64_tr_b16 a[242:243], v11 offset:3584
    v_mfma_f32_16x16x32_bf16 v[112:115], a[128:131], a[252:255], v[112:115]
    s_add_u32 m0, s48, 36864
    v_fma_f32 v40, -v69, v69, v40
    v_fmac_f32 v41, v69, v68
    v_mfma_f32_16x16x32_bf16 v[116:119], a[132:135], a[252:255], 0
    buffer_load_dwordx4 v9, s[12:15], s46 offen offset:0  lds
    v_mfma_f32_16x16x32_bf16 v[116:119], a[116:119], a[248:251], v[116:119]
    v_mul_f32 v20, v40, v40
    v_mul_f32 v21, v40, v41
    v_mfma_f32_16x16x32_bf16 v[120:123], a[120:123], a[248:251], 0
    ds_read_b64_tr_b16 a[244:245], v11 offset:7168
    ds_read_b64_tr_b16 a[246:247], v11 offset:10752
    v_mfma_f32_16x16x32_bf16 v[120:123], a[136:139], a[252:255], v[120:123]
    v_fma_f32 v20, -v41, v41, v20
    v_fmac_f32 v21, v41, v40
    v_mfma_f32_16x16x32_bf16 v[124:127], a[140:143], a[252:255], 0
    buffer_load_dwordx4 v10, s[12:15], s46 offen offset:1024  lds
    v_mfma_f32_16x16x32_bf16 v[124:127], a[124:127], a[248:251], v[124:127]
    s_waitcnt lgkmcnt(4)
    v_mul_f32 v24, v20, v20
    v_mul_f32 v25, v20, v21
    v_mfma_f32_16x16x32_bf16 v[140:143], a[124:127], a[232:235], 0
    ds_read_b64_tr_b16 a[248:249], v11 offset:14336
    ds_read_b64_tr_b16 a[250:251], v11 offset:17920
    v_mfma_f32_16x16x32_bf16 v[140:143], a[140:143], a[236:239], v[140:143]
    s_add_u32 m0, s47, 40960
    v_fma_f32 v24, -v21, v21, v24
    v_fmac_f32 v25, v21, v20
    v_mfma_f32_16x16x32_bf16 v[136:139], a[136:139], a[236:239], 0
    buffer_load_dwordx4 v6, s[8:11], s45 offen offset:0  lds
    v_mfma_f32_16x16x32_bf16 v[136:139], a[120:123], a[232:235], v[136:139]
    v_mul_f32 v28, v24, v24
    v_mul_f32 v29, v24, v25
    v_mfma_f32_16x16x32_bf16 v[132:135], a[116:119], a[232:235], 0
    ds_read_b64_tr_b16 a[252:253], v11 offset:21504
    ds_read_b64_tr_b16 a[254:255], v11 offset:25088
    v_mfma_f32_16x16x32_bf16 v[132:135], a[132:135], a[236:239], v[132:135]
    v_fma_f32 v28, -v25, v25, v28
    v_fmac_f32 v29, v25, v24
    v_mfma_f32_16x16x32_bf16 v[128:131], a[128:131], a[236:239], 0
    buffer_load_dwordx4 v7, s[8:11], s45 offen offset:1024  lds
    v_mfma_f32_16x16x32_bf16 v[128:131], a[112:115], a[232:235], v[128:131]
    s_waitcnt lgkmcnt(4)
    v_mul_f32 v70, v28, v28
    v_mul_f32 v71, v28, v29
    v_mfma_f32_16x16x32_bf16 v[144:147], a[240:243], a[112:115], 0
    ds_read_b64_tr_b16 a[232:233], v11 offset:32
    ds_read_b64_tr_b16 a[234:235], v11 offset:3616
    v_mfma_f32_16x16x32_bf16 v[144:147], a[244:247], a[128:131], v[144:147]
    v_fma_f32 v70, -v29, v29, v70
    v_fmac_f32 v71, v29, v28
    v_mfma_f32_16x16x32_bf16 v[148:151], a[244:247], a[132:135], 0
    buffer_load_dwordx4 v8, s[8:11], s45 offen offset:2048  lds
    v_mfma_f32_16x16x32_bf16 v[148:151], a[240:243], a[116:119], v[148:151]
    v_mul_f32 v44, v70, v70
    v_mul_f32 v45, v70, v71
    v_mfma_f32_16x16x32_bf16 v[152:155], a[240:243], a[120:123], 0
    ds_read_b64_tr_b16 a[236:237], v11 offset:7200
    ds_read_b64_tr_b16 a[238:239], v11 offset:10784
    v_mfma_f32_16x16x32_bf16 v[152:155], a[244:247], a[136:139], v[152:155]
    s_xor_b32 s44, s44, 12288
    v_fma_f32 v44, -v71, v71, v44
    v_fmac_f32 v45, v71, v70
    v_mfma_f32_16x16x32_bf16 v[156:159], a[244:247], a[140:143], 0
    buffer_load_dwordx4 a[144:147], v1, s[4:7], s44 offen offset:0 sc1
    v_mfma_f32_16x16x32_bf16 v[156:159], a[240:243], a[124:127], v[156:159]
    s_waitcnt lgkmcnt(4)
    v_mul_f32 v48, v44, v44
    v_mul_f32 v49, v44, v45
    v_mfma_f32_16x16x32_bf16 a[12:15], a[248:251], a[124:127], 0
    ds_read_b64_tr_b16 a[240:241], v11 offset:14368
    ds_read_b64_tr_b16 a[242:243], v11 offset:17952
    v_mfma_f32_16x16x32_bf16 a[12:15], a[252:255], a[140:143], a[12:15]
    v_fma_f32 v48, -v45, v45, v48
    v_fmac_f32 v49, v45, v44
    v_mfma_f32_16x16x32_bf16 a[8:11], a[252:255], a[136:139], 0
    buffer_load_dwordx4 a[148:151], v1, s[4:7], s44 offen offset:1024 sc1
    v_mfma_f32_16x16x32_bf16 a[8:11], a[248:251], a[120:123], a[8:11]
    v_mul_f32 v52, v48, v48
    v_mul_f32 v53, v48, v49
    v_mfma_f32_16x16x32_bf16 a[4:7], a[248:251], a[116:119], 0
    ds_read_b64_tr_b16 a[244:245], v11 offset:21536
    ds_read_b64_tr_b16 a[246:247], v11 offset:25120
    v_mfma_f32_16x16x32_bf16 a[4:7], a[252:255], a[132:135], a[4:7]
    v_fma_f32 v52, -v49, v49, v52
    v_fmac_f32 v53, v49, v48
    v_mfma_f32_16x16x32_bf16 a[0:3], a[252:255], a[128:131], 0
    buffer_load_dwordx4 a[152:155], v1, s[4:7], s44 offen offset:2048 sc1
    v_mfma_f32_16x16x32_bf16 a[0:3], a[248:251], a[112:115], a[0:3]
    s_waitcnt lgkmcnt(4)
    v_cndmask_b32 v66, 1.0, v20, s[52:53]
    v_cndmask_b32 v67, 0, v21, s[52:53]
    v_mfma_f32_16x16x32_bf16 v[160:163], a[232:235], a[112:115], 0
    ds_read_b64_tr_b16 a[248:249], v11 offset:64
    ds_read_b64_tr_b16 a[250:251], v11 offset:3648
    v_mfma_f32_16x16x32_bf16 v[160:163], a[236:239], a[128:131], v[160:163]
    v_cndmask_b32 v68, 1.0, v24, s[54:55]
    v_cndmask_b32 v69, 0, v25, s[54:55]
    v_mfma_f32_16x16x32_bf16 v[164:167], a[236:239], a[132:135], 0
    buffer_load_dwordx4 a[156:159], v1, s[4:7], s44 offen offset:3072 sc1
    v_mfma_f32_16x16x32_bf16 v[164:167], a[232:235], a[116:119], v[164:167]
    v_mul_f32 v56, v66, v68
    v_mul_f32 v57, v66, v69
    v_mfma_f32_16x16x32_bf16 v[168:171], a[232:235], a[120:123], 0
    ds_read_b64_tr_b16 a[252:253], v11 offset:7232
    ds_read_b64_tr_b16 a[254:255], v11 offset:10816
    v_mfma_f32_16x16x32_bf16 v[168:171], a[236:239], a[136:139], v[168:171]
    s_xor_b32 s44, s44, 4096
    v_fma_f32 v56, -v67, v69, v56
    v_fmac_f32 v57, v67, v68
    v_mfma_f32_16x16x32_bf16 v[172:175], a[236:239], a[140:143], 0
    buffer_load_dwordx4 a[160:163], v1, s[4:7], s44 offen offset:0 sc1
    v_mfma_f32_16x16x32_bf16 v[172:175], a[232:235], a[124:127], v[172:175]
    s_waitcnt lgkmcnt(4)
    v_cndmask_b32 v32, 0, v66, s[54:55]
    v_cndmask_b32 v33, 0, v67, s[54:55]
    v_mfma_f32_16x16x32_bf16 a[28:31], a[240:243], a[124:127], 0
    ds_read_b64_tr_b16 a[232:233], v11 offset:14400
    ds_read_b64_tr_b16 a[234:235], v11 offset:17984
    v_mfma_f32_16x16x32_bf16 a[28:31], a[244:247], a[140:143], a[28:31]
    v_cndmask_b32 v66, 1.0, v28, s[56:57]
    v_cndmask_b32 v67, 0, v29, s[56:57]
    v_mfma_f32_16x16x32_bf16 a[24:27], a[244:247], a[136:139], 0
    buffer_load_dwordx4 a[164:167], v1, s[4:7], s44 offen offset:1024 sc1
    v_mfma_f32_16x16x32_bf16 a[24:27], a[240:243], a[120:123], a[24:27]
    v_cndmask_b32 v68, 1.0, v70, s[58:59]
    v_cndmask_b32 v69, 0, v71, s[58:59]
    v_mfma_f32_16x16x32_bf16 a[20:23], a[240:243], a[116:119], 0
    ds_read_b64_tr_b16 a[236:237], v11 offset:21568
    ds_read_b64_tr_b16 a[238:239], v11 offset:25152
    v_mfma_f32_16x16x32_bf16 a[20:23], a[244:247], a[132:135], a[20:23]
    v_mul_f32 v60, v66, v68
    v_mul_f32 v61, v66, v69
    v_mfma_f32_16x16x32_bf16 a[16:19], a[244:247], a[128:131], 0
    buffer_load_dwordx4 a[168:171], v1, s[4:7], s44 offen offset:2048 sc1
    v_mfma_f32_16x16x32_bf16 a[16:19], a[240:243], a[112:115], a[16:19]
    s_waitcnt lgkmcnt(4)
    v_fma_f32 v60, -v67, v69, v60
    v_fmac_f32 v61, v67, v68
    v_mfma_f32_16x16x32_bf16 v[176:179], a[248:251], a[112:115], 0
    s_lshl_b32 s64, s16, 13
    ds_read_b64_tr_b16 a[240:241], v11 offset:96
    ds_read_b64_tr_b16 a[242:243], v11 offset:3680
    v_mfma_f32_16x16x32_bf16 v[176:179], a[252:255], a[128:131], v[176:179]
    s_mul_i32 s60, s49, 1835008
    s_lshl_b32 s61, s50, 8
    s_add_u32 s60, s60, s61
    v_mfma_f32_16x16x32_bf16 v[180:183], a[252:255], a[132:135], 0
    s_xor_b32 s62, s16, s50
    buffer_load_dwordx4 a[172:175], v1, s[4:7], s44 offen offset:3072 sc1
    v_mfma_f32_16x16x32_bf16 v[180:183], a[248:251], a[116:119], v[180:183]
    s_mul_i32 s61, s62, 7
    s_and_b32 s62, s62, 1
    s_add_u32 s61, s61, s62
    v_mfma_f32_16x16x32_bf16 v[184:187], a[248:251], a[120:123], 0
    v_and_b32 v12, 8, v0
    v_add_u32 v12, v12, v0
    v_and_b32 v12, 23, v12
    v_lshlrev_b32 v12, 7, v12
    ds_read_b64_tr_b16 a[244:245], v11 offset:7264
    ds_read_b64_tr_b16 a[246:247], v11 offset:10848
    v_mfma_f32_16x16x32_bf16 v[184:187], a[252:255], a[136:139], v[184:187]
    s_lshl_b32 s61, s61, 15
    s_add_u32 s65, s60, s61
    s_lshr_b32 s62, s50, 1
    v_mfma_f32_16x16x32_bf16 v[188:191], a[252:255], a[140:143], 0
    s_xor_b32 s62, s62, s16
    buffer_load_dword a216, v12, s[12:15], s68 offen offset:0
    v_mfma_f32_16x16x32_bf16 v[188:191], a[248:251], a[124:127], v[188:191]
    s_waitcnt lgkmcnt(4)
    s_mul_i32 s61, s62, 14
    s_add_u32 s61, s61, 6
    v_mfma_f32_16x16x32_bf16 a[44:47], a[232:235], a[124:127], 0
    s_add_u32 s3, s3, 917504
    v_and_b32 v12, 15, v0
    v_min_u32 v12, 13, v12
    v_lshlrev_b32 v12, 7, v12
    ds_read_b64_tr_b16 a[248:249], v11 offset:14432
    ds_read_b64_tr_b16 a[250:251], v11 offset:18016
    v_mfma_f32_16x16x32_bf16 a[44:47], a[236:239], a[140:143], a[44:47]
    s_lshl_b32 s61, s61, 15
    s_add_u32 s66, s60, s61
    s_lshl_b32 s60, s50, 18
    v_mfma_f32_16x16x32_bf16 a[40:43], a[236:239], a[136:139], 0
    s_lshr_b32 s61, s50, 2
    buffer_load_dword a216, v12, s[8:11], s3 offen offset:0
    v_mfma_f32_16x16x32_bf16 a[40:43], a[232:235], a[120:123], a[40:43]
    s_lshl1_add_u32 s61, s49, s61
    s_lshl_b32 s61, s61, 8
    s_add_u32 s60, s60, s61
    v_mfma_f32_16x16x32_bf16 a[36:39], a[232:235], a[116:119], 0
    s_xor_b32 s61, s16, s49
    ds_read_b64_tr_b16 a[252:253], v11 offset:21600
    ds_read_b64_tr_b16 a[254:255], v11 offset:25184
    v_mfma_f32_16x16x32_bf16 a[36:39], a[236:239], a[132:135], a[36:39]
    s_add_u32 s3, s3, 917504
    s_lshl_b32 s61, s61, 16
    s_add_u32 s67, s60, s61
    v_mfma_f32_16x16x32_bf16 a[32:35], a[236:239], a[128:131], 0
    s_and_b32 s60, s69, 0xffff0000
    buffer_load_dword a216, v12, s[8:11], s3 offen offset:0
    v_mfma_f32_16x16x32_bf16 a[32:35], a[232:235], a[112:115], a[32:35]
    s_waitcnt lgkmcnt(4)
    s_lshr_b32 s61, s50, 1
    s_lshr_b32 s62, s61, 1
    v_mfma_f32_16x16x32_bf16 v[192:195], a[240:243], a[112:115], 0
    s_and_b32 s61, s61, 1
    ds_read_b64_tr_b16 a[232:233], v11 offset:128
    ds_read_b64_tr_b16 a[234:235], v11 offset:3712
    v_mfma_f32_16x16x32_bf16 v[192:195], a[244:247], a[128:131], v[192:195]
    s_lshl2_add_u32 s61, s62, s61
    s_lshl_b32 s61, s61, 12
    s_add_u32 s60, s60, s61
    v_mfma_f32_16x16x32_bf16 v[196:199], a[244:247], a[132:135], 0
    s_and_b32 s61, s50, 1
    s_lshl_b32 s61, s61, 9
    s_add_u32 s60, s60, s61
    v_mfma_f32_16x16x32_bf16 v[196:199], a[240:243], a[116:119], v[196:199]
    s_add_u32 s72, s60, 67108864
    s_lshl_b32 s60, s18, 3
    s_add_u32 s60, s60, s17
    v_mfma_f32_16x16x32_bf16 v[200:203], a[240:243], a[120:123], 0
    s_lshl_b32 s60, s60, 8
    ds_read_b64_tr_b16 a[236:237], v11 offset:7296
    ds_read_b64_tr_b16 a[238:239], v11 offset:10880
    v_mfma_f32_16x16x32_bf16 v[200:203], a[244:247], a[136:139], v[200:203]
    s_add_u32 s70, s60, 29358080
    s_lshl_b32 s60, s19, 2
    s_add_u32 s60, s60, s49
    v_mfma_f32_16x16x32_bf16 v[204:207], a[244:247], a[140:143], 0
    s_lshl_b32 s60, s60, 9
    s_add_u32 s73, s60, 29491200
    v_lshrrev_b32 v66, 4, v0
    v_mfma_f32_16x16x32_bf16 v[204:207], a[240:243], a[124:127], v[204:207]
    s_waitcnt lgkmcnt(4)
    v_and_b32 v67, 15, v0
    s_lshl_b32 s60, s49, 2
    v_mfma_f32_16x16x32_bf16 a[60:63], a[248:251], a[124:127], 0
    ds_read_b64_tr_b16 a[240:241], v11 offset:14464
    ds_read_b64_tr_b16 a[242:243], v11 offset:18048
    v_mfma_f32_16x16x32_bf16 a[60:63], a[252:255], a[140:143], a[60:63]
    v_xor_b32 v67, s60, v67
    v_add_u32 v68, 0, v66
    v_mfma_f32_16x16x32_bf16 a[56:59], a[252:255], a[136:139], 0
    v_lshlrev_b32 v69, 11, v68
    v_subrev_u32 v69, 0, v69
    v_mfma_f32_16x16x32_bf16 a[56:59], a[248:251], a[120:123], a[56:59]
    v_and_b32 v68, 7, v68
    v_lshlrev_b32 v68, 1, v68
    v_mfma_f32_16x16x32_bf16 a[52:55], a[248:251], a[116:119], 0
    ds_read_b64_tr_b16 a[244:245], v11 offset:21632
    ds_read_b64_tr_b16 a[246:247], v11 offset:25216
    v_mfma_f32_16x16x32_bf16 a[52:55], a[252:255], a[132:135], a[52:55]
    v_xor_b32 v68, v68, v67
    v_lshl_add_u32 v74, v68, 4, v69
    v_mfma_f32_16x16x32_bf16 a[48:51], a[252:255], a[128:131], 0
    v_add_u32 v68, 4, v66
    v_lshlrev_b32 v69, 11, v68
    v_mfma_f32_16x16x32_bf16 a[48:51], a[248:251], a[112:115], a[48:51]
    s_waitcnt lgkmcnt(4)
    v_subrev_u32 v69, 1024, v69
    v_and_b32 v68, 7, v68
    v_mfma_f32_16x16x32_bf16 v[208:211], a[232:235], a[112:115], 0
    ds_read_b64_tr_b16 a[248:249], v11 offset:160
    ds_read_b64_tr_b16 a[250:251], v11 offset:3744
    v_mfma_f32_16x16x32_bf16 v[208:211], a[236:239], a[128:131], v[208:211]
    v_lshlrev_b32 v68, 1, v68
    v_xor_b32 v68, v68, v67
    v_mfma_f32_16x16x32_bf16 v[212:215], a[236:239], a[132:135], 0
    v_lshl_add_u32 v75, v68, 4, v69
    v_add_u32 v68, 8, v66
    v_mfma_f32_16x16x32_bf16 v[212:215], a[232:235], a[116:119], v[212:215]
    v_lshlrev_b32 v69, 11, v68
    v_subrev_u32 v69, 2048, v69
    v_mfma_f32_16x16x32_bf16 v[216:219], a[232:235], a[120:123], 0
    ds_read_b64_tr_b16 a[252:253], v11 offset:7328
    ds_read_b64_tr_b16 a[254:255], v11 offset:10912
    v_mfma_f32_16x16x32_bf16 v[216:219], a[236:239], a[136:139], v[216:219]
    v_and_b32 v68, 7, v68
    v_lshlrev_b32 v68, 1, v68
    v_mfma_f32_16x16x32_bf16 v[220:223], a[236:239], a[140:143], 0
    v_xor_b32 v68, v68, v67
    v_lshl_add_u32 v76, v68, 4, v69
    v_mfma_f32_16x16x32_bf16 v[220:223], a[232:235], a[124:127], v[220:223]
    s_waitcnt lgkmcnt(4)
    v_add_u32 v68, 12, v66
    v_lshlrev_b32 v69, 11, v68
    v_mfma_f32_16x16x32_bf16 a[76:79], a[240:243], a[124:127], 0
    ds_read_b64_tr_b16 a[232:233], v11 offset:14496
    ds_read_b64_tr_b16 a[234:235], v11 offset:18080
    v_mfma_f32_16x16x32_bf16 a[76:79], a[244:247], a[140:143], a[76:79]
    v_subrev_u32 v69, 3072, v69
    v_and_b32 v68, 7, v68
    v_mfma_f32_16x16x32_bf16 a[72:75], a[244:247], a[136:139], 0
    v_lshlrev_b32 v68, 1, v68
    v_xor_b32 v68, v68, v67
    v_mfma_f32_16x16x32_bf16 a[72:75], a[240:243], a[120:123], a[72:75]
    v_lshl_add_u32 v77, v68, 4, v69
    v_lshrrev_b32 v66, 4, v0
    v_mfma_f32_16x16x32_bf16 a[68:71], a[240:243], a[116:119], 0
    ds_read_b64_tr_b16 a[236:237], v11 offset:21664
    ds_read_b64_tr_b16 a[238:239], v11 offset:25248
    v_mfma_f32_16x16x32_bf16 a[68:71], a[244:247], a[132:135], a[68:71]
    v_and_b32 v67, 15, v0
    v_lshrrev_b32 v68, 2, v67
    v_mfma_f32_16x16x32_bf16 a[64:67], a[244:247], a[128:131], 0
    v_lshlrev_b32 v68, 4, v68
    v_and_b32 v69, 1, v67
    v_mfma_f32_16x16x32_bf16 a[64:67], a[240:243], a[112:115], a[64:67]
    s_waitcnt lgkmcnt(4)
    v_lshl_add_u32 v68, v69, 3, v68
    v_bfe_u32 v69, v67, 1, 1
    v_mfma_f32_16x16x32_bf16 v[224:227], a[248:251], a[112:115], 0
    ds_read_b64_tr_b16 a[240:241], v11 offset:192
    ds_read_b64_tr_b16 a[242:243], v11 offset:3776
    v_mfma_f32_16x16x32_bf16 v[224:227], a[252:255], a[128:131], v[224:227]
    v_add_u32 v68, v68, v69
    v_lshlrev_b32 v68, 11, v68
    v_mfma_f32_16x16x32_bf16 v[228:231], a[252:255], a[132:135], 0
    v_lshl_add_u32 v70, v66, 3, v68
    v_lshlrev_b32 v72, 3, v66
    v_mfma_f32_16x16x32_bf16 v[228:231], a[248:251], a[116:119], v[228:231]
    v_add_u32 v70, v70, v72
    s_lshl_b32 s60, s50, 2
    v_mfma_f32_16x16x32_bf16 v[232:235], a[248:251], a[120:123], 0
    s_add_u32 s60, s60, s49
    ds_read_b64_tr_b16 a[244:245], v11 offset:7360
    ds_read_b64_tr_b16 a[246:247], v11 offset:10944
    v_mfma_f32_16x16x32_bf16 v[232:235], a[252:255], a[136:139], v[232:235]
    s_lshl_b32 s51, s60, 6
    s_lshl_b32 s61, s19, 17
    s_add_u32 s58, s61, s51
    v_mfma_f32_16x16x32_bf16 v[236:239], a[252:255], a[140:143], 0
    s_and_b32 s62, s19, 7
    s_xor_b32 s60, s60, s62
    s_lshl_b32 s60, s60, 12
    v_mfma_f32_16x16x32_bf16 v[236:239], a[248:251], a[124:127], v[236:239]
    s_waitcnt lgkmcnt(4)
    s_add_u32 s59, s61, s60
    s_lshr_b32 s60, s2, 3
    v_mfma_f32_16x16x32_bf16 a[92:95], a[232:235], a[124:127], 0
    s_lshl_b32 s60, s60, 2
    ds_read_b64_tr_b16 a[248:249], v11 offset:14528
    ds_read_b64_tr_b16 a[250:251], v11 offset:18112
    v_mfma_f32_16x16x32_bf16 a[92:95], a[236:239], a[140:143], a[92:95]
    s_add_u32 s60, s60, s16
    s_lshl_b32 s60, s60, 7
    v_lshlrev_b32 v73, 14, v0
    v_mfma_f32_16x16x32_bf16 a[88:91], a[236:239], a[136:139], 0
    v_add_u32 v73, s60, v73
    v_min_u32 v73, CODE_END-K_PC-4, v73
    v_mfma_f32_16x16x32_bf16 a[88:91], a[232:235], a[120:123], a[88:91]
    s_getreg_b32 s63, hwreg(HW_REG_XCC_ID, 0, 4)
    s_lshl_b32 s60, s71, 5
    s_add_u32 s60, s60, s63
    v_mfma_f32_16x16x32_bf16 a[84:87], a[232:235], a[116:119], 0
    s_add_u32 s71, s79, 16
    ds_read_b64_tr_b16 a[252:253], v11 offset:21696
    ds_read_b64_tr_b16 a[254:255], v11 offset:25280
    v_mfma_f32_16x16x32_bf16 a[84:87], a[236:239], a[132:135], a[84:87]
    s_add_u32 s60, s60, s71
    v_mov_b32 v69, s60
    v_and_b32 v79, 7, v0
    v_mfma_f32_16x16x32_bf16 a[80:83], a[236:239], a[128:131], 0
    v_lshlrev_b32 v79, 2, v79
    v_subrev_u32 v78, s50, v0
    v_mfma_f32_16x16x32_bf16 a[80:83], a[232:235], a[112:115], a[80:83]
    s_waitcnt vmcnt(11) lgkmcnt(4)
    v_min_u32 v78, 1, v78
    v_lshl_add_u32 v78, v78, 28, v79
    v_mfma_f32_16x16x32_bf16 v[240:243], a[240:243], a[112:115], 0
    s_barrier
    ds_read_b128 a[232:235], v13 offset:36864
    s_lshl_b32 s60, s18, 7
    v_mfma_f32_16x16x32_bf16 v[240:243], a[244:247], a[128:131], v[240:243]
    s_add_u32 s60, s60, 29589504
    v_lshlrev_b32 v66, 10, v79
    v_add_u32 v66, s60, v66
    v_mfma_f32_16x16x32_bf16 v[244:247], a[244:247], a[132:135], 0
    s_lshl_b32 s60, s19, 10
    s_add_u32 s60, s60, 29589504
    v_lshlrev_b32 v71, 5, v79
    v_mfma_f32_16x16x32_bf16 v[244:247], a[240:243], a[116:119], v[244:247]
    v_add_u32 v71, s60, v71
    s_lshl2_add_u32 s60, s19, s49
    v_mfma_f32_16x16x32_bf16 v[248:251], a[240:243], a[120:123], 0
    ds_read_b128 a[236:239], v14 offset:36864
    v_bfe_u32 v68, v0, 3, 2
    v_mfma_f32_16x16x32_bf16 v[248:251], a[244:247], a[136:139], v[248:251]
    v_xor_b32 v68, s60, v68
    v_lshl_add_u32 v79, v68, 9, v79
    v_mfma_f32_16x16x32_bf16 v[252:255], a[244:247], a[140:143], 0
    v_add_u32 v79, 29491232, v79
F1_READY:
    s_lshl_b32 s60, s17, 5
    v_mfma_f32_16x16x32_bf16 v[252:255], a[240:243], a[124:127], v[252:255]
    s_waitcnt lgkmcnt(2)
    s_add_u32 s60, s60, s18
    s_lshl_b32 s60, s60, 7
    v_mfma_f32_16x16x32_bf16 a[108:111], a[248:251], a[124:127], 0
    s_add_u32 s60, s60, 29589504
    ds_read_b128 a[240:243], v13 offset:40960
    v_lshrrev_b32 v68, 5, v0
    v_mfma_f32_16x16x32_bf16 a[108:111], a[252:255], a[140:143], a[108:111]
    v_or_b32 v68, s16, v68
    v_min_u32 v68, 1, v68
    v_mfma_f32_16x16x32_bf16 a[104:107], a[252:255], a[136:139], 0
    v_lshlrev_b32 v68, 28, v68
    v_lshl_add_u32 v68, v0, 2, v68
    v_mfma_f32_16x16x32_bf16 a[104:107], a[248:251], a[120:123], a[104:107]
    v_mov_b32 v67, s79
    v_mfma_f32_16x16x32_bf16 a[100:103], a[248:251], a[116:119], 0
    ds_read_b128 a[244:247], v14 offset:40960
    v_mfma_f32_16x16x32_bf16 a[100:103], a[252:255], a[132:135], a[100:103]
    buffer_store_dword v67, v68, s[4:7], s60 offen sc1
    v_mfma_f32_16x16x32_bf16 a[96:99], a[252:255], a[128:131], 0
    v_mfma_f32_16x16x32_bf16 a[96:99], a[248:251], a[112:115], a[96:99]
    s_waitcnt vmcnt(4) lgkmcnt(2)
    v_mfma_f32_16x16x32_bf16 v[80:83], a[144:147], a[232:235], v[80:83]
    ds_read_b128 a[248:251], v13 offset:38912
    v_mfma_f32_16x16x32_bf16 v[80:83], a[160:163], a[236:239], v[80:83]
    v_mfma_f32_16x16x32_bf16 v[84:87], a[164:167], a[236:239], v[84:87]
    v_mfma_f32_16x16x32_bf16 v[84:87], a[148:151], a[232:235], v[84:87]
    v_mfma_f32_16x16x32_bf16 v[88:91], a[152:155], a[232:235], v[88:91]
    ds_read_b128 a[252:255], v14 offset:38912
    v_mfma_f32_16x16x32_bf16 v[88:91], a[168:171], a[236:239], v[88:91]
    v_mfma_f32_16x16x32_bf16 v[92:95], a[172:175], a[236:239], v[92:95]
    v_mfma_f32_16x16x32_bf16 v[92:95], a[156:159], a[232:235], v[92:95]
    s_waitcnt lgkmcnt(2)
    v_mfma_f32_16x16x32_bf16 v[108:111], a[156:159], a[240:243], v[108:111]
    ds_read_b128 a[232:235], v13 offset:43008
    v_mfma_f32_16x16x32_bf16 v[108:111], a[172:175], a[244:247], v[108:111]
    v_mfma_f32_16x16x32_bf16 v[104:107], a[168:171], a[244:247], v[104:107]
    v_mfma_f32_16x16x32_bf16 v[104:107], a[152:155], a[240:243], v[104:107]
    v_mfma_f32_16x16x32_bf16 v[100:103], a[148:151], a[240:243], v[100:103]
    ds_read_b128 a[236:239], v14 offset:43008
    v_mfma_f32_16x16x32_bf16 v[100:103], a[164:167], a[244:247], v[100:103]
    v_mfma_f32_16x16x32_bf16 v[96:99], a[160:163], a[244:247], v[96:99]
    v_mfma_f32_16x16x32_bf16 v[96:99], a[144:147], a[240:243], v[96:99]
    s_waitcnt lgkmcnt(2)
    v_mfma_f32_16x16x32_bf16 v[112:115], a[144:147], a[248:251], v[112:115]
    s_add_u32 s45, s45, 458752
    ds_read_b64_tr_b16 a[240:241], v11 offset:36864
    ds_read_b64_tr_b16 a[242:243], v11 offset:40448
    v_mfma_f32_16x16x32_bf16 v[112:115], a[160:163], a[252:255], v[112:115]
    s_add_u32 m0, s47, 73728
    v_mfma_f32_16x16x32_bf16 v[116:119], a[164:167], a[252:255], v[116:119]
    buffer_load_dwordx4 v2, s[8:11], s45 offen offset:0  lds
    v_mfma_f32_16x16x32_bf16 v[116:119], a[148:151], a[248:251], v[116:119]
    v_mfma_f32_16x16x32_bf16 v[120:123], a[152:155], a[248:251], v[120:123]
    ds_read_b64_tr_b16 a[244:245], v11 offset:44032
    ds_read_b64_tr_b16 a[246:247], v11 offset:47616
    v_mfma_f32_16x16x32_bf16 v[120:123], a[168:171], a[252:255], v[120:123]
    v_mfma_f32_16x16x32_bf16 v[124:127], a[172:175], a[252:255], v[124:127]
    buffer_load_dwordx4 v3, s[8:11], s45 offen offset:1024  lds
    v_mfma_f32_16x16x32_bf16 v[124:127], a[156:159], a[248:251], v[124:127]
    s_waitcnt lgkmcnt(4)
    v_mfma_f32_16x16x32_bf16 v[140:143], a[156:159], a[232:235], v[140:143]
    ds_read_b64_tr_b16 a[248:249], v11 offset:51200
    ds_read_b64_tr_b16 a[250:251], v11 offset:54784
    v_mfma_f32_16x16x32_bf16 v[140:143], a[172:175], a[236:239], v[140:143]
    v_mfma_f32_16x16x32_bf16 v[136:139], a[168:171], a[236:239], v[136:139]
    buffer_load_dwordx4 v4, s[8:11], s45 offen offset:2048  lds
    v_mfma_f32_16x16x32_bf16 v[136:139], a[152:155], a[232:235], v[136:139]
    v_mfma_f32_16x16x32_bf16 v[132:135], a[148:151], a[232:235], v[132:135]
    ds_read_b64_tr_b16 a[252:253], v11 offset:58368
    ds_read_b64_tr_b16 a[254:255], v11 offset:61952
    v_mfma_f32_16x16x32_bf16 v[132:135], a[164:167], a[236:239], v[132:135]
    v_mfma_f32_16x16x32_bf16 v[128:131], a[160:163], a[236:239], v[128:131]
    buffer_load_dwordx4 v5, s[8:11], s45 offen offset:3072  lds
    v_mfma_f32_16x16x32_bf16 v[128:131], a[144:147], a[232:235], v[128:131]
    s_waitcnt lgkmcnt(4)
    v_mfma_f32_16x16x32_bf16 v[144:147], a[240:243], a[144:147], v[144:147]
    s_add_u32 s46, s46, 128
    ds_read_b64_tr_b16 a[232:233], v11 offset:36896
    ds_read_b64_tr_b16 a[234:235], v11 offset:40480
    v_mfma_f32_16x16x32_bf16 v[144:147], a[244:247], a[160:163], v[144:147]
    s_add_u32 m0, s48, 73728
    v_mfma_f32_16x16x32_bf16 v[148:151], a[244:247], a[164:167], v[148:151]
    buffer_load_dwordx4 v9, s[12:15], s46 offen offset:0  lds
    v_mfma_f32_16x16x32_bf16 v[148:151], a[240:243], a[148:151], v[148:151]
    v_mfma_f32_16x16x32_bf16 v[152:155], a[240:243], a[152:155], v[152:155]
    ds_read_b64_tr_b16 a[236:237], v11 offset:44064
    ds_read_b64_tr_b16 a[238:239], v11 offset:47648
    v_mfma_f32_16x16x32_bf16 v[152:155], a[244:247], a[168:171], v[152:155]
    v_mfma_f32_16x16x32_bf16 v[156:159], a[244:247], a[172:175], v[156:159]
    buffer_load_dwordx4 v10, s[12:15], s46 offen offset:1024  lds
    v_mfma_f32_16x16x32_bf16 v[156:159], a[240:243], a[156:159], v[156:159]
    s_waitcnt lgkmcnt(4)
    v_mfma_f32_16x16x32_bf16 a[12:15], a[248:251], a[156:159], a[12:15]
    ds_read_b64_tr_b16 a[240:241], v11 offset:51232
    ds_read_b64_tr_b16 a[242:243], v11 offset:54816
    v_mfma_f32_16x16x32_bf16 a[12:15], a[252:255], a[172:175], a[12:15]
    s_add_u32 m0, s47, 77824
    v_mfma_f32_16x16x32_bf16 a[8:11], a[252:255], a[168:171], a[8:11]
    buffer_load_dwordx4 v6, s[8:11], s45 offen offset:0  lds
    v_mfma_f32_16x16x32_bf16 a[8:11], a[248:251], a[152:155], a[8:11]
    v_mfma_f32_16x16x32_bf16 a[4:7], a[248:251], a[148:151], a[4:7]
    ds_read_b64_tr_b16 a[244:245], v11 offset:58400
    ds_read_b64_tr_b16 a[246:247], v11 offset:61984
    v_mfma_f32_16x16x32_bf16 a[4:7], a[252:255], a[164:167], a[4:7]
    v_mfma_f32_16x16x32_bf16 a[0:3], a[252:255], a[160:163], a[0:3]
    buffer_load_dwordx4 v7, s[8:11], s45 offen offset:1024  lds
    v_mfma_f32_16x16x32_bf16 a[0:3], a[248:251], a[144:147], a[0:3]
    s_waitcnt lgkmcnt(4)
    v_mfma_f32_16x16x32_bf16 v[160:163], a[232:235], a[144:147], v[160:163]
    ds_read_b64_tr_b16 a[248:249], v11 offset:36928
    ds_read_b64_tr_b16 a[250:251], v11 offset:40512
    v_mfma_f32_16x16x32_bf16 v[160:163], a[236:239], a[160:163], v[160:163]
    v_mfma_f32_16x16x32_bf16 v[164:167], a[236:239], a[164:167], v[164:167]
    buffer_load_dwordx4 v8, s[8:11], s45 offen offset:2048  lds
    v_mfma_f32_16x16x32_bf16 v[164:167], a[232:235], a[148:151], v[164:167]
    v_mfma_f32_16x16x32_bf16 v[168:171], a[232:235], a[152:155], v[168:171]
    ds_read_b64_tr_b16 a[252:253], v11 offset:44096
    ds_read_b64_tr_b16 a[254:255], v11 offset:47680
    v_mfma_f32_16x16x32_bf16 v[168:171], a[236:239], a[168:171], v[168:171]
    s_xor_b32 s44, s44, 28672
    v_mfma_f32_16x16x32_bf16 v[172:175], a[236:239], a[172:175], v[172:175]
    buffer_load_dwordx4 a[112:115], v1, s[4:7], s44 offen offset:0 sc1
    v_mfma_f32_16x16x32_bf16 v[172:175], a[232:235], a[156:159], v[172:175]
    s_waitcnt lgkmcnt(4)
    v_mfma_f32_16x16x32_bf16 a[28:31], a[240:243], a[156:159], a[28:31]
    ds_read_b64_tr_b16 a[232:233], v11 offset:51264
    ds_read_b64_tr_b16 a[234:235], v11 offset:54848
    v_mfma_f32_16x16x32_bf16 a[28:31], a[244:247], a[172:175], a[28:31]
    v_mfma_f32_16x16x32_bf16 a[24:27], a[244:247], a[168:171], a[24:27]
    buffer_load_dwordx4 a[116:119], v1, s[4:7], s44 offen offset:1024 sc1
    v_mfma_f32_16x16x32_bf16 a[24:27], a[240:243], a[152:155], a[24:27]
    v_mfma_f32_16x16x32_bf16 a[20:23], a[240:243], a[148:151], a[20:23]
    ds_read_b64_tr_b16 a[236:237], v11 offset:58432
    ds_read_b64_tr_b16 a[238:239], v11 offset:62016
    v_mfma_f32_16x16x32_bf16 a[20:23], a[244:247], a[164:167], a[20:23]
    v_mfma_f32_16x16x32_bf16 a[16:19], a[244:247], a[160:163], a[16:19]
    buffer_load_dwordx4 a[120:123], v1, s[4:7], s44 offen offset:2048 sc1
    v_mfma_f32_16x16x32_bf16 a[16:19], a[240:243], a[144:147], a[16:19]
    s_waitcnt lgkmcnt(4)
    v_mfma_f32_16x16x32_bf16 v[176:179], a[248:251], a[144:147], v[176:179]
    ds_read_b64_tr_b16 a[240:241], v11 offset:36960
    ds_read_b64_tr_b16 a[242:243], v11 offset:40544
    v_mfma_f32_16x16x32_bf16 v[176:179], a[252:255], a[160:163], v[176:179]
    v_mfma_f32_16x16x32_bf16 v[180:183], a[252:255], a[164:167], v[180:183]
    buffer_load_dwordx4 a[124:127], v1, s[4:7], s44 offen offset:3072 sc1
    v_mfma_f32_16x16x32_bf16 v[180:183], a[248:251], a[148:151], v[180:183]
    v_mfma_f32_16x16x32_bf16 v[184:187], a[248:251], a[152:155], v[184:187]
    ds_read_b64_tr_b16 a[244:245], v11 offset:44128
    ds_read_b64_tr_b16 a[246:247], v11 offset:47712
    v_mfma_f32_16x16x32_bf16 v[184:187], a[252:255], a[168:171], v[184:187]
    v_mfma_f32_16x16x32_bf16 v[188:191], a[252:255], a[172:175], v[188:191]
    v_mfma_f32_16x16x32_bf16 v[188:191], a[248:251], a[156:159], v[188:191]
    s_waitcnt lgkmcnt(4)
    v_mfma_f32_16x16x32_bf16 a[44:47], a[232:235], a[156:159], a[44:47]
    ds_read_b64_tr_b16 a[248:249], v11 offset:51296
    ds_read_b64_tr_b16 a[250:251], v11 offset:54880
    v_mfma_f32_16x16x32_bf16 a[44:47], a[236:239], a[172:175], a[44:47]
    s_xor_b32 s44, s44, 4096
    v_mfma_f32_16x16x32_bf16 a[40:43], a[236:239], a[168:171], a[40:43]
    buffer_load_dwordx4 a[128:131], v1, s[4:7], s44 offen offset:0 sc1
    v_mfma_f32_16x16x32_bf16 a[40:43], a[232:235], a[152:155], a[40:43]
    v_mfma_f32_16x16x32_bf16 a[36:39], a[232:235], a[148:151], a[36:39]
    ds_read_b64_tr_b16 a[252:253], v11 offset:58464
    ds_read_b64_tr_b16 a[254:255], v11 offset:62048
    v_mfma_f32_16x16x32_bf16 a[36:39], a[236:239], a[164:167], a[36:39]
    v_mfma_f32_16x16x32_bf16 a[32:35], a[236:239], a[160:163], a[32:35]
    buffer_load_dwordx4 a[132:135], v1, s[4:7], s44 offen offset:1024 sc1
    v_mfma_f32_16x16x32_bf16 a[32:35], a[232:235], a[144:147], a[32:35]
    s_waitcnt lgkmcnt(4)
    v_mfma_f32_16x16x32_bf16 v[192:195], a[240:243], a[144:147], v[192:195]
    ds_read_b64_tr_b16 a[232:233], v11 offset:36992
    ds_read_b64_tr_b16 a[234:235], v11 offset:40576
    v_mfma_f32_16x16x32_bf16 v[192:195], a[244:247], a[160:163], v[192:195]
    v_mfma_f32_16x16x32_bf16 v[196:199], a[244:247], a[164:167], v[196:199]
    buffer_load_dwordx4 a[136:139], v1, s[4:7], s44 offen offset:2048 sc1
    v_mfma_f32_16x16x32_bf16 v[196:199], a[240:243], a[148:151], v[196:199]
    v_mfma_f32_16x16x32_bf16 v[200:203], a[240:243], a[152:155], v[200:203]
    ds_read_b64_tr_b16 a[236:237], v11 offset:44160
    ds_read_b64_tr_b16 a[238:239], v11 offset:47744
    v_mfma_f32_16x16x32_bf16 v[200:203], a[244:247], a[168:171], v[200:203]
    v_mfma_f32_16x16x32_bf16 v[204:207], a[244:247], a[172:175], v[204:207]
    buffer_load_dwordx4 a[140:143], v1, s[4:7], s44 offen offset:3072 sc1
    v_mfma_f32_16x16x32_bf16 v[204:207], a[240:243], a[156:159], v[204:207]
    s_waitcnt lgkmcnt(4)
    v_mfma_f32_16x16x32_bf16 a[60:63], a[248:251], a[156:159], a[60:63]
    s_add_u32 s45, s45, 458752
    ds_read_b64_tr_b16 a[240:241], v11 offset:51328
    ds_read_b64_tr_b16 a[242:243], v11 offset:54912
    v_mfma_f32_16x16x32_bf16 a[60:63], a[252:255], a[172:175], a[60:63]
    s_add_u32 m0, s47, 110592
    v_mfma_f32_16x16x32_bf16 a[56:59], a[252:255], a[168:171], a[56:59]
    buffer_load_dwordx4 v2, s[8:11], s45 offen offset:0  lds
    v_mfma_f32_16x16x32_bf16 a[56:59], a[248:251], a[152:155], a[56:59]
    v_mfma_f32_16x16x32_bf16 a[52:55], a[248:251], a[148:151], a[52:55]
    ds_read_b64_tr_b16 a[244:245], v11 offset:58496
    ds_read_b64_tr_b16 a[246:247], v11 offset:62080
    v_mfma_f32_16x16x32_bf16 a[52:55], a[252:255], a[164:167], a[52:55]
    v_mfma_f32_16x16x32_bf16 a[48:51], a[252:255], a[160:163], a[48:51]
    buffer_load_dwordx4 v3, s[8:11], s45 offen offset:1024  lds
    v_mfma_f32_16x16x32_bf16 a[48:51], a[248:251], a[144:147], a[48:51]
    s_waitcnt lgkmcnt(4)
    v_mfma_f32_16x16x32_bf16 v[208:211], a[232:235], a[144:147], v[208:211]
    ds_read_b64_tr_b16 a[248:249], v11 offset:37024
    ds_read_b64_tr_b16 a[250:251], v11 offset:40608
    v_mfma_f32_16x16x32_bf16 v[208:211], a[236:239], a[160:163], v[208:211]
    v_mfma_f32_16x16x32_bf16 v[212:215], a[236:239], a[164:167], v[212:215]
    buffer_load_dwordx4 v4, s[8:11], s45 offen offset:2048  lds
    v_mfma_f32_16x16x32_bf16 v[212:215], a[232:235], a[148:151], v[212:215]
    v_mfma_f32_16x16x32_bf16 v[216:219], a[232:235], a[152:155], v[216:219]
    ds_read_b64_tr_b16 a[252:253], v11 offset:44192
    ds_read_b64_tr_b16 a[254:255], v11 offset:47776
    v_mfma_f32_16x16x32_bf16 v[216:219], a[236:239], a[168:171], v[216:219]
    v_mfma_f32_16x16x32_bf16 v[220:223], a[236:239], a[172:175], v[220:223]
    buffer_load_dwordx4 v5, s[8:11], s45 offen offset:3072  lds
    v_mfma_f32_16x16x32_bf16 v[220:223], a[232:235], a[156:159], v[220:223]
    s_waitcnt lgkmcnt(4)
    v_mfma_f32_16x16x32_bf16 a[76:79], a[240:243], a[156:159], a[76:79]
    s_add_u32 s46, s46, 128
    ds_read_b64_tr_b16 a[232:233], v11 offset:51360
    ds_read_b64_tr_b16 a[234:235], v11 offset:54944
    v_mfma_f32_16x16x32_bf16 a[76:79], a[244:247], a[172:175], a[76:79]
    s_add_u32 m0, s48, 110592
    v_mfma_f32_16x16x32_bf16 a[72:75], a[244:247], a[168:171], a[72:75]
    buffer_load_dwordx4 v9, s[12:15], s46 offen offset:0  lds
    v_mfma_f32_16x16x32_bf16 a[72:75], a[240:243], a[152:155], a[72:75]
    v_mfma_f32_16x16x32_bf16 a[68:71], a[240:243], a[148:151], a[68:71]
    ds_read_b64_tr_b16 a[236:237], v11 offset:58528
    ds_read_b64_tr_b16 a[238:239], v11 offset:62112
    v_mfma_f32_16x16x32_bf16 a[68:71], a[244:247], a[164:167], a[68:71]
    v_mfma_f32_16x16x32_bf16 a[64:67], a[244:247], a[160:163], a[64:67]
    buffer_load_dwordx4 v10, s[12:15], s46 offen offset:1024  lds
    v_mfma_f32_16x16x32_bf16 a[64:67], a[240:243], a[144:147], a[64:67]
    s_waitcnt lgkmcnt(4)
    v_mfma_f32_16x16x32_bf16 v[224:227], a[248:251], a[144:147], v[224:227]
    ds_read_b64_tr_b16 a[240:241], v11 offset:37056
    ds_read_b64_tr_b16 a[242:243], v11 offset:40640
    v_mfma_f32_16x16x32_bf16 v[224:227], a[252:255], a[160:163], v[224:227]
    s_add_u32 m0, s47, 114688
    v_mfma_f32_16x16x32_bf16 v[228:231], a[252:255], a[164:167], v[228:231]
    buffer_load_dwordx4 v6, s[8:11], s45 offen offset:0  lds
    v_mfma_f32_16x16x32_bf16 v[228:231], a[248:251], a[148:151], v[228:231]
    v_mfma_f32_16x16x32_bf16 v[232:235], a[248:251], a[152:155], v[232:235]
    ds_read_b64_tr_b16 a[244:245], v11 offset:44224
    ds_read_b64_tr_b16 a[246:247], v11 offset:47808
    v_mfma_f32_16x16x32_bf16 v[232:235], a[252:255], a[168:171], v[232:235]
    v_mfma_f32_16x16x32_bf16 v[236:239], a[252:255], a[172:175], v[236:239]
    buffer_load_dwordx4 v7, s[8:11], s45 offen offset:1024  lds
    v_mfma_f32_16x16x32_bf16 v[236:239], a[248:251], a[156:159], v[236:239]
    s_waitcnt lgkmcnt(4)
    v_mfma_f32_16x16x32_bf16 a[92:95], a[232:235], a[156:159], a[92:95]
    ds_read_b64_tr_b16 a[248:249], v11 offset:51392
    ds_read_b64_tr_b16 a[250:251], v11 offset:54976
    v_mfma_f32_16x16x32_bf16 a[92:95], a[236:239], a[172:175], a[92:95]
    v_mfma_f32_16x16x32_bf16 a[88:91], a[236:239], a[168:171], a[88:91]
    buffer_load_dwordx4 v8, s[8:11], s45 offen offset:2048  lds
    v_mfma_f32_16x16x32_bf16 a[88:91], a[232:235], a[152:155], a[88:91]
    v_mfma_f32_16x16x32_bf16 a[84:87], a[232:235], a[148:151], a[84:87]
    ds_read_b64_tr_b16 a[252:253], v11 offset:58560
    ds_read_b64_tr_b16 a[254:255], v11 offset:62144
    v_mfma_f32_16x16x32_bf16 a[84:87], a[236:239], a[164:167], a[84:87]
    v_mfma_f32_16x16x32_bf16 a[80:83], a[236:239], a[160:163], a[80:83]
    v_mfma_f32_16x16x32_bf16 a[80:83], a[232:235], a[144:147], a[80:83]
    s_waitcnt vmcnt(17) lgkmcnt(4)
    v_mfma_f32_16x16x32_bf16 v[240:243], a[240:243], a[144:147], v[240:243]
    s_barrier
    ds_read_b128 a[232:235], v15 offset:0
    v_mfma_f32_16x16x32_bf16 v[240:243], a[244:247], a[160:163], v[240:243]
    v_mfma_f32_16x16x32_bf16 v[244:247], a[244:247], a[164:167], v[244:247]
    v_mfma_f32_16x16x32_bf16 v[244:247], a[240:243], a[148:151], v[244:247]
    v_mfma_f32_16x16x32_bf16 v[248:251], a[240:243], a[152:155], v[248:251]
    ds_read_b128 a[236:239], v16 offset:0
    v_mfma_f32_16x16x32_bf16 v[248:251], a[244:247], a[168:171], v[248:251]
    v_mfma_f32_16x16x32_bf16 v[252:255], a[244:247], a[172:175], v[252:255]
    v_mfma_f32_16x16x32_bf16 v[252:255], a[240:243], a[156:159], v[252:255]
    s_waitcnt lgkmcnt(2)
    v_mfma_f32_16x16x32_bf16 a[108:111], a[248:251], a[156:159], a[108:111]
    ds_read_b128 a[240:243], v15 offset:4096
    v_mfma_f32_16x16x32_bf16 a[108:111], a[252:255], a[172:175], a[108:111]
    v_mfma_f32_16x16x32_bf16 a[104:107], a[252:255], a[168:171], a[104:107]
    v_mfma_f32_16x16x32_bf16 a[104:107], a[248:251], a[152:155], a[104:107]
    v_mfma_f32_16x16x32_bf16 a[100:103], a[248:251], a[148:151], a[100:103]
    ds_read_b128 a[244:247], v16 offset:4096
    v_mfma_f32_16x16x32_bf16 a[100:103], a[252:255], a[164:167], a[100:103]
    v_mfma_f32_16x16x32_bf16 a[96:99], a[252:255], a[160:163], a[96:99]
    v_mfma_f32_16x16x32_bf16 a[96:99], a[248:251], a[144:147], a[96:99]
    s_waitcnt vmcnt(9) lgkmcnt(2)
    v_mfma_f32_16x16x32_bf16 v[80:83], a[112:115], a[232:235], v[80:83]
    ds_read_b128 a[248:251], v15 offset:2048
    v_mfma_f32_16x16x32_bf16 v[80:83], a[128:131], a[236:239], v[80:83]
    s_xor_b32 s44, s44, 12288
    buffer_load_dword v67, v71, s[4:7], 0 offen sc1
    v_mfma_f32_16x16x32_bf16 v[84:87], a[132:135], a[236:239], v[84:87]
    buffer_load_dwordx4 a[144:147], v1, s[4:7], s44 offen offset:0 sc1
    v_mfma_f32_16x16x32_bf16 v[84:87], a[116:119], a[232:235], v[84:87]
    v_mfma_f32_16x16x32_bf16 v[88:91], a[120:123], a[232:235], v[88:91]
    ds_read_b128 a[252:255], v16 offset:2048
    v_mfma_f32_16x16x32_bf16 v[88:91], a[136:139], a[236:239], v[88:91]
    v_mfma_f32_16x16x32_bf16 v[92:95], a[140:143], a[236:239], v[92:95]
    buffer_load_dwordx4 a[148:151], v1, s[4:7], s44 offen offset:1024 sc1
    v_mfma_f32_16x16x32_bf16 v[92:95], a[124:127], a[232:235], v[92:95]
    s_waitcnt lgkmcnt(2)
    v_mfma_f32_16x16x32_bf16 v[108:111], a[124:127], a[240:243], v[108:111]
    ds_read_b128 a[232:235], v15 offset:6144
    v_mfma_f32_16x16x32_bf16 v[108:111], a[140:143], a[244:247], v[108:111]
    v_mfma_f32_16x16x32_bf16 v[104:107], a[136:139], a[244:247], v[104:107]
    buffer_load_dwordx4 a[152:155], v1, s[4:7], s44 offen offset:2048 sc1
    v_mfma_f32_16x16x32_bf16 v[104:107], a[120:123], a[240:243], v[104:107]
    v_mfma_f32_16x16x32_bf16 v[100:103], a[116:119], a[240:243], v[100:103]
    ds_read_b128 a[236:239], v16 offset:6144
    v_mfma_f32_16x16x32_bf16 v[100:103], a[132:135], a[244:247], v[100:103]
    v_mfma_f32_16x16x32_bf16 v[96:99], a[128:131], a[244:247], v[96:99]
    v_mfma_f32_16x16x32_bf16 v[96:99], a[112:115], a[240:243], v[96:99]
    s_waitcnt lgkmcnt(2)
    v_mfma_f32_16x16x32_bf16 v[112:115], a[112:115], a[248:251], v[112:115]
    ds_read_b64_tr_b16 a[240:241], v17 offset:0
    ds_read_b64_tr_b16 a[242:243], v17 offset:3584
    v_mfma_f32_16x16x32_bf16 v[112:115], a[128:131], a[252:255], v[112:115]
    v_mfma_f32_16x16x32_bf16 v[116:119], a[132:135], a[252:255], v[116:119]
    buffer_load_dwordx4 a[156:159], v1, s[4:7], s44 offen offset:3072 sc1
    v_mfma_f32_16x16x32_bf16 v[116:119], a[116:119], a[248:251], v[116:119]
    v_mfma_f32_16x16x32_bf16 v[120:123], a[120:123], a[248:251], v[120:123]
    ds_read_b64_tr_b16 a[244:245], v17 offset:7168
    ds_read_b64_tr_b16 a[246:247], v17 offset:10752
    v_mfma_f32_16x16x32_bf16 v[120:123], a[136:139], a[252:255], v[120:123]
    s_xor_b32 s44, s44, 4096
    v_mfma_f32_16x16x32_bf16 v[124:127], a[140:143], a[252:255], v[124:127]
    buffer_load_dwordx4 a[160:163], v1, s[4:7], s44 offen offset:0 sc1
    v_mfma_f32_16x16x32_bf16 v[124:127], a[124:127], a[248:251], v[124:127]
    s_waitcnt lgkmcnt(4)
    v_mfma_f32_16x16x32_bf16 v[140:143], a[124:127], a[232:235], v[140:143]
    ds_read_b64_tr_b16 a[248:249], v17 offset:14336
    ds_read_b64_tr_b16 a[250:251], v17 offset:17920
    v_mfma_f32_16x16x32_bf16 v[140:143], a[140:143], a[236:239], v[140:143]
    v_mfma_f32_16x16x32_bf16 v[136:139], a[136:139], a[236:239], v[136:139]
    buffer_load_dwordx4 a[164:167], v1, s[4:7], s44 offen offset:1024 sc1
    v_mfma_f32_16x16x32_bf16 v[136:139], a[120:123], a[232:235], v[136:139]
    v_mfma_f32_16x16x32_bf16 v[132:135], a[116:119], a[232:235], v[132:135]
    ds_read_b64_tr_b16 a[252:253], v17 offset:21504
    ds_read_b64_tr_b16 a[254:255], v17 offset:25088
    v_mfma_f32_16x16x32_bf16 v[132:135], a[132:135], a[236:239], v[132:135]
    v_mfma_f32_16x16x32_bf16 v[128:131], a[128:131], a[236:239], v[128:131]
    v_mfma_f32_16x16x32_bf16 v[128:131], a[112:115], a[232:235], v[128:131]
    s_waitcnt lgkmcnt(4)
    v_mfma_f32_16x16x32_bf16 v[144:147], a[240:243], a[112:115], v[144:147]
    ds_read_b64_tr_b16 a[232:233], v17 offset:32
    ds_read_b64_tr_b16 a[234:235], v17 offset:3616
    v_mfma_f32_16x16x32_bf16 v[144:147], a[244:247], a[128:131], v[144:147]
    v_mfma_f32_16x16x32_bf16 v[148:151], a[244:247], a[132:135], v[148:151]
    buffer_load_dwordx4 a[168:171], v1, s[4:7], s44 offen offset:2048 sc1
    v_mfma_f32_16x16x32_bf16 v[148:151], a[240:243], a[116:119], v[148:151]
    v_mfma_f32_16x16x32_bf16 v[152:155], a[240:243], a[120:123], v[152:155]
    ds_read_b64_tr_b16 a[236:237], v17 offset:7200
    ds_read_b64_tr_b16 a[238:239], v17 offset:10784
    v_mfma_f32_16x16x32_bf16 v[152:155], a[244:247], a[136:139], v[152:155]
    v_mfma_f32_16x16x32_bf16 v[156:159], a[244:247], a[140:143], v[156:159]
    buffer_load_dwordx4 a[172:175], v1, s[4:7], s44 offen offset:3072 sc1
    v_mfma_f32_16x16x32_bf16 v[156:159], a[240:243], a[124:127], v[156:159]
    s_waitcnt lgkmcnt(4)
    v_mfma_f32_16x16x32_bf16 a[12:15], a[248:251], a[124:127], a[12:15]
    s_add_u32 s45, s45, 458752
    ds_read_b64_tr_b16 a[240:241], v17 offset:14368
    ds_read_b64_tr_b16 a[242:243], v17 offset:17952
    v_mfma_f32_16x16x32_bf16 a[12:15], a[252:255], a[140:143], a[12:15]
    s_add_u32 m0, s47, 0
    v_mfma_f32_16x16x32_bf16 a[8:11], a[252:255], a[136:139], a[8:11]
    buffer_load_dwordx4 v2, s[8:11], s45 offen offset:0  lds
    v_mfma_f32_16x16x32_bf16 a[8:11], a[248:251], a[120:123], a[8:11]
    v_mfma_f32_16x16x32_bf16 a[4:7], a[248:251], a[116:119], a[4:7]
    ds_read_b64_tr_b16 a[244:245], v17 offset:21536
    ds_read_b64_tr_b16 a[246:247], v17 offset:25120
    v_mfma_f32_16x16x32_bf16 a[4:7], a[252:255], a[132:135], a[4:7]
    v_mfma_f32_16x16x32_bf16 a[0:3], a[252:255], a[128:131], a[0:3]
    v_mfma_f32_16x16x32_bf16 a[0:3], a[248:251], a[112:115], a[0:3]
    s_waitcnt lgkmcnt(4)
    v_mfma_f32_16x16x32_bf16 v[160:163], a[232:235], a[112:115], v[160:163]
    ds_read_b64_tr_b16 a[248:249], v17 offset:64
    ds_read_b64_tr_b16 a[250:251], v17 offset:3648
    v_mfma_f32_16x16x32_bf16 v[160:163], a[236:239], a[128:131], v[160:163]
    v_mfma_f32_16x16x32_bf16 v[164:167], a[236:239], a[132:135], v[164:167]
    buffer_load_dwordx4 v3, s[8:11], s45 offen offset:1024  lds
    v_mfma_f32_16x16x32_bf16 v[164:167], a[232:235], a[116:119], v[164:167]
    v_mfma_f32_16x16x32_bf16 v[168:171], a[232:235], a[120:123], v[168:171]
    ds_read_b64_tr_b16 a[252:253], v17 offset:7232
    ds_read_b64_tr_b16 a[254:255], v17 offset:10816
    v_mfma_f32_16x16x32_bf16 v[168:171], a[236:239], a[136:139], v[168:171]
    v_mfma_f32_16x16x32_bf16 v[172:175], a[236:239], a[140:143], v[172:175]
    v_mfma_f32_16x16x32_bf16 v[172:175], a[232:235], a[124:127], v[172:175]
    s_waitcnt lgkmcnt(4)
    v_mfma_f32_16x16x32_bf16 a[28:31], a[240:243], a[124:127], a[28:31]
    ds_read_b64_tr_b16 a[232:233], v17 offset:14400
    ds_read_b64_tr_b16 a[234:235], v17 offset:17984
    v_mfma_f32_16x16x32_bf16 a[28:31], a[244:247], a[140:143], a[28:31]
    v_mfma_f32_16x16x32_bf16 a[24:27], a[244:247], a[136:139], a[24:27]
    buffer_load_dwordx4 v4, s[8:11], s45 offen offset:2048  lds
    v_mfma_f32_16x16x32_bf16 a[24:27], a[240:243], a[120:123], a[24:27]
    v_mfma_f32_16x16x32_bf16 a[20:23], a[240:243], a[116:119], a[20:23]
    ds_read_b64_tr_b16 a[236:237], v17 offset:21568
    ds_read_b64_tr_b16 a[238:239], v17 offset:25152
    v_mfma_f32_16x16x32_bf16 a[20:23], a[244:247], a[132:135], a[20:23]
    v_mfma_f32_16x16x32_bf16 a[16:19], a[244:247], a[128:131], a[16:19]
    buffer_load_dwordx4 v5, s[8:11], s45 offen offset:3072  lds
    v_mfma_f32_16x16x32_bf16 a[16:19], a[240:243], a[112:115], a[16:19]
    s_waitcnt lgkmcnt(4)
    v_mfma_f32_16x16x32_bf16 v[176:179], a[248:251], a[112:115], v[176:179]
    s_add_u32 s46, s46, 128
    ds_read_b64_tr_b16 a[240:241], v17 offset:96
    ds_read_b64_tr_b16 a[242:243], v17 offset:3680
    v_mfma_f32_16x16x32_bf16 v[176:179], a[252:255], a[128:131], v[176:179]
    s_add_u32 m0, s48, 0
    v_mfma_f32_16x16x32_bf16 v[180:183], a[252:255], a[132:135], v[180:183]
    buffer_load_dwordx4 v9, s[12:15], s46 offen offset:0  lds
    v_mfma_f32_16x16x32_bf16 v[180:183], a[248:251], a[116:119], v[180:183]
    v_mfma_f32_16x16x32_bf16 v[184:187], a[248:251], a[120:123], v[184:187]
    ds_read_b64_tr_b16 a[244:245], v17 offset:7264
    ds_read_b64_tr_b16 a[246:247], v17 offset:10848
    v_mfma_f32_16x16x32_bf16 v[184:187], a[252:255], a[136:139], v[184:187]
    v_mfma_f32_16x16x32_bf16 v[188:191], a[252:255], a[140:143], v[188:191]
    v_mfma_f32_16x16x32_bf16 v[188:191], a[248:251], a[124:127], v[188:191]
    s_waitcnt lgkmcnt(4)
    v_mfma_f32_16x16x32_bf16 a[44:47], a[232:235], a[124:127], a[44:47]
    ds_read_b64_tr_b16 a[248:249], v17 offset:14432
    ds_read_b64_tr_b16 a[250:251], v17 offset:18016
    v_mfma_f32_16x16x32_bf16 a[44:47], a[236:239], a[140:143], a[44:47]
    v_mfma_f32_16x16x32_bf16 a[40:43], a[236:239], a[136:139], a[40:43]
    buffer_load_dwordx4 v10, s[12:15], s46 offen offset:1024  lds
    v_mfma_f32_16x16x32_bf16 a[40:43], a[232:235], a[120:123], a[40:43]
    v_mfma_f32_16x16x32_bf16 a[36:39], a[232:235], a[116:119], a[36:39]
    ds_read_b64_tr_b16 a[252:253], v17 offset:21600
    ds_read_b64_tr_b16 a[254:255], v17 offset:25184
    v_mfma_f32_16x16x32_bf16 a[36:39], a[236:239], a[132:135], a[36:39]
    s_add_u32 m0, s47, 4096
    v_mfma_f32_16x16x32_bf16 a[32:35], a[236:239], a[128:131], a[32:35]
    buffer_load_dwordx4 v6, s[8:11], s45 offen offset:0  lds
    v_mfma_f32_16x16x32_bf16 a[32:35], a[232:235], a[112:115], a[32:35]
    s_waitcnt lgkmcnt(4)
    v_mfma_f32_16x16x32_bf16 v[192:195], a[240:243], a[112:115], v[192:195]
    ds_read_b64_tr_b16 a[232:233], v17 offset:128
    ds_read_b64_tr_b16 a[234:235], v17 offset:3712
    v_mfma_f32_16x16x32_bf16 v[192:195], a[244:247], a[128:131], v[192:195]
    v_mfma_f32_16x16x32_bf16 v[196:199], a[244:247], a[132:135], v[196:199]
    buffer_load_dwordx4 v7, s[8:11], s45 offen offset:1024  lds
    v_mfma_f32_16x16x32_bf16 v[196:199], a[240:243], a[116:119], v[196:199]
    v_mfma_f32_16x16x32_bf16 v[200:203], a[240:243], a[120:123], v[200:203]
    ds_read_b64_tr_b16 a[236:237], v17 offset:7296
    ds_read_b64_tr_b16 a[238:239], v17 offset:10880
    v_mfma_f32_16x16x32_bf16 v[200:203], a[244:247], a[136:139], v[200:203]
    v_mfma_f32_16x16x32_bf16 v[204:207], a[244:247], a[140:143], v[204:207]
    v_mfma_f32_16x16x32_bf16 v[204:207], a[240:243], a[124:127], v[204:207]
    s_waitcnt lgkmcnt(4)
    v_mfma_f32_16x16x32_bf16 a[60:63], a[248:251], a[124:127], a[60:63]
    ds_read_b64_tr_b16 a[240:241], v17 offset:14464
    ds_read_b64_tr_b16 a[242:243], v17 offset:18048
    v_mfma_f32_16x16x32_bf16 a[60:63], a[252:255], a[140:143], a[60:63]
    v_mfma_f32_16x16x32_bf16 a[56:59], a[252:255], a[136:139], a[56:59]
    buffer_load_dwordx4 v8, s[8:11], s45 offen offset:2048  lds
    v_mfma_f32_16x16x32_bf16 a[56:59], a[248:251], a[120:123], a[56:59]
    v_mfma_f32_16x16x32_bf16 a[52:55], a[248:251], a[116:119], a[52:55]
    ds_read_b64_tr_b16 a[244:245], v17 offset:21632
    ds_read_b64_tr_b16 a[246:247], v17 offset:25216
    v_mfma_f32_16x16x32_bf16 a[52:55], a[252:255], a[132:135], a[52:55]
    v_mfma_f32_16x16x32_bf16 a[48:51], a[252:255], a[128:131], a[48:51]
    v_mfma_f32_16x16x32_bf16 a[48:51], a[248:251], a[112:115], a[48:51]
    s_waitcnt lgkmcnt(4)
    v_mfma_f32_16x16x32_bf16 v[208:211], a[232:235], a[112:115], v[208:211]
    ds_read_b64_tr_b16 a[248:249], v17 offset:160
    ds_read_b64_tr_b16 a[250:251], v17 offset:3744
    v_mfma_f32_16x16x32_bf16 v[208:211], a[236:239], a[128:131], v[208:211]
    s_add_u32 s3, s3, 917504
    v_mfma_f32_16x16x32_bf16 v[212:215], a[236:239], a[132:135], v[212:215]
    buffer_load_dword a216, v12, s[8:11], s3 offen offset:0
    v_mfma_f32_16x16x32_bf16 v[212:215], a[232:235], a[116:119], v[212:215]
    v_mfma_f32_16x16x32_bf16 v[216:219], a[232:235], a[120:123], v[216:219]
    ds_read_b64_tr_b16 a[252:253], v17 offset:7328
    ds_read_b64_tr_b16 a[254:255], v17 offset:10912
    v_mfma_f32_16x16x32_bf16 v[216:219], a[236:239], a[136:139], v[216:219]
    s_add_u32 s3, s3, 917504
    v_mfma_f32_16x16x32_bf16 v[220:223], a[236:239], a[140:143], v[220:223]
    buffer_load_dword a216, v12, s[8:11], s3 offen offset:0
    v_mfma_f32_16x16x32_bf16 v[220:223], a[232:235], a[124:127], v[220:223]
    s_waitcnt lgkmcnt(4)
    v_mfma_f32_16x16x32_bf16 a[76:79], a[240:243], a[124:127], a[76:79]
    v_and_b32 v12, 8, v0
    v_add_u32 v12, v12, v0
    v_and_b32 v12, 23, v12
    v_lshlrev_b32 v12, 7, v12
    ds_read_b64_tr_b16 a[232:233], v17 offset:14496
    ds_read_b64_tr_b16 a[234:235], v17 offset:18080
    v_mfma_f32_16x16x32_bf16 a[76:79], a[244:247], a[140:143], a[76:79]
    v_mfma_f32_16x16x32_bf16 a[72:75], a[244:247], a[136:139], a[72:75]
    buffer_load_dword a216, v12, s[12:15], s68 offen offset:1024
    v_mfma_f32_16x16x32_bf16 a[72:75], a[240:243], a[120:123], a[72:75]
    v_mfma_f32_16x16x32_bf16 a[68:71], a[240:243], a[116:119], a[68:71]
    v_and_b32 v12, 32, v0
    v_mul_u32_u24 v12, 252, v12
    v_lshl_add_u32 v12, v0, 2, v12
    ds_read_b64_tr_b16 a[236:237], v17 offset:21664
    ds_read_b64_tr_b16 a[238:239], v17 offset:25248
    v_mfma_f32_16x16x32_bf16 a[68:71], a[244:247], a[132:135], a[68:71]
    v_mfma_f32_16x16x32_bf16 a[64:67], a[244:247], a[128:131], a[64:67]
    buffer_store_dword a212, v12, s[4:7], s69 offen sc1
    v_mfma_f32_16x16x32_bf16 a[64:67], a[240:243], a[112:115], a[64:67]
    s_waitcnt lgkmcnt(4)
    v_mfma_f32_16x16x32_bf16 v[224:227], a[248:251], a[112:115], v[224:227]
    ds_read_b64_tr_b16 a[240:241], v17 offset:192
    ds_read_b64_tr_b16 a[242:243], v17 offset:3776
    v_mfma_f32_16x16x32_bf16 v[224:227], a[252:255], a[128:131], v[224:227]
    v_mfma_f32_16x16x32_bf16 v[228:231], a[252:255], a[132:135], v[228:231]
    v_mfma_f32_16x16x32_bf16 v[228:231], a[248:251], a[116:119], v[228:231]
    v_mfma_f32_16x16x32_bf16 v[232:235], a[248:251], a[120:123], v[232:235]
    ds_read_b64_tr_b16 a[244:245], v17 offset:7360
    ds_read_b64_tr_b16 a[246:247], v17 offset:10944
    v_mfma_f32_16x16x32_bf16 v[232:235], a[252:255], a[136:139], v[232:235]
    v_mfma_f32_16x16x32_bf16 v[236:239], a[252:255], a[140:143], v[236:239]
    v_mfma_f32_16x16x32_bf16 v[236:239], a[248:251], a[124:127], v[236:239]
    s_waitcnt lgkmcnt(4)
    v_mfma_f32_16x16x32_bf16 a[92:95], a[232:235], a[124:127], a[92:95]
    s_waitcnt vmcnt(21)
    ds_read_b64_tr_b16 a[248:249], v17 offset:14528
    ds_read_b64_tr_b16 a[250:251], v17 offset:18112
    v_mfma_f32_16x16x32_bf16 a[92:95], a[236:239], a[140:143], a[92:95]
    v_cmp_ne_u32 vcc, s79, v67
    s_cbranch_vccnz SLOW_XB
BACK_XB:
    v_mfma_f32_16x16x32_bf16 a[88:91], a[236:239], a[136:139], a[88:91]
    v_mfma_f32_16x16x32_bf16 a[88:91], a[232:235], a[120:123], a[88:91]
    v_mfma_f32_16x16x32_bf16 a[84:87], a[232:235], a[116:119], a[84:87]
    ds_read_b64_tr_b16 a[252:253], v17 offset:21696
    ds_read_b64_tr_b16 a[254:255], v17 offset:25280
    v_mfma_f32_16x16x32_bf16 a[84:87], a[236:239], a[132:135], a[84:87]
    v_mfma_f32_16x16x32_bf16 a[80:83], a[236:239], a[128:131], a[80:83]
    v_mfma_f32_16x16x32_bf16 a[80:83], a[232:235], a[112:115], a[80:83]
    s_waitcnt lgkmcnt(4)
    v_mfma_f32_16x16x32_bf16 v[240:243], a[240:243], a[112:115], v[240:243]
    s_barrier
    ds_read_b128 a[232:235], v15 offset:36864
    v_mfma_f32_16x16x32_bf16 v[240:243], a[244:247], a[128:131], v[240:243]
    v_mfma_f32_16x16x32_bf16 v[244:247], a[244:247], a[132:135], v[244:247]
    v_mfma_f32_16x16x32_bf16 v[244:247], a[240:243], a[116:119], v[244:247]
    v_mfma_f32_16x16x32_bf16 v[248:251], a[240:243], a[120:123], v[248:251]
    ds_read_b128 a[236:239], v16 offset:36864
    v_mfma_f32_16x16x32_bf16 v[248:251], a[244:247], a[136:139], v[248:251]
    v_mfma_f32_16x16x32_bf16 v[252:255], a[244:247], a[140:143], v[252:255]
    v_mfma_f32_16x16x32_bf16 v[252:255], a[240:243], a[124:127], v[252:255]
    s_waitcnt lgkmcnt(2)
    v_mfma_f32_16x16x32_bf16 a[108:111], a[248:251], a[124:127], a[108:111]
    ds_read_b128 a[240:243], v15 offset:40960
    v_mfma_f32_16x16x32_bf16 a[108:111], a[252:255], a[140:143], a[108:111]
    v_mfma_f32_16x16x32_bf16 a[104:107], a[252:255], a[136:139], a[104:107]
    v_mfma_f32_16x16x32_bf16 a[104:107], a[248:251], a[120:123], a[104:107]
    v_mfma_f32_16x16x32_bf16 a[100:103], a[248:251], a[116:119], a[100:103]
    ds_read_b128 a[244:247], v16 offset:40960
    v_mfma_f32_16x16x32_bf16 a[100:103], a[252:255], a[132:135], a[100:103]
    v_mfma_f32_16x16x32_bf16 a[96:99], a[252:255], a[128:131], a[96:99]
    v_mfma_f32_16x16x32_bf16 a[96:99], a[248:251], a[112:115], a[96:99]
    s_waitcnt vmcnt(13) lgkmcnt(2)
    v_mfma_f32_16x16x32_bf16 v[80:83], a[144:147], a[232:235], v[80:83]
    ds_read_b128 a[248:251], v15 offset:38912
    v_mfma_f32_16x16x32_bf16 v[80:83], a[160:163], a[236:239], v[80:83]
    v_mfma_f32_16x16x32_bf16 v[84:87], a[164:167], a[236:239], v[84:87]
    v_mfma_f32_16x16x32_bf16 v[84:87], a[148:151], a[232:235], v[84:87]
    v_mfma_f32_16x16x32_bf16 v[88:91], a[152:155], a[232:235], v[88:91]
    ds_read_b128 a[252:255], v16 offset:38912
    v_mfma_f32_16x16x32_bf16 v[88:91], a[168:171], a[236:239], v[88:91]
    v_mfma_f32_16x16x32_bf16 v[92:95], a[172:175], a[236:239], v[92:95]
    v_mfma_f32_16x16x32_bf16 v[92:95], a[156:159], a[232:235], v[92:95]
    s_waitcnt lgkmcnt(2)
    v_mfma_f32_16x16x32_bf16 v[108:111], a[156:159], a[240:243], v[108:111]
    ds_read_b128 a[232:235], v15 offset:43008
    v_mfma_f32_16x16x32_bf16 v[108:111], a[172:175], a[244:247], v[108:111]
    v_mfma_f32_16x16x32_bf16 v[104:107], a[168:171], a[244:247], v[104:107]
    v_mfma_f32_16x16x32_bf16 v[104:107], a[152:155], a[240:243], v[104:107]
    v_mfma_f32_16x16x32_bf16 v[100:103], a[148:151], a[240:243], v[100:103]
    ds_read_b128 a[236:239], v16 offset:43008
    v_mfma_f32_16x16x32_bf16 v[100:103], a[164:167], a[244:247], v[100:103]
    v_mfma_f32_16x16x32_bf16 v[96:99], a[160:163], a[244:247], v[96:99]
    v_mfma_f32_16x16x32_bf16 v[96:99], a[144:147], a[240:243], v[96:99]
    s_waitcnt lgkmcnt(2)
    v_mfma_f32_16x16x32_bf16 v[112:115], a[144:147], a[248:251], v[112:115]
    ds_read_b64_tr_b16 a[240:241], v17 offset:36864
    ds_read_b64_tr_b16 a[242:243], v17 offset:40448
    v_mfma_f32_16x16x32_bf16 v[112:115], a[160:163], a[252:255], v[112:115]
    v_mfma_f32_16x16x32_bf16 v[116:119], a[164:167], a[252:255], v[116:119]
    v_mfma_f32_16x16x32_bf16 v[116:119], a[148:151], a[248:251], v[116:119]
    v_mfma_f32_16x16x32_bf16 v[120:123], a[152:155], a[248:251], v[120:123]
    ds_read_b64_tr_b16 a[244:245], v17 offset:44032
    ds_read_b64_tr_b16 a[246:247], v17 offset:47616
    v_mfma_f32_16x16x32_bf16 v[120:123], a[168:171], a[252:255], v[120:123]
    v_mfma_f32_16x16x32_bf16 v[124:127], a[172:175], a[252:255], v[124:127]
    v_mfma_f32_16x16x32_bf16 v[124:127], a[156:159], a[248:251], v[124:127]
    s_waitcnt lgkmcnt(4)
    v_mfma_f32_16x16x32_bf16 v[140:143], a[156:159], a[232:235], v[140:143]
    s_xor_b32 s60, s50, s16
    ds_read_b64_tr_b16 a[248:249], v17 offset:51200
    ds_read_b64_tr_b16 a[250:251], v17 offset:54784
    v_mfma_f32_16x16x32_bf16 v[140:143], a[172:175], a[236:239], v[140:143]
    s_and_b32 s60, s60, 1
    s_lshl_b32 s60, s60, 13
    s_add_u32 s60, s60, s69
    v_mfma_f32_16x16x32_bf16 v[136:139], a[168:171], a[236:239], v[136:139]
    s_add_u32 s61, s60, 128
    s_mov_b32 s0, 0
    v_mfma_f32_16x16x32_bf16 v[136:139], a[152:155], a[232:235], v[136:139]
    v_mfma_f32_16x16x32_bf16 v[132:135], a[148:151], a[232:235], v[132:135]
    ds_read_b64_tr_b16 a[252:253], v17 offset:58368
    ds_read_b64_tr_b16 a[254:255], v17 offset:61952
    v_mfma_f32_16x16x32_bf16 v[132:135], a[164:167], a[236:239], v[132:135]
    v_mfma_f32_16x16x32_bf16 v[128:131], a[160:163], a[236:239], v[128:131]
    v_mfma_f32_16x16x32_bf16 v[128:131], a[144:147], a[232:235], v[128:131]
    s_waitcnt lgkmcnt(4)
    v_mfma_f32_16x16x32_bf16 v[144:147], a[240:243], a[144:147], v[144:147]
    ds_read_b64_tr_b16 a[232:233], v17 offset:36896
    ds_read_b64_tr_b16 a[234:235], v17 offset:40480
    v_mfma_f32_16x16x32_bf16 v[144:147], a[244:247], a[160:163], v[144:147]
    v_mfma_f32_16x16x32_bf16 v[148:151], a[244:247], a[164:167], v[148:151]
    v_mfma_f32_16x16x32_bf16 v[148:151], a[240:243], a[148:151], v[148:151]
    v_mfma_f32_16x16x32_bf16 v[152:155], a[240:243], a[152:155], v[152:155]
    ds_read_b64_tr_b16 a[236:237], v17 offset:44064
    ds_read_b64_tr_b16 a[238:239], v17 offset:47648
    v_mfma_f32_16x16x32_bf16 v[152:155], a[244:247], a[168:171], v[152:155]
    v_mfma_f32_16x16x32_bf16 v[156:159], a[244:247], a[172:175], v[156:159]
    v_mfma_f32_16x16x32_bf16 v[156:159], a[240:243], a[156:159], v[156:159]
    s_waitcnt lgkmcnt(4)
    v_mfma_f32_16x16x32_bf16 a[12:15], a[248:251], a[156:159], a[12:15]
    ds_read_b64_tr_b16 a[240:241], v17 offset:51232
    ds_read_b64_tr_b16 a[242:243], v17 offset:54816
    v_mfma_f32_16x16x32_bf16 a[12:15], a[252:255], a[172:175], a[12:15]
    s_xor_b32 s44, s44, 61440
    v_mfma_f32_16x16x32_bf16 a[8:11], a[252:255], a[168:171], a[8:11]
    buffer_load_dwordx4 a[112:115], v1, s[4:7], s44 offen offset:0 sc1
    v_mfma_f32_16x16x32_bf16 a[8:11], a[248:251], a[152:155], a[8:11]
    v_mfma_f32_16x16x32_bf16 a[4:7], a[248:251], a[148:151], a[4:7]
    ds_read_b64_tr_b16 a[244:245], v17 offset:58400
    ds_read_b64_tr_b16 a[246:247], v17 offset:61984
    v_mfma_f32_16x16x32_bf16 a[4:7], a[252:255], a[164:167], a[4:7]
    v_mfma_f32_16x16x32_bf16 a[0:3], a[252:255], a[160:163], a[0:3]
    buffer_load_dwordx4 a[116:119], v1, s[4:7], s44 offen offset:1024 sc1
    v_mfma_f32_16x16x32_bf16 a[0:3], a[248:251], a[144:147], a[0:3]
    s_waitcnt lgkmcnt(4)
    v_mfma_f32_16x16x32_bf16 v[160:163], a[232:235], a[144:147], v[160:163]
    ds_read_b64_tr_b16 a[248:249], v17 offset:36928
    ds_read_b64_tr_b16 a[250:251], v17 offset:40512
    v_mfma_f32_16x16x32_bf16 v[160:163], a[236:239], a[160:163], v[160:163]
    v_mfma_f32_16x16x32_bf16 v[164:167], a[236:239], a[164:167], v[164:167]
    buffer_load_dwordx4 a[120:123], v1, s[4:7], s44 offen offset:2048 sc1
    v_mfma_f32_16x16x32_bf16 v[164:167], a[232:235], a[148:151], v[164:167]
    v_mfma_f32_16x16x32_bf16 v[168:171], a[232:235], a[152:155], v[168:171]
    ds_read_b64_tr_b16 a[252:253], v17 offset:44096
    ds_read_b64_tr_b16 a[254:255], v17 offset:47680
    v_mfma_f32_16x16x32_bf16 v[168:171], a[236:239], a[168:171], v[168:171]
    v_mfma_f32_16x16x32_bf16 v[172:175], a[236:239], a[172:175], v[172:175]
    buffer_load_dwordx4 a[124:127], v1, s[4:7], s44 offen offset:3072 sc1
    v_mfma_f32_16x16x32_bf16 v[172:175], a[232:235], a[156:159], v[172:175]
    s_waitcnt lgkmcnt(4)
    v_mfma_f32_16x16x32_bf16 a[28:31], a[240:243], a[156:159], a[28:31]
    ds_read_b64_tr_b16 a[232:233], v17 offset:51264
    ds_read_b64_tr_b16 a[234:235], v17 offset:54848
    v_mfma_f32_16x16x32_bf16 a[28:31], a[244:247], a[172:175], a[28:31]
    s_xor_b32 s44, s44, 4096
    v_mfma_f32_16x16x32_bf16 a[24:27], a[244:247], a[168:171], a[24:27]
    buffer_load_dwordx4 a[128:131], v1, s[4:7], s44 offen offset:0 sc1
    v_mfma_f32_16x16x32_bf16 a[24:27], a[240:243], a[152:155], a[24:27]
    v_mfma_f32_16x16x32_bf16 a[20:23], a[240:243], a[148:151], a[20:23]
    ds_read_b64_tr_b16 a[236:237], v17 offset:58432
    ds_read_b64_tr_b16 a[238:239], v17 offset:62016
    v_mfma_f32_16x16x32_bf16 a[20:23], a[244:247], a[164:167], a[20:23]
    v_mfma_f32_16x16x32_bf16 a[16:19], a[244:247], a[160:163], a[16:19]
    v_mfma_f32_16x16x32_bf16 a[16:19], a[240:243], a[144:147], a[16:19]
    s_waitcnt lgkmcnt(4)
    v_mfma_f32_16x16x32_bf16 v[176:179], a[248:251], a[144:147], v[176:179]
    ds_read_b64_tr_b16 a[240:241], v17 offset:36960
    ds_read_b64_tr_b16 a[242:243], v17 offset:40544
    v_mfma_f32_16x16x32_bf16 v[176:179], a[252:255], a[160:163], v[176:179]
    v_mfma_f32_16x16x32_bf16 v[180:183], a[252:255], a[164:167], v[180:183]
    buffer_load_dwordx4 a[132:135], v1, s[4:7], s44 offen offset:1024 sc1
    v_mfma_f32_16x16x32_bf16 v[180:183], a[248:251], a[148:151], v[180:183]
    v_mfma_f32_16x16x32_bf16 v[184:187], a[248:251], a[152:155], v[184:187]
    ds_read_b64_tr_b16 a[244:245], v17 offset:44128
    ds_read_b64_tr_b16 a[246:247], v17 offset:47712
    v_mfma_f32_16x16x32_bf16 v[184:187], a[252:255], a[168:171], v[184:187]
    v_mfma_f32_16x16x32_bf16 v[188:191], a[252:255], a[172:175], v[188:191]
    buffer_load_dwordx4 a[136:139], v1, s[4:7], s44 offen offset:2048 sc1
    v_mfma_f32_16x16x32_bf16 v[188:191], a[248:251], a[156:159], v[188:191]
    s_waitcnt lgkmcnt(4)
    v_mfma_f32_16x16x32_bf16 a[44:47], a[232:235], a[156:159], a[44:47]
    ds_read_b64_tr_b16 a[248:249], v17 offset:51296
    ds_read_b64_tr_b16 a[250:251], v17 offset:54880
    v_mfma_f32_16x16x32_bf16 a[44:47], a[236:239], a[172:175], a[44:47]
    v_mfma_f32_16x16x32_bf16 a[40:43], a[236:239], a[168:171], a[40:43]
    buffer_load_dwordx4 a[140:143], v1, s[4:7], s44 offen offset:3072 sc1
    v_mfma_f32_16x16x32_bf16 a[40:43], a[232:235], a[152:155], a[40:43]
    v_mfma_f32_16x16x32_bf16 a[36:39], a[232:235], a[148:151], a[36:39]
    ds_read_b64_tr_b16 a[252:253], v17 offset:58464
    ds_read_b64_tr_b16 a[254:255], v17 offset:62048
    v_mfma_f32_16x16x32_bf16 a[36:39], a[236:239], a[164:167], a[36:39]
    v_mfma_f32_16x16x32_bf16 a[32:35], a[236:239], a[160:163], a[32:35]
    v_mfma_f32_16x16x32_bf16 a[32:35], a[232:235], a[144:147], a[32:35]
    s_waitcnt lgkmcnt(4)
    v_mfma_f32_16x16x32_bf16 v[192:195], a[240:243], a[144:147], v[192:195]
    s_add_u32 s45, s45, 458752
    ds_read_b64_tr_b16 a[232:233], v17 offset:36992
    ds_read_b64_tr_b16 a[234:235], v17 offset:40576
    v_mfma_f32_16x16x32_bf16 v[192:195], a[244:247], a[160:163], v[192:195]
    s_add_u32 m0, s47, 36864
    v_mfma_f32_16x16x32_bf16 v[196:199], a[244:247], a[164:167], v[196:199]
    buffer_load_dwordx4 v2, s[8:11], s45 offen offset:0  lds
    v_mfma_f32_16x16x32_bf16 v[196:199], a[240:243], a[148:151], v[196:199]
    v_mfma_f32_16x16x32_bf16 v[200:203], a[240:243], a[152:155], v[200:203]
    ds_read_b64_tr_b16 a[236:237], v17 offset:44160
    ds_read_b64_tr_b16 a[238:239], v17 offset:47744
    v_mfma_f32_16x16x32_bf16 v[200:203], a[244:247], a[168:171], v[200:203]
    v_mfma_f32_16x16x32_bf16 v[204:207], a[244:247], a[172:175], v[204:207]
    buffer_load_dwordx4 v3, s[8:11], s45 offen offset:1024  lds
    v_mfma_f32_16x16x32_bf16 v[204:207], a[240:243], a[156:159], v[204:207]
    s_waitcnt lgkmcnt(4)
    v_mfma_f32_16x16x32_bf16 a[60:63], a[248:251], a[156:159], a[60:63]
    ds_read_b64_tr_b16 a[240:241], v17 offset:51328
    ds_read_b64_tr_b16 a[242:243], v17 offset:54912
    v_mfma_f32_16x16x32_bf16 a[60:63], a[252:255], a[172:175], a[60:63]
    v_mfma_f32_16x16x32_bf16 a[56:59], a[252:255], a[168:171], a[56:59]
    buffer_load_dwordx4 v4, s[8:11], s45 offen offset:2048  lds
    v_mfma_f32_16x16x32_bf16 a[56:59], a[248:251], a[152:155], a[56:59]
    v_mfma_f32_16x16x32_bf16 a[52:55], a[248:251], a[148:151], a[52:55]
    ds_read_b64_tr_b16 a[244:245], v17 offset:58496
    ds_read_b64_tr_b16 a[246:247], v17 offset:62080
    v_mfma_f32_16x16x32_bf16 a[52:55], a[252:255], a[164:167], a[52:55]
    v_mfma_f32_16x16x32_bf16 a[48:51], a[252:255], a[160:163], a[48:51]
    v_mfma_f32_16x16x32_bf16 a[48:51], a[248:251], a[144:147], a[48:51]
    s_waitcnt lgkmcnt(4)
    v_mfma_f32_16x16x32_bf16 v[208:211], a[232:235], a[144:147], v[208:211]
    ds_read_b64_tr_b16 a[248:249], v17 offset:37024
    ds_read_b64_tr_b16 a[250:251], v17 offset:40608
    v_mfma_f32_16x16x32_bf16 v[208:211], a[236:239], a[160:163], v[208:211]
    v_mfma_f32_16x16x32_bf16 v[212:215], a[236:239], a[164:167], v[212:215]
    buffer_load_dwordx4 v5, s[8:11], s45 offen offset:3072  lds
    v_mfma_f32_16x16x32_bf16 v[212:215], a[232:235], a[148:151], v[212:215]
    v_mfma_f32_16x16x32_bf16 v[216:219], a[232:235], a[152:155], v[216:219]
    s_add_u32 s46, s46, 128
    ds_read_b64_tr_b16 a[252:253], v17 offset:44192
    ds_read_b64_tr_b16 a[254:255], v17 offset:47776
    v_mfma_f32_16x16x32_bf16 v[216:219], a[236:239], a[168:171], v[216:219]
    s_add_u32 m0, s48, 36864
    v_mfma_f32_16x16x32_bf16 v[220:223], a[236:239], a[172:175], v[220:223]
    buffer_load_dwordx4 v9, s[12:15], s46 offen offset:0  lds
    v_mfma_f32_16x16x32_bf16 v[220:223], a[232:235], a[156:159], v[220:223]
    s_waitcnt lgkmcnt(4)
    v_mfma_f32_16x16x32_bf16 a[76:79], a[240:243], a[156:159], a[76:79]
    ds_read_b64_tr_b16 a[232:233], v17 offset:51360
    ds_read_b64_tr_b16 a[234:235], v17 offset:54944
    v_mfma_f32_16x16x32_bf16 a[76:79], a[244:247], a[172:175], a[76:79]
    v_mfma_f32_16x16x32_bf16 a[72:75], a[244:247], a[168:171], a[72:75]
    buffer_load_dwordx4 v10, s[12:15], s46 offen offset:1024  lds
    v_mfma_f32_16x16x32_bf16 a[72:75], a[240:243], a[152:155], a[72:75]
    v_mfma_f32_16x16x32_bf16 a[68:71], a[240:243], a[148:151], a[68:71]
    ds_read_b64_tr_b16 a[236:237], v17 offset:58528
    ds_read_b64_tr_b16 a[238:239], v17 offset:62112
    v_mfma_f32_16x16x32_bf16 a[68:71], a[244:247], a[164:167], a[68:71]
    v_mfma_f32_16x16x32_bf16 a[64:67], a[244:247], a[160:163], a[64:67]
    v_mfma_f32_16x16x32_bf16 a[64:67], a[240:243], a[144:147], a[64:67]
    s_waitcnt lgkmcnt(4)
    v_mfma_f32_16x16x32_bf16 v[224:227], a[248:251], a[144:147], v[224:227]
    s_waitcnt vmcnt(14)
    ds_read_b64_tr_b16 a[240:241], v17 offset:37056
    ds_read_b64_tr_b16 a[242:243], v17 offset:40640
    v_mfma_f32_16x16x32_bf16 v[224:227], a[252:255], a[160:163], v[224:227]
    s_add_u32 m0, s47, 40960
    s_mov_b32 s54, 0
    v_mfma_f32_16x16x32_bf16 v[228:231], a[252:255], a[164:167], v[228:231]
    buffer_load_dwordx4 v6, s[8:11], s45 offen offset:0  lds
    v_mfma_f32_16x16x32_bf16 v[228:231], a[248:251], a[148:151], v[228:231]
    v_mfma_f32_16x16x32_bf16 v[232:235], a[248:251], a[152:155], v[232:235]
    ds_read_b64_tr_b16 a[244:245], v17 offset:44224
    ds_read_b64_tr_b16 a[246:247], v17 offset:47808
    v_mfma_f32_16x16x32_bf16 v[232:235], a[252:255], a[168:171], v[232:235]
    v_mfma_f32_16x16x32_bf16 v[236:239], a[252:255], a[172:175], v[236:239]
    buffer_load_dwordx4 v7, s[8:11], s45 offen offset:1024  lds
    v_mfma_f32_16x16x32_bf16 v[236:239], a[248:251], a[156:159], v[236:239]
    s_waitcnt lgkmcnt(4)
    v_mfma_f32_16x16x32_bf16 a[92:95], a[232:235], a[156:159], a[92:95]
    s_load_dword s54, s[4:5], s60
    ds_read_b64_tr_b16 a[248:249], v17 offset:51392
    ds_read_b64_tr_b16 a[250:251], v17 offset:54976
    v_mfma_f32_16x16x32_bf16 a[92:95], a[236:239], a[172:175], a[92:95]
    v_mfma_f32_16x16x32_bf16 a[88:91], a[236:239], a[168:171], a[88:91]
    buffer_load_dwordx4 v8, s[8:11], s45 offen offset:2048  lds
    v_mfma_f32_16x16x32_bf16 a[88:91], a[232:235], a[152:155], a[88:91]
    v_mfma_f32_16x16x32_bf16 a[84:87], a[232:235], a[148:151], a[84:87]
    ds_read_b64_tr_b16 a[252:253], v17 offset:58560
    ds_read_b64_tr_b16 a[254:255], v17 offset:62144
    v_mfma_f32_16x16x32_bf16 a[84:87], a[236:239], a[164:167], a[84:87]
    v_mfma_f32_16x16x32_bf16 a[80:83], a[236:239], a[160:163], a[80:83]
    v_mfma_f32_16x16x32_bf16 a[80:83], a[232:235], a[144:147], a[80:83]
    s_waitcnt lgkmcnt(4)
    v_mfma_f32_16x16x32_bf16 v[240:243], a[240:243], a[144:147], v[240:243]
    s_barrier
    ds_read_b128 a[232:235], v13 offset:0
    v_mfma_f32_16x16x32_bf16 v[240:243], a[244:247], a[160:163], v[240:243]
    v_mfma_f32_16x16x32_bf16 v[244:247], a[244:247], a[164:167], v[244:247]
    v_mfma_f32_16x16x32_bf16 v[244:247], a[240:243], a[148:151], v[244:247]
    v_mfma_f32_16x16x32_bf16 v[248:251], a[240:243], a[152:155], v[248:251]
    ds_read_b128 a[236:239], v14 offset:0
    v_mfma_f32_16x16x32_bf16 v[248:251], a[244:247], a[168:171], v[248:251]
    v_mfma_f32_16x16x32_bf16 v[252:255], a[244:247], a[172:175], v[252:255]
    v_mfma_f32_16x16x32_bf16 v[252:255], a[240:243], a[156:159], v[252:255]
    s_waitcnt lgkmcnt(2)
    v_mfma_f32_16x16x32_bf16 a[108:111], a[248:251], a[156:159], a[108:111]
    s_add_u32 s0, s0, s54
    ds_read_b128 a[240:243], v13 offset:4096
    v_mfma_f32_16x16x32_bf16 a[108:111], a[252:255], a[172:175], a[108:111]
    v_mfma_f32_16x16x32_bf16 a[104:107], a[252:255], a[168:171], a[104:107]
    v_mfma_f32_16x16x32_bf16 a[104:107], a[248:251], a[152:155], a[104:107]
    s_add_u32 s0, s0, s54
    v_mfma_f32_16x16x32_bf16 a[100:103], a[248:251], a[148:151], a[100:103]
    ds_read_b128 a[244:247], v14 offset:4096
    v_mfma_f32_16x16x32_bf16 a[100:103], a[252:255], a[164:167], a[100:103]
    v_mfma_f32_16x16x32_bf16 a[96:99], a[252:255], a[160:163], a[96:99]
    s_add_u32 s0, s0, s54
    v_mfma_f32_16x16x32_bf16 a[96:99], a[248:251], a[144:147], a[96:99]
    s_waitcnt vmcnt(9) lgkmcnt(2)
    v_mfma_f32_16x16x32_bf16 v[80:83], a[112:115], a[232:235], v[80:83]
    ds_read_b128 a[248:251], v13 offset:2048
    v_mfma_f32_16x16x32_bf16 v[80:83], a[128:131], a[236:239], v[80:83]
    s_xor_b32 s44, s44, 12288
    s_add_u32 s0, s0, s54
    v_mfma_f32_16x16x32_bf16 v[84:87], a[132:135], a[236:239], v[84:87]
    buffer_load_dwordx4 a[144:147], v1, s[4:7], s44 offen offset:0 sc1
    v_mfma_f32_16x16x32_bf16 v[84:87], a[116:119], a[232:235], v[84:87]
    v_mfma_f32_16x16x32_bf16 v[88:91], a[120:123], a[232:235], v[88:91]
    s_add_u32 s0, s0, s54
    ds_read_b128 a[252:255], v14 offset:2048
    v_mfma_f32_16x16x32_bf16 v[88:91], a[136:139], a[236:239], v[88:91]
    v_mfma_f32_16x16x32_bf16 v[92:95], a[140:143], a[236:239], v[92:95]
    buffer_load_dwordx4 a[148:151], v1, s[4:7], s44 offen offset:1024 sc1
    v_mfma_f32_16x16x32_bf16 v[92:95], a[124:127], a[232:235], v[92:95]
    s_waitcnt lgkmcnt(2)
    s_add_u32 s0, s0, s54
    v_mfma_f32_16x16x32_bf16 v[108:111], a[124:127], a[240:243], v[108:111]
    ds_read_b128 a[232:235], v13 offset:6144
    v_mfma_f32_16x16x32_bf16 v[108:111], a[140:143], a[244:247], v[108:111]
    v_mfma_f32_16x16x32_bf16 v[104:107], a[136:139], a[244:247], v[104:107]
    s_add_u32 s0, s0, s54
    buffer_load_dwordx4 a[152:155], v1, s[4:7], s44 offen offset:2048 sc1
    v_mfma_f32_16x16x32_bf16 v[104:107], a[120:123], a[240:243], v[104:107]
    v_mfma_f32_16x16x32_bf16 v[100:103], a[116:119], a[240:243], v[100:103]
    ds_read_b128 a[236:239], v14 offset:6144
    v_mfma_f32_16x16x32_bf16 v[100:103], a[132:135], a[244:247], v[100:103]
    s_add_u32 s0, s0, s54
    v_mfma_f32_16x16x32_bf16 v[96:99], a[128:131], a[244:247], v[96:99]
    v_mfma_f32_16x16x32_bf16 v[96:99], a[112:115], a[240:243], v[96:99]
    s_waitcnt lgkmcnt(2)
    v_mfma_f32_16x16x32_bf16 v[112:115], a[112:115], a[248:251], v[112:115]
    s_add_u32 s0, s0, s54
    ds_read_b64_tr_b16 a[240:241], v11 offset:0
    ds_read_b64_tr_b16 a[242:243], v11 offset:3584
    v_mfma_f32_16x16x32_bf16 v[112:115], a[128:131], a[252:255], v[112:115]
    v_mfma_f32_16x16x32_bf16 v[116:119], a[132:135], a[252:255], v[116:119]
    buffer_load_dwordx4 a[156:159], v1, s[4:7], s44 offen offset:3072 sc1
    v_mfma_f32_16x16x32_bf16 v[116:119], a[116:119], a[248:251], v[116:119]
    s_add_u32 s0, s0, s54
    v_mfma_f32_16x16x32_bf16 v[120:123], a[120:123], a[248:251], v[120:123]
    ds_read_b64_tr_b16 a[244:245], v11 offset:7168
    ds_read_b64_tr_b16 a[246:247], v11 offset:10752
    v_mfma_f32_16x16x32_bf16 v[120:123], a[136:139], a[252:255], v[120:123]
    s_xor_b32 s44, s44, 4096
    v_mfma_f32_16x16x32_bf16 v[124:127], a[140:143], a[252:255], v[124:127]
    s_add_u32 s0, s0, s54
    buffer_load_dwordx4 a[160:163], v1, s[4:7], s44 offen offset:0 sc1
    v_mfma_f32_16x16x32_bf16 v[124:127], a[124:127], a[248:251], v[124:127]
    s_waitcnt lgkmcnt(4)
    v_mfma_f32_16x16x32_bf16 v[140:143], a[124:127], a[232:235], v[140:143]
    ds_read_b64_tr_b16 a[248:249], v11 offset:14336
    ds_read_b64_tr_b16 a[250:251], v11 offset:17920
    v_mfma_f32_16x16x32_bf16 v[140:143], a[140:143], a[236:239], v[140:143]
    s_add_u32 s0, s0, s54
    s_xor_b32 s60, s60, 8192
    v_mfma_f32_16x16x32_bf16 v[136:139], a[136:139], a[236:239], v[136:139]
    buffer_load_dwordx4 a[164:167], v1, s[4:7], s44 offen offset:1024 sc1
    v_mfma_f32_16x16x32_bf16 v[136:139], a[120:123], a[232:235], v[136:139]
    v_mfma_f32_16x16x32_bf16 v[132:135], a[116:119], a[232:235], v[132:135]
    ds_read_b64_tr_b16 a[252:253], v11 offset:21504
    ds_read_b64_tr_b16 a[254:255], v11 offset:25088
    v_mfma_f32_16x16x32_bf16 v[132:135], a[132:135], a[236:239], v[132:135]
    v_mfma_f32_16x16x32_bf16 v[128:131], a[128:131], a[236:239], v[128:131]
    v_mfma_f32_16x16x32_bf16 v[128:131], a[112:115], a[232:235], v[128:131]
    s_waitcnt lgkmcnt(4)
    v_mfma_f32_16x16x32_bf16 v[144:147], a[240:243], a[112:115], v[144:147]
    ds_read_b64_tr_b16 a[232:233], v11 offset:32
    ds_read_b64_tr_b16 a[234:235], v11 offset:3616
    v_mfma_f32_16x16x32_bf16 v[144:147], a[244:247], a[128:131], v[144:147]
    v_mfma_f32_16x16x32_bf16 v[148:151], a[244:247], a[132:135], v[148:151]
    buffer_load_dwordx4 a[168:171], v1, s[4:7], s44 offen offset:2048 sc1
    v_mfma_f32_16x16x32_bf16 v[148:151], a[240:243], a[116:119], v[148:151]
    v_mfma_f32_16x16x32_bf16 v[152:155], a[240:243], a[120:123], v[152:155]
    ds_read_b64_tr_b16 a[236:237], v11 offset:7200
    ds_read_b64_tr_b16 a[238:239], v11 offset:10784
    v_mfma_f32_16x16x32_bf16 v[152:155], a[244:247], a[136:139], v[152:155]
    v_mfma_f32_16x16x32_bf16 v[156:159], a[244:247], a[140:143], v[156:159]
    buffer_load_dwordx4 a[172:175], v1, s[4:7], s44 offen offset:3072 sc1
    v_mfma_f32_16x16x32_bf16 v[156:159], a[240:243], a[124:127], v[156:159]
    s_waitcnt lgkmcnt(4)
    v_mfma_f32_16x16x32_bf16 a[12:15], a[248:251], a[124:127], a[12:15]
    s_add_u32 s45, s45, 458752
    ds_read_b64_tr_b16 a[240:241], v11 offset:14368
    ds_read_b64_tr_b16 a[242:243], v11 offset:17952
    v_mfma_f32_16x16x32_bf16 a[12:15], a[252:255], a[140:143], a[12:15]
    s_add_u32 m0, s47, 73728
    v_mfma_f32_16x16x32_bf16 a[8:11], a[252:255], a[136:139], a[8:11]
    buffer_load_dwordx4 v2, s[8:11], s45 offen offset:0  lds
    v_mfma_f32_16x16x32_bf16 a[8:11], a[248:251], a[120:123], a[8:11]
    v_mfma_f32_16x16x32_bf16 a[4:7], a[248:251], a[116:119], a[4:7]
    ds_read_b64_tr_b16 a[244:245], v11 offset:21536
    ds_read_b64_tr_b16 a[246:247], v11 offset:25120
    v_mfma_f32_16x16x32_bf16 a[4:7], a[252:255], a[132:135], a[4:7]
    v_mfma_f32_16x16x32_bf16 a[0:3], a[252:255], a[128:131], a[0:3]
    v_mfma_f32_16x16x32_bf16 a[0:3], a[248:251], a[112:115], a[0:3]
    s_waitcnt lgkmcnt(4)
    v_mfma_f32_16x16x32_bf16 v[160:163], a[232:235], a[112:115], v[160:163]
    ds_read_b64_tr_b16 a[248:249], v11 offset:64
    ds_read_b64_tr_b16 a[250:251], v11 offset:3648
    v_mfma_f32_16x16x32_bf16 v[160:163], a[236:239], a[128:131], v[160:163]
    v_mfma_f32_16x16x32_bf16 v[164:167], a[236:239], a[132:135], v[164:167]
    buffer_load_dwordx4 v3, s[8:11], s45 offen offset:1024  lds
    v_mfma_f32_16x16x32_bf16 v[164:167], a[232:235], a[116:119], v[164:167]
    v_mfma_f32_16x16x32_bf16 v[168:171], a[232:235], a[120:123], v[168:171]
    ds_read_b64_tr_b16 a[252:253], v11 offset:7232
    ds_read_b64_tr_b16 a[254:255], v11 offset:10816
    v_mfma_f32_16x16x32_bf16 v[168:171], a[236:239], a[136:139], v[168:171]
    v_mfma_f32_16x16x32_bf16 v[172:175], a[236:239], a[140:143], v[172:175]
    v_mfma_f32_16x16x32_bf16 v[172:175], a[232:235], a[124:127], v[172:175]
    s_waitcnt lgkmcnt(4)
    v_mfma_f32_16x16x32_bf16 a[28:31], a[240:243], a[124:127], a[28:31]
    ds_read_b64_tr_b16 a[232:233], v11 offset:14400
    ds_read_b64_tr_b16 a[234:235], v11 offset:17984
    v_mfma_f32_16x16x32_bf16 a[28:31], a[244:247], a[140:143], a[28:31]
    v_mfma_f32_16x16x32_bf16 a[24:27], a[244:247], a[136:139], a[24:27]
    buffer_load_dwordx4 v4, s[8:11], s45 offen offset:2048  lds
    v_mfma_f32_16x16x32_bf16 a[24:27], a[240:243], a[120:123], a[24:27]
    v_mfma_f32_16x16x32_bf16 a[20:23], a[240:243], a[116:119], a[20:23]
    ds_read_b64_tr_b16 a[236:237], v11 offset:21568
    ds_read_b64_tr_b16 a[238:239], v11 offset:25152
    v_mfma_f32_16x16x32_bf16 a[20:23], a[244:247], a[132:135], a[20:23]
    v_mfma_f32_16x16x32_bf16 a[16:19], a[244:247], a[128:131], a[16:19]
    buffer_load_dwordx4 v5, s[8:11], s45 offen offset:3072  lds
    v_mfma_f32_16x16x32_bf16 a[16:19], a[240:243], a[112:115], a[16:19]
    s_waitcnt lgkmcnt(4)
    v_mfma_f32_16x16x32_bf16 v[176:179], a[248:251], a[112:115], v[176:179]
    s_add_u32 s46, s46, 128
    ds_read_b64_tr_b16 a[240:241], v11 offset:96
    ds_read_b64_tr_b16 a[242:243], v11 offset:3680
    v_mfma_f32_16x16x32_bf16 v[176:179], a[252:255], a[128:131], v[176:179]
    s_add_u32 m0, s48, 73728
    v_mfma_f32_16x16x32_bf16 v[180:183], a[252:255], a[132:135], v[180:183]
    buffer_load_dwordx4 v9, s[12:15], s46 offen offset:0  lds
    v_mfma_f32_16x16x32_bf16 v[180:183], a[248:251], a[116:119], v[180:183]
    v_mfma_f32_16x16x32_bf16 v[184:187], a[248:251], a[120:123], v[184:187]
    ds_read_b64_tr_b16 a[244:245], v11 offset:7264
    ds_read_b64_tr_b16 a[246:247], v11 offset:10848
    v_mfma_f32_16x16x32_bf16 v[184:187], a[252:255], a[136:139], v[184:187]
    v_mfma_f32_16x16x32_bf16 v[188:191], a[252:255], a[140:143], v[188:191]
    v_mfma_f32_16x16x32_bf16 v[188:191], a[248:251], a[124:127], v[188:191]
    s_waitcnt lgkmcnt(4)
    v_mfma_f32_16x16x32_bf16 a[44:47], a[232:235], a[124:127], a[44:47]
    ds_read_b64_tr_b16 a[248:249], v11 offset:14432
    ds_read_b64_tr_b16 a[250:251], v11 offset:18016
    v_mfma_f32_16x16x32_bf16 a[44:47], a[236:239], a[140:143], a[44:47]
    v_mfma_f32_16x16x32_bf16 a[40:43], a[236:239], a[136:139], a[40:43]
    buffer_load_dwordx4 v10, s[12:15], s46 offen offset:1024  lds
    v_mfma_f32_16x16x32_bf16 a[40:43], a[232:235], a[120:123], a[40:43]
    v_mfma_f32_16x16x32_bf16 a[36:39], a[232:235], a[116:119], a[36:39]
    ds_read_b64_tr_b16 a[252:253], v11 offset:21600
    ds_read_b64_tr_b16 a[254:255], v11 offset:25184
    v_mfma_f32_16x16x32_bf16 a[36:39], a[236:239], a[132:135], a[36:39]
    s_add_u32 m0, s47, 77824
    v_mfma_f32_16x16x32_bf16 a[32:35], a[236:239], a[128:131], a[32:35]
    buffer_load_dwordx4 v6, s[8:11], s45 offen offset:0  lds
    v_mfma_f32_16x16x32_bf16 a[32:35], a[232:235], a[112:115], a[32:35]
    s_waitcnt lgkmcnt(4)
    v_mfma_f32_16x16x32_bf16 v[192:195], a[240:243], a[112:115], v[192:195]
    ds_read_b64_tr_b16 a[232:233], v11 offset:128
    ds_read_b64_tr_b16 a[234:235], v11 offset:3712
    v_mfma_f32_16x16x32_bf16 v[192:195], a[244:247], a[128:131], v[192:195]
    v_mfma_f32_16x16x32_bf16 v[196:199], a[244:247], a[132:135], v[196:199]
    buffer_load_dwordx4 v7, s[8:11], s45 offen offset:1024  lds
    v_mfma_f32_16x16x32_bf16 v[196:199], a[240:243], a[116:119], v[196:199]
    v_mfma_f32_16x16x32_bf16 v[200:203], a[240:243], a[120:123], v[200:203]
    ds_read_b64_tr_b16 a[236:237], v11 offset:7296
    ds_read_b64_tr_b16 a[238:239], v11 offset:10880
    v_mfma_f32_16x16x32_bf16 v[200:203], a[244:247], a[136:139], v[200:203]
    v_mfma_f32_16x16x32_bf16 v[204:207], a[244:247], a[140:143], v[204:207]
    v_mfma_f32_16x16x32_bf16 v[204:207], a[240:243], a[124:127], v[204:207]
    s_waitcnt lgkmcnt(4)
    v_mfma_f32_16x16x32_bf16 a[60:63], a[248:251], a[124:127], a[60:63]
    ds_read_b64_tr_b16 a[240:241], v11 offset:14464
    ds_read_b64_tr_b16 a[242:243], v11 offset:18048
    v_mfma_f32_16x16x32_bf16 a[60:63], a[252:255], a[140:143], a[60:63]
    v_mfma_f32_16x16x32_bf16 a[56:59], a[252:255], a[136:139], a[56:59]
    buffer_load_dwordx4 v8, s[8:11], s45 offen offset:2048  lds
    v_mfma_f32_16x16x32_bf16 a[56:59], a[248:251], a[120:123], a[56:59]
    v_mfma_f32_16x16x32_bf16 a[52:55], a[248:251], a[116:119], a[52:55]
    ds_read_b64_tr_b16 a[244:245], v11 offset:21632
    ds_read_b64_tr_b16 a[246:247], v11 offset:25216
    v_mfma_f32_16x16x32_bf16 a[52:55], a[252:255], a[132:135], a[52:55]
    v_mfma_f32_16x16x32_bf16 a[48:51], a[252:255], a[128:131], a[48:51]
    v_mfma_f32_16x16x32_bf16 a[48:51], a[248:251], a[112:115], a[48:51]
    s_waitcnt lgkmcnt(4)
    v_mfma_f32_16x16x32_bf16 v[208:211], a[232:235], a[112:115], v[208:211]
    s_add_u32 s3, s3, 917504
    v_and_b32 v12, 15, v0
    v_min_u32 v12, 13, v12
    v_lshlrev_b32 v12, 7, v12
    ds_read_b64_tr_b16 a[248:249], v11 offset:160
    ds_read_b64_tr_b16 a[250:251], v11 offset:3744
    v_mfma_f32_16x16x32_bf16 v[208:211], a[236:239], a[128:131], v[208:211]
    buffer_load_dword a216, v12, s[8:11], s3 offen offset:0
    v_mfma_f32_16x16x32_bf16 v[212:215], a[236:239], a[132:135], v[212:215]
    s_add_u32 s3, s3, 917504
    v_mfma_f32_16x16x32_bf16 v[212:215], a[232:235], a[116:119], v[212:215]
    buffer_load_dword a216, v12, s[8:11], s3 offen offset:0
    v_mfma_f32_16x16x32_bf16 v[216:219], a[232:235], a[120:123], v[216:219]
    ds_read_b64_tr_b16 a[252:253], v11 offset:7328
    ds_read_b64_tr_b16 a[254:255], v11 offset:10912
    v_mfma_f32_16x16x32_bf16 v[216:219], a[236:239], a[136:139], v[216:219]
    v_mfma_f32_16x16x32_bf16 v[220:223], a[236:239], a[140:143], v[220:223]
    buffer_load_dword a216, v12, s[28:31], s76 offen offset:0
    v_mfma_f32_16x16x32_bf16 v[220:223], a[232:235], a[124:127], v[220:223]
    s_waitcnt lgkmcnt(4)
    v_mfma_f32_16x16x32_bf16 a[76:79], a[240:243], a[124:127], a[76:79]
    ds_read_b64_tr_b16 a[232:233], v11 offset:14496
    ds_read_b64_tr_b16 a[234:235], v11 offset:18080
    v_mfma_f32_16x16x32_bf16 a[76:79], a[244:247], a[140:143], a[76:79]
    v_mfma_f32_16x16x32_bf16 a[72:75], a[244:247], a[136:139], a[72:75]
    v_mfma_f32_16x16x32_bf16 a[72:75], a[240:243], a[120:123], a[72:75]
    v_mfma_f32_16x16x32_bf16 a[68:71], a[240:243], a[116:119], a[68:71]
    ds_read_b64_tr_b16 a[236:237], v11 offset:21664
    ds_read_b64_tr_b16 a[238:239], v11 offset:25248
    v_mfma_f32_16x16x32_bf16 a[68:71], a[244:247], a[132:135], a[68:71]
    v_mfma_f32_16x16x32_bf16 a[64:67], a[244:247], a[128:131], a[64:67]
    v_mfma_f32_16x16x32_bf16 a[64:67], a[240:243], a[112:115], a[64:67]
    s_waitcnt lgkmcnt(4)
    v_mfma_f32_16x16x32_bf16 v[224:227], a[248:251], a[112:115], v[224:227]
    ds_read_b64_tr_b16 a[240:241], v11 offset:192
    ds_read_b64_tr_b16 a[242:243], v11 offset:3776
    v_mfma_f32_16x16x32_bf16 v[224:227], a[252:255], a[128:131], v[224:227]
    v_mfma_f32_16x16x32_bf16 v[228:231], a[252:255], a[132:135], v[228:231]
    v_mfma_f32_16x16x32_bf16 v[228:231], a[248:251], a[116:119], v[228:231]
    v_mfma_f32_16x16x32_bf16 v[232:235], a[248:251], a[120:123], v[232:235]
    ds_read_b64_tr_b16 a[244:245], v11 offset:7360
    ds_read_b64_tr_b16 a[246:247], v11 offset:10944
    v_mfma_f32_16x16x32_bf16 v[232:235], a[252:255], a[136:139], v[232:235]
    v_mfma_f32_16x16x32_bf16 v[236:239], a[252:255], a[140:143], v[236:239]
    v_mfma_f32_16x16x32_bf16 v[236:239], a[248:251], a[124:127], v[236:239]
    s_waitcnt lgkmcnt(4)
    v_mfma_f32_16x16x32_bf16 a[92:95], a[232:235], a[124:127], a[92:95]
    ds_read_b64_tr_b16 a[248:249], v11 offset:14528
    ds_read_b64_tr_b16 a[250:251], v11 offset:18112
    v_mfma_f32_16x16x32_bf16 a[92:95], a[236:239], a[140:143], a[92:95]
    v_mfma_f32_16x16x32_bf16 a[88:91], a[236:239], a[136:139], a[88:91]
    v_mfma_f32_16x16x32_bf16 a[88:91], a[232:235], a[120:123], a[88:91]
    v_mfma_f32_16x16x32_bf16 a[84:87], a[232:235], a[116:119], a[84:87]
    ds_read_b64_tr_b16 a[252:253], v11 offset:21696
    ds_read_b64_tr_b16 a[254:255], v11 offset:25280
    v_mfma_f32_16x16x32_bf16 a[84:87], a[236:239], a[132:135], a[84:87]
    v_mfma_f32_16x16x32_bf16 a[80:83], a[236:239], a[128:131], a[80:83]
    v_mfma_f32_16x16x32_bf16 a[80:83], a[232:235], a[112:115], a[80:83]
    s_waitcnt vmcnt(20) lgkmcnt(4)
    v_mfma_f32_16x16x32_bf16 v[240:243], a[240:243], a[112:115], v[240:243]
    s_barrier
    ds_read_b128 a[232:235], v13 offset:36864
    v_mfma_f32_16x16x32_bf16 v[240:243], a[244:247], a[128:131], v[240:243]
    v_mfma_f32_16x16x32_bf16 v[244:247], a[244:247], a[132:135], v[244:247]
    v_mfma_f32_16x16x32_bf16 v[244:247], a[240:243], a[116:119], v[244:247]
    v_mfma_f32_16x16x32_bf16 v[248:251], a[240:243], a[120:123], v[248:251]
    ds_read_b128 a[236:239], v14 offset:36864
    v_mfma_f32_16x16x32_bf16 v[248:251], a[244:247], a[136:139], v[248:251]
    v_mfma_f32_16x16x32_bf16 v[252:255], a[244:247], a[140:143], v[252:255]
    v_mfma_f32_16x16x32_bf16 v[252:255], a[240:243], a[124:127], v[252:255]
    s_waitcnt lgkmcnt(2)
    v_mfma_f32_16x16x32_bf16 a[108:111], a[248:251], a[124:127], a[108:111]
    ds_read_b128 a[240:243], v13 offset:40960
    v_mfma_f32_16x16x32_bf16 a[108:111], a[252:255], a[140:143], a[108:111]
    v_mfma_f32_16x16x32_bf16 a[104:107], a[252:255], a[136:139], a[104:107]
    v_mfma_f32_16x16x32_bf16 a[104:107], a[248:251], a[120:123], a[104:107]
    v_mfma_f32_16x16x32_bf16 a[100:103], a[248:251], a[116:119], a[100:103]
    ds_read_b128 a[244:247], v14 offset:40960
    v_mfma_f32_16x16x32_bf16 a[100:103], a[252:255], a[132:135], a[100:103]
    v_mfma_f32_16x16x32_bf16 a[96:99], a[252:255], a[128:131], a[96:99]
    v_mfma_f32_16x16x32_bf16 a[96:99], a[248:251], a[112:115], a[96:99]
    s_waitcnt vmcnt(12) lgkmcnt(2)
    v_mfma_f32_16x16x32_bf16 v[80:83], a[144:147], a[232:235], v[80:83]
    ds_read_b128 a[248:251], v13 offset:38912
    v_mfma_f32_16x16x32_bf16 v[80:83], a[160:163], a[236:239], v[80:83]
    v_mfma_f32_16x16x32_bf16 v[84:87], a[164:167], a[236:239], v[84:87]
    v_mfma_f32_16x16x32_bf16 v[84:87], a[148:151], a[232:235], v[84:87]
    v_mfma_f32_16x16x32_bf16 v[88:91], a[152:155], a[232:235], v[88:91]
    ds_read_b128 a[252:255], v14 offset:38912
    v_mfma_f32_16x16x32_bf16 v[88:91], a[168:171], a[236:239], v[88:91]
    v_mfma_f32_16x16x32_bf16 v[92:95], a[172:175], a[236:239], v[92:95]
    v_mfma_f32_16x16x32_bf16 v[92:95], a[156:159], a[232:235], v[92:95]
    s_waitcnt lgkmcnt(2)
    v_mfma_f32_16x16x32_bf16 v[108:111], a[156:159], a[240:243], v[108:111]
    ds_read_b128 a[232:235], v13 offset:43008
    v_mfma_f32_16x16x32_bf16 v[108:111], a[172:175], a[244:247], v[108:111]
    v_mfma_f32_16x16x32_bf16 v[104:107], a[168:171], a[244:247], v[104:107]
    v_mfma_f32_16x16x32_bf16 v[104:107], a[152:155], a[240:243], v[104:107]
    v_mfma_f32_16x16x32_bf16 v[100:103], a[148:151], a[240:243], v[100:103]
    ds_read_b128 a[236:239], v14 offset:43008
    v_mfma_f32_16x16x32_bf16 v[100:103], a[164:167], a[244:247], v[100:103]
    v_mfma_f32_16x16x32_bf16 v[96:99], a[160:163], a[244:247], v[96:99]
    v_mfma_f32_16x16x32_bf16 v[96:99], a[144:147], a[240:243], v[96:99]
    s_waitcnt lgkmcnt(2)
    v_mfma_f32_16x16x32_bf16 v[112:115], a[144:147], a[248:251], v[112:115]
    ds_read_b64_tr_b16 a[240:241], v11 offset:36864
    ds_read_b64_tr_b16 a[242:243], v11 offset:40448
    v_mfma_f32_16x16x32_bf16 v[112:115], a[160:163], a[252:255], v[112:115]
    v_mfma_f32_16x16x32_bf16 v[116:119], a[164:167], a[252:255], v[116:119]
    v_mfma_f32_16x16x32_bf16 v[116:119], a[148:151], a[248:251], v[116:119]
    v_mfma_f32_16x16x32_bf16 v[120:123], a[152:155], a[248:251], v[120:123]
    ds_read_b64_tr_b16 a[244:245], v11 offset:44032
    ds_read_b64_tr_b16 a[246:247], v11 offset:47616
    v_mfma_f32_16x16x32_bf16 v[120:123], a[168:171], a[252:255], v[120:123]
    v_mfma_f32_16x16x32_bf16 v[124:127], a[172:175], a[252:255], v[124:127]
    v_mfma_f32_16x16x32_bf16 v[124:127], a[156:159], a[248:251], v[124:127]
    s_waitcnt lgkmcnt(4)
    v_mfma_f32_16x16x32_bf16 v[140:143], a[156:159], a[232:235], v[140:143]
    ds_read_b64_tr_b16 a[248:249], v11 offset:51200
    ds_read_b64_tr_b16 a[250:251], v11 offset:54784
    v_mfma_f32_16x16x32_bf16 v[140:143], a[172:175], a[236:239], v[140:143]
    v_mfma_f32_16x16x32_bf16 v[136:139], a[168:171], a[236:239], v[136:139]
    v_mfma_f32_16x16x32_bf16 v[136:139], a[152:155], a[232:235], v[136:139]
    v_mfma_f32_16x16x32_bf16 v[132:135], a[148:151], a[232:235], v[132:135]
    ds_read_b64_tr_b16 a[252:253], v11 offset:58368
    ds_read_b64_tr_b16 a[254:255], v11 offset:61952
    v_mfma_f32_16x16x32_bf16 v[132:135], a[164:167], a[236:239], v[132:135]
    v_mfma_f32_16x16x32_bf16 v[128:131], a[160:163], a[236:239], v[128:131]
    v_mfma_f32_16x16x32_bf16 v[128:131], a[144:147], a[232:235], v[128:131]
    s_waitcnt lgkmcnt(4)
    v_mfma_f32_16x16x32_bf16 v[144:147], a[240:243], a[144:147], v[144:147]
    ds_read_b64_tr_b16 a[232:233], v11 offset:36896
    ds_read_b64_tr_b16 a[234:235], v11 offset:40480
    v_mfma_f32_16x16x32_bf16 v[144:147], a[244:247], a[160:163], v[144:147]
    v_mfma_f32_16x16x32_bf16 v[148:151], a[244:247], a[164:167], v[148:151]
    v_mfma_f32_16x16x32_bf16 v[148:151], a[240:243], a[148:151], v[148:151]
    v_mfma_f32_16x16x32_bf16 v[152:155], a[240:243], a[152:155], v[152:155]
    ds_read_b64_tr_b16 a[236:237], v11 offset:44064
    ds_read_b64_tr_b16 a[238:239], v11 offset:47648
    v_mfma_f32_16x16x32_bf16 v[152:155], a[244:247], a[168:171], v[152:155]
    v_mfma_f32_16x16x32_bf16 v[156:159], a[244:247], a[172:175], v[156:159]
    v_mfma_f32_16x16x32_bf16 v[156:159], a[240:243], a[156:159], v[156:159]
    s_waitcnt lgkmcnt(4)
    v_mfma_f32_16x16x32_bf16 a[12:15], a[248:251], a[156:159], a[12:15]
    ds_read_b64_tr_b16 a[240:241], v11 offset:51232
    ds_read_b64_tr_b16 a[242:243], v11 offset:54816
    v_mfma_f32_16x16x32_bf16 a[12:15], a[252:255], a[172:175], a[12:15]
    s_xor_b32 s44, s44, 28672
    v_mfma_f32_16x16x32_bf16 a[8:11], a[252:255], a[168:171], a[8:11]
    buffer_load_dwordx4 a[112:115], v1, s[4:7], s44 offen offset:0 sc1
    v_mfma_f32_16x16x32_bf16 a[8:11], a[248:251], a[152:155], a[8:11]
    v_mfma_f32_16x16x32_bf16 a[4:7], a[248:251], a[148:151], a[4:7]
    ds_read_b64_tr_b16 a[244:245], v11 offset:58400
    ds_read_b64_tr_b16 a[246:247], v11 offset:61984
    v_mfma_f32_16x16x32_bf16 a[4:7], a[252:255], a[164:167], a[4:7]
    v_mfma_f32_16x16x32_bf16 a[0:3], a[252:255], a[160:163], a[0:3]
    buffer_load_dwordx4 a[116:119], v1, s[4:7], s44 offen offset:1024 sc1
    v_mfma_f32_16x16x32_bf16 a[0:3], a[248:251], a[144:147], a[0:3]
    s_waitcnt lgkmcnt(4)
    v_mfma_f32_16x16x32_bf16 v[160:163], a[232:235], a[144:147], v[160:163]
    ds_read_b64_tr_b16 a[248:249], v11 offset:36928
    ds_read_b64_tr_b16 a[250:251], v11 offset:40512
    v_mfma_f32_16x16x32_bf16 v[160:163], a[236:239], a[160:163], v[160:163]
    v_mfma_f32_16x16x32_bf16 v[164:167], a[236:239], a[164:167], v[164:167]
    buffer_load_dwordx4 a[120:123], v1, s[4:7], s44 offen offset:2048 sc1
    v_mfma_f32_16x16x32_bf16 v[164:167], a[232:235], a[148:151], v[164:167]
    v_mfma_f32_16x16x32_bf16 v[168:171], a[232:235], a[152:155], v[168:171]
    ds_read_b64_tr_b16 a[252:253], v11 offset:44096
    ds_read_b64_tr_b16 a[254:255], v11 offset:47680
    v_mfma_f32_16x16x32_bf16 v[168:171], a[236:239], a[168:171], v[168:171]
    v_mfma_f32_16x16x32_bf16 v[172:175], a[236:239], a[172:175], v[172:175]
    buffer_load_dwordx4 a[124:127], v1, s[4:7], s44 offen offset:3072 sc1
    v_mfma_f32_16x16x32_bf16 v[172:175], a[232:235], a[156:159], v[172:175]
    s_waitcnt lgkmcnt(4)
    v_mfma_f32_16x16x32_bf16 a[28:31], a[240:243], a[156:159], a[28:31]
    ds_read_b64_tr_b16 a[232:233], v11 offset:51264
    ds_read_b64_tr_b16 a[234:235], v11 offset:54848
    v_mfma_f32_16x16x32_bf16 a[28:31], a[244:247], a[172:175], a[28:31]
    s_xor_b32 s44, s44, 4096
    v_mfma_f32_16x16x32_bf16 a[24:27], a[244:247], a[168:171], a[24:27]
    buffer_load_dwordx4 a[128:131], v1, s[4:7], s44 offen offset:0 sc1
    v_mfma_f32_16x16x32_bf16 a[24:27], a[240:243], a[152:155], a[24:27]
    v_mfma_f32_16x16x32_bf16 a[20:23], a[240:243], a[148:151], a[20:23]
    ds_read_b64_tr_b16 a[236:237], v11 offset:58432
    ds_read_b64_tr_b16 a[238:239], v11 offset:62016
    v_mfma_f32_16x16x32_bf16 a[20:23], a[244:247], a[164:167], a[20:23]
    v_mfma_f32_16x16x32_bf16 a[16:19], a[244:247], a[160:163], a[16:19]
    v_mfma_f32_16x16x32_bf16 a[16:19], a[240:243], a[144:147], a[16:19]
    s_waitcnt lgkmcnt(4)
    v_mfma_f32_16x16x32_bf16 v[176:179], a[248:251], a[144:147], v[176:179]
    ds_read_b64_tr_b16 a[240:241], v11 offset:36960
    ds_read_b64_tr_b16 a[242:243], v11 offset:40544
    v_mfma_f32_16x16x32_bf16 v[176:179], a[252:255], a[160:163], v[176:179]
    v_mfma_f32_16x16x32_bf16 v[180:183], a[252:255], a[164:167], v[180:183]
    buffer_load_dwordx4 a[132:135], v1, s[4:7], s44 offen offset:1024 sc1
    v_mfma_f32_16x16x32_bf16 v[180:183], a[248:251], a[148:151], v[180:183]
    v_mfma_f32_16x16x32_bf16 v[184:187], a[248:251], a[152:155], v[184:187]
    ds_read_b64_tr_b16 a[244:245], v11 offset:44128
    ds_read_b64_tr_b16 a[246:247], v11 offset:47712
    v_mfma_f32_16x16x32_bf16 v[184:187], a[252:255], a[168:171], v[184:187]
    v_mfma_f32_16x16x32_bf16 v[188:191], a[252:255], a[172:175], v[188:191]
    buffer_load_dwordx4 a[136:139], v1, s[4:7], s44 offen offset:2048 sc1
    v_mfma_f32_16x16x32_bf16 v[188:191], a[248:251], a[156:159], v[188:191]
    s_waitcnt lgkmcnt(4)
    v_mfma_f32_16x16x32_bf16 a[44:47], a[232:235], a[156:159], a[44:47]
    ds_read_b64_tr_b16 a[248:249], v11 offset:51296
    ds_read_b64_tr_b16 a[250:251], v11 offset:54880
    v_mfma_f32_16x16x32_bf16 a[44:47], a[236:239], a[172:175], a[44:47]
    v_mfma_f32_16x16x32_bf16 a[40:43], a[236:239], a[168:171], a[40:43]
    buffer_load_dwordx4 a[140:143], v1, s[4:7], s44 offen offset:3072 sc1
    v_mfma_f32_16x16x32_bf16 a[40:43], a[232:235], a[152:155], a[40:43]
    v_mfma_f32_16x16x32_bf16 a[36:39], a[232:235], a[148:151], a[36:39]
    ds_read_b64_tr_b16 a[252:253], v11 offset:58464
    ds_read_b64_tr_b16 a[254:255], v11 offset:62048
    v_mfma_f32_16x16x32_bf16 a[36:39], a[236:239], a[164:167], a[36:39]
    v_mfma_f32_16x16x32_bf16 a[32:35], a[236:239], a[160:163], a[32:35]
    global_load_dword a216, v73, s[74:75]
    v_mfma_f32_16x16x32_bf16 a[32:35], a[232:235], a[144:147], a[32:35]
    s_waitcnt lgkmcnt(4)
    v_mfma_f32_16x16x32_bf16 v[192:195], a[240:243], a[144:147], v[192:195]
    s_add_u32 s45, s45, 458752
    ds_read_b64_tr_b16 a[232:233], v11 offset:36992
    ds_read_b64_tr_b16 a[234:235], v11 offset:40576
    v_mfma_f32_16x16x32_bf16 v[192:195], a[244:247], a[160:163], v[192:195]
    s_add_u32 m0, s47, 110592
    v_mfma_f32_16x16x32_bf16 v[196:199], a[244:247], a[164:167], v[196:199]
    buffer_load_dwordx4 v2, s[8:11], s45 offen offset:0  lds
    v_mfma_f32_16x16x32_bf16 v[196:199], a[240:243], a[148:151], v[196:199]
    v_mfma_f32_16x16x32_bf16 v[200:203], a[240:243], a[152:155], v[200:203]
    ds_read_b64_tr_b16 a[236:237], v11 offset:44160
    ds_read_b64_tr_b16 a[238:239], v11 offset:47744
    v_mfma_f32_16x16x32_bf16 v[200:203], a[244:247], a[168:171], v[200:203]
    v_mfma_f32_16x16x32_bf16 v[204:207], a[244:247], a[172:175], v[204:207]
    v_mfma_f32_16x16x32_bf16 v[204:207], a[240:243], a[156:159], v[204:207]
    s_waitcnt lgkmcnt(4)
    v_mfma_f32_16x16x32_bf16 a[60:63], a[248:251], a[156:159], a[60:63]
    ds_read_b64_tr_b16 a[240:241], v11 offset:51328
    ds_read_b64_tr_b16 a[242:243], v11 offset:54912
    v_mfma_f32_16x16x32_bf16 a[60:63], a[252:255], a[172:175], a[60:63]
    v_mfma_f32_16x16x32_bf16 a[56:59], a[252:255], a[168:171], a[56:59]
    buffer_load_dwordx4 v3, s[8:11], s45 offen offset:1024  lds
    v_mfma_f32_16x16x32_bf16 a[56:59], a[248:251], a[152:155], a[56:59]
    v_mfma_f32_16x16x32_bf16 a[52:55], a[248:251], a[148:151], a[52:55]
    ds_read_b64_tr_b16 a[244:245], v11 offset:58496
    ds_read_b64_tr_b16 a[246:247], v11 offset:62080
    v_mfma_f32_16x16x32_bf16 a[52:55], a[252:255], a[164:167], a[52:55]
    v_mfma_f32_16x16x32_bf16 a[48:51], a[252:255], a[160:163], a[48:51]
    buffer_load_dwordx4 v4, s[8:11], s45 offen offset:2048  lds
    v_mfma_f32_16x16x32_bf16 a[48:51], a[248:251], a[144:147], a[48:51]
    s_waitcnt lgkmcnt(4)
    v_mfma_f32_16x16x32_bf16 v[208:211], a[232:235], a[144:147], v[208:211]
    ds_read_b64_tr_b16 a[248:249], v11 offset:37024
    ds_read_b64_tr_b16 a[250:251], v11 offset:40608
    v_mfma_f32_16x16x32_bf16 v[208:211], a[236:239], a[160:163], v[208:211]
    v_mfma_f32_16x16x32_bf16 v[212:215], a[236:239], a[164:167], v[212:215]
    buffer_load_dwordx4 v5, s[8:11], s45 offen offset:3072  lds
    v_mfma_f32_16x16x32_bf16 v[212:215], a[232:235], a[148:151], v[212:215]
    v_mfma_f32_16x16x32_bf16 v[216:219], a[232:235], a[152:155], v[216:219]
    s_add_u32 s46, s46, 128
    ds_read_b64_tr_b16 a[252:253], v11 offset:44192
    ds_read_b64_tr_b16 a[254:255], v11 offset:47776
    v_mfma_f32_16x16x32_bf16 v[216:219], a[236:239], a[168:171], v[216:219]
    s_add_u32 m0, s48, 110592
    v_mfma_f32_16x16x32_bf16 v[220:223], a[236:239], a[172:175], v[220:223]
    buffer_load_dwordx4 v9, s[12:15], s46 offen offset:0  lds
    v_mfma_f32_16x16x32_bf16 v[220:223], a[232:235], a[156:159], v[220:223]
    s_waitcnt lgkmcnt(4)
    v_mfma_f32_16x16x32_bf16 a[76:79], a[240:243], a[156:159], a[76:79]
    ds_read_b64_tr_b16 a[232:233], v11 offset:51360
    ds_read_b64_tr_b16 a[234:235], v11 offset:54944
    v_mfma_f32_16x16x32_bf16 a[76:79], a[244:247], a[172:175], a[76:79]
    v_mfma_f32_16x16x32_bf16 a[72:75], a[244:247], a[168:171], a[72:75]
    buffer_load_dwordx4 v10, s[12:15], s46 offen offset:1024  lds
    v_mfma_f32_16x16x32_bf16 a[72:75], a[240:243], a[152:155], a[72:75]
    v_mfma_f32_16x16x32_bf16 a[68:71], a[240:243], a[148:151], a[68:71]
    ds_read_b64_tr_b16 a[236:237], v11 offset:58528
    ds_read_b64_tr_b16 a[238:239], v11 offset:62112
    v_mfma_f32_16x16x32_bf16 a[68:71], a[244:247], a[164:167], a[68:71]
    v_mfma_f32_16x16x32_bf16 a[64:67], a[244:247], a[160:163], a[64:67]
    v_mfma_f32_16x16x32_bf16 a[64:67], a[240:243], a[144:147], a[64:67]
    s_waitcnt lgkmcnt(4)
    v_mfma_f32_16x16x32_bf16 v[224:227], a[248:251], a[144:147], v[224:227]
    ds_read_b64_tr_b16 a[240:241], v11 offset:37056
    ds_read_b64_tr_b16 a[242:243], v11 offset:40640
    v_mfma_f32_16x16x32_bf16 v[224:227], a[252:255], a[160:163], v[224:227]
    s_add_u32 m0, s47, 114688
    s_mov_b32 s55, 0
    v_mfma_f32_16x16x32_bf16 v[228:231], a[252:255], a[164:167], v[228:231]
    buffer_load_dwordx4 v6, s[8:11], s45 offen offset:0  lds
    v_mfma_f32_16x16x32_bf16 v[228:231], a[248:251], a[148:151], v[228:231]
    v_mfma_f32_16x16x32_bf16 v[232:235], a[248:251], a[152:155], v[232:235]
    ds_read_b64_tr_b16 a[244:245], v11 offset:44224
    ds_read_b64_tr_b16 a[246:247], v11 offset:47808
    v_mfma_f32_16x16x32_bf16 v[232:235], a[252:255], a[168:171], v[232:235]
    v_mfma_f32_16x16x32_bf16 v[236:239], a[252:255], a[172:175], v[236:239]
    buffer_load_dwordx4 v7, s[8:11], s45 offen offset:1024  lds
    v_mfma_f32_16x16x32_bf16 v[236:239], a[248:251], a[156:159], v[236:239]
    s_waitcnt lgkmcnt(4)
    v_mfma_f32_16x16x32_bf16 a[92:95], a[232:235], a[156:159], a[92:95]
    s_load_dword s55, s[4:5], s60
    ds_read_b64_tr_b16 a[248:249], v11 offset:51392
    ds_read_b64_tr_b16 a[250:251], v11 offset:54976
    v_mfma_f32_16x16x32_bf16 a[92:95], a[236:239], a[172:175], a[92:95]
    v_mfma_f32_16x16x32_bf16 a[88:91], a[236:239], a[168:171], a[88:91]
    buffer_load_dwordx4 v8, s[8:11], s45 offen offset:2048  lds
    v_mfma_f32_16x16x32_bf16 a[88:91], a[232:235], a[152:155], a[88:91]
    v_mfma_f32_16x16x32_bf16 a[84:87], a[232:235], a[148:151], a[84:87]
    ds_read_b64_tr_b16 a[252:253], v11 offset:58560
    ds_read_b64_tr_b16 a[254:255], v11 offset:62144
    v_mfma_f32_16x16x32_bf16 a[84:87], a[236:239], a[164:167], a[84:87]
    v_mfma_f32_16x16x32_bf16 a[80:83], a[236:239], a[160:163], a[80:83]
    v_mfma_f32_16x16x32_bf16 a[80:83], a[232:235], a[144:147], a[80:83]
    s_waitcnt vmcnt(21) lgkmcnt(4)
    v_mfma_f32_16x16x32_bf16 v[240:243], a[240:243], a[144:147], v[240:243]
    s_barrier
    ds_read_b128 a[232:235], v15 offset:0
    v_mfma_f32_16x16x32_bf16 v[240:243], a[244:247], a[160:163], v[240:243]
    v_mfma_f32_16x16x32_bf16 v[244:247], a[244:247], a[164:167], v[244:247]
    v_mfma_f32_16x16x32_bf16 v[244:247], a[240:243], a[148:151], v[244:247]
    v_mfma_f32_16x16x32_bf16 v[248:251], a[240:243], a[152:155], v[248:251]
    ds_read_b128 a[236:239], v16 offset:0
    v_mfma_f32_16x16x32_bf16 v[248:251], a[244:247], a[168:171], v[248:251]
    v_mfma_f32_16x16x32_bf16 v[252:255], a[244:247], a[172:175], v[252:255]
    v_mfma_f32_16x16x32_bf16 v[252:255], a[240:243], a[156:159], v[252:255]
    s_waitcnt lgkmcnt(2)
    v_mfma_f32_16x16x32_bf16 a[108:111], a[248:251], a[156:159], a[108:111]
    s_sub_u32 s0, s0, s55
    ds_read_b128 a[240:243], v15 offset:4096
    v_mfma_f32_16x16x32_bf16 a[108:111], a[252:255], a[172:175], a[108:111]
    v_mfma_f32_16x16x32_bf16 a[104:107], a[252:255], a[168:171], a[104:107]
    v_mfma_f32_16x16x32_bf16 a[104:107], a[248:251], a[152:155], a[104:107]
    s_sub_u32 s0, s0, s55
    v_mfma_f32_16x16x32_bf16 a[100:103], a[248:251], a[148:151], a[100:103]
    ds_read_b128 a[244:247], v16 offset:4096
    v_mfma_f32_16x16x32_bf16 a[100:103], a[252:255], a[164:167], a[100:103]
    v_mfma_f32_16x16x32_bf16 a[96:99], a[252:255], a[160:163], a[96:99]
    s_sub_u32 s0, s0, s55
    v_mfma_f32_16x16x32_bf16 a[96:99], a[248:251], a[144:147], a[96:99]
    s_waitcnt vmcnt(10) lgkmcnt(2)
    v_mfma_f32_16x16x32_bf16 v[80:83], a[112:115], a[232:235], v[80:83]
    ds_read_b128 a[248:251], v15 offset:2048
    v_mfma_f32_16x16x32_bf16 v[80:83], a[128:131], a[236:239], v[80:83]
    s_xor_b32 s44, s44, 12288
    s_sub_u32 s0, s0, s55
    v_mfma_f32_16x16x32_bf16 v[84:87], a[132:135], a[236:239], v[84:87]
    buffer_load_dwordx4 a[144:147], v1, s[4:7], s44 offen offset:0 sc1
    v_mfma_f32_16x16x32_bf16 v[84:87], a[116:119], a[232:235], v[84:87]
    v_mfma_f32_16x16x32_bf16 v[88:91], a[120:123], a[232:235], v[88:91]
    s_sub_u32 s0, s0, s55
    ds_read_b128 a[252:255], v16 offset:2048
    v_mfma_f32_16x16x32_bf16 v[88:91], a[136:139], a[236:239], v[88:91]
    v_mfma_f32_16x16x32_bf16 v[92:95], a[140:143], a[236:239], v[92:95]
    buffer_load_dwordx4 a[148:151], v1, s[4:7], s44 offen offset:1024 sc1
    v_mfma_f32_16x16x32_bf16 v[92:95], a[124:127], a[232:235], v[92:95]
    s_waitcnt lgkmcnt(2)
    s_sub_u32 s0, s0, s55
    v_mfma_f32_16x16x32_bf16 v[108:111], a[124:127], a[240:243], v[108:111]
    ds_read_b128 a[232:235], v15 offset:6144
    v_mfma_f32_16x16x32_bf16 v[108:111], a[140:143], a[244:247], v[108:111]
    v_mfma_f32_16x16x32_bf16 v[104:107], a[136:139], a[244:247], v[104:107]
    s_sub_u32 s0, s0, s55
    buffer_load_dwordx4 a[152:155], v1, s[4:7], s44 offen offset:2048 sc1
    v_mfma_f32_16x16x32_bf16 v[104:107], a[120:123], a[240:243], v[104:107]
    v_mfma_f32_16x16x32_bf16 v[100:103], a[116:119], a[240:243], v[100:103]
    ds_read_b128 a[236:239], v16 offset:6144
    v_mfma_f32_16x16x32_bf16 v[100:103], a[132:135], a[244:247], v[100:103]
    s_sub_u32 s0, s0, s55
    v_mfma_f32_16x16x32_bf16 v[96:99], a[128:131], a[244:247], v[96:99]
    v_mfma_f32_16x16x32_bf16 v[96:99], a[112:115], a[240:243], v[96:99]
    s_waitcnt lgkmcnt(2)
    v_mfma_f32_16x16x32_bf16 v[112:115], a[112:115], a[248:251], v[112:115]
    s_sub_u32 s0, s0, s55
    ds_read_b64_tr_b16 a[240:241], v17 offset:0
    ds_read_b64_tr_b16 a[242:243], v17 offset:3584
    v_mfma_f32_16x16x32_bf16 v[112:115], a[128:131], a[252:255], v[112:115]
    v_mfma_f32_16x16x32_bf16 v[116:119], a[132:135], a[252:255], v[116:119]
    buffer_load_dwordx4 a[156:159], v1, s[4:7], s44 offen offset:3072 sc1
    v_mfma_f32_16x16x32_bf16 v[116:119], a[116:119], a[248:251], v[116:119]
    s_sub_u32 s0, s0, s55
    v_mfma_f32_16x16x32_bf16 v[120:123], a[120:123], a[248:251], v[120:123]
    ds_read_b64_tr_b16 a[244:245], v17 offset:7168
    ds_read_b64_tr_b16 a[246:247], v17 offset:10752
    v_mfma_f32_16x16x32_bf16 v[120:123], a[136:139], a[252:255], v[120:123]
    s_xor_b32 s44, s44, 4096
    v_mfma_f32_16x16x32_bf16 v[124:127], a[140:143], a[252:255], v[124:127]
    s_sub_u32 s0, s0, s55
    buffer_load_dwordx4 a[160:163], v1, s[4:7], s44 offen offset:0 sc1
    v_mfma_f32_16x16x32_bf16 v[124:127], a[124:127], a[248:251], v[124:127]
    s_waitcnt lgkmcnt(4)
    v_mfma_f32_16x16x32_bf16 v[140:143], a[124:127], a[232:235], v[140:143]
    ds_read_b64_tr_b16 a[248:249], v17 offset:14336
    ds_read_b64_tr_b16 a[250:251], v17 offset:17920
    v_mfma_f32_16x16x32_bf16 v[140:143], a[140:143], a[236:239], v[140:143]
    s_sub_u32 s0, s0, s55
    s_xor_b32 s60, s60, 8192
    s_lshr_b32 s60, s0, 31
    v_mfma_f32_16x16x32_bf16 v[136:139], a[136:139], a[236:239], v[136:139]
    s_lshl_b32 s60, s60, 5
    buffer_load_dwordx4 a[164:167], v1, s[4:7], s44 offen offset:1024 sc1
    v_mfma_f32_16x16x32_bf16 v[136:139], a[120:123], a[232:235], v[136:139]
    v_add_u32 v69, s60, v69
VOTED:
    v_mfma_f32_16x16x32_bf16 v[132:135], a[116:119], a[232:235], v[132:135]
    ds_read_b64_tr_b16 a[252:253], v17 offset:21504
    ds_read_b64_tr_b16 a[254:255], v17 offset:25088
    v_mfma_f32_16x16x32_bf16 v[132:135], a[132:135], a[236:239], v[132:135]
    v_mfma_f32_16x16x32_bf16 v[128:131], a[128:131], a[236:239], v[128:131]
    v_mfma_f32_16x16x32_bf16 v[128:131], a[112:115], a[232:235], v[128:131]
    s_waitcnt lgkmcnt(4)
    v_mfma_f32_16x16x32_bf16 v[144:147], a[240:243], a[112:115], v[144:147]
    ds_read_b64_tr_b16 a[232:233], v17 offset:32
    ds_read_b64_tr_b16 a[234:235], v17 offset:3616
    v_mfma_f32_16x16x32_bf16 v[144:147], a[244:247], a[128:131], v[144:147]
    v_mfma_f32_16x16x32_bf16 v[148:151], a[244:247], a[132:135], v[148:151]
    buffer_load_dwordx4 a[168:171], v1, s[4:7], s44 offen offset:2048 sc1
    v_mfma_f32_16x16x32_bf16 v[148:151], a[240:243], a[116:119], v[148:151]
    v_mfma_f32_16x16x32_bf16 v[152:155], a[240:243], a[120:123], v[152:155]
    ds_read_b64_tr_b16 a[236:237], v17 offset:7200
    ds_read_b64_tr_b16 a[238:239], v17 offset:10784
    v_mfma_f32_16x16x32_bf16 v[152:155], a[244:247], a[136:139], v[152:155]
    v_mfma_f32_16x16x32_bf16 v[156:159], a[244:247], a[140:143], v[156:159]
    buffer_load_dwordx4 a[172:175], v1, s[4:7], s44 offen offset:3072 sc1
    v_mfma_f32_16x16x32_bf16 v[156:159], a[240:243], a[124:127], v[156:159]
    s_waitcnt lgkmcnt(4)
    v_mfma_f32_16x16x32_bf16 a[12:15], a[248:251], a[124:127], a[12:15]
    s_add_u32 s45, s45, 458752
    ds_read_b64_tr_b16 a[240:241], v17 offset:14368
    ds_read_b64_tr_b16 a[242:243], v17 offset:17952
    v_mfma_f32_16x16x32_bf16 a[12:15], a[252:255], a[140:143], a[12:15]
    s_add_u32 m0, s47, 0
    v_mfma_f32_16x16x32_bf16 a[8:11], a[252:255], a[136:139], a[8:11]
    buffer_load_dwordx4 v2, s[8:11], s45 offen offset:0  lds
    v_mfma_f32_16x16x32_bf16 a[8:11], a[248:251], a[120:123], a[8:11]
    v_mfma_f32_16x16x32_bf16 a[4:7], a[248:251], a[116:119], a[4:7]
    ds_read_b64_tr_b16 a[244:245], v17 offset:21536
    ds_read_b64_tr_b16 a[246:247], v17 offset:25120
    v_mfma_f32_16x16x32_bf16 a[4:7], a[252:255], a[132:135], a[4:7]
    v_mfma_f32_16x16x32_bf16 a[0:3], a[252:255], a[128:131], a[0:3]
    v_mfma_f32_16x16x32_bf16 a[0:3], a[248:251], a[112:115], a[0:3]
    s_waitcnt lgkmcnt(4)
    v_mfma_f32_16x16x32_bf16 v[160:163], a[232:235], a[112:115], v[160:163]
    ds_read_b64_tr_b16 a[248:249], v17 offset:64
    ds_read_b64_tr_b16 a[250:251], v17 offset:3648
    v_mfma_f32_16x16x32_bf16 v[160:163], a[236:239], a[128:131], v[160:163]
    v_mfma_f32_16x16x32_bf16 v[164:167], a[236:239], a[132:135], v[164:167]
    buffer_load_dwordx4 v3, s[8:11], s45 offen offset:1024  lds
    v_mfma_f32_16x16x32_bf16 v[164:167], a[232:235], a[116:119], v[164:167]
    v_mfma_f32_16x16x32_bf16 v[168:171], a[232:235], a[120:123], v[168:171]
    ds_read_b64_tr_b16 a[252:253], v17 offset:7232
    ds_read_b64_tr_b16 a[254:255], v17 offset:10816
    v_mfma_f32_16x16x32_bf16 v[168:171], a[236:239], a[136:139], v[168:171]
    v_mfma_f32_16x16x32_bf16 v[172:175], a[236:239], a[140:143], v[172:175]
    v_mfma_f32_16x16x32_bf16 v[172:175], a[232:235], a[124:127], v[172:175]
    s_waitcnt lgkmcnt(4)
    v_mfma_f32_16x16x32_bf16 a[28:31], a[240:243], a[124:127], a[28:31]
    ds_read_b64_tr_b16 a[232:233], v17 offset:14400
    ds_read_b64_tr_b16 a[234:235], v17 offset:17984
    v_mfma_f32_16x16x32_bf16 a[28:31], a[244:247], a[140:143], a[28:31]
    v_mfma_f32_16x16x32_bf16 a[24:27], a[244:247], a[136:139], a[24:27]
    buffer_load_dwordx4 v4, s[8:11], s45 offen offset:2048  lds
    v_mfma_f32_16x16x32_bf16 a[24:27], a[240:243], a[120:123], a[24:27]
    v_mfma_f32_16x16x32_bf16 a[20:23], a[240:243], a[116:119], a[20:23]
    ds_read_b64_tr_b16 a[236:237], v17 offset:21568
    ds_read_b64_tr_b16 a[238:239], v17 offset:25152
    v_mfma_f32_16x16x32_bf16 a[20:23], a[244:247], a[132:135], a[20:23]
    v_mfma_f32_16x16x32_bf16 a[16:19], a[244:247], a[128:131], a[16:19]
    buffer_load_dwordx4 v5, s[8:11], s45 offen offset:3072  lds
    v_mfma_f32_16x16x32_bf16 a[16:19], a[240:243], a[112:115], a[16:19]
    s_waitcnt lgkmcnt(4)
    v_mfma_f32_16x16x32_bf16 v[176:179], a[248:251], a[112:115], v[176:179]
    s_add_u32 s46, s46, 128
    ds_read_b64_tr_b16 a[240:241], v17 offset:96
    ds_read_b64_tr_b16 a[242:243], v17 offset:3680
    v_mfma_f32_16x16x32_bf16 v[176:179], a[252:255], a[128:131], v[176:179]
    s_add_u32 m0, s48, 0
    v_mfma_f32_16x16x32_bf16 v[180:183], a[252:255], a[132:135], v[180:183]
    buffer_load_dwordx4 v9, s[12:15], s46 offen offset:0  lds
    v_mfma_f32_16x16x32_bf16 v[180:183], a[248:251], a[116:119], v[180:183]
    v_mfma_f32_16x16x32_bf16 v[184:187], a[248:251], a[120:123], v[184:187]
    ds_read_b64_tr_b16 a[244:245], v17 offset:7264
    ds_read_b64_tr_b16 a[246:247], v17 offset:10848
    v_mfma_f32_16x16x32_bf16 v[184:187], a[252:255], a[136:139], v[184:187]
    v_mfma_f32_16x16x32_bf16 v[188:191], a[252:255], a[140:143], v[188:191]
    v_mfma_f32_16x16x32_bf16 v[188:191], a[248:251], a[124:127], v[188:191]
    s_waitcnt lgkmcnt(4)
    v_mfma_f32_16x16x32_bf16 a[44:47], a[232:235], a[124:127], a[44:47]
    ds_read_b64_tr_b16 a[248:249], v17 offset:14432
    ds_read_b64_tr_b16 a[250:251], v17 offset:18016
    v_mfma_f32_16x16x32_bf16 a[44:47], a[236:239], a[140:143], a[44:47]
    v_mfma_f32_16x16x32_bf16 a[40:43], a[236:239], a[136:139], a[40:43]
    buffer_load_dwordx4 v10, s[12:15], s46 offen offset:1024  lds
    v_mfma_f32_16x16x32_bf16 a[40:43], a[232:235], a[120:123], a[40:43]
    v_mfma_f32_16x16x32_bf16 a[36:39], a[232:235], a[116:119], a[36:39]
    ds_read_b64_tr_b16 a[252:253], v17 offset:21600
    ds_read_b64_tr_b16 a[254:255], v17 offset:25184
    v_mfma_f32_16x16x32_bf16 a[36:39], a[236:239], a[132:135], a[36:39]
    s_add_u32 m0, s47, 4096
    v_mfma_f32_16x16x32_bf16 a[32:35], a[236:239], a[128:131], a[32:35]
    buffer_load_dwordx4 v6, s[8:11], s45 offen offset:0  lds
    v_mfma_f32_16x16x32_bf16 a[32:35], a[232:235], a[112:115], a[32:35]
    s_waitcnt lgkmcnt(4)
    v_mfma_f32_16x16x32_bf16 v[192:195], a[240:243], a[112:115], v[192:195]
    ds_read_b64_tr_b16 a[232:233], v17 offset:128
    ds_read_b64_tr_b16 a[234:235], v17 offset:3712
    v_mfma_f32_16x16x32_bf16 v[192:195], a[244:247], a[128:131], v[192:195]
    v_mfma_f32_16x16x32_bf16 v[196:199], a[244:247], a[132:135], v[196:199]
    buffer_load_dwordx4 v7, s[8:11], s45 offen offset:1024  lds
    v_mfma_f32_16x16x32_bf16 v[196:199], a[240:243], a[116:119], v[196:199]
    v_mfma_f32_16x16x32_bf16 v[200:203], a[240:243], a[120:123], v[200:203]
    ds_read_b64_tr_b16 a[236:237], v17 offset:7296
    ds_read_b64_tr_b16 a[238:239], v17 offset:10880
    v_mfma_f32_16x16x32_bf16 v[200:203], a[244:247], a[136:139], v[200:203]
    v_mfma_f32_16x16x32_bf16 v[204:207], a[244:247], a[140:143], v[204:207]
    v_mfma_f32_16x16x32_bf16 v[204:207], a[240:243], a[124:127], v[204:207]
    s_waitcnt lgkmcnt(4)
    v_mfma_f32_16x16x32_bf16 a[60:63], a[248:251], a[124:127], a[60:63]
    ds_read_b64_tr_b16 a[240:241], v17 offset:14464
    ds_read_b64_tr_b16 a[242:243], v17 offset:18048
    v_mfma_f32_16x16x32_bf16 a[60:63], a[252:255], a[140:143], a[60:63]
    v_mfma_f32_16x16x32_bf16 a[56:59], a[252:255], a[136:139], a[56:59]
    buffer_load_dwordx4 v8, s[8:11], s45 offen offset:2048  lds
    v_mfma_f32_16x16x32_bf16 a[56:59], a[248:251], a[120:123], a[56:59]
    v_mfma_f32_16x16x32_bf16 a[52:55], a[248:251], a[116:119], a[52:55]
    ds_read_b64_tr_b16 a[244:245], v17 offset:21632
    ds_read_b64_tr_b16 a[246:247], v17 offset:25216
    v_mfma_f32_16x16x32_bf16 a[52:55], a[252:255], a[132:135], a[52:55]
    v_mfma_f32_16x16x32_bf16 a[48:51], a[252:255], a[128:131], a[48:51]
    v_mfma_f32_16x16x32_bf16 a[48:51], a[248:251], a[112:115], a[48:51]
    s_waitcnt lgkmcnt(4)
    v_mfma_f32_16x16x32_bf16 v[208:211], a[232:235], a[112:115], v[208:211]
    s_add_u32 s3, s3, 917504
    ds_read_b64_tr_b16 a[248:249], v17 offset:160
    ds_read_b64_tr_b16 a[250:251], v17 offset:3744
    v_mfma_f32_16x16x32_bf16 v[208:211], a[236:239], a[128:131], v[208:211]
    buffer_load_dword a216, v12, s[8:11], s3 offen offset:0
    v_mfma_f32_16x16x32_bf16 v[212:215], a[236:239], a[132:135], v[212:215]
    s_add_u32 s76, s76, 1835008
    v_mfma_f32_16x16x32_bf16 v[212:215], a[232:235], a[116:119], v[212:215]
    buffer_load_dword a216, v12, s[28:31], s76 offen offset:0
    v_mfma_f32_16x16x32_bf16 v[216:219], a[232:235], a[120:123], v[216:219]
    ds_read_b64_tr_b16 a[252:253], v17 offset:7328
    ds_read_b64_tr_b16 a[254:255], v17 offset:10912
    v_mfma_f32_16x16x32_bf16 v[216:219], a[236:239], a[136:139], v[216:219]
    s_add_u32 s76, s76, 1835008
    v_mfma_f32_16x16x32_bf16 v[220:223], a[236:239], a[140:143], v[220:223]
    buffer_load_dword a216, v12, s[28:31], s76 offen offset:0
    v_mfma_f32_16x16x32_bf16 v[220:223], a[232:235], a[124:127], v[220:223]
    s_waitcnt lgkmcnt(4)
    v_mfma_f32_16x16x32_bf16 a[76:79], a[240:243], a[124:127], a[76:79]
    ds_read_b64_tr_b16 a[232:233], v17 offset:14496
    ds_read_b64_tr_b16 a[234:235], v17 offset:18080
    v_mfma_f32_16x16x32_bf16 a[76:79], a[244:247], a[140:143], a[76:79]
    v_mfma_f32_16x16x32_bf16 a[72:75], a[244:247], a[136:139], a[72:75]
    v_mfma_f32_16x16x32_bf16 a[72:75], a[240:243], a[120:123], a[72:75]
    v_mfma_f32_16x16x32_bf16 a[68:71], a[240:243], a[116:119], a[68:71]
    ds_read_b64_tr_b16 a[236:237], v17 offset:21664
    ds_read_b64_tr_b16 a[238:239], v17 offset:25248
    v_mfma_f32_16x16x32_bf16 a[68:71], a[244:247], a[132:135], a[68:71]
    v_mfma_f32_16x16x32_bf16 a[64:67], a[244:247], a[128:131], a[64:67]
    v_mfma_f32_16x16x32_bf16 a[64:67], a[240:243], a[112:115], a[64:67]
    s_waitcnt lgkmcnt(4)
    v_mfma_f32_16x16x32_bf16 v[224:227], a[248:251], a[112:115], v[224:227]
    ds_read_b64_tr_b16 a[240:241], v17 offset:192
    ds_read_b64_tr_b16 a[242:243], v17 offset:3776
    v_mfma_f32_16x16x32_bf16 v[224:227], a[252:255], a[128:131], v[224:227]
    v_mfma_f32_16x16x32_bf16 v[228:231], a[252:255], a[132:135], v[228:231]
    v_mfma_f32_16x16x32_bf16 v[228:231], a[248:251], a[116:119], v[228:231]
    v_mfma_f32_16x16x32_bf16 v[232:235], a[248:251], a[120:123], v[232:235]
    ds_read_b64_tr_b16 a[244:245], v17 offset:7360
    ds_read_b64_tr_b16 a[246:247], v17 offset:10944
    v_mfma_f32_16x16x32_bf16 v[232:235], a[252:255], a[136:139], v[232:235]
    v_mfma_f32_16x16x32_bf16 v[236:239], a[252:255], a[140:143], v[236:239]
    v_mfma_f32_16x16x32_bf16 v[236:239], a[248:251], a[124:127], v[236:239]
    s_waitcnt lgkmcnt(4)
    v_mfma_f32_16x16x32_bf16 a[92:95], a[232:235], a[124:127], a[92:95]
    ds_read_b64_tr_b16 a[248:249], v17 offset:14528
    ds_read_b64_tr_b16 a[250:251], v17 offset:18112
    v_mfma_f32_16x16x32_bf16 a[92:95], a[236:239], a[140:143], a[92:95]
    v_mfma_f32_16x16x32_bf16 a[88:91], a[236:239], a[136:139], a[88:91]
    v_mfma_f32_16x16x32_bf16 a[88:91], a[232:235], a[120:123], a[88:91]
    v_mfma_f32_16x16x32_bf16 a[84:87], a[232:235], a[116:119], a[84:87]
    ds_read_b64_tr_b16 a[252:253], v17 offset:21696
    ds_read_b64_tr_b16 a[254:255], v17 offset:25280
    v_mfma_f32_16x16x32_bf16 a[84:87], a[236:239], a[132:135], a[84:87]
    v_mfma_f32_16x16x32_bf16 a[80:83], a[236:239], a[128:131], a[80:83]
    v_mfma_f32_16x16x32_bf16 a[80:83], a[232:235], a[112:115], a[80:83]
    s_waitcnt vmcnt(20) lgkmcnt(4)
    v_mfma_f32_16x16x32_bf16 v[240:243], a[240:243], a[112:115], v[240:243]
    s_barrier
    ds_read_b128 a[232:235], v15 offset:36864
    v_mfma_f32_16x16x32_bf16 v[240:243], a[244:247], a[128:131], v[240:243]
    v_mfma_f32_16x16x32_bf16 v[244:247], a[244:247], a[132:135], v[244:247]
    v_mfma_f32_16x16x32_bf16 v[244:247], a[240:243], a[116:119], v[244:247]
    v_mfma_f32_16x16x32_bf16 v[248:251], a[240:243], a[120:123], v[248:251]
    ds_read_b128 a[236:239], v16 offset:36864
    v_mfma_f32_16x16x32_bf16 v[248:251], a[244:247], a[136:139], v[248:251]
    v_mfma_f32_16x16x32_bf16 v[252:255], a[244:247], a[140:143], v[252:255]
    v_mfma_f32_16x16x32_bf16 v[252:255], a[240:243], a[124:127], v[252:255]
    s_waitcnt lgkmcnt(2)
    v_mfma_f32_16x16x32_bf16 a[108:111], a[248:251], a[124:127], a[108:111]
    ds_read_b128 a[240:243], v15 offset:40960
    v_mfma_f32_16x16x32_bf16 a[108:111], a[252:255], a[140:143], a[108:111]
    v_mfma_f32_16x16x32_bf16 a[104:107], a[252:255], a[136:139], a[104:107]
    v_mfma_f32_16x16x32_bf16 a[104:107], a[248:251], a[120:123], a[104:107]
    v_mfma_f32_16x16x32_bf16 a[100:103], a[248:251], a[116:119], a[100:103]
    ds_read_b128 a[244:247], v16 offset:40960
    v_mfma_f32_16x16x32_bf16 a[100:103], a[252:255], a[132:135], a[100:103]
    v_mfma_f32_16x16x32_bf16 a[96:99], a[252:255], a[128:131], a[96:99]
    v_mfma_f32_16x16x32_bf16 a[96:99], a[248:251], a[112:115], a[96:99]
    s_waitcnt vmcnt(12) lgkmcnt(2)
    v_mfma_f32_16x16x32_bf16 v[80:83], a[144:147], a[232:235], v[80:83]
    ds_read_b128 a[248:251], v15 offset:38912
    v_mfma_f32_16x16x32_bf16 v[80:83], a[160:163], a[236:239], v[80:83]
    v_mfma_f32_16x16x32_bf16 v[84:87], a[164:167], a[236:239], v[84:87]
    v_mfma_f32_16x16x32_bf16 v[84:87], a[148:151], a[232:235], v[84:87]
    v_mfma_f32_16x16x32_bf16 v[88:91], a[152:155], a[232:235], v[88:91]
    ds_read_b128 a[252:255], v16 offset:38912
    v_mfma_f32_16x16x32_bf16 v[88:91], a[168:171], a[236:239], v[88:91]
    v_mfma_f32_16x16x32_bf16 v[92:95], a[172:175], a[236:239], v[92:95]
    v_mfma_f32_16x16x32_bf16 v[92:95], a[156:159], a[232:235], v[92:95]
    s_waitcnt lgkmcnt(2)
    v_mfma_f32_16x16x32_bf16 v[108:111], a[156:159], a[240:243], v[108:111]
    ds_read_b128 a[232:235], v15 offset:43008
    v_mfma_f32_16x16x32_bf16 v[108:111], a[172:175], a[244:247], v[108:111]
    v_mfma_f32_16x16x32_bf16 v[104:107], a[168:171], a[244:247], v[104:107]
    v_mfma_f32_16x16x32_bf16 v[104:107], a[152:155], a[240:243], v[104:107]
    v_mfma_f32_16x16x32_bf16 v[100:103], a[148:151], a[240:243], v[100:103]
    ds_read_b128 a[236:239], v16 offset:43008
    v_mfma_f32_16x16x32_bf16 v[100:103], a[164:167], a[244:247], v[100:103]
    v_mfma_f32_16x16x32_bf16 v[96:99], a[160:163], a[244:247], v[96:99]
    v_mfma_f32_16x16x32_bf16 v[96:99], a[144:147], a[240:243], v[96:99]
    s_waitcnt lgkmcnt(2)
    v_mfma_f32_16x16x32_bf16 v[112:115], a[144:147], a[248:251], v[112:115]
    ds_read_b64_tr_b16 a[240:241], v17 offset:36864
    ds_read_b64_tr_b16 a[242:243], v17 offset:40448
    v_mfma_f32_16x16x32_bf16 v[112:115], a[160:163], a[252:255], v[112:115]
    v_mfma_f32_16x16x32_bf16 v[116:119], a[164:167], a[252:255], v[116:119]
    v_mfma_f32_16x16x32_bf16 v[116:119], a[148:151], a[248:251], v[116:119]
    v_mfma_f32_16x16x32_bf16 v[120:123], a[152:155], a[248:251], v[120:123]
    ds_read_b64_tr_b16 a[244:245], v17 offset:44032
    ds_read_b64_tr_b16 a[246:247], v17 offset:47616
    v_mfma_f32_16x16x32_bf16 v[120:123], a[168:171], a[252:255], v[120:123]
    v_mfma_f32_16x16x32_bf16 v[124:127], a[172:175], a[252:255], v[124:127]
    v_mfma_f32_16x16x32_bf16 v[124:127], a[156:159], a[248:251], v[124:127]
    s_waitcnt lgkmcnt(4)
    v_mfma_f32_16x16x32_bf16 v[140:143], a[156:159], a[232:235], v[140:143]
    ds_read_b64_tr_b16 a[248:249], v17 offset:51200
    ds_read_b64_tr_b16 a[250:251], v17 offset:54784
    v_mfma_f32_16x16x32_bf16 v[140:143], a[172:175], a[236:239], v[140:143]
    v_mfma_f32_16x16x32_bf16 v[136:139], a[168:171], a[236:239], v[136:139]
    v_mfma_f32_16x16x32_bf16 v[136:139], a[152:155], a[232:235], v[136:139]
    v_mfma_f32_16x16x32_bf16 v[132:135], a[148:151], a[232:235], v[132:135]
    ds_read_b64_tr_b16 a[252:253], v17 offset:58368
    ds_read_b64_tr_b16 a[254:255], v17 offset:61952
    v_mfma_f32_16x16x32_bf16 v[132:135], a[164:167], a[236:239], v[132:135]
    v_mfma_f32_16x16x32_bf16 v[128:131], a[160:163], a[236:239], v[128:131]
    v_mfma_f32_16x16x32_bf16 v[128:131], a[144:147], a[232:235], v[128:131]
    s_waitcnt lgkmcnt(4)
    v_mfma_f32_16x16x32_bf16 v[144:147], a[240:243], a[144:147], v[144:147]
    ds_read_b64_tr_b16 a[232:233], v17 offset:36896
    ds_read_b64_tr_b16 a[234:235], v17 offset:40480
    v_mfma_f32_16x16x32_bf16 v[144:147], a[244:247], a[160:163], v[144:147]
    v_mfma_f32_16x16x32_bf16 v[148:151], a[244:247], a[164:167], v[148:151]
    v_mfma_f32_16x16x32_bf16 v[148:151], a[240:243], a[148:151], v[148:151]
    v_mfma_f32_16x16x32_bf16 v[152:155], a[240:243], a[152:155], v[152:155]
    ds_read_b64_tr_b16 a[236:237], v17 offset:44064
    ds_read_b64_tr_b16 a[238:239], v17 offset:47648
    v_mfma_f32_16x16x32_bf16 v[152:155], a[244:247], a[168:171], v[152:155]
    v_mfma_f32_16x16x32_bf16 v[156:159], a[244:247], a[172:175], v[156:159]
    v_mfma_f32_16x16x32_bf16 v[156:159], a[240:243], a[156:159], v[156:159]
    s_waitcnt lgkmcnt(4)
    v_mfma_f32_16x16x32_bf16 a[12:15], a[248:251], a[156:159], a[12:15]
    ds_read_b64_tr_b16 a[240:241], v17 offset:51232
    ds_read_b64_tr_b16 a[242:243], v17 offset:54816
    v_mfma_f32_16x16x32_bf16 a[12:15], a[252:255], a[172:175], a[12:15]
    s_xor_b32 s44, s44, 126976
    v_mfma_f32_16x16x32_bf16 a[8:11], a[252:255], a[168:171], a[8:11]
    buffer_load_dwordx4 a[112:115], v1, s[4:7], s44 offen offset:0 sc1
    v_mfma_f32_16x16x32_bf16 a[8:11], a[248:251], a[152:155], a[8:11]
    v_mfma_f32_16x16x32_bf16 a[4:7], a[248:251], a[148:151], a[4:7]
    ds_read_b64_tr_b16 a[244:245], v17 offset:58400
    ds_read_b64_tr_b16 a[246:247], v17 offset:61984
    v_mfma_f32_16x16x32_bf16 a[4:7], a[252:255], a[164:167], a[4:7]
    v_mfma_f32_16x16x32_bf16 a[0:3], a[252:255], a[160:163], a[0:3]
    buffer_load_dwordx4 a[116:119], v1, s[4:7], s44 offen offset:1024 sc1
    v_mfma_f32_16x16x32_bf16 a[0:3], a[248:251], a[144:147], a[0:3]
    s_waitcnt lgkmcnt(4)
    v_mfma_f32_16x16x32_bf16 v[160:163], a[232:235], a[144:147], v[160:163]
    ds_read_b64_tr_b16 a[248:249], v17 offset:36928
    ds_read_b64_tr_b16 a[250:251], v17 offset:40512
    v_mfma_f32_16x16x32_bf16 v[160:163], a[236:239], a[160:163], v[160:163]
    v_mfma_f32_16x16x32_bf16 v[164:167], a[236:239], a[164:167], v[164:167]
    buffer_load_dwordx4 a[120:123], v1, s[4:7], s44 offen offset:2048 sc1
    v_mfma_f32_16x16x32_bf16 v[164:167], a[232:235], a[148:151], v[164:167]
    v_mfma_f32_16x16x32_bf16 v[168:171], a[232:235], a[152:155], v[168:171]
    ds_read_b64_tr_b16 a[252:253], v17 offset:44096
    ds_read_b64_tr_b16 a[254:255], v17 offset:47680
    v_mfma_f32_16x16x32_bf16 v[168:171], a[236:239], a[168:171], v[168:171]
    v_mfma_f32_16x16x32_bf16 v[172:175], a[236:239], a[172:175], v[172:175]
    buffer_load_dwordx4 a[124:127], v1, s[4:7], s44 offen offset:3072 sc1
    v_mfma_f32_16x16x32_bf16 v[172:175], a[232:235], a[156:159], v[172:175]
    s_waitcnt lgkmcnt(4)
    v_mfma_f32_16x16x32_bf16 a[28:31], a[240:243], a[156:159], a[28:31]
    ds_read_b64_tr_b16 a[232:233], v17 offset:51264
    ds_read_b64_tr_b16 a[234:235], v17 offset:54848
    v_mfma_f32_16x16x32_bf16 a[28:31], a[244:247], a[172:175], a[28:31]
    s_xor_b32 s44, s44, 4096
    v_mfma_f32_16x16x32_bf16 a[24:27], a[244:247], a[168:171], a[24:27]
    buffer_load_dwordx4 a[128:131], v1, s[4:7], s44 offen offset:0 sc1
    v_mfma_f32_16x16x32_bf16 a[24:27], a[240:243], a[152:155], a[24:27]
    v_mfma_f32_16x16x32_bf16 a[20:23], a[240:243], a[148:151], a[20:23]
    ds_read_b64_tr_b16 a[236:237], v17 offset:58432
    ds_read_b64_tr_b16 a[238:239], v17 offset:62016
    v_mfma_f32_16x16x32_bf16 a[20:23], a[244:247], a[164:167], a[20:23]
    v_mfma_f32_16x16x32_bf16 a[16:19], a[244:247], a[160:163], a[16:19]
    v_mfma_f32_16x16x32_bf16 a[16:19], a[240:243], a[144:147], a[16:19]
    s_waitcnt lgkmcnt(4)
    v_mfma_f32_16x16x32_bf16 v[176:179], a[248:251], a[144:147], v[176:179]
    ds_read_b64_tr_b16 a[240:241], v17 offset:36960
    ds_read_b64_tr_b16 a[242:243], v17 offset:40544
    v_mfma_f32_16x16x32_bf16 v[176:179], a[252:255], a[160:163], v[176:179]
    v_mfma_f32_16x16x32_bf16 v[180:183], a[252:255], a[164:167], v[180:183]
    buffer_load_dwordx4 a[132:135], v1, s[4:7], s44 offen offset:1024 sc1
    v_mfma_f32_16x16x32_bf16 v[180:183], a[248:251], a[148:151], v[180:183]
    v_mfma_f32_16x16x32_bf16 v[184:187], a[248:251], a[152:155], v[184:187]
    ds_read_b64_tr_b16 a[244:245], v17 offset:44128
    ds_read_b64_tr_b16 a[246:247], v17 offset:47712
    v_mfma_f32_16x16x32_bf16 v[184:187], a[252:255], a[168:171], v[184:187]
    v_mfma_f32_16x16x32_bf16 v[188:191], a[252:255], a[172:175], v[188:191]
    buffer_load_dwordx4 a[136:139], v1, s[4:7], s44 offen offset:2048 sc1
    v_mfma_f32_16x16x32_bf16 v[188:191], a[248:251], a[156:159], v[188:191]
    s_waitcnt lgkmcnt(4)
    v_mfma_f32_16x16x32_bf16 a[44:47], a[232:235], a[156:159], a[44:47]
    ds_read_b64_tr_b16 a[248:249], v17 offset:51296
    ds_read_b64_tr_b16 a[250:251], v17 offset:54880
    v_mfma_f32_16x16x32_bf16 a[44:47], a[236:239], a[172:175], a[44:47]
    v_mfma_f32_16x16x32_bf16 a[40:43], a[236:239], a[168:171], a[40:43]
    buffer_load_dwordx4 a[140:143], v1, s[4:7], s44 offen offset:3072 sc1
    v_mfma_f32_16x16x32_bf16 a[40:43], a[232:235], a[152:155], a[40:43]
    v_mfma_f32_16x16x32_bf16 a[36:39], a[232:235], a[148:151], a[36:39]
    ds_read_b64_tr_b16 a[252:253], v17 offset:58464
    ds_read_b64_tr_b16 a[254:255], v17 offset:62048
    v_mfma_f32_16x16x32_bf16 a[36:39], a[236:239], a[164:167], a[36:39]
    v_mfma_f32_16x16x32_bf16 a[32:35], a[236:239], a[160:163], a[32:35]
    buffer_store_dword v69, v78, s[4:7], s73 offen offset:32 sc1
    v_mfma_f32_16x16x32_bf16 a[32:35], a[232:235], a[144:147], a[32:35]
    s_waitcnt lgkmcnt(4)
    v_mfma_f32_16x16x32_bf16 v[192:195], a[240:243], a[144:147], v[192:195]
    s_add_u32 s45, s45, 458752
    ds_read_b64_tr_b16 a[232:233], v17 offset:36992
    ds_read_b64_tr_b16 a[234:235], v17 offset:40576
    v_mfma_f32_16x16x32_bf16 v[192:195], a[244:247], a[160:163], v[192:195]
    s_add_u32 m0, s47, 36864
    v_mfma_f32_16x16x32_bf16 v[196:199], a[244:247], a[164:167], v[196:199]
    buffer_load_dwordx4 v2, s[8:11], s45 offen offset:0  lds
    v_mfma_f32_16x16x32_bf16 v[196:199], a[240:243], a[148:151], v[196:199]
    v_mfma_f32_16x16x32_bf16 v[200:203], a[240:243], a[152:155], v[200:203]
    ds_read_b64_tr_b16 a[236:237], v17 offset:44160
    ds_read_b64_tr_b16 a[238:239], v17 offset:47744
    v_mfma_f32_16x16x32_bf16 v[200:203], a[244:247], a[168:171], v[200:203]
    v_mfma_f32_16x16x32_bf16 v[204:207], a[244:247], a[172:175], v[204:207]
    v_mfma_f32_16x16x32_bf16 v[204:207], a[240:243], a[156:159], v[204:207]
    s_waitcnt lgkmcnt(4)
    v_mfma_f32_16x16x32_bf16 a[60:63], a[248:251], a[156:159], a[60:63]
    ds_read_b64_tr_b16 a[240:241], v17 offset:51328
    ds_read_b64_tr_b16 a[242:243], v17 offset:54912
    v_mfma_f32_16x16x32_bf16 a[60:63], a[252:255], a[172:175], a[60:63]
    v_mfma_f32_16x16x32_bf16 a[56:59], a[252:255], a[168:171], a[56:59]
    buffer_load_dwordx4 v3, s[8:11], s45 offen offset:1024  lds
    v_mfma_f32_16x16x32_bf16 a[56:59], a[248:251], a[152:155], a[56:59]
    v_mfma_f32_16x16x32_bf16 a[52:55], a[248:251], a[148:151], a[52:55]
    ds_read_b64_tr_b16 a[244:245], v17 offset:58496
    ds_read_b64_tr_b16 a[246:247], v17 offset:62080
    v_mfma_f32_16x16x32_bf16 a[52:55], a[252:255], a[164:167], a[52:55]
    v_mfma_f32_16x16x32_bf16 a[48:51], a[252:255], a[160:163], a[48:51]
    buffer_load_dwordx4 v4, s[8:11], s45 offen offset:2048  lds
    v_mfma_f32_16x16x32_bf16 a[48:51], a[248:251], a[144:147], a[48:51]
    s_waitcnt lgkmcnt(4)
    v_mfma_f32_16x16x32_bf16 v[208:211], a[232:235], a[144:147], v[208:211]
    ds_read_b64_tr_b16 a[248:249], v17 offset:37024
    ds_read_b64_tr_b16 a[250:251], v17 offset:40608
    v_mfma_f32_16x16x32_bf16 v[208:211], a[236:239], a[160:163], v[208:211]
    v_mfma_f32_16x16x32_bf16 v[212:215], a[236:239], a[164:167], v[212:215]
    buffer_load_dwordx4 v5, s[8:11], s45 offen offset:3072  lds
    v_mfma_f32_16x16x32_bf16 v[212:215], a[232:235], a[148:151], v[212:215]
    v_mfma_f32_16x16x32_bf16 v[216:219], a[232:235], a[152:155], v[216:219]
    s_add_u32 s46, s46, 128
    ds_read_b64_tr_b16 a[252:253], v17 offset:44192
    ds_read_b64_tr_b16 a[254:255], v17 offset:47776
    v_mfma_f32_16x16x32_bf16 v[216:219], a[236:239], a[168:171], v[216:219]
    s_add_u32 m0, s48, 36864
    v_mfma_f32_16x16x32_bf16 v[220:223], a[236:239], a[172:175], v[220:223]
    buffer_load_dwordx4 v9, s[12:15], s46 offen offset:0  lds
    v_mfma_f32_16x16x32_bf16 v[220:223], a[232:235], a[156:159], v[220:223]
    s_waitcnt lgkmcnt(4)
    v_mfma_f32_16x16x32_bf16 a[76:79], a[240:243], a[156:159], a[76:79]
    ds_read_b64_tr_b16 a[232:233], v17 offset:51360
    ds_read_b64_tr_b16 a[234:235], v17 offset:54944
    v_mfma_f32_16x16x32_bf16 a[76:79], a[244:247], a[172:175], a[76:79]
    v_mfma_f32_16x16x32_bf16 a[72:75], a[244:247], a[168:171], a[72:75]
    buffer_load_dwordx4 v10, s[12:15], s46 offen offset:1024  lds
    v_mfma_f32_16x16x32_bf16 a[72:75], a[240:243], a[152:155], a[72:75]
    v_mfma_f32_16x16x32_bf16 a[68:71], a[240:243], a[148:151], a[68:71]
    ds_read_b64_tr_b16 a[236:237], v17 offset:58528
    ds_read_b64_tr_b16 a[238:239], v17 offset:62112
    v_mfma_f32_16x16x32_bf16 a[68:71], a[244:247], a[164:167], a[68:71]
    v_mfma_f32_16x16x32_bf16 a[64:67], a[244:247], a[160:163], a[64:67]
    v_mfma_f32_16x16x32_bf16 a[64:67], a[240:243], a[144:147], a[64:67]
    s_waitcnt lgkmcnt(4)
    v_mfma_f32_16x16x32_bf16 v[224:227], a[248:251], a[144:147], v[224:227]
    ds_read_b64_tr_b16 a[240:241], v17 offset:37056
    ds_read_b64_tr_b16 a[242:243], v17 offset:40640
    v_mfma_f32_16x16x32_bf16 v[224:227], a[252:255], a[160:163], v[224:227]
    s_add_u32 m0, s47, 40960
    v_mfma_f32_16x16x32_bf16 v[228:231], a[252:255], a[164:167], v[228:231]
    buffer_load_dwordx4 v6, s[8:11], s45 offen offset:0  lds
    v_mfma_f32_16x16x32_bf16 v[228:231], a[248:251], a[148:151], v[228:231]
    v_mfma_f32_16x16x32_bf16 v[232:235], a[248:251], a[152:155], v[232:235]
    ds_read_b64_tr_b16 a[244:245], v17 offset:44224
    ds_read_b64_tr_b16 a[246:247], v17 offset:47808
    v_mfma_f32_16x16x32_bf16 v[232:235], a[252:255], a[168:171], v[232:235]
    v_mfma_f32_16x16x32_bf16 v[236:239], a[252:255], a[172:175], v[236:239]
    buffer_load_dwordx4 v7, s[8:11], s45 offen offset:1024  lds
    v_mfma_f32_16x16x32_bf16 v[236:239], a[248:251], a[156:159], v[236:239]
    s_waitcnt lgkmcnt(4)
    v_mfma_f32_16x16x32_bf16 a[92:95], a[232:235], a[156:159], a[92:95]
    ds_read_b64_tr_b16 a[248:249], v17 offset:51392
    ds_read_b64_tr_b16 a[250:251], v17 offset:54976
    v_mfma_f32_16x16x32_bf16 a[92:95], a[236:239], a[172:175], a[92:95]
    v_mfma_f32_16x16x32_bf16 a[88:91], a[236:239], a[168:171], a[88:91]
    buffer_load_dwordx4 v8, s[8:11], s45 offen offset:2048  lds
    v_mfma_f32_16x16x32_bf16 a[88:91], a[232:235], a[152:155], a[88:91]
    v_mfma_f32_16x16x32_bf16 a[84:87], a[232:235], a[148:151], a[84:87]
    ds_read_b64_tr_b16 a[252:253], v17 offset:58560
    ds_read_b64_tr_b16 a[254:255], v17 offset:62144
    v_mfma_f32_16x16x32_bf16 a[84:87], a[236:239], a[164:167], a[84:87]
    v_mfma_f32_16x16x32_bf16 a[80:83], a[236:239], a[160:163], a[80:83]
    v_mfma_f32_16x16x32_bf16 a[80:83], a[232:235], a[144:147], a[80:83]
    s_waitcnt vmcnt(21) lgkmcnt(4)
    v_mfma_f32_16x16x32_bf16 v[240:243], a[240:243], a[144:147], v[240:243]
    s_barrier
    ds_read_b128 a[232:235], v13 offset:0
    v_mfma_f32_16x16x32_bf16 v[240:243], a[244:247], a[160:163], v[240:243]
    v_mfma_f32_16x16x32_bf16 v[244:247], a[244:247], a[164:167], v[244:247]
    v_mfma_f32_16x16x32_bf16 v[244:247], a[240:243], a[148:151], v[244:247]
    v_mfma_f32_16x16x32_bf16 v[248:251], a[240:243], a[152:155], v[248:251]
    ds_read_b128 a[236:239], v14 offset:0
    v_mfma_f32_16x16x32_bf16 v[248:251], a[244:247], a[168:171], v[248:251]
    v_mfma_f32_16x16x32_bf16 v[252:255], a[244:247], a[172:175], v[252:255]
    v_mfma_f32_16x16x32_bf16 v[252:255], a[240:243], a[156:159], v[252:255]
    s_waitcnt lgkmcnt(2)
    v_mfma_f32_16x16x32_bf16 a[108:111], a[248:251], a[156:159], a[108:111]
    ds_read_b128 a[240:243], v13 offset:4096
    v_mfma_f32_16x16x32_bf16 a[108:111], a[252:255], a[172:175], a[108:111]
    v_mfma_f32_16x16x32_bf16 a[104:107], a[252:255], a[168:171], a[104:107]
    v_mfma_f32_16x16x32_bf16 a[104:107], a[248:251], a[152:155], a[104:107]
    v_mfma_f32_16x16x32_bf16 a[100:103], a[248:251], a[148:151], a[100:103]
    ds_read_b128 a[244:247], v14 offset:4096
    v_mfma_f32_16x16x32_bf16 a[100:103], a[252:255], a[164:167], a[100:103]
    v_mfma_f32_16x16x32_bf16 a[96:99], a[252:255], a[160:163], a[96:99]
    v_mfma_f32_16x16x32_bf16 a[96:99], a[248:251], a[144:147], a[96:99]
    s_waitcnt vmcnt(10) lgkmcnt(2)
    v_mfma_f32_16x16x32_bf16 v[80:83], a[112:115], a[232:235], v[80:83]
    ds_read_b128 a[248:251], v13 offset:2048
    v_mfma_f32_16x16x32_bf16 v[80:83], a[128:131], a[236:239], v[80:83]
    s_xor_b32 s44, s44, 12288
    v_mfma_f32_16x16x32_bf16 v[84:87], a[132:135], a[236:239], v[84:87]
    buffer_load_dwordx4 a[144:147], v1, s[4:7], s44 offen offset:0 sc1
    v_mfma_f32_16x16x32_bf16 v[84:87], a[116:119], a[232:235], v[84:87]
    v_mfma_f32_16x16x32_bf16 v[88:91], a[120:123], a[232:235], v[88:91]
    ds_read_b128 a[252:255], v14 offset:2048
    v_mfma_f32_16x16x32_bf16 v[88:91], a[136:139], a[236:239], v[88:91]
    v_mfma_f32_16x16x32_bf16 v[92:95], a[140:143], a[236:239], v[92:95]
    buffer_load_dwordx4 a[148:151], v1, s[4:7], s44 offen offset:1024 sc1
    v_mfma_f32_16x16x32_bf16 v[92:95], a[124:127], a[232:235], v[92:95]
    s_waitcnt lgkmcnt(2)
    v_mfma_f32_16x16x32_bf16 v[108:111], a[124:127], a[240:243], v[108:111]
    ds_read_b128 a[232:235], v13 offset:6144
    v_mfma_f32_16x16x32_bf16 v[108:111], a[140:143], a[244:247], v[108:111]
    v_mfma_f32_16x16x32_bf16 v[104:107], a[136:139], a[244:247], v[104:107]
    buffer_load_dwordx4 a[152:155], v1, s[4:7], s44 offen offset:2048 sc1
    v_mfma_f32_16x16x32_bf16 v[104:107], a[120:123], a[240:243], v[104:107]
    v_mfma_f32_16x16x32_bf16 v[100:103], a[116:119], a[240:243], v[100:103]
    ds_read_b128 a[236:239], v14 offset:6144
    v_mfma_f32_16x16x32_bf16 v[100:103], a[132:135], a[244:247], v[100:103]
    v_mfma_f32_16x16x32_bf16 v[96:99], a[128:131], a[244:247], v[96:99]
    v_mfma_f32_16x16x32_bf16 v[96:99], a[112:115], a[240:243], v[96:99]
    s_waitcnt lgkmcnt(2)
    v_mfma_f32_16x16x32_bf16 v[112:115], a[112:115], a[248:251], v[112:115]
    ds_read_b64_tr_b16 a[240:241], v11 offset:0
    ds_read_b64_tr_b16 a[242:243], v11 offset:3584
    v_mfma_f32_16x16x32_bf16 v[112:115], a[128:131], a[252:255], v[112:115]
    v_mfma_f32_16x16x32_bf16 v[116:119], a[132:135], a[252:255], v[116:119]
    buffer_load_dwordx4 a[156:159], v1, s[4:7], s44 offen offset:3072 sc1
    v_mfma_f32_16x16x32_bf16 v[116:119], a[116:119], a[248:251], v[116:119]
    v_mfma_f32_16x16x32_bf16 v[120:123], a[120:123], a[248:251], v[120:123]
    ds_read_b64_tr_b16 a[244:245], v11 offset:7168
    ds_read_b64_tr_b16 a[246:247], v11 offset:10752
    v_mfma_f32_16x16x32_bf16 v[120:123], a[136:139], a[252:255], v[120:123]
    s_xor_b32 s44, s44, 4096
    v_mfma_f32_16x16x32_bf16 v[124:127], a[140:143], a[252:255], v[124:127]
    buffer_load_dwordx4 a[160:163], v1, s[4:7], s44 offen offset:0 sc1
    v_mfma_f32_16x16x32_bf16 v[124:127], a[124:127], a[248:251], v[124:127]
    s_waitcnt lgkmcnt(4)
    v_mfma_f32_16x16x32_bf16 v[140:143], a[124:127], a[232:235], v[140:143]
    ds_read_b64_tr_b16 a[248:249], v11 offset:14336
    ds_read_b64_tr_b16 a[250:251], v11 offset:17920
    v_mfma_f32_16x16x32_bf16 v[140:143], a[140:143], a[236:239], v[140:143]
    v_mfma_f32_16x16x32_bf16 v[136:139], a[136:139], a[236:239], v[136:139]
    buffer_load_dwordx4 a[164:167], v1, s[4:7], s44 offen offset:1024 sc1
    v_mfma_f32_16x16x32_bf16 v[136:139], a[120:123], a[232:235], v[136:139]
    v_mfma_f32_16x16x32_bf16 v[132:135], a[116:119], a[232:235], v[132:135]
    ds_read_b64_tr_b16 a[252:253], v11 offset:21504
    ds_read_b64_tr_b16 a[254:255], v11 offset:25088
    v_mfma_f32_16x16x32_bf16 v[132:135], a[132:135], a[236:239], v[132:135]
    v_mfma_f32_16x16x32_bf16 v[128:131], a[128:131], a[236:239], v[128:131]
    v_mfma_f32_16x16x32_bf16 v[128:131], a[112:115], a[232:235], v[128:131]
    s_waitcnt lgkmcnt(4)
    v_mfma_f32_16x16x32_bf16 v[144:147], a[240:243], a[112:115], v[144:147]
    ds_read_b64_tr_b16 a[232:233], v11 offset:32
    ds_read_b64_tr_b16 a[234:235], v11 offset:3616
    v_mfma_f32_16x16x32_bf16 v[144:147], a[244:247], a[128:131], v[144:147]
    v_mfma_f32_16x16x32_bf16 v[148:151], a[244:247], a[132:135], v[148:151]
    buffer_load_dwordx4 a[168:171], v1, s[4:7], s44 offen offset:2048 sc1
    v_mfma_f32_16x16x32_bf16 v[148:151], a[240:243], a[116:119], v[148:151]
    v_mfma_f32_16x16x32_bf16 v[152:155], a[240:243], a[120:123], v[152:155]
    ds_read_b64_tr_b16 a[236:237], v11 offset:7200
    ds_read_b64_tr_b16 a[238:239], v11 offset:10784
    v_mfma_f32_16x16x32_bf16 v[152:155], a[244:247], a[136:139], v[152:155]
    v_mfma_f32_16x16x32_bf16 v[156:159], a[244:247], a[140:143], v[156:159]
    buffer_load_dwordx4 a[172:175], v1, s[4:7], s44 offen offset:3072 sc1
    v_mfma_f32_16x16x32_bf16 v[156:159], a[240:243], a[124:127], v[156:159]
    s_waitcnt lgkmcnt(4)
    v_mfma_f32_16x16x32_bf16 a[12:15], a[248:251], a[124:127], a[12:15]
    s_add_u32 s45, s45, 458752
    ds_read_b64_tr_b16 a[240:241], v11 offset:14368
    ds_read_b64_tr_b16 a[242:243], v11 offset:17952
    v_mfma_f32_16x16x32_bf16 a[12:15], a[252:255], a[140:143], a[12:15]
    s_add_u32 m0, s47, 73728
    v_mfma_f32_16x16x32_bf16 a[8:11], a[252:255], a[136:139], a[8:11]
    buffer_load_dwordx4 v2, s[8:11], s45 offen offset:0  lds
    v_mfma_f32_16x16x32_bf16 a[8:11], a[248:251], a[120:123], a[8:11]
    v_mfma_f32_16x16x32_bf16 a[4:7], a[248:251], a[116:119], a[4:7]
    ds_read_b64_tr_b16 a[244:245], v11 offset:21536
    ds_read_b64_tr_b16 a[246:247], v11 offset:25120
    v_mfma_f32_16x16x32_bf16 a[4:7], a[252:255], a[132:135], a[4:7]
    v_mfma_f32_16x16x32_bf16 a[0:3], a[252:255], a[128:131], a[0:3]
    v_mfma_f32_16x16x32_bf16 a[0:3], a[248:251], a[112:115], a[0:3]
    s_waitcnt lgkmcnt(4)
    v_mfma_f32_16x16x32_bf16 v[160:163], a[232:235], a[112:115], v[160:163]
    ds_read_b64_tr_b16 a[248:249], v11 offset:64
    ds_read_b64_tr_b16 a[250:251], v11 offset:3648
    v_mfma_f32_16x16x32_bf16 v[160:163], a[236:239], a[128:131], v[160:163]
    v_mfma_f32_16x16x32_bf16 v[164:167], a[236:239], a[132:135], v[164:167]
    buffer_load_dwordx4 v3, s[8:11], s45 offen offset:1024  lds
    v_mfma_f32_16x16x32_bf16 v[164:167], a[232:235], a[116:119], v[164:167]
    v_mfma_f32_16x16x32_bf16 v[168:171], a[232:235], a[120:123], v[168:171]
    ds_read_b64_tr_b16 a[252:253], v11 offset:7232
    ds_read_b64_tr_b16 a[254:255], v11 offset:10816
    v_mfma_f32_16x16x32_bf16 v[168:171], a[236:239], a[136:139], v[168:171]
    v_mfma_f32_16x16x32_bf16 v[172:175], a[236:239], a[140:143], v[172:175]
    v_mfma_f32_16x16x32_bf16 v[172:175], a[232:235], a[124:127], v[172:175]
    s_waitcnt lgkmcnt(4)
    v_mfma_f32_16x16x32_bf16 a[28:31], a[240:243], a[124:127], a[28:31]
    ds_read_b64_tr_b16 a[232:233], v11 offset:14400
    ds_read_b64_tr_b16 a[234:235], v11 offset:17984
    v_mfma_f32_16x16x32_bf16 a[28:31], a[244:247], a[140:143], a[28:31]
    v_mfma_f32_16x16x32_bf16 a[24:27], a[244:247], a[136:139], a[24:27]
    buffer_load_dwordx4 v4, s[8:11], s45 offen offset:2048  lds
    v_mfma_f32_16x16x32_bf16 a[24:27], a[240:243], a[120:123], a[24:27]
    v_mfma_f32_16x16x32_bf16 a[20:23], a[240:243], a[116:119], a[20:23]
    ds_read_b64_tr_b16 a[236:237], v11 offset:21568
    ds_read_b64_tr_b16 a[238:239], v11 offset:25152
    v_mfma_f32_16x16x32_bf16 a[20:23], a[244:247], a[132:135], a[20:23]
    v_mfma_f32_16x16x32_bf16 a[16:19], a[244:247], a[128:131], a[16:19]
    buffer_load_dwordx4 v5, s[8:11], s45 offen offset:3072  lds
    v_mfma_f32_16x16x32_bf16 a[16:19], a[240:243], a[112:115], a[16:19]
    s_waitcnt lgkmcnt(4)
    v_mfma_f32_16x16x32_bf16 v[176:179], a[248:251], a[112:115], v[176:179]
    s_add_u32 s46, s46, 128
    ds_read_b64_tr_b16 a[240:241], v11 offset:96
    ds_read_b64_tr_b16 a[242:243], v11 offset:3680
    v_mfma_f32_16x16x32_bf16 v[176:179], a[252:255], a[128:131], v[176:179]
    s_add_u32 m0, s48, 73728
    v_mfma_f32_16x16x32_bf16 v[180:183], a[252:255], a[132:135], v[180:183]
    buffer_load_dwordx4 v9, s[12:15], s46 offen offset:0  lds
    v_mfma_f32_16x16x32_bf16 v[180:183], a[248:251], a[116:119], v[180:183]
    v_mfma_f32_16x16x32_bf16 v[184:187], a[248:251], a[120:123], v[184:187]
    ds_read_b64_tr_b16 a[244:245], v11 offset:7264
    ds_read_b64_tr_b16 a[246:247], v11 offset:10848
    v_mfma_f32_16x16x32_bf16 v[184:187], a[252:255], a[136:139], v[184:187]
    v_mfma_f32_16x16x32_bf16 v[188:191], a[252:255], a[140:143], v[188:191]
    v_mfma_f32_16x16x32_bf16 v[188:191], a[248:251], a[124:127], v[188:191]
    s_waitcnt lgkmcnt(4)
    v_mfma_f32_16x16x32_bf16 a[44:47], a[232:235], a[124:127], a[44:47]
    ds_read_b64_tr_b16 a[248:249], v11 offset:14432
    ds_read_b64_tr_b16 a[250:251], v11 offset:18016
    v_mfma_f32_16x16x32_bf16 a[44:47], a[236:239], a[140:143], a[44:47]
    v_mfma_f32_16x16x32_bf16 a[40:43], a[236:239], a[136:139], a[40:43]
    buffer_load_dwordx4 v10, s[12:15], s46 offen offset:1024  lds
    v_mfma_f32_16x16x32_bf16 a[40:43], a[232:235], a[120:123], a[40:43]
    v_mfma_f32_16x16x32_bf16 a[36:39], a[232:235], a[116:119], a[36:39]
    ds_read_b64_tr_b16 a[252:253], v11 offset:21600
    ds_read_b64_tr_b16 a[254:255], v11 offset:25184
    v_mfma_f32_16x16x32_bf16 a[36:39], a[236:239], a[132:135], a[36:39]
    s_add_u32 m0, s47, 77824
    v_mfma_f32_16x16x32_bf16 a[32:35], a[236:239], a[128:131], a[32:35]
    buffer_load_dwordx4 v6, s[8:11], s45 offen offset:0  lds
    v_mfma_f32_16x16x32_bf16 a[32:35], a[232:235], a[112:115], a[32:35]
    s_waitcnt lgkmcnt(4)
    v_mfma_f32_16x16x32_bf16 v[192:195], a[240:243], a[112:115], v[192:195]
    ds_read_b64_tr_b16 a[232:233], v11 offset:128
    ds_read_b64_tr_b16 a[234:235], v11 offset:3712
    v_mfma_f32_16x16x32_bf16 v[192:195], a[244:247], a[128:131], v[192:195]
    v_mfma_f32_16x16x32_bf16 v[196:199], a[244:247], a[132:135], v[196:199]
    buffer_load_dwordx4 v7, s[8:11], s45 offen offset:1024  lds
    v_mfma_f32_16x16x32_bf16 v[196:199], a[240:243], a[116:119], v[196:199]
    v_mfma_f32_16x16x32_bf16 v[200:203], a[240:243], a[120:123], v[200:203]
    ds_read_b64_tr_b16 a[236:237], v11 offset:7296
    ds_read_b64_tr_b16 a[238:239], v11 offset:10880
    v_mfma_f32_16x16x32_bf16 v[200:203], a[244:247], a[136:139], v[200:203]
    v_mfma_f32_16x16x32_bf16 v[204:207], a[244:247], a[140:143], v[204:207]
    v_mfma_f32_16x16x32_bf16 v[204:207], a[240:243], a[124:127], v[204:207]
    s_waitcnt lgkmcnt(4)
    v_mfma_f32_16x16x32_bf16 a[60:63], a[248:251], a[124:127], a[60:63]
    ds_read_b64_tr_b16 a[240:241], v11 offset:14464
    ds_read_b64_tr_b16 a[242:243], v11 offset:18048
    v_mfma_f32_16x16x32_bf16 a[60:63], a[252:255], a[140:143], a[60:63]
    v_mfma_f32_16x16x32_bf16 a[56:59], a[252:255], a[136:139], a[56:59]
    buffer_load_dwordx4 v8, s[8:11], s45 offen offset:2048  lds
    v_mfma_f32_16x16x32_bf16 a[56:59], a[248:251], a[120:123], a[56:59]
    v_mfma_f32_16x16x32_bf16 a[52:55], a[248:251], a[116:119], a[52:55]
    ds_read_b64_tr_b16 a[244:245], v11 offset:21632
    ds_read_b64_tr_b16 a[246:247], v11 offset:25216
    v_mfma_f32_16x16x32_bf16 a[52:55], a[252:255], a[132:135], a[52:55]
    v_mfma_f32_16x16x32_bf16 a[48:51], a[252:255], a[128:131], a[48:51]
    v_mfma_f32_16x16x32_bf16 a[48:51], a[248:251], a[112:115], a[48:51]
    s_waitcnt lgkmcnt(4)
    v_mfma_f32_16x16x32_bf16 v[208:211], a[232:235], a[112:115], v[208:211]
    s_add_u32 s76, s76, 1835008
    ds_read_b64_tr_b16 a[248:249], v11 offset:160
    ds_read_b64_tr_b16 a[250:251], v11 offset:3744
    v_mfma_f32_16x16x32_bf16 v[208:211], a[236:239], a[128:131], v[208:211]
    buffer_load_dword a216, v12, s[28:31], s76 offen offset:0
    v_mfma_f32_16x16x32_bf16 v[212:215], a[236:239], a[132:135], v[212:215]
    v_and_b32 v12, 15, v0
    v_lshlrev_b32 v12, 7, v12
    v_mfma_f32_16x16x32_bf16 v[212:215], a[232:235], a[116:119], v[212:215]
    buffer_load_dword a216, v12, s[20:23], s77 offen offset:0
    v_mfma_f32_16x16x32_bf16 v[216:219], a[232:235], a[120:123], v[216:219]
    ds_read_b64_tr_b16 a[252:253], v11 offset:7328
    ds_read_b64_tr_b16 a[254:255], v11 offset:10912
    v_mfma_f32_16x16x32_bf16 v[216:219], a[236:239], a[136:139], v[216:219]
    v_mfma_f32_16x16x32_bf16 v[220:223], a[236:239], a[140:143], v[220:223]
    buffer_load_dword a216, v12, s[24:27], s77 offen offset:0
    v_mfma_f32_16x16x32_bf16 v[220:223], a[232:235], a[124:127], v[220:223]
    s_waitcnt lgkmcnt(4)
    v_mfma_f32_16x16x32_bf16 a[76:79], a[240:243], a[124:127], a[76:79]
    ds_read_b64_tr_b16 a[232:233], v11 offset:14496
    ds_read_b64_tr_b16 a[234:235], v11 offset:18080
    v_mfma_f32_16x16x32_bf16 a[76:79], a[244:247], a[140:143], a[76:79]
    v_mfma_f32_16x16x32_bf16 a[72:75], a[244:247], a[136:139], a[72:75]
    v_mfma_f32_16x16x32_bf16 a[72:75], a[240:243], a[120:123], a[72:75]
    v_mfma_f32_16x16x32_bf16 a[68:71], a[240:243], a[116:119], a[68:71]
    ds_read_b64_tr_b16 a[236:237], v11 offset:21664
    ds_read_b64_tr_b16 a[238:239], v11 offset:25248
    v_mfma_f32_16x16x32_bf16 a[68:71], a[244:247], a[132:135], a[68:71]
    v_mfma_f32_16x16x32_bf16 a[64:67], a[244:247], a[128:131], a[64:67]
    v_mfma_f32_16x16x32_bf16 a[64:67], a[240:243], a[112:115], a[64:67]
    s_waitcnt lgkmcnt(4)
    v_mfma_f32_16x16x32_bf16 v[224:227], a[248:251], a[112:115], v[224:227]
    ds_read_b64_tr_b16 a[240:241], v11 offset:192
    ds_read_b64_tr_b16 a[242:243], v11 offset:3776
    v_mfma_f32_16x16x32_bf16 v[224:227], a[252:255], a[128:131], v[224:227]
    v_mfma_f32_16x16x32_bf16 v[228:231], a[252:255], a[132:135], v[228:231]
    v_mfma_f32_16x16x32_bf16 v[228:231], a[248:251], a[116:119], v[228:231]
    v_mfma_f32_16x16x32_bf16 v[232:235], a[248:251], a[120:123], v[232:235]
    ds_read_b64_tr_b16 a[244:245], v11 offset:7360
    ds_read_b64_tr_b16 a[246:247], v11 offset:10944
    v_mfma_f32_16x16x32_bf16 v[232:235], a[252:255], a[136:139], v[232:235]
    v_mfma_f32_16x16x32_bf16 v[236:239], a[252:255], a[140:143], v[236:239]
    v_mfma_f32_16x16x32_bf16 v[236:239], a[248:251], a[124:127], v[236:239]
    s_waitcnt lgkmcnt(4)
    v_mfma_f32_16x16x32_bf16 a[92:95], a[232:235], a[124:127], a[92:95]
    ds_read_b64_tr_b16 a[248:249], v11 offset:14528
    ds_read_b64_tr_b16 a[250:251], v11 offset:18112
    v_mfma_f32_16x16x32_bf16 a[92:95], a[236:239], a[140:143], a[92:95]
    v_mfma_f32_16x16x32_bf16 a[88:91], a[236:239], a[136:139], a[88:91]
    v_mfma_f32_16x16x32_bf16 a[88:91], a[232:235], a[120:123], a[88:91]
    v_mfma_f32_16x16x32_bf16 a[84:87], a[232:235], a[116:119], a[84:87]
    ds_read_b64_tr_b16 a[252:253], v11 offset:21696
    ds_read_b64_tr_b16 a[254:255], v11 offset:25280
    v_mfma_f32_16x16x32_bf16 a[84:87], a[236:239], a[132:135], a[84:87]
    v_mfma_f32_16x16x32_bf16 a[80:83], a[236:239], a[128:131], a[80:83]
    v_mfma_f32_16x16x32_bf16 a[80:83], a[232:235], a[112:115], a[80:83]
    s_waitcnt vmcnt(20) lgkmcnt(4)
    v_mfma_f32_16x16x32_bf16 v[240:243], a[240:243], a[112:115], v[240:243]
    s_barrier
    ds_read_b128 a[232:235], v13 offset:36864
    v_mfma_f32_16x16x32_bf16 v[240:243], a[244:247], a[128:131], v[240:243]
    v_mfma_f32_16x16x32_bf16 v[244:247], a[244:247], a[132:135], v[244:247]
    v_mfma_f32_16x16x32_bf16 v[244:247], a[240:243], a[116:119], v[244:247]
    v_mfma_f32_16x16x32_bf16 v[248:251], a[240:243], a[120:123], v[248:251]
    ds_read_b128 a[236:239], v14 offset:36864
    v_mfma_f32_16x16x32_bf16 v[248:251], a[244:247], a[136:139], v[248:251]
    v_mfma_f32_16x16x32_bf16 v[252:255], a[244:247], a[140:143], v[252:255]
    v_mfma_f32_16x16x32_bf16 v[252:255], a[240:243], a[124:127], v[252:255]
    s_waitcnt lgkmcnt(2)
    v_mfma_f32_16x16x32_bf16 a[108:111], a[248:251], a[124:127], a[108:111]
    ds_read_b128 a[240:243], v13 offset:40960
    v_mfma_f32_16x16x32_bf16 a[108:111], a[252:255], a[140:143], a[108:111]
    v_mfma_f32_16x16x32_bf16 a[104:107], a[252:255], a[136:139], a[104:107]
    v_mfma_f32_16x16x32_bf16 a[104:107], a[248:251], a[120:123], a[104:107]
    v_mfma_f32_16x16x32_bf16 a[100:103], a[248:251], a[116:119], a[100:103]
    ds_read_b128 a[244:247], v14 offset:40960
    v_mfma_f32_16x16x32_bf16 a[100:103], a[252:255], a[132:135], a[100:103]
    v_mfma_f32_16x16x32_bf16 a[96:99], a[252:255], a[128:131], a[96:99]
    v_mfma_f32_16x16x32_bf16 a[96:99], a[248:251], a[112:115], a[96:99]
    s_waitcnt vmcnt(12) lgkmcnt(2)
    v_mfma_f32_16x16x32_bf16 v[80:83], a[144:147], a[232:235], v[80:83]
    ds_read_b128 a[248:251], v13 offset:38912
    v_mfma_f32_16x16x32_bf16 v[80:83], a[160:163], a[236:239], v[80:83]
    v_mfma_f32_16x16x32_bf16 v[84:87], a[164:167], a[236:239], v[84:87]
    v_mfma_f32_16x16x32_bf16 v[84:87], a[148:151], a[232:235], v[84:87]
    v_mfma_f32_16x16x32_bf16 v[88:91], a[152:155], a[232:235], v[88:91]
    ds_read_b128 a[252:255], v14 offset:38912
    v_mfma_f32_16x16x32_bf16 v[88:91], a[168:171], a[236:239], v[88:91]
    v_mfma_f32_16x16x32_bf16 v[92:95], a[172:175], a[236:239], v[92:95]
    v_mfma_f32_16x16x32_bf16 v[92:95], a[156:159], a[232:235], v[92:95]
    s_waitcnt lgkmcnt(2)
    v_mfma_f32_16x16x32_bf16 v[108:111], a[156:159], a[240:243], v[108:111]
    ds_read_b128 a[232:235], v13 offset:43008
    v_mfma_f32_16x16x32_bf16 v[108:111], a[172:175], a[244:247], v[108:111]
    v_mfma_f32_16x16x32_bf16 v[104:107], a[168:171], a[244:247], v[104:107]
    v_mfma_f32_16x16x32_bf16 v[104:107], a[152:155], a[240:243], v[104:107]
    v_mfma_f32_16x16x32_bf16 v[100:103], a[148:151], a[240:243], v[100:103]
    ds_read_b128 a[236:239], v14 offset:43008
    v_mfma_f32_16x16x32_bf16 v[100:103], a[164:167], a[244:247], v[100:103]
    v_mfma_f32_16x16x32_bf16 v[96:99], a[160:163], a[244:247], v[96:99]
    v_mfma_f32_16x16x32_bf16 v[96:99], a[144:147], a[240:243], v[96:99]
    s_waitcnt lgkmcnt(2)
    v_mfma_f32_16x16x32_bf16 v[112:115], a[144:147], a[248:251], v[112:115]
    ds_read_b64_tr_b16 a[240:241], v11 offset:36864
    ds_read_b64_tr_b16 a[242:243], v11 offset:40448
    v_mfma_f32_16x16x32_bf16 v[112:115], a[160:163], a[252:255], v[112:115]
    v_mfma_f32_16x16x32_bf16 v[116:119], a[164:167], a[252:255], v[116:119]
    v_mfma_f32_16x16x32_bf16 v[116:119], a[148:151], a[248:251], v[116:119]
    v_mfma_f32_16x16x32_bf16 v[120:123], a[152:155], a[248:251], v[120:123]
    ds_read_b64_tr_b16 a[244:245], v11 offset:44032
    ds_read_b64_tr_b16 a[246:247], v11 offset:47616
    v_mfma_f32_16x16x32_bf16 v[120:123], a[168:171], a[252:255], v[120:123]
    v_mfma_f32_16x16x32_bf16 v[124:127], a[172:175], a[252:255], v[124:127]
    v_mfma_f32_16x16x32_bf16 v[124:127], a[156:159], a[248:251], v[124:127]
    s_waitcnt lgkmcnt(4)
    v_mfma_f32_16x16x32_bf16 v[140:143], a[156:159], a[232:235], v[140:143]
    ds_read_b64_tr_b16 a[248:249], v11 offset:51200
    ds_read_b64_tr_b16 a[250:251], v11 offset:54784
    v_mfma_f32_16x16x32_bf16 v[140:143], a[172:175], a[236:239], v[140:143]
    v_mfma_f32_16x16x32_bf16 v[136:139], a[168:171], a[236:239], v[136:139]
    v_mfma_f32_16x16x32_bf16 v[136:139], a[152:155], a[232:235], v[136:139]
    v_mfma_f32_16x16x32_bf16 v[132:135], a[148:151], a[232:235], v[132:135]
    ds_read_b64_tr_b16 a[252:253], v11 offset:58368
    ds_read_b64_tr_b16 a[254:255], v11 offset:61952
    v_mfma_f32_16x16x32_bf16 v[132:135], a[164:167], a[236:239], v[132:135]
    v_mfma_f32_16x16x32_bf16 v[128:131], a[160:163], a[236:239], v[128:131]
    v_mfma_f32_16x16x32_bf16 v[128:131], a[144:147], a[232:235], v[128:131]
    s_waitcnt lgkmcnt(4)
    v_mfma_f32_16x16x32_bf16 v[144:147], a[240:243], a[144:147], v[144:147]
    ds_read_b64_tr_b16 a[232:233], v11 offset:36896
    ds_read_b64_tr_b16 a[234:235], v11 offset:40480
    v_mfma_f32_16x16x32_bf16 v[144:147], a[244:247], a[160:163], v[144:147]
    v_mfma_f32_16x16x32_bf16 v[148:151], a[244:247], a[164:167], v[148:151]
    v_mfma_f32_16x16x32_bf16 v[148:151], a[240:243], a[148:151], v[148:151]
    v_mfma_f32_16x16x32_bf16 v[152:155], a[240:243], a[152:155], v[152:155]
    ds_read_b64_tr_b16 a[236:237], v11 offset:44064
    ds_read_b64_tr_b16 a[238:239], v11 offset:47648
    v_mfma_f32_16x16x32_bf16 v[152:155], a[244:247], a[168:171], v[152:155]
    v_mfma_f32_16x16x32_bf16 v[156:159], a[244:247], a[172:175], v[156:159]
    v_mfma_f32_16x16x32_bf16 v[156:159], a[240:243], a[156:159], v[156:159]
    s_waitcnt lgkmcnt(4)
    v_mfma_f32_16x16x32_bf16 a[12:15], a[248:251], a[156:159], a[12:15]
    ds_read_b64_tr_b16 a[240:241], v11 offset:51232
    ds_read_b64_tr_b16 a[242:243], v11 offset:54816
    v_mfma_f32_16x16x32_bf16 a[12:15], a[252:255], a[172:175], a[12:15]
    s_xor_b32 s44, s44, 28672
    v_mfma_f32_16x16x32_bf16 a[8:11], a[252:255], a[168:171], a[8:11]
    buffer_load_dwordx4 a[112:115], v1, s[4:7], s44 offen offset:0 sc1
    v_mfma_f32_16x16x32_bf16 a[8:11], a[248:251], a[152:155], a[8:11]
    v_mfma_f32_16x16x32_bf16 a[4:7], a[248:251], a[148:151], a[4:7]
    ds_read_b64_tr_b16 a[244:245], v11 offset:58400
    ds_read_b64_tr_b16 a[246:247], v11 offset:61984
    v_mfma_f32_16x16x32_bf16 a[4:7], a[252:255], a[164:167], a[4:7]
    v_mfma_f32_16x16x32_bf16 a[0:3], a[252:255], a[160:163], a[0:3]
    buffer_load_dwordx4 a[116:119], v1, s[4:7], s44 offen offset:1024 sc1
    v_mfma_f32_16x16x32_bf16 a[0:3], a[248:251], a[144:147], a[0:3]
    s_waitcnt lgkmcnt(4)
    v_mfma_f32_16x16x32_bf16 v[160:163], a[232:235], a[144:147], v[160:163]
    ds_read_b64_tr_b16 a[248:249], v11 offset:36928
    ds_read_b64_tr_b16 a[250:251], v11 offset:40512
    v_mfma_f32_16x16x32_bf16 v[160:163], a[236:239], a[160:163], v[160:163]
    v_mfma_f32_16x16x32_bf16 v[164:167], a[236:239], a[164:167], v[164:167]
    buffer_load_dwordx4 a[120:123], v1, s[4:7], s44 offen offset:2048 sc1
    v_mfma_f32_16x16x32_bf16 v[164:167], a[232:235], a[148:151], v[164:167]
    v_mfma_f32_16x16x32_bf16 v[168:171], a[232:235], a[152:155], v[168:171]
    ds_read_b64_tr_b16 a[252:253], v11 offset:44096
    ds_read_b64_tr_b16 a[254:255], v11 offset:47680
    v_mfma_f32_16x16x32_bf16 v[168:171], a[236:239], a[168:171], v[168:171]
    v_mfma_f32_16x16x32_bf16 v[172:175], a[236:239], a[172:175], v[172:175]
    buffer_load_dwordx4 a[124:127], v1, s[4:7], s44 offen offset:3072 sc1
    v_mfma_f32_16x16x32_bf16 v[172:175], a[232:235], a[156:159], v[172:175]
    s_waitcnt lgkmcnt(4)
    v_mfma_f32_16x16x32_bf16 a[28:31], a[240:243], a[156:159], a[28:31]
    ds_read_b64_tr_b16 a[232:233], v11 offset:51264
    ds_read_b64_tr_b16 a[234:235], v11 offset:54848
    v_mfma_f32_16x16x32_bf16 a[28:31], a[244:247], a[172:175], a[28:31]
    s_xor_b32 s44, s44, 4096
    v_mfma_f32_16x16x32_bf16 a[24:27], a[244:247], a[168:171], a[24:27]
    buffer_load_dwordx4 a[128:131], v1, s[4:7], s44 offen offset:0 sc1
    v_mfma_f32_16x16x32_bf16 a[24:27], a[240:243], a[152:155], a[24:27]
    v_mfma_f32_16x16x32_bf16 a[20:23], a[240:243], a[148:151], a[20:23]
    ds_read_b64_tr_b16 a[236:237], v11 offset:58432
    ds_read_b64_tr_b16 a[238:239], v11 offset:62016
    v_mfma_f32_16x16x32_bf16 a[20:23], a[244:247], a[164:167], a[20:23]
    v_mfma_f32_16x16x32_bf16 a[16:19], a[244:247], a[160:163], a[16:19]
    v_mfma_f32_16x16x32_bf16 a[16:19], a[240:243], a[144:147], a[16:19]
    s_waitcnt lgkmcnt(4)
    v_mfma_f32_16x16x32_bf16 v[176:179], a[248:251], a[144:147], v[176:179]
    ds_read_b64_tr_b16 a[240:241], v11 offset:36960
    ds_read_b64_tr_b16 a[242:243], v11 offset:40544
    v_mfma_f32_16x16x32_bf16 v[176:179], a[252:255], a[160:163], v[176:179]
    v_mfma_f32_16x16x32_bf16 v[180:183], a[252:255], a[164:167], v[180:183]
    buffer_load_dwordx4 a[132:135], v1, s[4:7], s44 offen offset:1024 sc1
    v_mfma_f32_16x16x32_bf16 v[180:183], a[248:251], a[148:151], v[180:183]
    v_mfma_f32_16x16x32_bf16 v[184:187], a[248:251], a[152:155], v[184:187]
    ds_read_b64_tr_b16 a[244:245], v11 offset:44128
    ds_read_b64_tr_b16 a[246:247], v11 offset:47712
    v_mfma_f32_16x16x32_bf16 v[184:187], a[252:255], a[168:171], v[184:187]
    v_mfma_f32_16x16x32_bf16 v[188:191], a[252:255], a[172:175], v[188:191]
    buffer_load_dwordx4 a[136:139], v1, s[4:7], s44 offen offset:2048 sc1
    v_mfma_f32_16x16x32_bf16 v[188:191], a[248:251], a[156:159], v[188:191]
    s_waitcnt lgkmcnt(4)
    v_mfma_f32_16x16x32_bf16 a[44:47], a[232:235], a[156:159], a[44:47]
    ds_read_b64_tr_b16 a[248:249], v11 offset:51296
    ds_read_b64_tr_b16 a[250:251], v11 offset:54880
    v_mfma_f32_16x16x32_bf16 a[44:47], a[236:239], a[172:175], a[44:47]
    v_mfma_f32_16x16x32_bf16 a[40:43], a[236:239], a[168:171], a[40:43]
    buffer_load_dwordx4 a[140:143], v1, s[4:7], s44 offen offset:3072 sc1
    v_mfma_f32_16x16x32_bf16 a[40:43], a[232:235], a[152:155], a[40:43]
    v_mfma_f32_16x16x32_bf16 a[36:39], a[232:235], a[148:151], a[36:39]
    ds_read_b64_tr_b16 a[252:253], v11 offset:58464
    ds_read_b64_tr_b16 a[254:255], v11 offset:62048
    v_mfma_f32_16x16x32_bf16 a[36:39], a[236:239], a[164:167], a[36:39]
    v_mfma_f32_16x16x32_bf16 a[32:35], a[236:239], a[160:163], a[32:35]
    global_load_dword a216, v73, s[74:75]
    v_mfma_f32_16x16x32_bf16 a[32:35], a[232:235], a[144:147], a[32:35]
    s_waitcnt lgkmcnt(4)
    v_mfma_f32_16x16x32_bf16 v[192:195], a[240:243], a[144:147], v[192:195]
    s_add_u32 s45, s45, 458752
    ds_read_b64_tr_b16 a[232:233], v11 offset:36992
    ds_read_b64_tr_b16 a[234:235], v11 offset:40576
    v_mfma_f32_16x16x32_bf16 v[192:195], a[244:247], a[160:163], v[192:195]
    s_add_u32 m0, s47, 110592
    v_mfma_f32_16x16x32_bf16 v[196:199], a[244:247], a[164:167], v[196:199]
    buffer_load_dwordx4 v2, s[8:11], s45 offen offset:0  lds
    v_mfma_f32_16x16x32_bf16 v[196:199], a[240:243], a[148:151], v[196:199]
    v_mfma_f32_16x16x32_bf16 v[200:203], a[240:243], a[152:155], v[200:203]
    ds_read_b64_tr_b16 a[236:237], v11 offset:44160
    ds_read_b64_tr_b16 a[238:239], v11 offset:47744
    v_mfma_f32_16x16x32_bf16 v[200:203], a[244:247], a[168:171], v[200:203]
    v_mfma_f32_16x16x32_bf16 v[204:207], a[244:247], a[172:175], v[204:207]
    v_mfma_f32_16x16x32_bf16 v[204:207], a[240:243], a[156:159], v[204:207]
    s_waitcnt lgkmcnt(4)
    v_mfma_f32_16x16x32_bf16 a[60:63], a[248:251], a[156:159], a[60:63]
    ds_read_b64_tr_b16 a[240:241], v11 offset:51328
    ds_read_b64_tr_b16 a[242:243], v11 offset:54912
    v_mfma_f32_16x16x32_bf16 a[60:63], a[252:255], a[172:175], a[60:63]
    v_mfma_f32_16x16x32_bf16 a[56:59], a[252:255], a[168:171], a[56:59]
    buffer_load_dwordx4 v3, s[8:11], s45 offen offset:1024  lds
    v_mfma_f32_16x16x32_bf16 a[56:59], a[248:251], a[152:155], a[56:59]
    v_mfma_f32_16x16x32_bf16 a[52:55], a[248:251], a[148:151], a[52:55]
    ds_read_b64_tr_b16 a[244:245], v11 offset:58496
    ds_read_b64_tr_b16 a[246:247], v11 offset:62080
    v_mfma_f32_16x16x32_bf16 a[52:55], a[252:255], a[164:167], a[52:55]
    v_mfma_f32_16x16x32_bf16 a[48:51], a[252:255], a[160:163], a[48:51]
    buffer_load_dwordx4 v4, s[8:11], s45 offen offset:2048  lds
    v_mfma_f32_16x16x32_bf16 a[48:51], a[248:251], a[144:147], a[48:51]
    s_waitcnt lgkmcnt(4)
    v_mfma_f32_16x16x32_bf16 v[208:211], a[232:235], a[144:147], v[208:211]
    ds_read_b64_tr_b16 a[248:249], v11 offset:37024
    ds_read_b64_tr_b16 a[250:251], v11 offset:40608
    v_mfma_f32_16x16x32_bf16 v[208:211], a[236:239], a[160:163], v[208:211]
    v_mfma_f32_16x16x32_bf16 v[212:215], a[236:239], a[164:167], v[212:215]
    buffer_load_dwordx4 v5, s[8:11], s45 offen offset:3072  lds
    v_mfma_f32_16x16x32_bf16 v[212:215], a[232:235], a[148:151], v[212:215]
    v_mfma_f32_16x16x32_bf16 v[216:219], a[232:235], a[152:155], v[216:219]
    s_add_u32 s46, s46, 128
    ds_read_b64_tr_b16 a[252:253], v11 offset:44192
    ds_read_b64_tr_b16 a[254:255], v11 offset:47776
    v_mfma_f32_16x16x32_bf16 v[216:219], a[236:239], a[168:171], v[216:219]
    s_add_u32 m0, s48, 110592
    v_mfma_f32_16x16x32_bf16 v[220:223], a[236:239], a[172:175], v[220:223]
    buffer_load_dwordx4 v9, s[12:15], s46 offen offset:0  lds
    v_mfma_f32_16x16x32_bf16 v[220:223], a[232:235], a[156:159], v[220:223]
    s_waitcnt lgkmcnt(4)
    v_mfma_f32_16x16x32_bf16 a[76:79], a[240:243], a[156:159], a[76:79]
    ds_read_b64_tr_b16 a[232:233], v11 offset:51360
    ds_read_b64_tr_b16 a[234:235], v11 offset:54944
    v_mfma_f32_16x16x32_bf16 a[76:79], a[244:247], a[172:175], a[76:79]
    v_mfma_f32_16x16x32_bf16 a[72:75], a[244:247], a[168:171], a[72:75]
    buffer_load_dwordx4 v10, s[12:15], s46 offen offset:1024  lds
    v_mfma_f32_16x16x32_bf16 a[72:75], a[240:243], a[152:155], a[72:75]
    v_mfma_f32_16x16x32_bf16 a[68:71], a[240:243], a[148:151], a[68:71]
    ds_read_b64_tr_b16 a[236:237], v11 offset:58528
    ds_read_b64_tr_b16 a[238:239], v11 offset:62112
    v_mfma_f32_16x16x32_bf16 a[68:71], a[244:247], a[164:167], a[68:71]
    v_mfma_f32_16x16x32_bf16 a[64:67], a[244:247], a[160:163], a[64:67]
    v_mfma_f32_16x16x32_bf16 a[64:67], a[240:243], a[144:147], a[64:67]
    s_waitcnt lgkmcnt(4)
    v_mfma_f32_16x16x32_bf16 v[224:227], a[248:251], a[144:147], v[224:227]
    ds_read_b64_tr_b16 a[240:241], v11 offset:37056
    ds_read_b64_tr_b16 a[242:243], v11 offset:40640
    v_mfma_f32_16x16x32_bf16 v[224:227], a[252:255], a[160:163], v[224:227]
    s_add_u32 m0, s47, 114688
    v_mfma_f32_16x16x32_bf16 v[228:231], a[252:255], a[164:167], v[228:231]
    buffer_load_dwordx4 v6, s[8:11], s45 offen offset:0  lds
    v_mfma_f32_16x16x32_bf16 v[228:231], a[248:251], a[148:151], v[228:231]
    v_mfma_f32_16x16x32_bf16 v[232:235], a[248:251], a[152:155], v[232:235]
    ds_read_b64_tr_b16 a[244:245], v11 offset:44224
    ds_read_b64_tr_b16 a[246:247], v11 offset:47808
    v_mfma_f32_16x16x32_bf16 v[232:235], a[252:255], a[168:171], v[232:235]
    v_mfma_f32_16x16x32_bf16 v[236:239], a[252:255], a[172:175], v[236:239]
    buffer_load_dwordx4 v7, s[8:11], s45 offen offset:1024  lds
    v_mfma_f32_16x16x32_bf16 v[236:239], a[248:251], a[156:159], v[236:239]
    s_waitcnt lgkmcnt(4)
    v_mfma_f32_16x16x32_bf16 a[92:95], a[232:235], a[156:159], a[92:95]
    ds_read_b64_tr_b16 a[248:249], v11 offset:51392
    ds_read_b64_tr_b16 a[250:251], v11 offset:54976
    v_mfma_f32_16x16x32_bf16 a[92:95], a[236:239], a[172:175], a[92:95]
    v_mfma_f32_16x16x32_bf16 a[88:91], a[236:239], a[168:171], a[88:91]
    buffer_load_dwordx4 v8, s[8:11], s45 offen offset:2048  lds
    v_mfma_f32_16x16x32_bf16 a[88:91], a[232:235], a[152:155], a[88:91]
    v_mfma_f32_16x16x32_bf16 a[84:87], a[232:235], a[148:151], a[84:87]
    ds_read_b64_tr_b16 a[252:253], v11 offset:58560
    ds_read_b64_tr_b16 a[254:255], v11 offset:62144
    v_mfma_f32_16x16x32_bf16 a[84:87], a[236:239], a[164:167], a[84:87]
    v_mfma_f32_16x16x32_bf16 a[80:83], a[236:239], a[160:163], a[80:83]
    v_mfma_f32_16x16x32_bf16 a[80:83], a[232:235], a[144:147], a[80:83]
    s_waitcnt vmcnt(21) lgkmcnt(4)
    v_mfma_f32_16x16x32_bf16 v[240:243], a[240:243], a[144:147], v[240:243]
    s_barrier
    ds_read_b128 a[232:235], v15 offset:0
    v_mfma_f32_16x16x32_bf16 v[240:243], a[244:247], a[160:163], v[240:243]
    v_mfma_f32_16x16x32_bf16 v[244:247], a[244:247], a[164:167], v[244:247]
    v_mfma_f32_16x16x32_bf16 v[244:247], a[240:243], a[148:151], v[244:247]
    v_mfma_f32_16x16x32_bf16 v[248:251], a[240:243], a[152:155], v[248:251]
    ds_read_b128 a[236:239], v16 offset:0
    v_mfma_f32_16x16x32_bf16 v[248:251], a[244:247], a[168:171], v[248:251]
    v_mfma_f32_16x16x32_bf16 v[252:255], a[244:247], a[172:175], v[252:255]
    v_mfma_f32_16x16x32_bf16 v[252:255], a[240:243], a[156:159], v[252:255]
    s_waitcnt lgkmcnt(2)
    v_mfma_f32_16x16x32_bf16 a[108:111], a[248:251], a[156:159], a[108:111]
    ds_read_b128 a[240:243], v15 offset:4096
    v_mfma_f32_16x16x32_bf16 a[108:111], a[252:255], a[172:175], a[108:111]
    v_mfma_f32_16x16x32_bf16 a[104:107], a[252:255], a[168:171], a[104:107]
    v_mfma_f32_16x16x32_bf16 a[104:107], a[248:251], a[152:155], a[104:107]
    v_mfma_f32_16x16x32_bf16 a[100:103], a[248:251], a[148:151], a[100:103]
    ds_read_b128 a[244:247], v16 offset:4096
    v_mfma_f32_16x16x32_bf16 a[100:103], a[252:255], a[164:167], a[100:103]
    v_mfma_f32_16x16x32_bf16 a[96:99], a[252:255], a[160:163], a[96:99]
    v_mfma_f32_16x16x32_bf16 a[96:99], a[248:251], a[144:147], a[96:99]
    s_waitcnt vmcnt(10) lgkmcnt(2)
    v_mfma_f32_16x16x32_bf16 v[80:83], a[112:115], a[232:235], v[80:83]
    ds_read_b128 a[248:251], v15 offset:2048
    v_mfma_f32_16x16x32_bf16 v[80:83], a[128:131], a[236:239], v[80:83]
    s_xor_b32 s44, s44, 12288
    v_mfma_f32_16x16x32_bf16 v[84:87], a[132:135], a[236:239], v[84:87]
    buffer_load_dwordx4 a[144:147], v1, s[4:7], s44 offen offset:0 sc1
    v_mfma_f32_16x16x32_bf16 v[84:87], a[116:119], a[232:235], v[84:87]
    v_mfma_f32_16x16x32_bf16 v[88:91], a[120:123], a[232:235], v[88:91]
    ds_read_b128 a[252:255], v16 offset:2048
    v_mfma_f32_16x16x32_bf16 v[88:91], a[136:139], a[236:239], v[88:91]
    v_mfma_f32_16x16x32_bf16 v[92:95], a[140:143], a[236:239], v[92:95]
    buffer_load_dwordx4 a[148:151], v1, s[4:7], s44 offen offset:1024 sc1
    v_mfma_f32_16x16x32_bf16 v[92:95], a[124:127], a[232:235], v[92:95]
    s_waitcnt lgkmcnt(2)
    v_mfma_f32_16x16x32_bf16 v[108:111], a[124:127], a[240:243], v[108:111]
    ds_read_b128 a[232:235], v15 offset:6144
    v_mfma_f32_16x16x32_bf16 v[108:111], a[140:143], a[244:247], v[108:111]
    v_mfma_f32_16x16x32_bf16 v[104:107], a[136:139], a[244:247], v[104:107]
    buffer_load_dwordx4 a[152:155], v1, s[4:7], s44 offen offset:2048 sc1
    v_mfma_f32_16x16x32_bf16 v[104:107], a[120:123], a[240:243], v[104:107]
    v_mfma_f32_16x16x32_bf16 v[100:103], a[116:119], a[240:243], v[100:103]
    ds_read_b128 a[236:239], v16 offset:6144
    v_mfma_f32_16x16x32_bf16 v[100:103], a[132:135], a[244:247], v[100:103]
    v_mfma_f32_16x16x32_bf16 v[96:99], a[128:131], a[244:247], v[96:99]
    buffer_load_dwordx4 a[156:159], v1, s[4:7], s44 offen offset:3072 sc1
    v_mfma_f32_16x16x32_bf16 v[96:99], a[112:115], a[240:243], v[96:99]
    s_waitcnt lgkmcnt(2)
    v_mfma_f32_16x16x32_bf16 v[112:115], a[112:115], a[248:251], v[112:115]
    ds_read_b64_tr_b16 a[240:241], v17 offset:0
    ds_read_b64_tr_b16 a[242:243], v17 offset:3584
    v_mfma_f32_16x16x32_bf16 v[112:115], a[128:131], a[252:255], v[112:115]
    s_xor_b32 s44, s44, 4096
    v_mfma_f32_16x16x32_bf16 v[116:119], a[132:135], a[252:255], v[116:119]
    buffer_load_dwordx4 a[160:163], v1, s[4:7], s44 offen offset:0 sc1
    v_mfma_f32_16x16x32_bf16 v[116:119], a[116:119], a[248:251], v[116:119]
    v_mfma_f32_16x16x32_bf16 v[120:123], a[120:123], a[248:251], v[120:123]
    ds_read_b64_tr_b16 a[244:245], v17 offset:7168
    ds_read_b64_tr_b16 a[246:247], v17 offset:10752
    v_mfma_f32_16x16x32_bf16 v[120:123], a[136:139], a[252:255], v[120:123]
    v_mfma_f32_16x16x32_bf16 v[124:127], a[140:143], a[252:255], v[124:127]
    v_mfma_f32_16x16x32_bf16 v[124:127], a[124:127], a[248:251], v[124:127]
    s_waitcnt lgkmcnt(4)
    v_mfma_f32_16x16x32_bf16 v[140:143], a[124:127], a[232:235], v[140:143]
    ds_read_b64_tr_b16 a[248:249], v17 offset:14336
    ds_read_b64_tr_b16 a[250:251], v17 offset:17920
    v_mfma_f32_16x16x32_bf16 v[140:143], a[140:143], a[236:239], v[140:143]
    v_mfma_f32_16x16x32_bf16 v[136:139], a[136:139], a[236:239], v[136:139]
    buffer_load_dwordx4 a[164:167], v1, s[4:7], s44 offen offset:1024 sc1
    v_mfma_f32_16x16x32_bf16 v[136:139], a[120:123], a[232:235], v[136:139]
    v_mfma_f32_16x16x32_bf16 v[132:135], a[116:119], a[232:235], v[132:135]
    ds_read_b64_tr_b16 a[252:253], v17 offset:21504
    ds_read_b64_tr_b16 a[254:255], v17 offset:25088
    v_mfma_f32_16x16x32_bf16 v[132:135], a[132:135], a[236:239], v[132:135]
    v_mfma_f32_16x16x32_bf16 v[128:131], a[128:131], a[236:239], v[128:131]
    buffer_load_dwordx4 a[168:171], v1, s[4:7], s44 offen offset:2048 sc1
    v_mfma_f32_16x16x32_bf16 v[128:131], a[112:115], a[232:235], v[128:131]
    s_waitcnt lgkmcnt(4)
    v_mfma_f32_16x16x32_bf16 v[144:147], a[240:243], a[112:115], v[144:147]
    ds_read_b64_tr_b16 a[232:233], v17 offset:32
    ds_read_b64_tr_b16 a[234:235], v17 offset:3616
    v_mfma_f32_16x16x32_bf16 v[144:147], a[244:247], a[128:131], v[144:147]
    v_mfma_f32_16x16x32_bf16 v[148:151], a[244:247], a[132:135], v[148:151]
    buffer_load_dwordx4 a[172:175], v1, s[4:7], s44 offen offset:3072 sc1
    v_mfma_f32_16x16x32_bf16 v[148:151], a[240:243], a[116:119], v[148:151]
    v_mfma_f32_16x16x32_bf16 v[152:155], a[240:243], a[120:123], v[152:155]
    ds_read_b64_tr_b16 a[236:237], v17 offset:7200
    ds_read_b64_tr_b16 a[238:239], v17 offset:10784
    v_mfma_f32_16x16x32_bf16 v[152:155], a[244:247], a[136:139], v[152:155]
    v_mfma_f32_16x16x32_bf16 v[156:159], a[244:247], a[140:143], v[156:159]
    v_mfma_f32_16x16x32_bf16 v[156:159], a[240:243], a[124:127], v[156:159]
    s_waitcnt lgkmcnt(4)
    v_mfma_f32_16x16x32_bf16 a[12:15], a[248:251], a[124:127], a[12:15]
    ds_read_b64_tr_b16 a[240:241], v17 offset:14368
    ds_read_b64_tr_b16 a[242:243], v17 offset:17952
    v_mfma_f32_16x16x32_bf16 a[12:15], a[252:255], a[140:143], a[12:15]
    v_mfma_f32_16x16x32_bf16 a[8:11], a[252:255], a[136:139], a[8:11]
    buffer_load_dword v68, v79, s[4:7], 0 offen sc1
    v_mfma_f32_16x16x32_bf16 a[8:11], a[248:251], a[120:123], a[8:11]
    v_mfma_f32_16x16x32_bf16 a[4:7], a[248:251], a[116:119], a[4:7]
    ds_read_b64_tr_b16 a[244:245], v17 offset:21536
    ds_read_b64_tr_b16 a[246:247], v17 offset:25120
    v_mfma_f32_16x16x32_bf16 a[4:7], a[252:255], a[132:135], a[4:7]
    v_mfma_f32_16x16x32_bf16 a[0:3], a[252:255], a[128:131], a[0:3]
    buffer_load_dword v67, v66, s[4:7], 0 offen sc1
    v_mfma_f32_16x16x32_bf16 a[0:3], a[248:251], a[112:115], a[0:3]
    s_waitcnt lgkmcnt(4)
    v_mfma_f32_16x16x32_bf16 v[160:163], a[232:235], a[112:115], v[160:163]
    s_add_u32 s45, s45, 458752
    ds_read_b64_tr_b16 a[248:249], v17 offset:64
    ds_read_b64_tr_b16 a[250:251], v17 offset:3648
    v_mfma_f32_16x16x32_bf16 v[160:163], a[236:239], a[128:131], v[160:163]
    s_add_u32 m0, s47, 0
    v_mfma_f32_16x16x32_bf16 v[164:167], a[236:239], a[132:135], v[164:167]
    buffer_load_dwordx4 v2, s[8:11], s45 offen offset:0  lds
    v_mfma_f32_16x16x32_bf16 v[164:167], a[232:235], a[116:119], v[164:167]
    v_mfma_f32_16x16x32_bf16 v[168:171], a[232:235], a[120:123], v[168:171]
    ds_read_b64_tr_b16 a[252:253], v17 offset:7232
    ds_read_b64_tr_b16 a[254:255], v17 offset:10816
    v_mfma_f32_16x16x32_bf16 v[168:171], a[236:239], a[136:139], v[168:171]
    v_mfma_f32_16x16x32_bf16 v[172:175], a[236:239], a[140:143], v[172:175]
    v_mfma_f32_16x16x32_bf16 v[172:175], a[232:235], a[124:127], v[172:175]
    s_waitcnt lgkmcnt(4)
    v_mfma_f32_16x16x32_bf16 a[28:31], a[240:243], a[124:127], a[28:31]
    ds_read_b64_tr_b16 a[232:233], v17 offset:14400
    ds_read_b64_tr_b16 a[234:235], v17 offset:17984
    v_mfma_f32_16x16x32_bf16 a[28:31], a[244:247], a[140:143], a[28:31]
    v_mfma_f32_16x16x32_bf16 a[24:27], a[244:247], a[136:139], a[24:27]
    buffer_load_dwordx4 v3, s[8:11], s45 offen offset:1024  lds
    v_mfma_f32_16x16x32_bf16 a[24:27], a[240:243], a[120:123], a[24:27]
    v_mfma_f32_16x16x32_bf16 a[20:23], a[240:243], a[116:119], a[20:23]
    ds_read_b64_tr_b16 a[236:237], v17 offset:21568
    ds_read_b64_tr_b16 a[238:239], v17 offset:25152
    v_mfma_f32_16x16x32_bf16 a[20:23], a[244:247], a[132:135], a[20:23]
    v_mfma_f32_16x16x32_bf16 a[16:19], a[244:247], a[128:131], a[16:19]
    buffer_load_dwordx4 v4, s[8:11], s45 offen offset:2048  lds
    v_mfma_f32_16x16x32_bf16 a[16:19], a[240:243], a[112:115], a[16:19]
    s_waitcnt lgkmcnt(4)
    v_mfma_f32_16x16x32_bf16 v[176:179], a[248:251], a[112:115], v[176:179]
    ds_read_b64_tr_b16 a[240:241], v17 offset:96
    ds_read_b64_tr_b16 a[242:243], v17 offset:3680
    v_mfma_f32_16x16x32_bf16 v[176:179], a[252:255], a[128:131], v[176:179]
    v_mfma_f32_16x16x32_bf16 v[180:183], a[252:255], a[132:135], v[180:183]
    buffer_load_dwordx4 v5, s[8:11], s45 offen offset:3072  lds
    v_mfma_f32_16x16x32_bf16 v[180:183], a[248:251], a[116:119], v[180:183]
    v_mfma_f32_16x16x32_bf16 v[184:187], a[248:251], a[120:123], v[184:187]
    ds_read_b64_tr_b16 a[244:245], v17 offset:7264
    ds_read_b64_tr_b16 a[246:247], v17 offset:10848
    v_mfma_f32_16x16x32_bf16 v[184:187], a[252:255], a[136:139], v[184:187]
    v_mfma_f32_16x16x32_bf16 v[188:191], a[252:255], a[140:143], v[188:191]
    v_mfma_f32_16x16x32_bf16 v[188:191], a[248:251], a[124:127], v[188:191]
    s_waitcnt lgkmcnt(4)
    v_mfma_f32_16x16x32_bf16 a[44:47], a[232:235], a[124:127], a[44:47]
    s_add_u32 s46, s46, 128
    ds_read_b64_tr_b16 a[248:249], v17 offset:14432
    ds_read_b64_tr_b16 a[250:251], v17 offset:18016
    v_mfma_f32_16x16x32_bf16 a[44:47], a[236:239], a[140:143], a[44:47]
    s_add_u32 m0, s48, 0
    v_mfma_f32_16x16x32_bf16 a[40:43], a[236:239], a[136:139], a[40:43]
    buffer_load_dwordx4 v9, s[12:15], s46 offen offset:0  lds
    v_mfma_f32_16x16x32_bf16 a[40:43], a[232:235], a[120:123], a[40:43]
    v_mfma_f32_16x16x32_bf16 a[36:39], a[232:235], a[116:119], a[36:39]
    ds_read_b64_tr_b16 a[252:253], v17 offset:21600
    ds_read_b64_tr_b16 a[254:255], v17 offset:25184
    v_mfma_f32_16x16x32_bf16 a[36:39], a[236:239], a[132:135], a[36:39]
    v_mfma_f32_16x16x32_bf16 a[32:35], a[236:239], a[128:131], a[32:35]
    buffer_load_dwordx4 v10, s[12:15], s46 offen offset:1024  lds
    v_mfma_f32_16x16x32_bf16 a[32:35], a[232:235], a[112:115], a[32:35]
    s_waitcnt lgkmcnt(4)
    v_mfma_f32_16x16x32_bf16 v[192:195], a[240:243], a[112:115], v[192:195]
    ds_read_b64_tr_b16 a[232:233], v17 offset:128
    ds_read_b64_tr_b16 a[234:235], v17 offset:3712
    v_mfma_f32_16x16x32_bf16 v[192:195], a[244:247], a[128:131], v[192:195]
    s_add_u32 m0, s47, 4096
    v_mfma_f32_16x16x32_bf16 v[196:199], a[244:247], a[132:135], v[196:199]
    buffer_load_dwordx4 v6, s[8:11], s45 offen offset:0  lds
    v_mfma_f32_16x16x32_bf16 v[196:199], a[240:243], a[116:119], v[196:199]
    v_mfma_f32_16x16x32_bf16 v[200:203], a[240:243], a[120:123], v[200:203]
    ds_read_b64_tr_b16 a[236:237], v17 offset:7296
    ds_read_b64_tr_b16 a[238:239], v17 offset:10880
    v_mfma_f32_16x16x32_bf16 v[200:203], a[244:247], a[136:139], v[200:203]
    v_mfma_f32_16x16x32_bf16 v[204:207], a[244:247], a[140:143], v[204:207]
    v_mfma_f32_16x16x32_bf16 v[204:207], a[240:243], a[124:127], v[204:207]
    s_waitcnt lgkmcnt(4)
    v_mfma_f32_16x16x32_bf16 a[60:63], a[248:251], a[124:127], a[60:63]
    ds_read_b64_tr_b16 a[240:241], v17 offset:14464
    ds_read_b64_tr_b16 a[242:243], v17 offset:18048
    v_mfma_f32_16x16x32_bf16 a[60:63], a[252:255], a[140:143], a[60:63]
    v_mfma_f32_16x16x32_bf16 a[56:59], a[252:255], a[136:139], a[56:59]
    buffer_load_dwordx4 v7, s[8:11], s45 offen offset:1024  lds
    v_mfma_f32_16x16x32_bf16 a[56:59], a[248:251], a[120:123], a[56:59]
    v_mfma_f32_16x16x32_bf16 a[52:55], a[248:251], a[116:119], a[52:55]
    ds_read_b64_tr_b16 a[244:245], v17 offset:21632
    ds_read_b64_tr_b16 a[246:247], v17 offset:25216
    v_mfma_f32_16x16x32_bf16 a[52:55], a[252:255], a[132:135], a[52:55]
    v_mfma_f32_16x16x32_bf16 a[48:51], a[252:255], a[128:131], a[48:51]
    buffer_load_dwordx4 v8, s[8:11], s45 offen offset:2048  lds
    v_mfma_f32_16x16x32_bf16 a[48:51], a[248:251], a[112:115], a[48:51]
    s_waitcnt lgkmcnt(4)
    v_mfma_f32_16x16x32_bf16 v[208:211], a[232:235], a[112:115], v[208:211]
    ds_read_b64_tr_b16 a[248:249], v17 offset:160
    ds_read_b64_tr_b16 a[250:251], v17 offset:3744
    v_mfma_f32_16x16x32_bf16 v[208:211], a[236:239], a[128:131], v[208:211]
    v_mfma_f32_16x16x32_bf16 v[212:215], a[236:239], a[132:135], v[212:215]
    buffer_load_dwordx2 a[208:209], v72, s[40:43], s51 offen offset:0
    v_mfma_f32_16x16x32_bf16 v[212:215], a[232:235], a[116:119], v[212:215]
    v_mfma_f32_16x16x32_bf16 v[216:219], a[232:235], a[120:123], v[216:219]
    ds_read_b64_tr_b16 a[252:253], v17 offset:7328
    ds_read_b64_tr_b16 a[254:255], v17 offset:10912
    v_mfma_f32_16x16x32_bf16 v[216:219], a[236:239], a[136:139], v[216:219]
    v_mfma_f32_16x16x32_bf16 v[220:223], a[236:239], a[140:143], v[220:223]
    v_mfma_f32_16x16x32_bf16 v[220:223], a[232:235], a[124:127], v[220:223]
    s_waitcnt lgkmcnt(4)
    v_mfma_f32_16x16x32_bf16 a[76:79], a[240:243], a[124:127], a[76:79]
    ds_read_b64_tr_b16 a[232:233], v17 offset:14496
    ds_read_b64_tr_b16 a[234:235], v17 offset:18080
    v_mfma_f32_16x16x32_bf16 a[76:79], a[244:247], a[140:143], a[76:79]
    v_mfma_f32_16x16x32_bf16 a[72:75], a[244:247], a[136:139], a[72:75]
    buffer_load_dwordx2 a[210:211], v72, s[40:43], s51 offen offset:32
    v_mfma_f32_16x16x32_bf16 a[72:75], a[240:243], a[120:123], a[72:75]
    v_mfma_f32_16x16x32_bf16 a[68:71], a[240:243], a[116:119], a[68:71]
    ds_read_b64_tr_b16 a[236:237], v17 offset:21664
    ds_read_b64_tr_b16 a[238:239], v17 offset:25248
    v_mfma_f32_16x16x32_bf16 a[68:71], a[244:247], a[132:135], a[68:71]
    v_mfma_f32_16x16x32_bf16 a[64:67], a[244:247], a[128:131], a[64:67]
    buffer_load_dwordx4 a[192:195], v1, s[4:7], s59 offen offset:0 sc1
    v_mfma_f32_16x16x32_bf16 a[64:67], a[240:243], a[112:115], a[64:67]
    s_waitcnt lgkmcnt(4)
    v_mfma_f32_16x16x32_bf16 v[224:227], a[248:251], a[112:115], v[224:227]
    ds_read_b64_tr_b16 a[240:241], v17 offset:192
    ds_read_b64_tr_b16 a[242:243], v17 offset:3776
    v_mfma_f32_16x16x32_bf16 v[224:227], a[252:255], a[128:131], v[224:227]
    v_mfma_f32_16x16x32_bf16 v[228:231], a[252:255], a[132:135], v[228:231]
    buffer_load_dwordx4 a[176:179], v70, s[36:39], s58 offen
    v_mfma_f32_16x16x32_bf16 v[228:231], a[248:251], a[116:119], v[228:231]
    v_mfma_f32_16x16x32_bf16 v[232:235], a[248:251], a[120:123], v[232:235]
    ds_read_b64_tr_b16 a[244:245], v17 offset:7360
    ds_read_b64_tr_b16 a[246:247], v17 offset:10944
    v_mfma_f32_16x16x32_bf16 v[232:235], a[252:255], a[136:139], v[232:235]
    v_mfma_f32_16x16x32_bf16 v[236:239], a[252:255], a[140:143], v[236:239]
    v_mfma_f32_16x16x32_bf16 v[236:239], a[248:251], a[124:127], v[236:239]
    s_waitcnt lgkmcnt(4)
    v_mfma_f32_16x16x32_bf16 a[92:95], a[232:235], a[124:127], a[92:95]
    ds_read_b64_tr_b16 a[248:249], v17 offset:14528
    ds_read_b64_tr_b16 a[250:251], v17 offset:18112
    v_mfma_f32_16x16x32_bf16 a[92:95], a[236:239], a[140:143], a[92:95]
    v_mfma_f32_16x16x32_bf16 a[88:91], a[236:239], a[136:139], a[88:91]
    v_mfma_f32_16x16x32_bf16 a[88:91], a[232:235], a[120:123], a[88:91]
    v_mfma_f32_16x16x32_bf16 a[84:87], a[232:235], a[116:119], a[84:87]
    ds_read_b64_tr_b16 a[252:253], v17 offset:21696
    ds_read_b64_tr_b16 a[254:255], v17 offset:25280
    v_mfma_f32_16x16x32_bf16 a[84:87], a[236:239], a[132:135], a[84:87]
    v_mfma_f32_16x16x32_bf16 a[80:83], a[236:239], a[128:131], a[80:83]
    v_mfma_f32_16x16x32_bf16 a[80:83], a[232:235], a[112:115], a[80:83]
    s_waitcnt vmcnt(23) lgkmcnt(4)
    v_mfma_f32_16x16x32_bf16 v[240:243], a[240:243], a[112:115], v[240:243]
    s_barrier
    ds_read_b128 a[232:235], v15 offset:36864
    v_mfma_f32_16x16x32_bf16 v[240:243], a[244:247], a[128:131], v[240:243]
    v_mfma_f32_16x16x32_bf16 v[244:247], a[244:247], a[132:135], v[244:247]
    v_mfma_f32_16x16x32_bf16 v[244:247], a[240:243], a[116:119], v[244:247]
    v_mfma_f32_16x16x32_bf16 v[248:251], a[240:243], a[120:123], v[248:251]
    ds_read_b128 a[236:239], v16 offset:36864
    v_mfma_f32_16x16x32_bf16 v[248:251], a[244:247], a[136:139], v[248:251]
    v_mfma_f32_16x16x32_bf16 v[252:255], a[244:247], a[140:143], v[252:255]
    v_mfma_f32_16x16x32_bf16 v[252:255], a[240:243], a[124:127], v[252:255]
    s_waitcnt lgkmcnt(2)
    v_mfma_f32_16x16x32_bf16 a[108:111], a[248:251], a[124:127], a[108:111]
    ds_read_b128 a[240:243], v15 offset:40960
    v_mfma_f32_16x16x32_bf16 a[108:111], a[252:255], a[140:143], a[108:111]
    v_mfma_f32_16x16x32_bf16 a[104:107], a[252:255], a[136:139], a[104:107]
    v_mfma_f32_16x16x32_bf16 a[104:107], a[248:251], a[120:123], a[104:107]
    v_mfma_f32_16x16x32_bf16 a[100:103], a[248:251], a[116:119], a[100:103]
    ds_read_b128 a[244:247], v16 offset:40960
    v_mfma_f32_16x16x32_bf16 a[100:103], a[252:255], a[132:135], a[100:103]
    v_mfma_f32_16x16x32_bf16 a[96:99], a[252:255], a[128:131], a[96:99]
    v_mfma_f32_16x16x32_bf16 a[96:99], a[248:251], a[112:115], a[96:99]
    s_waitcnt vmcnt(15) lgkmcnt(2)
    v_mfma_f32_16x16x32_bf16 v[80:83], a[144:147], a[232:235], v[80:83]
    ds_read_b128 a[248:251], v15 offset:38912
    v_mfma_f32_16x16x32_bf16 v[80:83], a[160:163], a[236:239], v[80:83]
    s_xor_b32 s44, s44, 61440
    v_mfma_f32_16x16x32_bf16 v[84:87], a[164:167], a[236:239], v[84:87]
    buffer_load_dwordx4 a[112:115], v1, s[4:7], s44 offen offset:0 sc1
    v_mfma_f32_16x16x32_bf16 v[84:87], a[148:151], a[232:235], v[84:87]
    v_mfma_f32_16x16x32_bf16 v[88:91], a[152:155], a[232:235], v[88:91]
    ds_read_b128 a[252:255], v16 offset:38912
    v_mfma_f32_16x16x32_bf16 v[88:91], a[168:171], a[236:239], v[88:91]
    v_mfma_f32_16x16x32_bf16 v[92:95], a[172:175], a[236:239], v[92:95]
    buffer_load_dwordx4 a[116:119], v1, s[4:7], s44 offen offset:1024 sc1
    v_mfma_f32_16x16x32_bf16 v[92:95], a[156:159], a[232:235], v[92:95]
    s_waitcnt lgkmcnt(2)
    v_mfma_f32_16x16x32_bf16 v[108:111], a[156:159], a[240:243], v[108:111]
    ds_read_b128 a[232:235], v15 offset:43008
    v_mfma_f32_16x16x32_bf16 v[108:111], a[172:175], a[244:247], v[108:111]
    v_mfma_f32_16x16x32_bf16 v[104:107], a[168:171], a[244:247], v[104:107]
    buffer_load_dwordx4 a[120:123], v1, s[4:7], s44 offen offset:2048 sc1
    v_mfma_f32_16x16x32_bf16 v[104:107], a[152:155], a[240:243], v[104:107]
    v_mfma_f32_16x16x32_bf16 v[100:103], a[148:151], a[240:243], v[100:103]
    ds_read_b128 a[236:239], v16 offset:43008
    v_mfma_f32_16x16x32_bf16 v[100:103], a[164:167], a[244:247], v[100:103]
    v_mfma_f32_16x16x32_bf16 v[96:99], a[160:163], a[244:247], v[96:99]
    v_mfma_f32_16x16x32_bf16 v[96:99], a[144:147], a[240:243], v[96:99]
    s_waitcnt lgkmcnt(2)
    v_mfma_f32_16x16x32_bf16 v[112:115], a[144:147], a[248:251], v[112:115]
    ds_read_b64_tr_b16 a[240:241], v17 offset:36864
    ds_read_b64_tr_b16 a[242:243], v17 offset:40448
    v_mfma_f32_16x16x32_bf16 v[112:115], a[160:163], a[252:255], v[112:115]
    v_mfma_f32_16x16x32_bf16 v[116:119], a[164:167], a[252:255], v[116:119]
    buffer_load_dwordx4 a[124:127], v1, s[4:7], s44 offen offset:3072 sc1
    v_mfma_f32_16x16x32_bf16 v[116:119], a[148:151], a[248:251], v[116:119]
    v_mfma_f32_16x16x32_bf16 v[120:123], a[152:155], a[248:251], v[120:123]
    ds_read_b64_tr_b16 a[244:245], v17 offset:44032
    ds_read_b64_tr_b16 a[246:247], v17 offset:47616
    v_mfma_f32_16x16x32_bf16 v[120:123], a[168:171], a[252:255], v[120:123]
    v_mfma_f32_16x16x32_bf16 v[124:127], a[172:175], a[252:255], v[124:127]
    v_mfma_f32_16x16x32_bf16 v[124:127], a[156:159], a[248:251], v[124:127]
    s_waitcnt lgkmcnt(4)
    v_mfma_f32_16x16x32_bf16 v[140:143], a[156:159], a[232:235], v[140:143]
    ds_read_b64_tr_b16 a[248:249], v17 offset:51200
    ds_read_b64_tr_b16 a[250:251], v17 offset:54784
    v_mfma_f32_16x16x32_bf16 v[140:143], a[172:175], a[236:239], v[140:143]
    s_xor_b32 s44, s44, 4096
    v_mfma_f32_16x16x32_bf16 v[136:139], a[168:171], a[236:239], v[136:139]
    buffer_load_dwordx4 a[128:131], v1, s[4:7], s44 offen offset:0 sc1
    v_mfma_f32_16x16x32_bf16 v[136:139], a[152:155], a[232:235], v[136:139]
    v_mfma_f32_16x16x32_bf16 v[132:135], a[148:151], a[232:235], v[132:135]
    ds_read_b64_tr_b16 a[252:253], v17 offset:58368
    ds_read_b64_tr_b16 a[254:255], v17 offset:61952
    v_mfma_f32_16x16x32_bf16 v[132:135], a[164:167], a[236:239], v[132:135]
    v_mfma_f32_16x16x32_bf16 v[128:131], a[160:163], a[236:239], v[128:131]
    buffer_load_dwordx4 a[132:135], v1, s[4:7], s44 offen offset:1024 sc1
    v_mfma_f32_16x16x32_bf16 v[128:131], a[144:147], a[232:235], v[128:131]
    s_waitcnt lgkmcnt(4)
    v_mfma_f32_16x16x32_bf16 v[144:147], a[240:243], a[144:147], v[144:147]
    ds_read_b64_tr_b16 a[232:233], v17 offset:36896
    ds_read_b64_tr_b16 a[234:235], v17 offset:40480
    v_mfma_f32_16x16x32_bf16 v[144:147], a[244:247], a[160:163], v[144:147]
    v_mfma_f32_16x16x32_bf16 v[148:151], a[244:247], a[164:167], v[148:151]
    buffer_load_dwordx4 a[136:139], v1, s[4:7], s44 offen offset:2048 sc1
    v_mfma_f32_16x16x32_bf16 v[148:151], a[240:243], a[148:151], v[148:151]
    v_mfma_f32_16x16x32_bf16 v[152:155], a[240:243], a[152:155], v[152:155]
    ds_read_b64_tr_b16 a[236:237], v17 offset:44064
    ds_read_b64_tr_b16 a[238:239], v17 offset:47648
    v_mfma_f32_16x16x32_bf16 v[152:155], a[244:247], a[168:171], v[152:155]
    v_mfma_f32_16x16x32_bf16 v[156:159], a[244:247], a[172:175], v[156:159]
    v_mfma_f32_16x16x32_bf16 v[156:159], a[240:243], a[156:159], v[156:159]
    s_waitcnt lgkmcnt(4)
    v_mfma_f32_16x16x32_bf16 a[12:15], a[248:251], a[156:159], a[12:15]
    ds_read_b64_tr_b16 a[240:241], v17 offset:51232
    ds_read_b64_tr_b16 a[242:243], v17 offset:54816
    v_mfma_f32_16x16x32_bf16 a[12:15], a[252:255], a[172:175], a[12:15]
    v_mfma_f32_16x16x32_bf16 a[8:11], a[252:255], a[168:171], a[8:11]
    buffer_load_dwordx4 a[140:143], v1, s[4:7], s44 offen offset:3072 sc1
    v_mfma_f32_16x16x32_bf16 a[8:11], a[248:251], a[152:155], a[8:11]
    v_mfma_f32_16x16x32_bf16 a[4:7], a[248:251], a[148:151], a[4:7]
    ds_read_b64_tr_b16 a[244:245], v17 offset:58400
    ds_read_b64_tr_b16 a[246:247], v17 offset:61984
    v_mfma_f32_16x16x32_bf16 a[4:7], a[252:255], a[164:167], a[4:7]
    v_mfma_f32_16x16x32_bf16 a[0:3], a[252:255], a[160:163], a[0:3]
    v_mfma_f32_16x16x32_bf16 a[0:3], a[248:251], a[144:147], a[0:3]
    s_waitcnt lgkmcnt(4)
    v_mfma_f32_16x16x32_bf16 v[160:163], a[232:235], a[144:147], v[160:163]
    s_add_u32 s45, s45, 458752
    ds_read_b64_tr_b16 a[248:249], v17 offset:36928
    ds_read_b64_tr_b16 a[250:251], v17 offset:40512
    v_mfma_f32_16x16x32_bf16 v[160:163], a[236:239], a[160:163], v[160:163]
    s_add_u32 m0, s47, 36864
    v_mfma_f32_16x16x32_bf16 v[164:167], a[236:239], a[164:167], v[164:167]
    buffer_load_dwordx4 v2, s[8:11], s45 offen offset:0  lds
    v_mfma_f32_16x16x32_bf16 v[164:167], a[232:235], a[148:151], v[164:167]
    v_mfma_f32_16x16x32_bf16 v[168:171], a[232:235], a[152:155], v[168:171]
    ds_read_b64_tr_b16 a[252:253], v17 offset:44096
    ds_read_b64_tr_b16 a[254:255], v17 offset:47680
    v_mfma_f32_16x16x32_bf16 v[168:171], a[236:239], a[168:171], v[168:171]
    v_mfma_f32_16x16x32_bf16 v[172:175], a[236:239], a[172:175], v[172:175]
    v_mfma_f32_16x16x32_bf16 v[172:175], a[232:235], a[156:159], v[172:175]
    s_waitcnt lgkmcnt(4)
    v_mfma_f32_16x16x32_bf16 a[28:31], a[240:243], a[156:159], a[28:31]
    ds_read_b64_tr_b16 a[232:233], v17 offset:51264
    ds_read_b64_tr_b16 a[234:235], v17 offset:54848
    v_mfma_f32_16x16x32_bf16 a[28:31], a[244:247], a[172:175], a[28:31]
    v_mfma_f32_16x16x32_bf16 a[24:27], a[244:247], a[168:171], a[24:27]
    buffer_load_dwordx4 v3, s[8:11], s45 offen offset:1024  lds
    v_mfma_f32_16x16x32_bf16 a[24:27], a[240:243], a[152:155], a[24:27]
    v_mfma_f32_16x16x32_bf16 a[20:23], a[240:243], a[148:151], a[20:23]
    ds_read_b64_tr_b16 a[236:237], v17 offset:58432
    ds_read_b64_tr_b16 a[238:239], v17 offset:62016
    v_mfma_f32_16x16x32_bf16 a[20:23], a[244:247], a[164:167], a[20:23]
    v_mfma_f32_16x16x32_bf16 a[16:19], a[244:247], a[160:163], a[16:19]
    buffer_load_dwordx4 v4, s[8:11], s45 offen offset:2048  lds
    v_mfma_f32_16x16x32_bf16 a[16:19], a[240:243], a[144:147], a[16:19]
    s_waitcnt lgkmcnt(4)
    v_mfma_f32_16x16x32_bf16 v[176:179], a[248:251], a[144:147], v[176:179]
    ds_read_b64_tr_b16 a[240:241], v17 offset:36960
    ds_read_b64_tr_b16 a[242:243], v17 offset:40544
    v_mfma_f32_16x16x32_bf16 v[176:179], a[252:255], a[160:163], v[176:179]
    v_mfma_f32_16x16x32_bf16 v[180:183], a[252:255], a[164:167], v[180:183]
    buffer_load_dwordx4 v5, s[8:11], s45 offen offset:3072  lds
    v_mfma_f32_16x16x32_bf16 v[180:183], a[248:251], a[148:151], v[180:183]
    v_mfma_f32_16x16x32_bf16 v[184:187], a[248:251], a[152:155], v[184:187]
    ds_read_b64_tr_b16 a[244:245], v17 offset:44128
    ds_read_b64_tr_b16 a[246:247], v17 offset:47712
    v_mfma_f32_16x16x32_bf16 v[184:187], a[252:255], a[168:171], v[184:187]
    v_mfma_f32_16x16x32_bf16 v[188:191], a[252:255], a[172:175], v[188:191]
    v_mfma_f32_16x16x32_bf16 v[188:191], a[248:251], a[156:159], v[188:191]
    s_waitcnt lgkmcnt(4)
    v_mfma_f32_16x16x32_bf16 a[44:47], a[232:235], a[156:159], a[44:47]
    s_add_u32 s46, s46, 128
    ds_read_b64_tr_b16 a[248:249], v17 offset:51296
    ds_read_b64_tr_b16 a[250:251], v17 offset:54880
    v_mfma_f32_16x16x32_bf16 a[44:47], a[236:239], a[172:175], a[44:47]
    s_add_u32 m0, s48, 36864
    v_mfma_f32_16x16x32_bf16 a[40:43], a[236:239], a[168:171], a[40:43]
    buffer_load_dwordx4 v9, s[12:15], s46 offen offset:0  lds
    v_mfma_f32_16x16x32_bf16 a[40:43], a[232:235], a[152:155], a[40:43]
    v_mfma_f32_16x16x32_bf16 a[36:39], a[232:235], a[148:151], a[36:39]
    ds_read_b64_tr_b16 a[252:253], v17 offset:58464
    ds_read_b64_tr_b16 a[254:255], v17 offset:62048
    v_mfma_f32_16x16x32_bf16 a[36:39], a[236:239], a[164:167], a[36:39]
    v_mfma_f32_16x16x32_bf16 a[32:35], a[236:239], a[160:163], a[32:35]
    v_mfma_f32_16x16x32_bf16 a[32:35], a[232:235], a[144:147], a[32:35]
    s_waitcnt lgkmcnt(4)
    v_mfma_f32_16x16x32_bf16 v[192:195], a[240:243], a[144:147], v[192:195]
    ds_read_b64_tr_b16 a[232:233], v17 offset:36992
    ds_read_b64_tr_b16 a[234:235], v17 offset:40576
    v_mfma_f32_16x16x32_bf16 v[192:195], a[244:247], a[160:163], v[192:195]
    v_mfma_f32_16x16x32_bf16 v[196:199], a[244:247], a[164:167], v[196:199]
    buffer_load_dwordx4 v10, s[12:15], s46 offen offset:1024  lds
    v_mfma_f32_16x16x32_bf16 v[196:199], a[240:243], a[148:151], v[196:199]
    v_mfma_f32_16x16x32_bf16 v[200:203], a[240:243], a[152:155], v[200:203]
    ds_read_b64_tr_b16 a[236:237], v17 offset:44160
    ds_read_b64_tr_b16 a[238:239], v17 offset:47744
    v_mfma_f32_16x16x32_bf16 v[200:203], a[244:247], a[168:171], v[200:203]
    v_mfma_f32_16x16x32_bf16 v[204:207], a[244:247], a[172:175], v[204:207]
    v_mfma_f32_16x16x32_bf16 v[204:207], a[240:243], a[156:159], v[204:207]
    s_waitcnt lgkmcnt(4)
    v_mfma_f32_16x16x32_bf16 a[60:63], a[248:251], a[156:159], a[60:63]
    ds_read_b64_tr_b16 a[240:241], v17 offset:51328
    ds_read_b64_tr_b16 a[242:243], v17 offset:54912
    v_mfma_f32_16x16x32_bf16 a[60:63], a[252:255], a[172:175], a[60:63]
    s_add_u32 m0, s47, 40960
    v_mfma_f32_16x16x32_bf16 a[56:59], a[252:255], a[168:171], a[56:59]
    buffer_load_dwordx4 v6, s[8:11], s45 offen offset:0  lds
    v_mfma_f32_16x16x32_bf16 a[56:59], a[248:251], a[152:155], a[56:59]
    v_mfma_f32_16x16x32_bf16 a[52:55], a[248:251], a[148:151], a[52:55]
    ds_read_b64_tr_b16 a[244:245], v17 offset:58496
    ds_read_b64_tr_b16 a[246:247], v17 offset:62080
    v_mfma_f32_16x16x32_bf16 a[52:55], a[252:255], a[164:167], a[52:55]
    v_mfma_f32_16x16x32_bf16 a[48:51], a[252:255], a[160:163], a[48:51]
    buffer_load_dwordx4 v7, s[8:11], s45 offen offset:1024  lds
    v_mfma_f32_16x16x32_bf16 a[48:51], a[248:251], a[144:147], a[48:51]
    s_waitcnt lgkmcnt(4)
    v_mfma_f32_16x16x32_bf16 v[208:211], a[232:235], a[144:147], v[208:211]
    ds_read_b64_tr_b16 a[248:249], v17 offset:37024
    ds_read_b64_tr_b16 a[250:251], v17 offset:40608
    v_mfma_f32_16x16x32_bf16 v[208:211], a[236:239], a[160:163], v[208:211]
    v_mfma_f32_16x16x32_bf16 v[212:215], a[236:239], a[164:167], v[212:215]
    buffer_load_dwordx4 v8, s[8:11], s45 offen offset:2048  lds
    v_mfma_f32_16x16x32_bf16 v[212:215], a[232:235], a[148:151], v[212:215]
    v_mfma_f32_16x16x32_bf16 v[216:219], a[232:235], a[152:155], v[216:219]
    ds_read_b64_tr_b16 a[252:253], v17 offset:44192
    ds_read_b64_tr_b16 a[254:255], v17 offset:47776
    v_mfma_f32_16x16x32_bf16 v[216:219], a[236:239], a[168:171], v[216:219]
    v_mfma_f32_16x16x32_bf16 v[220:223], a[236:239], a[172:175], v[220:223]
    v_mfma_f32_16x16x32_bf16 v[220:223], a[232:235], a[156:159], v[220:223]
    s_waitcnt lgkmcnt(4)
    v_mfma_f32_16x16x32_bf16 a[76:79], a[240:243], a[156:159], a[76:79]
    ds_read_b64_tr_b16 a[232:233], v17 offset:51360
    ds_read_b64_tr_b16 a[234:235], v17 offset:54944
    v_mfma_f32_16x16x32_bf16 a[76:79], a[244:247], a[172:175], a[76:79]
    v_mfma_f32_16x16x32_bf16 a[72:75], a[244:247], a[168:171], a[72:75]
    buffer_load_dwordx4 a[196:199], v1, s[4:7], s59 offen offset:1024 sc1
    v_mfma_f32_16x16x32_bf16 a[72:75], a[240:243], a[152:155], a[72:75]
    v_mfma_f32_16x16x32_bf16 a[68:71], a[240:243], a[148:151], a[68:71]
    ds_read_b64_tr_b16 a[236:237], v17 offset:58528
    ds_read_b64_tr_b16 a[238:239], v17 offset:62112
    v_mfma_f32_16x16x32_bf16 a[68:71], a[244:247], a[164:167], a[68:71]
    v_mfma_f32_16x16x32_bf16 a[64:67], a[244:247], a[160:163], a[64:67]
    v_mfma_f32_16x16x32_bf16 a[64:67], a[240:243], a[144:147], a[64:67]
    s_waitcnt lgkmcnt(4)
    v_mfma_f32_16x16x32_bf16 v[224:227], a[248:251], a[144:147], v[224:227]
    ds_read_b64_tr_b16 a[240:241], v17 offset:37056
    ds_read_b64_tr_b16 a[242:243], v17 offset:40640
    v_mfma_f32_16x16x32_bf16 v[224:227], a[252:255], a[160:163], v[224:227]
    s_add_u32 s58, s58, 4096
    v_mfma_f32_16x16x32_bf16 v[228:231], a[252:255], a[164:167], v[228:231]
    buffer_load_dwordx4 a[180:183], v70, s[36:39], s58 offen
    v_mfma_f32_16x16x32_bf16 v[228:231], a[248:251], a[148:151], v[228:231]
    v_mfma_f32_16x16x32_bf16 v[232:235], a[248:251], a[152:155], v[232:235]
    ds_read_b64_tr_b16 a[244:245], v17 offset:44224
    ds_read_b64_tr_b16 a[246:247], v17 offset:47808
    v_mfma_f32_16x16x32_bf16 v[232:235], a[252:255], a[168:171], v[232:235]
    v_mfma_f32_16x16x32_bf16 v[236:239], a[252:255], a[172:175], v[236:239]
    v_mfma_f32_16x16x32_bf16 v[236:239], a[248:251], a[156:159], v[236:239]
    s_waitcnt lgkmcnt(4)
    v_mfma_f32_16x16x32_bf16 a[92:95], a[232:235], a[156:159], a[92:95]
    ds_read_b64_tr_b16 a[248:249], v17 offset:51392
    ds_read_b64_tr_b16 a[250:251], v17 offset:54976
    v_mfma_f32_16x16x32_bf16 a[92:95], a[236:239], a[172:175], a[92:95]
    v_mfma_f32_16x16x32_bf16 a[88:91], a[236:239], a[168:171], a[88:91]
    v_mfma_f32_16x16x32_bf16 a[88:91], a[232:235], a[152:155], a[88:91]
    v_mfma_f32_16x16x32_bf16 a[84:87], a[232:235], a[148:151], a[84:87]
    ds_read_b64_tr_b16 a[252:253], v17 offset:58560
    ds_read_b64_tr_b16 a[254:255], v17 offset:62144
    v_mfma_f32_16x16x32_bf16 a[84:87], a[236:239], a[164:167], a[84:87]
    v_mfma_f32_16x16x32_bf16 a[80:83], a[236:239], a[160:163], a[80:83]
    v_mfma_f32_16x16x32_bf16 a[80:83], a[232:235], a[144:147], a[80:83]
    s_waitcnt vmcnt(23) lgkmcnt(4)
    v_mfma_f32_16x16x32_bf16 v[240:243], a[240:243], a[144:147], v[240:243]
    s_barrier
    ds_read_b128 a[232:235], v13 offset:0
    v_mfma_f32_16x16x32_bf16 v[240:243], a[244:247], a[160:163], v[240:243]
    v_mfma_f32_16x16x32_bf16 v[244:247], a[244:247], a[164:167], v[244:247]
    v_mfma_f32_16x16x32_bf16 v[244:247], a[240:243], a[148:151], v[244:247]
    v_mfma_f32_16x16x32_bf16 v[248:251], a[240:243], a[152:155], v[248:251]
    ds_read_b128 a[236:239], v14 offset:0
    v_mfma_f32_16x16x32_bf16 v[248:251], a[244:247], a[168:171], v[248:251]
    v_mfma_f32_16x16x32_bf16 v[252:255], a[244:247], a[172:175], v[252:255]
    v_mfma_f32_16x16x32_bf16 v[252:255], a[240:243], a[156:159], v[252:255]
    s_waitcnt lgkmcnt(2)
    v_mfma_f32_16x16x32_bf16 a[108:111], a[248:251], a[156:159], a[108:111]
    ds_read_b128 a[240:243], v13 offset:4096
    v_mfma_f32_16x16x32_bf16 a[108:111], a[252:255], a[172:175], a[108:111]
    v_mfma_f32_16x16x32_bf16 a[104:107], a[252:255], a[168:171], a[104:107]
    v_mfma_f32_16x16x32_bf16 a[104:107], a[248:251], a[152:155], a[104:107]
    v_mfma_f32_16x16x32_bf16 a[100:103], a[248:251], a[148:151], a[100:103]
    ds_read_b128 a[244:247], v14 offset:4096
    v_mfma_f32_16x16x32_bf16 a[100:103], a[252:255], a[164:167], a[100:103]
    v_mfma_f32_16x16x32_bf16 a[96:99], a[252:255], a[160:163], a[96:99]
    v_mfma_f32_16x16x32_bf16 a[96:99], a[248:251], a[144:147], a[96:99]
    s_waitcnt vmcnt(11) lgkmcnt(2)
    v_mfma_f32_16x16x32_bf16 v[80:83], a[112:115], a[232:235], v[80:83]
    s_mov_b32 s60, 0
    ds_read_b128 a[248:251], v13 offset:2048
    v_mfma_f32_16x16x32_bf16 v[80:83], a[128:131], a[236:239], v[80:83]
    s_xor_b32 s44, s44, 12288
    v_subrev_u32 v68, s71, v68
    v_cmp_lt_u32 vcc, 47, v68
    v_mfma_f32_16x16x32_bf16 v[84:87], a[132:135], a[236:239], v[84:87]
    s_cbranch_vccnz SLOW_ID0
BACK_ID0:
    buffer_load_dwordx4 a[144:147], v1, s[4:7], s44 offen offset:0 sc1
    v_mfma_f32_16x16x32_bf16 v[84:87], a[116:119], a[232:235], v[84:87]
    v_cmp_lt_u32 s[76:77], 31, v68
    v_and_b32 v68, 15, v68
    v_mfma_f32_16x16x32_bf16 v[88:91], a[120:123], a[232:235], v[88:91]
    s_bcnt1_i32_b64 s61, s[76:77]
    ds_read_b128 a[252:255], v14 offset:2048
    s_and_b32 s76, s76, 0x55555555
    v_mfma_f32_16x16x32_bf16 v[88:91], a[136:139], a[236:239], v[88:91]
    s_and_b32 s77, s77, 0x55555555
    s_sub_u32 s60, s60, s61
    s_bcnt1_i32_b64 s61, s[76:77]
    v_mfma_f32_16x16x32_bf16 v[92:95], a[140:143], a[236:239], v[92:95]
    s_lshl1_add_u32 s60, s61, s60
    buffer_load_dwordx4 a[148:151], v1, s[4:7], s44 offen offset:1024 sc1
    v_mfma_f32_16x16x32_bf16 v[92:95], a[124:127], a[232:235], v[92:95]
    s_waitcnt lgkmcnt(2)
    v_cmp_ne_u32 s[76:77], s63, v68
    s_min_u32 s61, s60, 1
    v_mfma_f32_16x16x32_bf16 v[108:111], a[124:127], a[240:243], v[108:111]
    s_and_b32 s61, s61, s16
    ds_read_b128 a[232:235], v13 offset:6144
    s_lshr_b32 s60, s60, 31
    v_mfma_f32_16x16x32_bf16 v[108:111], a[140:143], a[244:247], v[108:111]
    s_xor_b32 s60, s60, s61
    s_lshl_b32 s60, s60, 13
    s_xor_b32 s69, s69, s60
    v_mfma_f32_16x16x32_bf16 v[104:107], a[136:139], a[244:247], v[104:107]
    s_xor_b32 s72, s72, s60
    buffer_load_dwordx4 a[152:155], v1, s[4:7], s44 offen offset:2048 sc1
    v_mfma_f32_16x16x32_bf16 v[104:107], a[120:123], a[240:243], v[104:107]
    s_mov_b32 s71, s69
    s_mov_b32 s0, s69
    s_and_b32 s76, s76, 0xff
    v_mfma_f32_16x16x32_bf16 v[100:103], a[116:119], a[240:243], v[100:103]
    s_mov_b32 s77, 0
    ds_read_b128 a[236:239], v14 offset:6144
    v_mfma_f32_16x16x32_bf16 v[100:103], a[132:135], a[244:247], v[100:103]
    v_cmp_ne_u32 vcc, s79, v67
    s_cbranch_vccnz SLOW_MF
BACK_MF:
    v_mfma_f32_16x16x32_bf16 v[96:99], a[128:131], a[244:247], v[96:99]
    v_mfma_f32_16x16x32_bf16 v[96:99], a[112:115], a[240:243], v[96:99]
    s_waitcnt lgkmcnt(2)
    v_mfma_f32_16x16x32_bf16 v[112:115], a[112:115], a[248:251], v[112:115]
    ds_read_b64_tr_b16 a[240:241], v11 offset:0
    ds_read_b64_tr_b16 a[242:243], v11 offset:3584
    v_mfma_f32_16x16x32_bf16 v[112:115], a[128:131], a[252:255], v[112:115]
    v_mfma_f32_16x16x32_bf16 v[116:119], a[132:135], a[252:255], v[116:119]
    buffer_load_dwordx4 a[156:159], v1, s[4:7], s44 offen offset:3072 sc1
    v_mfma_f32_16x16x32_bf16 v[116:119], a[116:119], a[248:251], v[116:119]
    v_mfma_f32_16x16x32_bf16 v[120:123], a[120:123], a[248:251], v[120:123]
    ds_read_b64_tr_b16 a[244:245], v11 offset:7168
    ds_read_b64_tr_b16 a[246:247], v11 offset:10752
    v_mfma_f32_16x16x32_bf16 v[120:123], a[136:139], a[252:255], v[120:123]
    v_mfma_f32_16x16x32_bf16 v[124:127], a[140:143], a[252:255], v[124:127]
    v_mfma_f32_16x16x32_bf16 v[124:127], a[124:127], a[248:251], v[124:127]
    s_waitcnt lgkmcnt(4)
    v_mfma_f32_16x16x32_bf16 v[140:143], a[124:127], a[232:235], v[140:143]
    ds_read_b64_tr_b16 a[248:249], v11 offset:14336
    ds_read_b64_tr_b16 a[250:251], v11 offset:17920
    v_mfma_f32_16x16x32_bf16 v[140:143], a[140:143], a[236:239], v[140:143]
    s_xor_b32 s44, s44, 4096
    v_mfma_f32_16x16x32_bf16 v[136:139], a[136:139], a[236:239], v[136:139]
    buffer_load_dwordx4 a[160:163], v1, s[4:7], s44 offen offset:0 sc1
    v_mfma_f32_16x16x32_bf16 v[136:139], a[120:123], a[232:235], v[136:139]
    v_mfma_f32_16x16x32_bf16 v[132:135], a[116:119], a[232:235], v[132:135]
    ds_read_b64_tr_b16 a[252:253], v11 offset:21504
    ds_read_b64_tr_b16 a[254:255], v11 offset:25088
    v_mfma_f32_16x16x32_bf16 v[132:135], a[132:135], a[236:239], v[132:135]
    v_mfma_f32_16x16x32_bf16 v[128:131], a[128:131], a[236:239], v[128:131]
    buffer_load_dwordx4 a[164:167], v1, s[4:7], s44 offen offset:1024 sc1
    v_mfma_f32_16x16x32_bf16 v[128:131], a[112:115], a[232:235], v[128:131]
    s_waitcnt lgkmcnt(4)
    v_mfma_f32_16x16x32_bf16 v[144:147], a[240:243], a[112:115], v[144:147]
    ds_read_b64_tr_b16 a[232:233], v11 offset:32
    ds_read_b64_tr_b16 a[234:235], v11 offset:3616
    v_mfma_f32_16x16x32_bf16 v[144:147], a[244:247], a[128:131], v[144:147]
    v_mfma_f32_16x16x32_bf16 v[148:151], a[244:247], a[132:135], v[148:151]
    buffer_load_dwordx4 a[168:171], v1, s[4:7], s44 offen offset:2048 sc1
    v_mfma_f32_16x16x32_bf16 v[148:151], a[240:243], a[116:119], v[148:151]
    v_mfma_f32_16x16x32_bf16 v[152:155], a[240:243], a[120:123], v[152:155]
    ds_read_b64_tr_b16 a[236:237], v11 offset:7200
    ds_read_b64_tr_b16 a[238:239], v11 offset:10784
    v_mfma_f32_16x16x32_bf16 v[152:155], a[244:247], a[136:139], v[152:155]
    v_mfma_f32_16x16x32_bf16 v[156:159], a[244:247], a[140:143], v[156:159]
    v_mfma_f32_16x16x32_bf16 v[156:159], a[240:243], a[124:127], v[156:159]
    s_waitcnt lgkmcnt(4)
    v_mfma_f32_16x16x32_bf16 a[12:15], a[248:251], a[124:127], a[12:15]
    ds_read_b64_tr_b16 a[240:241], v11 offset:14368
    ds_read_b64_tr_b16 a[242:243], v11 offset:17952
    v_mfma_f32_16x16x32_bf16 a[12:15], a[252:255], a[140:143], a[12:15]
    v_mfma_f32_16x16x32_bf16 a[8:11], a[252:255], a[136:139], a[8:11]
    buffer_load_dwordx4 a[172:175], v1, s[4:7], s44 offen offset:3072 sc1
    v_mfma_f32_16x16x32_bf16 a[8:11], a[248:251], a[120:123], a[8:11]
    v_mfma_f32_16x16x32_bf16 a[4:7], a[248:251], a[116:119], a[4:7]
    ds_read_b64_tr_b16 a[244:245], v11 offset:21536
    ds_read_b64_tr_b16 a[246:247], v11 offset:25120
    v_mfma_f32_16x16x32_bf16 a[4:7], a[252:255], a[132:135], a[4:7]
    v_mfma_f32_16x16x32_bf16 a[0:3], a[252:255], a[128:131], a[0:3]
    v_mfma_f32_16x16x32_bf16 a[0:3], a[248:251], a[112:115], a[0:3]
    s_waitcnt lgkmcnt(4)
    v_mfma_f32_16x16x32_bf16 v[160:163], a[232:235], a[112:115], v[160:163]
    s_add_u32 s45, s45, 458752
    ds_read_b64_tr_b16 a[248:249], v11 offset:64
    ds_read_b64_tr_b16 a[250:251], v11 offset:3648
    v_mfma_f32_16x16x32_bf16 v[160:163], a[236:239], a[128:131], v[160:163]
    s_add_u32 m0, s47, 73728
    v_mfma_f32_16x16x32_bf16 v[164:167], a[236:239], a[132:135], v[164:167]
    buffer_load_dwordx4 v2, s[8:11], s45 offen offset:0  lds
    v_mfma_f32_16x16x32_bf16 v[164:167], a[232:235], a[116:119], v[164:167]
    v_mfma_f32_16x16x32_bf16 v[168:171], a[232:235], a[120:123], v[168:171]
    ds_read_b64_tr_b16 a[252:253], v11 offset:7232
    ds_read_b64_tr_b16 a[254:255], v11 offset:10816
    v_mfma_f32_16x16x32_bf16 v[168:171], a[236:239], a[136:139], v[168:171]
    v_mfma_f32_16x16x32_bf16 v[172:175], a[236:239], a[140:143], v[172:175]
    v_mfma_f32_16x16x32_bf16 v[172:175], a[232:235], a[124:127], v[172:175]
    s_waitcnt lgkmcnt(4)
    v_mfma_f32_16x16x32_bf16 a[28:31], a[240:243], a[124:127], a[28:31]
    ds_read_b64_tr_b16 a[232:233], v11 offset:14400
    ds_read_b64_tr_b16 a[234:235], v11 offset:17984
    v_mfma_f32_16x16x32_bf16 a[28:31], a[244:247], a[140:143], a[28:31]
    v_mfma_f32_16x16x32_bf16 a[24:27], a[244:247], a[136:139], a[24:27]
    buffer_load_dwordx4 v3, s[8:11], s45 offen offset:1024  lds
    v_mfma_f32_16x16x32_bf16 a[24:27], a[240:243], a[120:123], a[24:27]
    v_mfma_f32_16x16x32_bf16 a[20:23], a[240:243], a[116:119], a[20:23]
    ds_read_b64_tr_b16 a[236:237], v11 offset:21568
    ds_read_b64_tr_b16 a[238:239], v11 offset:25152
    v_mfma_f32_16x16x32_bf16 a[20:23], a[244:247], a[132:135], a[20:23]
    v_mfma_f32_16x16x32_bf16 a[16:19], a[244:247], a[128:131], a[16:19]
    buffer_load_dwordx4 v4, s[8:11], s45 offen offset:2048  lds
    v_mfma_f32_16x16x32_bf16 a[16:19], a[240:243], a[112:115], a[16:19]
    s_waitcnt lgkmcnt(4)
    v_mfma_f32_16x16x32_bf16 v[176:179], a[248:251], a[112:115], v[176:179]
    ds_read_b64_tr_b16 a[240:241], v11 offset:96
    ds_read_b64_tr_b16 a[242:243], v11 offset:3680
    v_mfma_f32_16x16x32_bf16 v[176:179], a[252:255], a[128:131], v[176:179]
    v_mfma_f32_16x16x32_bf16 v[180:183], a[252:255], a[132:135], v[180:183]
    buffer_load_dwordx4 v5, s[8:11], s45 offen offset:3072  lds
    v_mfma_f32_16x16x32_bf16 v[180:183], a[248:251], a[116:119], v[180:183]
    v_mfma_f32_16x16x32_bf16 v[184:187], a[248:251], a[120:123], v[184:187]
    ds_read_b64_tr_b16 a[244:245], v11 offset:7264
    ds_read_b64_tr_b16 a[246:247], v11 offset:10848
    v_mfma_f32_16x16x32_bf16 v[184:187], a[252:255], a[136:139], v[184:187]
    v_mfma_f32_16x16x32_bf16 v[188:191], a[252:255], a[140:143], v[188:191]
    v_mfma_f32_16x16x32_bf16 v[188:191], a[248:251], a[124:127], v[188:191]
    s_waitcnt lgkmcnt(4)
    v_mfma_f32_16x16x32_bf16 a[44:47], a[232:235], a[124:127], a[44:47]
    s_add_u32 s46, s46, 128
    ds_read_b64_tr_b16 a[248:249], v11 offset:14432
    ds_read_b64_tr_b16 a[250:251], v11 offset:18016
    v_mfma_f32_16x16x32_bf16 a[44:47], a[236:239], a[140:143], a[44:47]
    s_add_u32 m0, s48, 73728
    v_mfma_f32_16x16x32_bf16 a[40:43], a[236:239], a[136:139], a[40:43]
    buffer_load_dwordx4 v9, s[12:15], s46 offen offset:0  lds
    v_mfma_f32_16x16x32_bf16 a[40:43], a[232:235], a[120:123], a[40:43]
    v_mfma_f32_16x16x32_bf16 a[36:39], a[232:235], a[116:119], a[36:39]
    ds_read_b64_tr_b16 a[252:253], v11 offset:21600
    ds_read_b64_tr_b16 a[254:255], v11 offset:25184
    v_mfma_f32_16x16x32_bf16 a[36:39], a[236:239], a[132:135], a[36:39]
    v_mfma_f32_16x16x32_bf16 a[32:35], a[236:239], a[128:131], a[32:35]
    v_mfma_f32_16x16x32_bf16 a[32:35], a[232:235], a[112:115], a[32:35]
    s_waitcnt lgkmcnt(4)
    v_mfma_f32_16x16x32_bf16 v[192:195], a[240:243], a[112:115], v[192:195]
    ds_read_b64_tr_b16 a[232:233], v11 offset:128
    ds_read_b64_tr_b16 a[234:235], v11 offset:3712
    v_mfma_f32_16x16x32_bf16 v[192:195], a[244:247], a[128:131], v[192:195]
    v_mfma_f32_16x16x32_bf16 v[196:199], a[244:247], a[132:135], v[196:199]
    buffer_load_dwordx4 v10, s[12:15], s46 offen offset:1024  lds
    v_mfma_f32_16x16x32_bf16 v[196:199], a[240:243], a[116:119], v[196:199]
    v_mfma_f32_16x16x32_bf16 v[200:203], a[240:243], a[120:123], v[200:203]
    ds_read_b64_tr_b16 a[236:237], v11 offset:7296
    ds_read_b64_tr_b16 a[238:239], v11 offset:10880
    v_mfma_f32_16x16x32_bf16 v[200:203], a[244:247], a[136:139], v[200:203]
    v_mfma_f32_16x16x32_bf16 v[204:207], a[244:247], a[140:143], v[204:207]
    v_mfma_f32_16x16x32_bf16 v[204:207], a[240:243], a[124:127], v[204:207]
    s_waitcnt lgkmcnt(4)
    v_mfma_f32_16x16x32_bf16 a[60:63], a[248:251], a[124:127], a[60:63]
    ds_read_b64_tr_b16 a[240:241], v11 offset:14464
    ds_read_b64_tr_b16 a[242:243], v11 offset:18048
    v_mfma_f32_16x16x32_bf16 a[60:63], a[252:255], a[140:143], a[60:63]
    s_add_u32 m0, s47, 77824
    v_mfma_f32_16x16x32_bf16 a[56:59], a[252:255], a[136:139], a[56:59]
    buffer_load_dwordx4 v6, s[8:11], s45 offen offset:0  lds
    v_mfma_f32_16x16x32_bf16 a[56:59], a[248:251], a[120:123], a[56:59]
    v_mfma_f32_16x16x32_bf16 a[52:55], a[248:251], a[116:119], a[52:55]
    ds_read_b64_tr_b16 a[244:245], v11 offset:21632
    ds_read_b64_tr_b16 a[246:247], v11 offset:25216
    v_mfma_f32_16x16x32_bf16 a[52:55], a[252:255], a[132:135], a[52:55]
    v_mfma_f32_16x16x32_bf16 a[48:51], a[252:255], a[128:131], a[48:51]
    buffer_load_dwordx4 v7, s[8:11], s45 offen offset:1024  lds
    v_mfma_f32_16x16x32_bf16 a[48:51], a[248:251], a[112:115], a[48:51]
    s_waitcnt lgkmcnt(4)
    v_mfma_f32_16x16x32_bf16 v[208:211], a[232:235], a[112:115], v[208:211]
    ds_read_b64_tr_b16 a[248:249], v11 offset:160
    ds_read_b64_tr_b16 a[250:251], v11 offset:3744
    v_mfma_f32_16x16x32_bf16 v[208:211], a[236:239], a[128:131], v[208:211]
    v_mfma_f32_16x16x32_bf16 v[212:215], a[236:239], a[132:135], v[212:215]
    buffer_load_dwordx4 v8, s[8:11], s45 offen offset:2048  lds
    v_mfma_f32_16x16x32_bf16 v[212:215], a[232:235], a[116:119], v[212:215]
    v_mfma_f32_16x16x32_bf16 v[216:219], a[232:235], a[120:123], v[216:219]
    ds_read_b64_tr_b16 a[252:253], v11 offset:7328
    ds_read_b64_tr_b16 a[254:255], v11 offset:10912
    v_mfma_f32_16x16x32_bf16 v[216:219], a[236:239], a[136:139], v[216:219]
    v_mfma_f32_16x16x32_bf16 v[220:223], a[236:239], a[140:143], v[220:223]
    v_mfma_f32_16x16x32_bf16 v[220:223], a[232:235], a[124:127], v[220:223]
    s_waitcnt lgkmcnt(4)
    v_mfma_f32_16x16x32_bf16 a[76:79], a[240:243], a[124:127], a[76:79]
    ds_read_b64_tr_b16 a[232:233], v11 offset:14496
    ds_read_b64_tr_b16 a[234:235], v11 offset:18080
    v_mfma_f32_16x16x32_bf16 a[76:79], a[244:247], a[140:143], a[76:79]
    v_mfma_f32_16x16x32_bf16 a[72:75], a[244:247], a[136:139], a[72:75]
    buffer_load_dwordx4 a[200:203], v1, s[4:7], s59 offen offset:2048 sc1
    v_mfma_f32_16x16x32_bf16 a[72:75], a[240:243], a[120:123], a[72:75]
    v_mfma_f32_16x16x32_bf16 a[68:71], a[240:243], a[116:119], a[68:71]
    ds_read_b64_tr_b16 a[236:237], v11 offset:21664
    ds_read_b64_tr_b16 a[238:239], v11 offset:25248
    v_mfma_f32_16x16x32_bf16 a[68:71], a[244:247], a[132:135], a[68:71]
    v_mfma_f32_16x16x32_bf16 a[64:67], a[244:247], a[128:131], a[64:67]
    v_mfma_f32_16x16x32_bf16 a[64:67], a[240:243], a[112:115], a[64:67]
    s_waitcnt lgkmcnt(4)
    v_mfma_f32_16x16x32_bf16 v[224:227], a[248:251], a[112:115], v[224:227]
    ds_read_b64_tr_b16 a[240:241], v11 offset:192
    ds_read_b64_tr_b16 a[242:243], v11 offset:3776
    v_mfma_f32_16x16x32_bf16 v[224:227], a[252:255], a[128:131], v[224:227]
    s_add_u32 s58, s58, 4096
    v_mfma_f32_16x16x32_bf16 v[228:231], a[252:255], a[132:135], v[228:231]
    buffer_load_dwordx4 a[184:187], v70, s[36:39], s58 offen
    v_mfma_f32_16x16x32_bf16 v[228:231], a[248:251], a[116:119], v[228:231]
    v_mfma_f32_16x16x32_bf16 v[232:235], a[248:251], a[120:123], v[232:235]
    ds_read_b64_tr_b16 a[244:245], v11 offset:7360
    ds_read_b64_tr_b16 a[246:247], v11 offset:10944
    v_mfma_f32_16x16x32_bf16 v[232:235], a[252:255], a[136:139], v[232:235]
    v_mfma_f32_16x16x32_bf16 v[236:239], a[252:255], a[140:143], v[236:239]
    v_mfma_f32_16x16x32_bf16 v[236:239], a[248:251], a[124:127], v[236:239]
    s_waitcnt lgkmcnt(4)
    v_mfma_f32_16x16x32_bf16 a[92:95], a[232:235], a[124:127], a[92:95]
    ds_read_b64_tr_b16 a[248:249], v11 offset:14528
    ds_read_b64_tr_b16 a[250:251], v11 offset:18112
    v_mfma_f32_16x16x32_bf16 a[92:95], a[236:239], a[140:143], a[92:95]
    v_mfma_f32_16x16x32_bf16 a[88:91], a[236:239], a[136:139], a[88:91]
    v_mfma_f32_16x16x32_bf16 a[88:91], a[232:235], a[120:123], a[88:91]
    v_mfma_f32_16x16x32_bf16 a[84:87], a[232:235], a[116:119], a[84:87]
    ds_read_b64_tr_b16 a[252:253], v11 offset:21696
    ds_read_b64_tr_b16 a[254:255], v11 offset:25280
    v_mfma_f32_16x16x32_bf16 a[84:87], a[236:239], a[132:135], a[84:87]
    v_mfma_f32_16x16x32_bf16 a[80:83], a[236:239], a[128:131], a[80:83]
    v_mfma_f32_16x16x32_bf16 a[80:83], a[232:235], a[112:115], a[80:83]
    s_waitcnt vmcnt(21) lgkmcnt(4)
    v_mfma_f32_16x16x32_bf16 v[240:243], a[240:243], a[112:115], v[240:243]
    s_barrier
    ds_read_b128 a[232:235], v13 offset:36864
    v_mfma_f32_16x16x32_bf16 v[240:243], a[244:247], a[128:131], v[240:243]
    v_mfma_f32_16x16x32_bf16 v[244:247], a[244:247], a[132:135], v[244:247]
    v_mfma_f32_16x16x32_bf16 v[244:247], a[240:243], a[116:119], v[244:247]
    v_mfma_f32_16x16x32_bf16 v[248:251], a[240:243], a[120:123], v[248:251]
    ds_read_b128 a[236:239], v14 offset:36864
    v_mfma_f32_16x16x32_bf16 v[248:251], a[244:247], a[136:139], v[248:251]
    v_mfma_f32_16x16x32_bf16 v[252:255], a[244:247], a[140:143], v[252:255]
    v_mfma_f32_16x16x32_bf16 v[252:255], a[240:243], a[124:127], v[252:255]
    s_waitcnt lgkmcnt(2)
    v_mfma_f32_16x16x32_bf16 a[108:111], a[248:251], a[124:127], a[108:111]
    ds_read_b128 a[240:243], v13 offset:40960
    v_mfma_f32_16x16x32_bf16 a[108:111], a[252:255], a[140:143], a[108:111]
    v_mfma_f32_16x16x32_bf16 a[104:107], a[252:255], a[136:139], a[104:107]
    v_mfma_f32_16x16x32_bf16 a[104:107], a[248:251], a[120:123], a[104:107]
    v_mfma_f32_16x16x32_bf16 a[100:103], a[248:251], a[116:119], a[100:103]
    ds_read_b128 a[244:247], v14 offset:40960
    v_mfma_f32_16x16x32_bf16 a[100:103], a[252:255], a[132:135], a[100:103]
    v_mfma_f32_16x16x32_bf16 a[96:99], a[252:255], a[128:131], a[96:99]
    v_mfma_f32_16x16x32_bf16 a[96:99], a[248:251], a[112:115], a[96:99]
    s_waitcnt vmcnt(11) lgkmcnt(2)
    v_mfma_f32_16x16x32_bf16 v[80:83], a[144:147], a[232:235], v[80:83]
    ds_read_b128 a[248:251], v13 offset:38912
    v_mfma_f32_16x16x32_bf16 v[80:83], a[160:163], a[236:239], v[80:83]
    s_xor_b32 s44, s44, 28672
    v_mfma_f32_16x16x32_bf16 v[84:87], a[164:167], a[236:239], v[84:87]
    buffer_load_dwordx4 a[112:115], v1, s[4:7], s44 offen offset:0 sc1
    v_mfma_f32_16x16x32_bf16 v[84:87], a[148:151], a[232:235], v[84:87]
    v_mfma_f32_16x16x32_bf16 v[88:91], a[152:155], a[232:235], v[88:91]
    ds_read_b128 a[252:255], v14 offset:38912
    v_mfma_f32_16x16x32_bf16 v[88:91], a[168:171], a[236:239], v[88:91]
    v_mfma_f32_16x16x32_bf16 v[92:95], a[172:175], a[236:239], v[92:95]
    buffer_load_dwordx4 a[116:119], v1, s[4:7], s44 offen offset:1024 sc1
    v_mfma_f32_16x16x32_bf16 v[92:95], a[156:159], a[232:235], v[92:95]
    s_waitcnt lgkmcnt(2)
    v_mfma_f32_16x16x32_bf16 v[108:111], a[156:159], a[240:243], v[108:111]
    ds_read_b128 a[232:235], v13 offset:43008
    v_mfma_f32_16x16x32_bf16 v[108:111], a[172:175], a[244:247], v[108:111]
    v_mfma_f32_16x16x32_bf16 v[104:107], a[168:171], a[244:247], v[104:107]
    buffer_load_dwordx4 a[120:123], v1, s[4:7], s44 offen offset:2048 sc1
    v_mfma_f32_16x16x32_bf16 v[104:107], a[152:155], a[240:243], v[104:107]
    v_mfma_f32_16x16x32_bf16 v[100:103], a[148:151], a[240:243], v[100:103]
    ds_read_b128 a[236:239], v14 offset:43008
    v_mfma_f32_16x16x32_bf16 v[100:103], a[164:167], a[244:247], v[100:103]
    v_mfma_f32_16x16x32_bf16 v[96:99], a[160:163], a[244:247], v[96:99]
    v_mfma_f32_16x16x32_bf16 v[96:99], a[144:147], a[240:243], v[96:99]
    s_waitcnt lgkmcnt(2)
    v_mfma_f32_16x16x32_bf16 v[112:115], a[144:147], a[248:251], v[112:115]
    ds_read_b64_tr_b16 a[240:241], v11 offset:36864
    ds_read_b64_tr_b16 a[242:243], v11 offset:40448
    v_mfma_f32_16x16x32_bf16 v[112:115], a[160:163], a[252:255], v[112:115]
    v_mfma_f32_16x16x32_bf16 v[116:119], a[164:167], a[252:255], v[116:119]
    buffer_load_dwordx4 a[124:127], v1, s[4:7], s44 offen offset:3072 sc1
    v_mfma_f32_16x16x32_bf16 v[116:119], a[148:151], a[248:251], v[116:119]
    v_mfma_f32_16x16x32_bf16 v[120:123], a[152:155], a[248:251], v[120:123]
    ds_read_b64_tr_b16 a[244:245], v11 offset:44032
    ds_read_b64_tr_b16 a[246:247], v11 offset:47616
    v_mfma_f32_16x16x32_bf16 v[120:123], a[168:171], a[252:255], v[120:123]
    v_mfma_f32_16x16x32_bf16 v[124:127], a[172:175], a[252:255], v[124:127]
    v_mfma_f32_16x16x32_bf16 v[124:127], a[156:159], a[248:251], v[124:127]
    s_waitcnt lgkmcnt(4)
    v_mfma_f32_16x16x32_bf16 v[140:143], a[156:159], a[232:235], v[140:143]
    ds_read_b64_tr_b16 a[248:249], v11 offset:51200
    ds_read_b64_tr_b16 a[250:251], v11 offset:54784
    v_mfma_f32_16x16x32_bf16 v[140:143], a[172:175], a[236:239], v[140:143]
    s_xor_b32 s44, s44, 4096
    v_mfma_f32_16x16x32_bf16 v[136:139], a[168:171], a[236:239], v[136:139]
    buffer_load_dwordx4 a[128:131], v1, s[4:7], s44 offen offset:0 sc1
    v_mfma_f32_16x16x32_bf16 v[136:139], a[152:155], a[232:235], v[136:139]
    v_mfma_f32_16x16x32_bf16 v[132:135], a[148:151], a[232:235], v[132:135]
    ds_read_b64_tr_b16 a[252:253], v11 offset:58368
    ds_read_b64_tr_b16 a[254:255], v11 offset:61952
    v_mfma_f32_16x16x32_bf16 v[132:135], a[164:167], a[236:239], v[132:135]
    v_mfma_f32_16x16x32_bf16 v[128:131], a[160:163], a[236:239], v[128:131]
    buffer_load_dwordx4 a[132:135], v1, s[4:7], s44 offen offset:1024 sc1
    v_mfma_f32_16x16x32_bf16 v[128:131], a[144:147], a[232:235], v[128:131]
    s_waitcnt lgkmcnt(4)
    v_mfma_f32_16x16x32_bf16 v[144:147], a[240:243], a[144:147], v[144:147]
    ds_read_b64_tr_b16 a[232:233], v11 offset:36896
    ds_read_b64_tr_b16 a[234:235], v11 offset:40480
    v_mfma_f32_16x16x32_bf16 v[144:147], a[244:247], a[160:163], v[144:147]
    v_mfma_f32_16x16x32_bf16 v[148:151], a[244:247], a[164:167], v[148:151]
    buffer_load_dwordx4 a[136:139], v1, s[4:7], s44 offen offset:2048 sc1
    v_mfma_f32_16x16x32_bf16 v[148:151], a[240:243], a[148:151], v[148:151]
    v_mfma_f32_16x16x32_bf16 v[152:155], a[240:243], a[152:155], v[152:155]
    ds_read_b64_tr_b16 a[236:237], v11 offset:44064
    ds_read_b64_tr_b16 a[238:239], v11 offset:47648
    v_mfma_f32_16x16x32_bf16 v[152:155], a[244:247], a[168:171], v[152:155]
    v_mfma_f32_16x16x32_bf16 v[156:159], a[244:247], a[172:175], v[156:159]
    v_mfma_f32_16x16x32_bf16 v[156:159], a[240:243], a[156:159], v[156:159]
    s_waitcnt lgkmcnt(4)
    v_mfma_f32_16x16x32_bf16 a[12:15], a[248:251], a[156:159], a[12:15]
    ds_read_b64_tr_b16 a[240:241], v11 offset:51232
    ds_read_b64_tr_b16 a[242:243], v11 offset:54816
    v_mfma_f32_16x16x32_bf16 a[12:15], a[252:255], a[172:175], a[12:15]
    v_mfma_f32_16x16x32_bf16 a[8:11], a[252:255], a[168:171], a[8:11]
    buffer_load_dwordx4 a[140:143], v1, s[4:7], s44 offen offset:3072 sc1
    v_mfma_f32_16x16x32_bf16 a[8:11], a[248:251], a[152:155], a[8:11]
    v_mfma_f32_16x16x32_bf16 a[4:7], a[248:251], a[148:151], a[4:7]
    ds_read_b64_tr_b16 a[244:245], v11 offset:58400
    ds_read_b64_tr_b16 a[246:247], v11 offset:61984
    v_mfma_f32_16x16x32_bf16 a[4:7], a[252:255], a[164:167], a[4:7]
    v_mfma_f32_16x16x32_bf16 a[0:3], a[252:255], a[160:163], a[0:3]
    v_mfma_f32_16x16x32_bf16 a[0:3], a[248:251], a[144:147], a[0:3]
    s_waitcnt lgkmcnt(4)
    v_mfma_f32_16x16x32_bf16 v[160:163], a[232:235], a[144:147], v[160:163]
    ds_read_b64_tr_b16 a[248:249], v11 offset:36928
    ds_read_b64_tr_b16 a[250:251], v11 offset:40512
    v_mfma_f32_16x16x32_bf16 v[160:163], a[236:239], a[160:163], v[160:163]
    v_mfma_f32_16x16x32_bf16 v[164:167], a[236:239], a[164:167], v[164:167]
    global_load_dword a216, v73, s[74:75]
    v_mfma_f32_16x16x32_bf16 v[164:167], a[232:235], a[148:151], v[164:167]
    v_mfma_f32_16x16x32_bf16 v[168:171], a[232:235], a[152:155], v[168:171]
    s_add_u32 s45, s45, 458752
    ds_read_b64_tr_b16 a[252:253], v11 offset:44096
    ds_read_b64_tr_b16 a[254:255], v11 offset:47680
    v_mfma_f32_16x16x32_bf16 v[168:171], a[236:239], a[168:171], v[168:171]
    s_add_u32 m0, s47, 110592
    v_mfma_f32_16x16x32_bf16 v[172:175], a[236:239], a[172:175], v[172:175]
    buffer_load_dwordx4 v2, s[8:11], s45 offen offset:0  lds
    v_mfma_f32_16x16x32_bf16 v[172:175], a[232:235], a[156:159], v[172:175]
    s_waitcnt lgkmcnt(4)
    v_mfma_f32_16x16x32_bf16 a[28:31], a[240:243], a[156:159], a[28:31]
    ds_read_b64_tr_b16 a[232:233], v11 offset:51264
    ds_read_b64_tr_b16 a[234:235], v11 offset:54848
    v_mfma_f32_16x16x32_bf16 a[28:31], a[244:247], a[172:175], a[28:31]
    v_mfma_f32_16x16x32_bf16 a[24:27], a[244:247], a[168:171], a[24:27]
    buffer_load_dwordx4 v3, s[8:11], s45 offen offset:1024  lds
    v_mfma_f32_16x16x32_bf16 a[24:27], a[240:243], a[152:155], a[24:27]
    v_mfma_f32_16x16x32_bf16 a[20:23], a[240:243], a[148:151], a[20:23]
    ds_read_b64_tr_b16 a[236:237], v11 offset:58432
    ds_read_b64_tr_b16 a[238:239], v11 offset:62016
    v_mfma_f32_16x16x32_bf16 a[20:23], a[244:247], a[164:167], a[20:23]
    v_mfma_f32_16x16x32_bf16 a[16:19], a[244:247], a[160:163], a[16:19]
    v_mfma_f32_16x16x32_bf16 a[16:19], a[240:243], a[144:147], a[16:19]
    s_waitcnt lgkmcnt(4)
    v_mfma_f32_16x16x32_bf16 v[176:179], a[248:251], a[144:147], v[176:179]
    ds_read_b64_tr_b16 a[240:241], v11 offset:36960
    ds_read_b64_tr_b16 a[242:243], v11 offset:40544
    v_mfma_f32_16x16x32_bf16 v[176:179], a[252:255], a[160:163], v[176:179]
    v_mfma_f32_16x16x32_bf16 v[180:183], a[252:255], a[164:167], v[180:183]
    buffer_load_dwordx4 v4, s[8:11], s45 offen offset:2048  lds
    v_mfma_f32_16x16x32_bf16 v[180:183], a[248:251], a[148:151], v[180:183]
    v_mfma_f32_16x16x32_bf16 v[184:187], a[248:251], a[152:155], v[184:187]
    ds_read_b64_tr_b16 a[244:245], v11 offset:44128
    ds_read_b64_tr_b16 a[246:247], v11 offset:47712
    v_mfma_f32_16x16x32_bf16 v[184:187], a[252:255], a[168:171], v[184:187]
    v_mfma_f32_16x16x32_bf16 v[188:191], a[252:255], a[172:175], v[188:191]
    v_mfma_f32_16x16x32_bf16 v[188:191], a[248:251], a[156:159], v[188:191]
    s_waitcnt lgkmcnt(4)
    v_mfma_f32_16x16x32_bf16 a[44:47], a[232:235], a[156:159], a[44:47]
    ds_read_b64_tr_b16 a[248:249], v11 offset:51296
    ds_read_b64_tr_b16 a[250:251], v11 offset:54880
    v_mfma_f32_16x16x32_bf16 a[44:47], a[236:239], a[172:175], a[44:47]
    v_mfma_f32_16x16x32_bf16 a[40:43], a[236:239], a[168:171], a[40:43]
    buffer_load_dwordx4 v5, s[8:11], s45 offen offset:3072  lds
    v_mfma_f32_16x16x32_bf16 a[40:43], a[232:235], a[152:155], a[40:43]
    v_mfma_f32_16x16x32_bf16 a[36:39], a[232:235], a[148:151], a[36:39]
    s_add_u32 s46, s46, 128
    ds_read_b64_tr_b16 a[252:253], v11 offset:58464
    ds_read_b64_tr_b16 a[254:255], v11 offset:62048
    v_mfma_f32_16x16x32_bf16 a[36:39], a[236:239], a[164:167], a[36:39]
    s_add_u32 m0, s48, 110592
    v_mfma_f32_16x16x32_bf16 a[32:35], a[236:239], a[160:163], a[32:35]
    buffer_load_dwordx4 v9, s[12:15], s46 offen offset:0  lds
    v_mfma_f32_16x16x32_bf16 a[32:35], a[232:235], a[144:147], a[32:35]
    s_waitcnt lgkmcnt(4)
    v_mfma_f32_16x16x32_bf16 v[192:195], a[240:243], a[144:147], v[192:195]
    ds_read_b64_tr_b16 a[232:233], v11 offset:36992
    ds_read_b64_tr_b16 a[234:235], v11 offset:40576
    v_mfma_f32_16x16x32_bf16 v[192:195], a[244:247], a[160:163], v[192:195]
    v_mfma_f32_16x16x32_bf16 v[196:199], a[244:247], a[164:167], v[196:199]
    buffer_load_dwordx4 v10, s[12:15], s46 offen offset:1024  lds
    v_mfma_f32_16x16x32_bf16 v[196:199], a[240:243], a[148:151], v[196:199]
    v_mfma_f32_16x16x32_bf16 v[200:203], a[240:243], a[152:155], v[200:203]
    ds_read_b64_tr_b16 a[236:237], v11 offset:44160
    ds_read_b64_tr_b16 a[238:239], v11 offset:47744
    v_mfma_f32_16x16x32_bf16 v[200:203], a[244:247], a[168:171], v[200:203]
    v_mfma_f32_16x16x32_bf16 v[204:207], a[244:247], a[172:175], v[204:207]
    v_mfma_f32_16x16x32_bf16 v[204:207], a[240:243], a[156:159], v[204:207]
    s_waitcnt lgkmcnt(4)
    v_mfma_f32_16x16x32_bf16 a[60:63], a[248:251], a[156:159], a[60:63]
    ds_read_b64_tr_b16 a[240:241], v11 offset:51328
    ds_read_b64_tr_b16 a[242:243], v11 offset:54912
    v_mfma_f32_16x16x32_bf16 a[60:63], a[252:255], a[172:175], a[60:63]
    s_add_u32 m0, s47, 114688
    v_mfma_f32_16x16x32_bf16 a[56:59], a[252:255], a[168:171], a[56:59]
    buffer_load_dwordx4 v6, s[8:11], s45 offen offset:0  lds
    v_mfma_f32_16x16x32_bf16 a[56:59], a[248:251], a[152:155], a[56:59]
    v_mfma_f32_16x16x32_bf16 a[52:55], a[248:251], a[148:151], a[52:55]
    ds_read_b64_tr_b16 a[244:245], v11 offset:58496
    ds_read_b64_tr_b16 a[246:247], v11 offset:62080
    v_mfma_f32_16x16x32_bf16 a[52:55], a[252:255], a[164:167], a[52:55]
    v_mfma_f32_16x16x32_bf16 a[48:51], a[252:255], a[160:163], a[48:51]
    v_mfma_f32_16x16x32_bf16 a[48:51], a[248:251], a[144:147], a[48:51]
    s_waitcnt lgkmcnt(4)
    v_mfma_f32_16x16x32_bf16 v[208:211], a[232:235], a[144:147], v[208:211]
    ds_read_b64_tr_b16 a[248:249], v11 offset:37024
    ds_read_b64_tr_b16 a[250:251], v11 offset:40608
    v_mfma_f32_16x16x32_bf16 v[208:211], a[236:239], a[160:163], v[208:211]
    v_mfma_f32_16x16x32_bf16 v[212:215], a[236:239], a[164:167], v[212:215]
    buffer_load_dwordx4 v7, s[8:11], s45 offen offset:1024  lds
    v_mfma_f32_16x16x32_bf16 v[212:215], a[232:235], a[148:151], v[212:215]
    v_mfma_f32_16x16x32_bf16 v[216:219], a[232:235], a[152:155], v[216:219]
    ds_read_b64_tr_b16 a[252:253], v11 offset:44192
    ds_read_b64_tr_b16 a[254:255], v11 offset:47776
    v_mfma_f32_16x16x32_bf16 v[216:219], a[236:239], a[168:171], v[216:219]
    v_mfma_f32_16x16x32_bf16 v[220:223], a[236:239], a[172:175], v[220:223]
    buffer_load_dwordx4 v8, s[8:11], s45 offen offset:2048  lds
    v_mfma_f32_16x16x32_bf16 v[220:223], a[232:235], a[156:159], v[220:223]
    s_waitcnt lgkmcnt(4)
    v_mfma_f32_16x16x32_bf16 a[76:79], a[240:243], a[156:159], a[76:79]
    ds_read_b64_tr_b16 a[232:233], v11 offset:51360
    ds_read_b64_tr_b16 a[234:235], v11 offset:54944
    v_mfma_f32_16x16x32_bf16 a[76:79], a[244:247], a[172:175], a[76:79]
    v_mfma_f32_16x16x32_bf16 a[72:75], a[244:247], a[168:171], a[72:75]
    buffer_load_dwordx4 a[204:207], v1, s[4:7], s59 offen offset:3072 sc1
    v_mfma_f32_16x16x32_bf16 a[72:75], a[240:243], a[152:155], a[72:75]
    v_mfma_f32_16x16x32_bf16 a[68:71], a[240:243], a[148:151], a[68:71]
    ds_read_b64_tr_b16 a[236:237], v11 offset:58528
    ds_read_b64_tr_b16 a[238:239], v11 offset:62112
    v_mfma_f32_16x16x32_bf16 a[68:71], a[244:247], a[164:167], a[68:71]
    v_mfma_f32_16x16x32_bf16 a[64:67], a[244:247], a[160:163], a[64:67]
    v_mfma_f32_16x16x32_bf16 a[64:67], a[240:243], a[144:147], a[64:67]
    s_waitcnt lgkmcnt(4)
    v_mfma_f32_16x16x32_bf16 v[224:227], a[248:251], a[144:147], v[224:227]
    ds_read_b64_tr_b16 a[240:241], v11 offset:37056
    ds_read_b64_tr_b16 a[242:243], v11 offset:40640
    v_mfma_f32_16x16x32_bf16 v[224:227], a[252:255], a[160:163], v[224:227]
    s_add_u32 s58, s58, 4096
    v_mfma_f32_16x16x32_bf16 v[228:231], a[252:255], a[164:167], v[228:231]
    buffer_load_dwordx4 a[188:191], v70, s[36:39], s58 offen
    v_mfma_f32_16x16x32_bf16 v[228:231], a[248:251], a[148:151], v[228:231]
    v_mfma_f32_16x16x32_bf16 v[232:235], a[248:251], a[152:155], v[232:235]
    ds_read_b64_tr_b16 a[244:245], v11 offset:44224
    ds_read_b64_tr_b16 a[246:247], v11 offset:47808
    v_mfma_f32_16x16x32_bf16 v[232:235], a[252:255], a[168:171], v[232:235]
    v_mfma_f32_16x16x32_bf16 v[236:239], a[252:255], a[172:175], v[236:239]
    v_mfma_f32_16x16x32_bf16 v[236:239], a[248:251], a[156:159], v[236:239]
    s_waitcnt lgkmcnt(4)
    v_mfma_f32_16x16x32_bf16 a[92:95], a[232:235], a[156:159], a[92:95]
    ds_read_b64_tr_b16 a[248:249], v11 offset:51392
    ds_read_b64_tr_b16 a[250:251], v11 offset:54976
    v_mfma_f32_16x16x32_bf16 a[92:95], a[236:239], a[172:175], a[92:95]
    v_mfma_f32_16x16x32_bf16 a[88:91], a[236:239], a[168:171], a[88:91]
    v_mfma_f32_16x16x32_bf16 a[88:91], a[232:235], a[152:155], a[88:91]
    v_mfma_f32_16x16x32_bf16 a[84:87], a[232:235], a[148:151], a[84:87]
    ds_read_b64_tr_b16 a[252:253], v11 offset:58560
    ds_read_b64_tr_b16 a[254:255], v11 offset:62144
    v_mfma_f32_16x16x32_bf16 a[84:87], a[236:239], a[164:167], a[84:87]
    v_mfma_f32_16x16x32_bf16 a[80:83], a[236:239], a[160:163], a[80:83]
    v_mfma_f32_16x16x32_bf16 a[80:83], a[232:235], a[144:147], a[80:83]
    s_waitcnt vmcnt(22) lgkmcnt(4)
    v_mfma_f32_16x16x32_bf16 v[240:243], a[240:243], a[144:147], v[240:243]
    s_barrier
    ds_read_b128 a[232:235], v15 offset:0
    v_mov_b32 v2, v74
    v_mfma_f32_16x16x32_bf16 v[240:243], a[244:247], a[160:163], v[240:243]
    v_mov_b32 v3, v75
    v_mov_b32 v4, v76
    v_mfma_f32_16x16x32_bf16 v[244:247], a[244:247], a[164:167], v[244:247]
    v_mov_b32 v5, v77
    s_lshr_b32 s60, s50, 2
    v_mfma_f32_16x16x32_bf16 v[244:247], a[240:243], a[148:151], v[244:247]
    s_mul_i32 s60, s60, 1835008
    s_sub_u32 s60, 917504, s60
    s_add_u32 s45, s65, s60
    v_mfma_f32_16x16x32_bf16 v[248:251], a[240:243], a[152:155], v[248:251]
    s_and_b32 s48, s72, 0xfffffdff
    ds_read_b128 a[236:239], v16 offset:0
    v_mfma_f32_16x16x32_bf16 v[248:251], a[244:247], a[168:171], v[248:251]
    v_mfma_f32_16x16x32_bf16 v[252:255], a[244:247], a[172:175], v[252:255]
    v_mfma_f32_16x16x32_bf16 v[252:255], a[240:243], a[156:159], v[252:255]
    s_waitcnt lgkmcnt(2)
    v_mfma_f32_16x16x32_bf16 a[108:111], a[248:251], a[156:159], a[108:111]
    ds_read_b128 a[240:243], v15 offset:4096
    v_mfma_f32_16x16x32_bf16 a[108:111], a[252:255], a[172:175], a[108:111]
    v_mfma_f32_16x16x32_bf16 a[104:107], a[252:255], a[168:171], a[104:107]
    v_mfma_f32_16x16x32_bf16 a[104:107], a[248:251], a[152:155], a[104:107]
    v_mfma_f32_16x16x32_bf16 a[100:103], a[248:251], a[148:151], a[100:103]
    ds_read_b128 a[244:247], v16 offset:4096
    v_mfma_f32_16x16x32_bf16 a[100:103], a[252:255], a[164:167], a[100:103]
    v_mfma_f32_16x16x32_bf16 a[96:99], a[252:255], a[160:163], a[96:99]
    v_mfma_f32_16x16x32_bf16 a[96:99], a[248:251], a[144:147], a[96:99]
    s_waitcnt vmcnt(12) lgkmcnt(2)
    v_mfma_f32_16x16x32_bf16 v[80:83], a[112:115], a[232:235], v[80:83]
    ds_read_b128 a[248:251], v15 offset:2048
    v_mfma_f32_16x16x32_bf16 v[80:83], a[128:131], a[236:239], v[80:83]
    s_xor_b32 s44, s44, 12288
    v_mfma_f32_16x16x32_bf16 v[84:87], a[132:135], a[236:239], v[84:87]
    buffer_load_dwordx4 a[144:147], v1, s[4:7], s44 offen offset:0 sc1
    v_mfma_f32_16x16x32_bf16 v[84:87], a[116:119], a[232:235], v[84:87]
    v_mfma_f32_16x16x32_bf16 v[88:91], a[120:123], a[232:235], v[88:91]
    ds_read_b128 a[252:255], v16 offset:2048
    v_mfma_f32_16x16x32_bf16 v[88:91], a[136:139], a[236:239], v[88:91]
    v_mfma_f32_16x16x32_bf16 v[92:95], a[140:143], a[236:239], v[92:95]
    buffer_load_dwordx4 a[148:151], v1, s[4:7], s44 offen offset:1024 sc1
    v_mfma_f32_16x16x32_bf16 v[92:95], a[124:127], a[232:235], v[92:95]
    s_waitcnt lgkmcnt(2)
    v_mfma_f32_16x16x32_bf16 v[108:111], a[124:127], a[240:243], v[108:111]
    ds_read_b128 a[232:235], v15 offset:6144
    v_mfma_f32_16x16x32_bf16 v[108:111], a[140:143], a[244:247], v[108:111]
    v_mfma_f32_16x16x32_bf16 v[104:107], a[136:139], a[244:247], v[104:107]
    buffer_load_dwordx4 a[152:155], v1, s[4:7], s44 offen offset:2048 sc1
    v_mfma_f32_16x16x32_bf16 v[104:107], a[120:123], a[240:243], v[104:107]
    v_mfma_f32_16x16x32_bf16 v[100:103], a[116:119], a[240:243], v[100:103]
    ds_read_b128 a[236:239], v16 offset:6144
    v_mfma_f32_16x16x32_bf16 v[100:103], a[132:135], a[244:247], v[100:103]
    v_mfma_f32_16x16x32_bf16 v[96:99], a[128:131], a[244:247], v[96:99]
    buffer_load_dwordx4 a[156:159], v1, s[4:7], s44 offen offset:3072 sc1
    v_mfma_f32_16x16x32_bf16 v[96:99], a[112:115], a[240:243], v[96:99]
    s_waitcnt lgkmcnt(2)
    v_mfma_f32_16x16x32_bf16 v[112:115], a[112:115], a[248:251], v[112:115]
    ds_read_b64_tr_b16 a[240:241], v17 offset:0
    ds_read_b64_tr_b16 a[242:243], v17 offset:3584
    v_mfma_f32_16x16x32_bf16 v[112:115], a[128:131], a[252:255], v[112:115]
    s_xor_b32 s44, s44, 4096
    v_mfma_f32_16x16x32_bf16 v[116:119], a[132:135], a[252:255], v[116:119]
    buffer_load_dwordx4 a[160:163], v1, s[4:7], s44 offen offset:0 sc1
    v_mfma_f32_16x16x32_bf16 v[116:119], a[116:119], a[248:251], v[116:119]
    v_mfma_f32_16x16x32_bf16 v[120:123], a[120:123], a[248:251], v[120:123]
    ds_read_b64_tr_b16 a[244:245], v17 offset:7168
    ds_read_b64_tr_b16 a[246:247], v17 offset:10752
    v_mfma_f32_16x16x32_bf16 v[120:123], a[136:139], a[252:255], v[120:123]
    v_mfma_f32_16x16x32_bf16 v[124:127], a[140:143], a[252:255], v[124:127]
    buffer_load_dwordx4 a[164:167], v1, s[4:7], s44 offen offset:1024 sc1
    v_mfma_f32_16x16x32_bf16 v[124:127], a[124:127], a[248:251], v[124:127]
    s_waitcnt lgkmcnt(4)
    v_mfma_f32_16x16x32_bf16 v[140:143], a[124:127], a[232:235], v[140:143]
    s_xor_b32 s78, s0, 851968
    ds_read_b64_tr_b16 a[248:249], v17 offset:14336
    ds_read_b64_tr_b16 a[250:251], v17 offset:17920
    v_mfma_f32_16x16x32_bf16 v[140:143], a[140:143], a[236:239], v[140:143]
    v_mfma_f32_16x16x32_bf16 v[136:139], a[136:139], a[236:239], v[136:139]
    buffer_load_dwordx4 a[168:171], v1, s[4:7], s44 offen offset:2048 sc1
    v_mfma_f32_16x16x32_bf16 v[136:139], a[120:123], a[232:235], v[136:139]
    v_mfma_f32_16x16x32_bf16 v[132:135], a[116:119], a[232:235], v[132:135]
    ds_read_b64_tr_b16 a[252:253], v17 offset:21504
    ds_read_b64_tr_b16 a[254:255], v17 offset:25088
    v_mfma_f32_16x16x32_bf16 v[132:135], a[132:135], a[236:239], v[132:135]
    v_mfma_f32_16x16x32_bf16 v[128:131], a[128:131], a[236:239], v[128:131]
    buffer_load_dwordx4 a[172:175], v1, s[4:7], s44 offen offset:3072 sc1
    v_mfma_f32_16x16x32_bf16 v[128:131], a[112:115], a[232:235], v[128:131]
    s_waitcnt lgkmcnt(4)
    v_mfma_f32_16x16x32_bf16 v[144:147], a[240:243], a[112:115], v[144:147]
    s_add_u32 s68, s65, 0
    ds_read_b64_tr_b16 a[232:233], v17 offset:32
    ds_read_b64_tr_b16 a[234:235], v17 offset:3616
    v_mfma_f32_16x16x32_bf16 v[144:147], a[244:247], a[128:131], v[144:147]
    s_add_u32 m0, s64, 0
    buffer_store_dwordx4 a[212:215], v1, s[4:7], s78 offen offset:0 sc1
    v_mfma_f32_16x16x32_bf16 v[148:151], a[244:247], a[132:135], v[148:151]
    buffer_load_dwordx4 v2, s[28:31], s68 offen offset:0  lds
    v_mfma_f32_16x16x32_bf16 v[148:151], a[240:243], a[116:119], v[148:151]
    v_mfma_f32_16x16x32_bf16 v[152:155], a[240:243], a[120:123], v[152:155]
    ds_read_b64_tr_b16 a[236:237], v17 offset:7200
    ds_read_b64_tr_b16 a[238:239], v17 offset:10784
    v_mfma_f32_16x16x32_bf16 v[152:155], a[244:247], a[136:139], v[152:155]
    v_mfma_f32_16x16x32_bf16 v[156:159], a[244:247], a[140:143], v[156:159]
    v_mfma_f32_16x16x32_bf16 v[156:159], a[240:243], a[124:127], v[156:159]
    s_waitcnt lgkmcnt(4)
    v_mfma_f32_16x16x32_bf16 a[12:15], a[248:251], a[124:127], a[12:15]
    ds_read_b64_tr_b16 a[240:241], v17 offset:14368
    ds_read_b64_tr_b16 a[242:243], v17 offset:17952
    v_mfma_f32_16x16x32_bf16 a[12:15], a[252:255], a[140:143], a[12:15]
    v_mfma_f32_16x16x32_bf16 a[8:11], a[252:255], a[136:139], a[8:11]
    buffer_load_dwordx4 v3, s[28:31], s68 offen offset:1024  lds
    v_mfma_f32_16x16x32_bf16 a[8:11], a[248:251], a[120:123], a[8:11]
    v_mfma_f32_16x16x32_bf16 a[4:7], a[248:251], a[116:119], a[4:7]
    ds_read_b64_tr_b16 a[244:245], v17 offset:21536
    ds_read_b64_tr_b16 a[246:247], v17 offset:25120
    v_mfma_f32_16x16x32_bf16 a[4:7], a[252:255], a[132:135], a[4:7]
    v_mfma_f32_16x16x32_bf16 a[0:3], a[252:255], a[128:131], a[0:3]
    v_mfma_f32_16x16x32_bf16 a[0:3], a[248:251], a[112:115], a[0:3]
    s_waitcnt lgkmcnt(4)
    v_mfma_f32_16x16x32_bf16 v[160:163], a[232:235], a[112:115], v[160:163]
    ds_read_b64_tr_b16 a[248:249], v17 offset:64
    ds_read_b64_tr_b16 a[250:251], v17 offset:3648
    v_mfma_f32_16x16x32_bf16 v[160:163], a[236:239], a[128:131], v[160:163]
    v_mfma_f32_16x16x32_bf16 v[164:167], a[236:239], a[132:135], v[164:167]
    buffer_load_dwordx4 v4, s[28:31], s68 offen offset:2048  lds
    v_mfma_f32_16x16x32_bf16 v[164:167], a[232:235], a[116:119], v[164:167]
    v_mfma_f32_16x16x32_bf16 v[168:171], a[232:235], a[120:123], v[168:171]
    ds_read_b64_tr_b16 a[252:253], v17 offset:7232
    ds_read_b64_tr_b16 a[254:255], v17 offset:10816
    v_mfma_f32_16x16x32_bf16 v[168:171], a[236:239], a[136:139], v[168:171]
    buffer_store_dwordx4 a[212:215], v1, s[4:7], s78 offen offset:1024 sc1
    v_mfma_f32_16x16x32_bf16 v[172:175], a[236:239], a[140:143], v[172:175]
    v_mfma_f32_16x16x32_bf16 v[172:175], a[232:235], a[124:127], v[172:175]
    s_waitcnt lgkmcnt(4)
    v_mfma_f32_16x16x32_bf16 a[28:31], a[240:243], a[124:127], a[28:31]
    ds_read_b64_tr_b16 a[232:233], v17 offset:14400
    ds_read_b64_tr_b16 a[234:235], v17 offset:17984
    v_mfma_f32_16x16x32_bf16 a[28:31], a[244:247], a[140:143], a[28:31]
    v_mfma_f32_16x16x32_bf16 a[24:27], a[244:247], a[136:139], a[24:27]
    buffer_load_dwordx4 v5, s[28:31], s68 offen offset:3072  lds
    v_mfma_f32_16x16x32_bf16 a[24:27], a[240:243], a[120:123], a[24:27]
    v_mfma_f32_16x16x32_bf16 a[20:23], a[240:243], a[116:119], a[20:23]
    ds_read_b64_tr_b16 a[236:237], v17 offset:21568
    ds_read_b64_tr_b16 a[238:239], v17 offset:25152
    v_mfma_f32_16x16x32_bf16 a[20:23], a[244:247], a[132:135], a[20:23]
    v_mfma_f32_16x16x32_bf16 a[16:19], a[244:247], a[128:131], a[16:19]
    v_mfma_f32_16x16x32_bf16 a[16:19], a[240:243], a[112:115], a[16:19]
    s_waitcnt vmcnt(16) lgkmcnt(4)
    v_mfma_f32_16x16x32_bf16 v[176:179], a[248:251], a[112:115], v[176:179]
    s_barrier
    s_add_u32 s68, s65, 32768
    ds_read_b128 a[240:243], v15 offset:36864
    v_mfma_f32_16x16x32_bf16 v[176:179], a[252:255], a[128:131], v[176:179]
    s_add_u32 m0, s64, 4096
    v_mfma_f32_16x16x32_bf16 v[180:183], a[252:255], a[132:135], v[180:183]
    buffer_load_dwordx4 v2, s[28:31], s68 offen offset:0  lds
    v_mfma_f32_16x16x32_bf16 v[180:183], a[248:251], a[116:119], v[180:183]
    v_mfma_f32_16x16x32_bf16 v[184:187], a[248:251], a[120:123], v[184:187]
    ds_read_b128 a[244:247], v16 offset:36864
    v_mfma_f32_16x16x32_bf16 v[184:187], a[252:255], a[136:139], v[184:187]
    v_mfma_f32_16x16x32_bf16 v[188:191], a[252:255], a[140:143], v[188:191]
    v_mfma_f32_16x16x32_bf16 v[188:191], a[248:251], a[124:127], v[188:191]
    s_waitcnt lgkmcnt(2)
    v_mfma_f32_16x16x32_bf16 a[44:47], a[232:235], a[124:127], a[44:47]
    ds_read_b128 a[248:251], v15 offset:40960
    v_mfma_f32_16x16x32_bf16 a[44:47], a[236:239], a[140:143], a[44:47]
    v_mfma_f32_16x16x32_bf16 a[40:43], a[236:239], a[136:139], a[40:43]
    buffer_load_dwordx4 v3, s[28:31], s68 offen offset:1024  lds
    v_mfma_f32_16x16x32_bf16 a[40:43], a[232:235], a[120:123], a[40:43]
    buffer_store_dwordx4 a[212:215], v1, s[4:7], s78 offen offset:2048 sc1
    v_mfma_f32_16x16x32_bf16 a[36:39], a[232:235], a[116:119], a[36:39]
    ds_read_b128 a[252:255], v16 offset:40960
    v_mfma_f32_16x16x32_bf16 a[36:39], a[236:239], a[132:135], a[36:39]
    v_mfma_f32_16x16x32_bf16 a[32:35], a[236:239], a[128:131], a[32:35]
    v_mfma_f32_16x16x32_bf16 a[32:35], a[232:235], a[112:115], a[32:35]
    s_waitcnt vmcnt(9) lgkmcnt(2)
    v_mfma_f32_16x16x32_bf16 v[80:83], a[144:147], a[240:243], v[80:83]
    ds_read_b128 a[232:235], v15 offset:38912
    v_mfma_f32_16x16x32_bf16 v[80:83], a[160:163], a[244:247], v[80:83]
    v_mfma_f32_16x16x32_bf16 v[84:87], a[164:167], a[244:247], v[84:87]
    buffer_load_dwordx4 v4, s[28:31], s68 offen offset:2048  lds
    v_mfma_f32_16x16x32_bf16 v[84:87], a[148:151], a[240:243], v[84:87]
    v_mfma_f32_16x16x32_bf16 v[88:91], a[152:155], a[240:243], v[88:91]
    ds_read_b128 a[236:239], v16 offset:38912
    v_mfma_f32_16x16x32_bf16 v[88:91], a[168:171], a[244:247], v[88:91]
    v_mfma_f32_16x16x32_bf16 v[92:95], a[172:175], a[244:247], v[92:95]
    v_mfma_f32_16x16x32_bf16 v[92:95], a[156:159], a[240:243], v[92:95]
    s_waitcnt lgkmcnt(2)
    v_mfma_f32_16x16x32_bf16 v[108:111], a[156:159], a[248:251], v[108:111]
    ds_read_b128 a[240:243], v15 offset:43008
    v_mfma_f32_16x16x32_bf16 v[108:111], a[172:175], a[252:255], v[108:111]
    v_mfma_f32_16x16x32_bf16 v[104:107], a[168:171], a[252:255], v[104:107]
    buffer_load_dwordx4 v5, s[28:31], s68 offen offset:3072  lds
    v_mfma_f32_16x16x32_bf16 v[104:107], a[152:155], a[248:251], v[104:107]
    v_mfma_f32_16x16x32_bf16 v[100:103], a[148:151], a[248:251], v[100:103]
    ds_read_b128 a[244:247], v16 offset:43008
    v_mfma_f32_16x16x32_bf16 v[100:103], a[164:167], a[252:255], v[100:103]
    v_mfma_f32_16x16x32_bf16 v[96:99], a[160:163], a[252:255], v[96:99]
    v_mfma_f32_16x16x32_bf16 v[96:99], a[144:147], a[248:251], v[96:99]
    s_waitcnt lgkmcnt(2)
    buffer_store_dwordx4 a[212:215], v1, s[4:7], s78 offen offset:3072 sc1
    v_mfma_f32_16x16x32_bf16 v[112:115], a[144:147], a[232:235], v[112:115]
    ds_read_b64_tr_b16 a[248:249], v17 offset:96
    ds_read_b64_tr_b16 a[250:251], v17 offset:3680
    v_mfma_f32_16x16x32_bf16 v[112:115], a[160:163], a[236:239], v[112:115]
    v_mfma_f32_16x16x32_bf16 v[116:119], a[164:167], a[236:239], v[116:119]
    v_mfma_f32_16x16x32_bf16 v[116:119], a[148:151], a[232:235], v[116:119]
    v_mfma_f32_16x16x32_bf16 v[120:123], a[152:155], a[232:235], v[120:123]
    ds_read_b64_tr_b16 a[252:253], v17 offset:7264
    ds_read_b64_tr_b16 a[254:255], v17 offset:10848
    v_mfma_f32_16x16x32_bf16 v[120:123], a[168:171], a[236:239], v[120:123]
    v_mfma_f32_16x16x32_bf16 v[124:127], a[172:175], a[236:239], v[124:127]
    v_mfma_f32_16x16x32_bf16 v[124:127], a[156:159], a[232:235], v[124:127]
    s_waitcnt lgkmcnt(4)
    v_mfma_f32_16x16x32_bf16 v[140:143], a[156:159], a[240:243], v[140:143]
    s_add_u32 s68, s45, 0
    ds_read_b64_tr_b16 a[232:233], v17 offset:14432
    ds_read_b64_tr_b16 a[234:235], v17 offset:18016
    v_mfma_f32_16x16x32_bf16 v[140:143], a[172:175], a[244:247], v[140:143]
    s_add_u32 m0, s64, 32768
    v_mfma_f32_16x16x32_bf16 v[136:139], a[168:171], a[244:247], v[136:139]
    buffer_load_dwordx4 v2, s[28:31], s68 offen offset:0  lds
    v_mfma_f32_16x16x32_bf16 v[136:139], a[152:155], a[240:243], v[136:139]
    v_mfma_f32_16x16x32_bf16 v[132:135], a[148:151], a[240:243], v[132:135]
    s_xor_b32 s78, s0, 1441792
    ds_read_b64_tr_b16 a[236:237], v17 offset:21600
    ds_read_b64_tr_b16 a[238:239], v17 offset:25184
    v_mfma_f32_16x16x32_bf16 v[132:135], a[164:167], a[244:247], v[132:135]
    v_mfma_f32_16x16x32_bf16 v[128:131], a[160:163], a[244:247], v[128:131]
    v_mfma_f32_16x16x32_bf16 v[128:131], a[144:147], a[240:243], v[128:131]
    s_waitcnt lgkmcnt(4)
    v_mfma_f32_16x16x32_bf16 v[192:195], a[248:251], a[112:115], v[192:195]
    ds_read_b64_tr_b16 a[240:241], v17 offset:128
    ds_read_b64_tr_b16 a[242:243], v17 offset:3712
    v_mfma_f32_16x16x32_bf16 v[192:195], a[252:255], a[128:131], v[192:195]
    v_mfma_f32_16x16x32_bf16 v[196:199], a[252:255], a[132:135], v[196:199]
    buffer_load_dwordx4 v3, s[28:31], s68 offen offset:1024  lds
    v_mfma_f32_16x16x32_bf16 v[196:199], a[248:251], a[116:119], v[196:199]
    v_mfma_f32_16x16x32_bf16 v[200:203], a[248:251], a[120:123], v[200:203]
    ds_read_b64_tr_b16 a[244:245], v17 offset:7296
    ds_read_b64_tr_b16 a[246:247], v17 offset:10880
    v_mfma_f32_16x16x32_bf16 v[200:203], a[252:255], a[136:139], v[200:203]
    buffer_store_dwordx4 a[212:215], v1, s[4:7], s78 offen offset:0 sc1
    v_mfma_f32_16x16x32_bf16 v[204:207], a[252:255], a[140:143], v[204:207]
    v_fma_f32 v66, v34, v80, v82
    v_fma_f32 v68, v34, v96, v98
    v_mfma_f32_16x16x32_bf16 v[204:207], a[248:251], a[124:127], v[204:207]
    s_waitcnt lgkmcnt(4)
    v_fma_f32 v67, v34, v81, v83
    v_fma_f32 v69, v34, v97, v99
    v_mfma_f32_16x16x32_bf16 a[60:63], a[232:235], a[124:127], a[60:63]
    ds_read_b64_tr_b16 a[248:249], v17 offset:14464
    ds_read_b64_tr_b16 a[250:251], v17 offset:18048
    v_mfma_f32_16x16x32_bf16 a[60:63], a[236:239], a[140:143], a[60:63]
    v_fma_f32 v70, v36, v112, v114
    v_fma_f32 v72, v36, v128, v130
    v_mfma_f32_16x16x32_bf16 a[56:59], a[236:239], a[136:139], a[56:59]
    buffer_load_dwordx4 v4, s[28:31], s68 offen offset:2048  lds
    v_mfma_f32_16x16x32_bf16 a[56:59], a[232:235], a[120:123], a[56:59]
    v_fma_f32 v71, v36, v113, v115
    v_fma_f32 v73, v36, v129, v131
    v_mfma_f32_16x16x32_bf16 a[52:55], a[232:235], a[116:119], a[52:55]
    ds_read_b64_tr_b16 a[252:253], v17 offset:21632
    ds_read_b64_tr_b16 a[254:255], v17 offset:25216
    v_mfma_f32_16x16x32_bf16 a[52:55], a[236:239], a[132:135], a[52:55]
    v_fma_f32 v66, -v35, v96, v66
    v_fmac_f32 v68, v35, v80
    v_mfma_f32_16x16x32_bf16 a[48:51], a[236:239], a[128:131], a[48:51]
    v_fma_f32 v67, -v35, v97, v67
    v_fmac_f32 v69, v35, v81
    v_mfma_f32_16x16x32_bf16 a[48:51], a[232:235], a[112:115], a[48:51]
    s_waitcnt lgkmcnt(4)
    v_fma_f32 v70, -v37, v128, v70
    v_fmac_f32 v72, v37, v112
    v_mfma_f32_16x16x32_bf16 v[208:211], a[240:243], a[112:115], v[208:211]
    ds_read_b64_tr_b16 a[232:233], v17 offset:160
    ds_read_b64_tr_b16 a[234:235], v17 offset:3744
    v_mfma_f32_16x16x32_bf16 v[208:211], a[244:247], a[128:131], v[208:211]
    v_fma_f32 v71, -v37, v129, v71
    v_fmac_f32 v73, v37, v113
    v_mfma_f32_16x16x32_bf16 v[212:215], a[244:247], a[132:135], v[212:215]
    buffer_load_dwordx4 v5, s[28:31], s68 offen offset:3072  lds
    v_mfma_f32_16x16x32_bf16 v[212:215], a[240:243], a[116:119], v[212:215]
    v_fma_f32 v6, v34, v66, v84
    v_fma_f32 v8, v34, v68, v100
    v_mfma_f32_16x16x32_bf16 v[216:219], a[240:243], a[120:123], v[216:219]
    ds_read_b64_tr_b16 a[236:237], v17 offset:7328
    ds_read_b64_tr_b16 a[238:239], v17 offset:10912
    v_mfma_f32_16x16x32_bf16 v[216:219], a[244:247], a[136:139], v[216:219]
    v_fma_f32 v7, v34, v67, v85
    v_fma_f32 v9, v34, v69, v101
    v_mfma_f32_16x16x32_bf16 v[220:223], a[244:247], a[140:143], v[220:223]
    v_fma_f32 v10, v36, v70, v116
    v_fma_f32 v12, v36, v72, v132
    v_mfma_f32_16x16x32_bf16 v[220:223], a[240:243], a[124:127], v[220:223]
    s_waitcnt lgkmcnt(4)
    v_fma_f32 v11, v36, v71, v117
    v_fma_f32 v13, v36, v73, v133
    v_mfma_f32_16x16x32_bf16 a[76:79], a[248:251], a[124:127], a[76:79]
    ds_read_b64_tr_b16 a[240:241], v17 offset:14496
    ds_read_b64_tr_b16 a[242:243], v17 offset:18080
    v_mfma_f32_16x16x32_bf16 a[76:79], a[252:255], a[140:143], a[76:79]
    buffer_store_dwordx4 a[212:215], v1, s[4:7], s78 offen offset:1024 sc1
    v_mfma_f32_16x16x32_bf16 a[72:75], a[252:255], a[136:139], a[72:75]
    v_fma_f32 v6, -v35, v68, v6
    v_fmac_f32 v8, v35, v66
    v_mfma_f32_16x16x32_bf16 a[72:75], a[248:251], a[120:123], a[72:75]
    v_fma_f32 v7, -v35, v69, v7
    v_fmac_f32 v9, v35, v67
    v_mfma_f32_16x16x32_bf16 a[68:71], a[248:251], a[116:119], a[68:71]
    ds_read_b64_tr_b16 a[244:245], v17 offset:21664
    ds_read_b64_tr_b16 a[246:247], v17 offset:25248
    v_mfma_f32_16x16x32_bf16 a[68:71], a[252:255], a[132:135], a[68:71]
    v_fma_f32 v10, -v37, v72, v10
    v_fmac_f32 v12, v37, v70
    v_mfma_f32_16x16x32_bf16 a[64:67], a[252:255], a[128:131], a[64:67]
    v_fma_f32 v11, -v37, v73, v11
    v_fmac_f32 v13, v37, v71
    v_mfma_f32_16x16x32_bf16 a[64:67], a[248:251], a[112:115], a[64:67]
    s_waitcnt lgkmcnt(4)
    v_fma_f32 v66, v34, v6, v86
    v_fma_f32 v68, v34, v8, v102
    v_mfma_f32_16x16x32_bf16 v[224:227], a[232:235], a[112:115], v[224:227]
    s_add_u32 s68, s45, 32768
    ds_read_b64_tr_b16 a[248:249], v17 offset:192
    ds_read_b64_tr_b16 a[250:251], v17 offset:3776
    v_mfma_f32_16x16x32_bf16 v[224:227], a[236:239], a[128:131], v[224:227]
    s_add_u32 m0, s64, 36864
    v_fma_f32 v67, v34, v7, v87
    v_fma_f32 v69, v34, v9, v103
    v_mfma_f32_16x16x32_bf16 v[228:231], a[236:239], a[132:135], v[228:231]
    buffer_load_dwordx4 v2, s[28:31], s68 offen offset:0  lds
    v_mfma_f32_16x16x32_bf16 v[228:231], a[232:235], a[116:119], v[228:231]
    v_fma_f32 v70, v36, v10, v118
    v_fma_f32 v72, v36, v12, v134
    v_mfma_f32_16x16x32_bf16 v[232:235], a[232:235], a[120:123], v[232:235]
    ds_read_b64_tr_b16 a[252:253], v17 offset:7360
    ds_read_b64_tr_b16 a[254:255], v17 offset:10944
    v_mfma_f32_16x16x32_bf16 v[232:235], a[236:239], a[136:139], v[232:235]
    v_fma_f32 v71, v36, v11, v119
    v_fma_f32 v73, v36, v13, v135
    v_mfma_f32_16x16x32_bf16 v[236:239], a[236:239], a[140:143], v[236:239]
    v_fma_f32 v66, -v35, v8, v66
    v_fmac_f32 v68, v35, v6
    v_mfma_f32_16x16x32_bf16 v[236:239], a[232:235], a[124:127], v[236:239]
    s_waitcnt lgkmcnt(4)
    v_fma_f32 v67, -v35, v9, v67
    v_fmac_f32 v69, v35, v7
    v_mfma_f32_16x16x32_bf16 a[92:95], a[240:243], a[124:127], a[92:95]
    ds_read_b64_tr_b16 a[232:233], v17 offset:14528
    ds_read_b64_tr_b16 a[234:235], v17 offset:18112
    v_mfma_f32_16x16x32_bf16 a[92:95], a[244:247], a[140:143], a[92:95]
    v_fma_f32 v70, -v37, v12, v70
    v_fmac_f32 v72, v37, v10
    v_mfma_f32_16x16x32_bf16 a[88:91], a[244:247], a[136:139], a[88:91]
    buffer_load_dwordx4 v3, s[28:31], s68 offen offset:1024  lds
    v_mfma_f32_16x16x32_bf16 a[88:91], a[240:243], a[120:123], a[88:91]
    v_fma_f32 v71, -v37, v13, v71
    v_fmac_f32 v73, v37, v11
    v_mfma_f32_16x16x32_bf16 a[84:87], a[240:243], a[116:119], a[84:87]
    ds_read_b64_tr_b16 a[236:237], v17 offset:21696
    ds_read_b64_tr_b16 a[238:239], v17 offset:25280
    v_mfma_f32_16x16x32_bf16 a[84:87], a[244:247], a[132:135], a[84:87]
    buffer_store_dwordx4 a[212:215], v1, s[4:7], s78 offen offset:2048 sc1
    v_mfma_f32_16x16x32_bf16 a[80:83], a[244:247], a[128:131], a[80:83]
    v_fma_f32 v6, v34, v66, v88
    v_fma_f32 v8, v34, v68, v104
    v_mfma_f32_16x16x32_bf16 a[80:83], a[240:243], a[112:115], a[80:83]
    s_waitcnt lgkmcnt(4)
    v_fma_f32 v7, v34, v67, v89
    v_fma_f32 v9, v34, v69, v105
    v_mfma_f32_16x16x32_bf16 v[240:243], a[248:251], a[112:115], v[240:243]
    ds_read_b64_tr_b16 a[240:241], v17 offset:36864
    ds_read_b64_tr_b16 a[242:243], v17 offset:40448
    v_mfma_f32_16x16x32_bf16 v[240:243], a[252:255], a[128:131], v[240:243]
    v_fma_f32 v10, v36, v70, v120
    v_fma_f32 v12, v36, v72, v136
    v_mfma_f32_16x16x32_bf16 v[244:247], a[252:255], a[132:135], v[244:247]
    buffer_load_dwordx4 v4, s[28:31], s68 offen offset:2048  lds
    v_mfma_f32_16x16x32_bf16 v[244:247], a[248:251], a[116:119], v[244:247]
    v_fma_f32 v11, v36, v71, v121
    v_fma_f32 v13, v36, v73, v137
    v_mfma_f32_16x16x32_bf16 v[248:251], a[248:251], a[120:123], v[248:251]
    ds_read_b64_tr_b16 a[244:245], v17 offset:44032
    ds_read_b64_tr_b16 a[246:247], v17 offset:47616
    v_mfma_f32_16x16x32_bf16 v[248:251], a[252:255], a[136:139], v[248:251]
    v_fma_f32 v6, -v35, v68, v6
    v_fmac_f32 v8, v35, v66
    v_mfma_f32_16x16x32_bf16 v[252:255], a[252:255], a[140:143], v[252:255]
    v_fma_f32 v7, -v35, v69, v7
    v_fmac_f32 v9, v35, v67
    v_mfma_f32_16x16x32_bf16 v[252:255], a[248:251], a[124:127], v[252:255]
    s_waitcnt lgkmcnt(4)
    v_fma_f32 v10, -v37, v72, v10
    v_fmac_f32 v12, v37, v70
    v_mfma_f32_16x16x32_bf16 a[108:111], a[232:235], a[124:127], a[108:111]
    ds_read_b64_tr_b16 a[248:249], v17 offset:51200
    ds_read_b64_tr_b16 a[250:251], v17 offset:54784
    v_mfma_f32_16x16x32_bf16 a[108:111], a[236:239], a[140:143], a[108:111]
    v_fma_f32 v11, -v37, v73, v11
    v_fmac_f32 v13, v37, v71
    v_mfma_f32_16x16x32_bf16 a[104:107], a[236:239], a[136:139], a[104:107]
    buffer_load_dwordx4 v5, s[28:31], s68 offen offset:3072  lds
    v_mfma_f32_16x16x32_bf16 a[104:107], a[232:235], a[120:123], a[104:107]
    v_fma_f32 v66, v34, v6, v90
    v_fma_f32 v68, v34, v8, v106
    v_mfma_f32_16x16x32_bf16 a[100:103], a[232:235], a[116:119], a[100:103]
    ds_read_b64_tr_b16 a[252:253], v17 offset:58368
    ds_read_b64_tr_b16 a[254:255], v17 offset:61952
    v_mfma_f32_16x16x32_bf16 a[100:103], a[236:239], a[132:135], a[100:103]
    v_fma_f32 v67, v34, v7, v91
    v_fma_f32 v69, v34, v9, v107
    v_mfma_f32_16x16x32_bf16 a[96:99], a[236:239], a[128:131], a[96:99]
    v_fma_f32 v70, v36, v10, v122
    v_fma_f32 v72, v36, v12, v138
    v_mfma_f32_16x16x32_bf16 a[96:99], a[232:235], a[112:115], a[96:99]
    s_waitcnt lgkmcnt(4)
    v_fma_f32 v71, v36, v11, v123
    v_fma_f32 v73, v36, v13, v139
    v_mfma_f32_16x16x32_bf16 v[144:147], a[240:243], a[144:147], v[144:147]
    ds_read_b64_tr_b16 a[232:233], v17 offset:36896
    ds_read_b64_tr_b16 a[234:235], v17 offset:40480
    v_mfma_f32_16x16x32_bf16 v[144:147], a[244:247], a[160:163], v[144:147]
    v_fma_f32 v66, -v35, v8, v66
    v_fmac_f32 v68, v35, v6
    v_mfma_f32_16x16x32_bf16 v[148:151], a[244:247], a[164:167], v[148:151]
    buffer_store_dwordx4 a[212:215], v1, s[4:7], s78 offen offset:3072 sc1
    v_mfma_f32_16x16x32_bf16 v[148:151], a[240:243], a[148:151], v[148:151]
    v_fma_f32 v67, -v35, v9, v67
    v_fmac_f32 v69, v35, v7
    v_mfma_f32_16x16x32_bf16 v[152:155], a[240:243], a[152:155], v[152:155]
    s_barrier
    ds_read_b64_tr_b16 a[236:237], v17 offset:44064
    ds_read_b64_tr_b16 a[238:239], v17 offset:47648
    v_mfma_f32_16x16x32_bf16 v[152:155], a[244:247], a[168:171], v[152:155]
    v_fma_f32 v70, -v37, v12, v70
    v_fmac_f32 v72, v37, v10
    v_mfma_f32_16x16x32_bf16 v[156:159], a[244:247], a[172:175], v[156:159]
    v_fma_f32 v71, -v37, v13, v71
    v_fmac_f32 v73, v37, v11
    v_mfma_f32_16x16x32_bf16 v[156:159], a[240:243], a[156:159], v[156:159]
    s_waitcnt lgkmcnt(4)
    v_fma_f32 v6, v34, v66, v92
    v_fma_f32 v8, v34, v68, v108
    v_mfma_f32_16x16x32_bf16 a[12:15], a[248:251], a[156:159], a[12:15]
    ds_read_b64_tr_b16 a[240:241], v17 offset:51232
    ds_read_b64_tr_b16 a[242:243], v17 offset:54816
    v_mfma_f32_16x16x32_bf16 a[12:15], a[252:255], a[172:175], a[12:15]
    v_fma_f32 v7, v34, v67, v93
    v_fma_f32 v9, v34, v69, v109
    v_mfma_f32_16x16x32_bf16 a[8:11], a[252:255], a[168:171], a[8:11]
    v_fma_f32 v10, v36, v70, v124
    v_fma_f32 v12, v36, v72, v140
    v_mfma_f32_16x16x32_bf16 a[8:11], a[248:251], a[152:155], a[8:11]
    v_fma_f32 v11, v36, v71, v125
    v_fma_f32 v13, v36, v73, v141
    v_mfma_f32_16x16x32_bf16 a[4:7], a[248:251], a[148:151], a[4:7]
    ds_read_b64_tr_b16 a[244:245], v17 offset:58400
    ds_read_b64_tr_b16 a[246:247], v17 offset:61984
    v_mfma_f32_16x16x32_bf16 a[4:7], a[252:255], a[164:167], a[4:7]
    v_fma_f32 v6, -v35, v68, v6
    v_fmac_f32 v8, v35, v66
    v_mfma_f32_16x16x32_bf16 a[0:3], a[252:255], a[160:163], a[0:3]
    v_fma_f32 v7, -v35, v69, v7
    v_fmac_f32 v9, v35, v67
    v_mfma_f32_16x16x32_bf16 a[0:3], a[248:251], a[144:147], a[0:3]
    s_waitcnt lgkmcnt(4)
    s_xor_b32 s78, s0, 2031616
    v_fma_f32 v10, -v37, v72, v10
    v_mfma_f32_16x16x32_bf16 v[160:163], a[232:235], a[144:147], v[160:163]
    ds_read_b64_tr_b16 a[248:249], v17 offset:36928
    ds_read_b64_tr_b16 a[250:251], v17 offset:40512
    v_mfma_f32_16x16x32_bf16 v[160:163], a[236:239], a[160:163], v[160:163]
    v_fmac_f32 v12, v37, v70
    v_fma_f32 v11, -v37, v73, v11
    v_mfma_f32_16x16x32_bf16 v[164:167], a[236:239], a[164:167], v[164:167]
    v_fmac_f32 v13, v37, v71
    v_fma_f32 v66, v34, v6, v94
    v_mfma_f32_16x16x32_bf16 v[164:167], a[232:235], a[148:151], v[164:167]
    v_fma_f32 v68, v34, v8, v110
    v_fma_f32 v67, v34, v7, v95
    v_mfma_f32_16x16x32_bf16 v[168:171], a[232:235], a[152:155], v[168:171]
    ds_read_b64_tr_b16 a[252:253], v17 offset:44096
    ds_read_b64_tr_b16 a[254:255], v17 offset:47680
    v_mfma_f32_16x16x32_bf16 v[168:171], a[236:239], a[168:171], v[168:171]
    v_fma_f32 v69, v34, v9, v111
    v_fma_f32 v70, v36, v10, v126
    v_mfma_f32_16x16x32_bf16 v[172:175], a[236:239], a[172:175], v[172:175]
    v_fma_f32 v72, v36, v12, v142
    v_fma_f32 v71, v36, v11, v127
    v_mfma_f32_16x16x32_bf16 v[172:175], a[232:235], a[156:159], v[172:175]
    s_waitcnt lgkmcnt(4)
    buffer_store_dwordx4 a[212:215], v1, s[4:7], s78 offen offset:0 sc1
    v_mfma_f32_16x16x32_bf16 a[28:31], a[240:243], a[156:159], a[28:31]
    ds_read_b64_tr_b16 a[232:233], v17 offset:51264
    ds_read_b64_tr_b16 a[234:235], v17 offset:54848
    v_mfma_f32_16x16x32_bf16 a[28:31], a[244:247], a[172:175], a[28:31]
    v_fma_f32 v73, v36, v13, v143
    v_fma_f32 v66, -v35, v8, v66
    v_mfma_f32_16x16x32_bf16 a[24:27], a[244:247], a[168:171], a[24:27]
    v_fmac_f32 v68, v35, v6
    v_fma_f32 v67, -v35, v9, v67
    v_mfma_f32_16x16x32_bf16 a[24:27], a[240:243], a[152:155], a[24:27]
    v_fmac_f32 v69, v35, v7
    v_fma_f32 v70, -v37, v12, v70
    v_mfma_f32_16x16x32_bf16 a[20:23], a[240:243], a[148:151], a[20:23]
    ds_read_b64_tr_b16 a[236:237], v17 offset:58432
    ds_read_b64_tr_b16 a[238:239], v17 offset:62016
    v_mfma_f32_16x16x32_bf16 a[20:23], a[244:247], a[164:167], a[20:23]
    v_fmac_f32 v72, v37, v10
    v_fma_f32 v71, -v37, v13, v71
    v_mfma_f32_16x16x32_bf16 a[16:19], a[244:247], a[160:163], a[16:19]
    v_fmac_f32 v73, v37, v11
    v_fma_f32 v6, v38, v66, v67
    v_mfma_f32_16x16x32_bf16 a[16:19], a[240:243], a[144:147], a[16:19]
    s_waitcnt lgkmcnt(4)
    v_fma_f32 v7, v38, v68, v69
    v_fma_f32 v8, v40, v70, v71
    v_mfma_f32_16x16x32_bf16 v[176:179], a[248:251], a[144:147], v[176:179]
    ds_read_b64_tr_b16 a[240:241], v17 offset:36960
    ds_read_b64_tr_b16 a[242:243], v17 offset:40544
    v_mfma_f32_16x16x32_bf16 v[176:179], a[252:255], a[160:163], v[176:179]
    v_fma_f32 v9, v40, v72, v73
    v_fma_f32 v6, -v39, v68, v6
    v_mfma_f32_16x16x32_bf16 v[180:183], a[252:255], a[164:167], v[180:183]
    v_fmac_f32 v7, v39, v66
    v_fma_f32 v8, -v41, v72, v8
    v_mfma_f32_16x16x32_bf16 v[180:183], a[248:251], a[148:151], v[180:183]
    v_fmac_f32 v9, v41, v70
    v_mov_b32 v10, v6
    v_mfma_f32_16x16x32_bf16 v[184:187], a[248:251], a[152:155], v[184:187]
    ds_read_b64_tr_b16 a[244:245], v17 offset:44128
    ds_read_b64_tr_b16 a[246:247], v17 offset:47712
    v_mfma_f32_16x16x32_bf16 v[184:187], a[252:255], a[168:171], v[184:187]
    v_mov_b32 v11, v7
    v_mov_b32 v12, v8
    v_mfma_f32_16x16x32_bf16 v[188:191], a[252:255], a[172:175], v[188:191]
    v_mov_b32 v13, v9
    v_permlane16_swap_b32 v6, v10
    v_mfma_f32_16x16x32_bf16 v[188:191], a[248:251], a[156:159], v[188:191]
    s_waitcnt lgkmcnt(4)
    v_permlane16_swap_b32 v7, v11
    v_permlane16_swap_b32 v8, v12
    v_mfma_f32_16x16x32_bf16 a[44:47], a[232:235], a[156:159], a[44:47]
    ds_read_b64_tr_b16 a[248:249], v17 offset:51296
    ds_read_b64_tr_b16 a[250:251], v17 offset:54880
    v_mfma_f32_16x16x32_bf16 a[44:47], a[236:239], a[172:175], a[44:47]
    v_permlane16_swap_b32 v9, v13
    v_fma_f32 v14, v18, v6, v10
    v_mfma_f32_16x16x32_bf16 a[40:43], a[236:239], a[168:171], a[40:43]
    v_fma_f32 v15, v18, v7, v11
    v_fma_f32 v78, v20, v8, v12
    v_mfma_f32_16x16x32_bf16 a[40:43], a[232:235], a[152:155], a[40:43]
    v_fma_f32 v79, v20, v9, v13
    v_fma_f32 v14, -v19, v7, v14
    v_mfma_f32_16x16x32_bf16 a[36:39], a[232:235], a[148:151], a[36:39]
    ds_read_b64_tr_b16 a[252:253], v17 offset:58464
    ds_read_b64_tr_b16 a[254:255], v17 offset:62048
    v_mfma_f32_16x16x32_bf16 a[36:39], a[236:239], a[164:167], a[36:39]
    buffer_store_dwordx4 a[212:215], v1, s[4:7], s78 offen offset:1024 sc1
    v_mfma_f32_16x16x32_bf16 a[32:35], a[236:239], a[160:163], a[32:35]
    v_fmac_f32 v15, v19, v6
    v_fma_f32 v78, -v21, v9, v78
    v_mfma_f32_16x16x32_bf16 a[32:35], a[232:235], a[144:147], a[32:35]
    s_waitcnt lgkmcnt(4)
    v_fmac_f32 v79, v21, v8
    v_mov_b32 v74, v14
    v_mfma_f32_16x16x32_bf16 v[192:195], a[240:243], a[144:147], v[192:195]
    ds_read_b64_tr_b16 a[232:233], v17 offset:36992
    ds_read_b64_tr_b16 a[234:235], v17 offset:40576
    v_mfma_f32_16x16x32_bf16 v[192:195], a[244:247], a[160:163], v[192:195]
    v_mov_b32 v75, v15
    v_mov_b32 v76, v78
    v_mfma_f32_16x16x32_bf16 v[196:199], a[244:247], a[164:167], v[196:199]
    v_mov_b32 v77, v79
    v_permlane32_swap_b32 v14, v74
    v_mfma_f32_16x16x32_bf16 v[196:199], a[240:243], a[148:151], v[196:199]
    v_permlane32_swap_b32 v15, v75
    v_permlane32_swap_b32 v78, v76
    v_mfma_f32_16x16x32_bf16 v[200:203], a[240:243], a[152:155], v[200:203]
    ds_read_b64_tr_b16 a[236:237], v17 offset:44160
    ds_read_b64_tr_b16 a[238:239], v17 offset:47744
    v_mfma_f32_16x16x32_bf16 v[200:203], a[244:247], a[168:171], v[200:203]
    v_permlane32_swap_b32 v79, v77
    s_lshl_b32 s60, s16, 8
    v_mfma_f32_16x16x32_bf16 v[204:207], a[244:247], a[172:175], v[204:207]
    v_and_b32 v16, 15, v0
    s_add_u32 s60, s60, 147456
    v_mfma_f32_16x16x32_bf16 v[204:207], a[240:243], a[156:159], v[204:207]
    s_waitcnt lgkmcnt(4)
    v_lshlrev_b32 v16, 4, v16
    v_add_u32 v16, s60, v16
    v_mfma_f32_16x16x32_bf16 a[60:63], a[248:251], a[156:159], a[60:63]
    ds_read_b64_tr_b16 a[240:241], v17 offset:51328
    ds_read_b64_tr_b16 a[242:243], v17 offset:54912
    v_mfma_f32_16x16x32_bf16 a[60:63], a[252:255], a[172:175], a[60:63]
    v_fmac_f32 v74, v22, v14
    v_fmac_f32 v75, v22, v15
    v_mfma_f32_16x16x32_bf16 a[56:59], a[252:255], a[168:171], a[56:59]
    v_fmac_f32 v76, v24, v78
    v_fmac_f32 v77, v24, v79
    v_mfma_f32_16x16x32_bf16 a[56:59], a[248:251], a[152:155], a[56:59]
    v_fma_f32 v74, -v23, v15, v74
    v_fmac_f32 v75, v23, v14
    v_mfma_f32_16x16x32_bf16 a[52:55], a[248:251], a[148:151], a[52:55]
    ds_read_b64_tr_b16 a[244:245], v17 offset:58496
    ds_read_b64_tr_b16 a[246:247], v17 offset:62080
    v_mfma_f32_16x16x32_bf16 a[52:55], a[252:255], a[164:167], a[52:55]
    v_fma_f32 v76, -v25, v79, v76
    v_fmac_f32 v77, v25, v78
    v_mfma_f32_16x16x32_bf16 a[48:51], a[252:255], a[160:163], a[48:51]
    ds_write_b128 v16, v[74:77] offset:768
    v_cndmask_b32 v10, 0, v6, s[52:53]
    v_mfma_f32_16x16x32_bf16 a[48:51], a[248:251], a[144:147], a[48:51]
    s_waitcnt lgkmcnt(5)
    v_cndmask_b32 v11, 0, v7, s[52:53]
    v_cndmask_b32 v12, 0, v8, s[52:53]
    v_mfma_f32_16x16x32_bf16 v[208:211], a[232:235], a[144:147], v[208:211]
    ds_read_b64_tr_b16 a[248:249], v17 offset:37024
    ds_read_b64_tr_b16 a[250:251], v17 offset:40608
    v_mfma_f32_16x16x32_bf16 v[208:211], a[236:239], a[160:163], v[208:211]
    buffer_store_dwordx4 a[212:215], v1, s[4:7], s78 offen offset:2048 sc1
    v_mfma_f32_16x16x32_bf16 v[212:215], a[236:239], a[164:167], v[212:215]
    v_cndmask_b32 v13, 0, v9, s[52:53]
    v_fmac_f32 v10, v30, v14
    v_mfma_f32_16x16x32_bf16 v[212:215], a[232:235], a[148:151], v[212:215]
    v_fmac_f32 v11, v30, v15
    v_fmac_f32 v12, v32, v78
    v_mfma_f32_16x16x32_bf16 v[216:219], a[232:235], a[152:155], v[216:219]
    ds_read_b64_tr_b16 a[252:253], v17 offset:44192
    ds_read_b64_tr_b16 a[254:255], v17 offset:47776
    v_mfma_f32_16x16x32_bf16 v[216:219], a[236:239], a[168:171], v[216:219]
    v_fmac_f32 v13, v32, v79
    v_fma_f32 v10, -v31, v15, v10
    v_mfma_f32_16x16x32_bf16 v[220:223], a[236:239], a[172:175], v[220:223]
    v_fmac_f32 v11, v31, v14
    v_fma_f32 v12, -v33, v79, v12
    v_mfma_f32_16x16x32_bf16 v[220:223], a[232:235], a[156:159], v[220:223]
    s_waitcnt lgkmcnt(5)
    v_fmac_f32 v13, v33, v78
    s_waitcnt lgkmcnt(4)
    v_mfma_f32_16x16x32_bf16 a[76:79], a[240:243], a[156:159], a[76:79]
    s_add_u32 s68, s65, 65536
    ds_read_b64_tr_b16 a[232:233], v17 offset:51360
    ds_read_b64_tr_b16 a[234:235], v17 offset:54944
    v_mfma_f32_16x16x32_bf16 a[76:79], a[244:247], a[172:175], a[76:79]
    s_add_u32 m0, s64, 65536
    s_barrier
    ds_read_b128 v[6:9], v16
    v_mfma_f32_16x16x32_bf16 a[72:75], a[244:247], a[168:171], a[72:75]
    buffer_load_dwordx4 v2, s[28:31], s68 offen offset:0  lds
    v_mfma_f32_16x16x32_bf16 a[72:75], a[240:243], a[152:155], a[72:75]
    ds_read_b128 v[18:21], v16 offset:256
    ds_read_b128 v[22:25], v16 offset:512
    v_mfma_f32_16x16x32_bf16 a[68:71], a[240:243], a[148:151], a[68:71]
    s_add_u32 s60, s16, 1
    ds_read_b64_tr_b16 a[236:237], v17 offset:58528
    ds_read_b64_tr_b16 a[238:239], v17 offset:62112
    v_mfma_f32_16x16x32_bf16 a[68:71], a[244:247], a[164:167], a[68:71]
    v_and_b32 v79, 15, v0
    s_and_b32 s60, s60, 4
    v_mfma_f32_16x16x32_bf16 a[64:67], a[244:247], a[160:163], a[64:67]
    buffer_load_dwordx4 v3, s[28:31], s68 offen offset:1024  lds
    v_mfma_f32_16x16x32_bf16 a[64:67], a[240:243], a[144:147], a[64:67]
    s_waitcnt lgkmcnt(7)
    v_lshlrev_b32 v79, 4, v79
    s_lshl_b32 s60, s60, 2
    v_mfma_f32_16x16x32_bf16 v[224:227], a[248:251], a[144:147], v[224:227]
    ds_read_b64_tr_b16 a[240:241], v17 offset:37056
    ds_read_b64_tr_b16 a[242:243], v17 offset:40640
    v_mfma_f32_16x16x32_bf16 v[224:227], a[252:255], a[160:163], v[224:227]
    v_mov_b32 v31, 268435456
    v_cmp_gt_u32 vcc, s60, v0
    v_mfma_f32_16x16x32_bf16 v[228:231], a[252:255], a[164:167], v[228:231]
    buffer_load_dwordx4 v4, s[28:31], s68 offen offset:2048  lds
    v_mfma_f32_16x16x32_bf16 v[228:231], a[248:251], a[148:151], v[228:231]
    v_lshrrev_b32 v32, 4, v0
    s_sub_u32 s61, 8, s17
    v_mfma_f32_16x16x32_bf16 v[232:235], a[248:251], a[152:155], v[232:235]
    ds_read_b64_tr_b16 a[244:245], v17 offset:44224
    ds_read_b64_tr_b16 a[246:247], v17 offset:47808
    v_mfma_f32_16x16x32_bf16 v[232:235], a[252:255], a[168:171], v[232:235]
    buffer_store_dwordx4 a[212:215], v1, s[4:7], s78 offen offset:3072 sc1
    v_mfma_f32_16x16x32_bf16 v[236:239], a[252:255], a[172:175], v[236:239]
    buffer_load_dwordx4 v5, s[28:31], s68 offen offset:3072  lds
    v_mfma_f32_16x16x32_bf16 v[236:239], a[248:251], a[156:159], v[236:239]
    s_waitcnt lgkmcnt(4)
    v_lshl_add_u32 v14, v32, 9, v79
    v_cndmask_b32 v30, v31, v79, vcc
    v_mfma_f32_16x16x32_bf16 a[92:95], a[232:235], a[156:159], a[92:95]
    s_add_u32 s68, s65, 98304
    ds_read_b64_tr_b16 a[248:249], v17 offset:51392
    ds_read_b64_tr_b16 a[250:251], v17 offset:54976
    v_mfma_f32_16x16x32_bf16 a[92:95], a[236:239], a[172:175], a[92:95]
    s_add_u32 m0, s64, 69632
    v_lshlrev_b32 v32, 1, v32
    v_add_u32 v15, 256, v14
    v_mfma_f32_16x16x32_bf16 a[88:91], a[236:239], a[168:171], a[88:91]
    buffer_load_dwordx4 v2, s[28:31], s68 offen offset:0  lds
    v_mfma_f32_16x16x32_bf16 a[88:91], a[232:235], a[152:155], a[88:91]
    v_cmp_le_u32 vcc, s61, v32
    v_add_u32 v32, 1, v32
    v_mfma_f32_16x16x32_bf16 a[84:87], a[232:235], a[148:151], a[84:87]
    ds_read_b64_tr_b16 a[252:253], v17 offset:58560
    ds_read_b64_tr_b16 a[254:255], v17 offset:62144
    v_mfma_f32_16x16x32_bf16 a[84:87], a[236:239], a[164:167], a[84:87]
    v_and_b32 v16, 7, v0
    v_cndmask_b32 v14, v31, v14, vcc
    v_mfma_f32_16x16x32_bf16 a[80:83], a[236:239], a[160:163], a[80:83]
    buffer_load_dwordx4 v3, s[28:31], s68 offen offset:1024  lds
    v_mfma_f32_16x16x32_bf16 a[80:83], a[232:235], a[144:147], a[80:83]
    s_waitcnt lgkmcnt(4)
    v_cmp_le_u32 vcc, s61, v32
    v_lshlrev_b32 v16, 2, v16
    v_mfma_f32_16x16x32_bf16 v[240:243], a[240:243], a[144:147], v[240:243]
    v_bfe_u32 v33, v0, 4, 1
    v_cndmask_b32 v15, v31, v15, vcc
    v_mfma_f32_16x16x32_bf16 v[240:243], a[244:247], a[160:163], v[240:243]
    v_fmac_f32 v18, v26, v6
    v_fmac_f32 v19, v26, v7
    v_mfma_f32_16x16x32_bf16 v[244:247], a[244:247], a[164:167], v[244:247]
    buffer_load_dwordx4 v4, s[28:31], s68 offen offset:2048  lds
    v_mfma_f32_16x16x32_bf16 v[244:247], a[240:243], a[148:151], v[244:247]
    v_fmac_f32 v20, v28, v8
    v_fmac_f32 v21, v28, v9
    v_mfma_f32_16x16x32_bf16 v[248:251], a[240:243], a[152:155], v[248:251]
    v_fma_f32 v18, -v27, v7, v18
    v_fmac_f32 v19, v27, v6
    v_mfma_f32_16x16x32_bf16 v[248:251], a[244:247], a[168:171], v[248:251]
    v_fma_f32 v20, -v29, v9, v20
    v_fmac_f32 v21, v29, v8
    v_mfma_f32_16x16x32_bf16 v[252:255], a[244:247], a[172:175], v[252:255]
    buffer_load_dwordx4 v5, s[28:31], s68 offen offset:3072  lds
    v_mfma_f32_16x16x32_bf16 v[252:255], a[240:243], a[156:159], v[252:255]
    s_waitcnt lgkmcnt(0)
    v_fma_f32 v6, v26, v18, v22
    v_fma_f32 v7, v26, v19, v23
    v_mfma_f32_16x16x32_bf16 a[108:111], a[248:251], a[156:159], a[108:111]
    v_fma_f32 v8, v28, v20, v24
    v_fma_f32 v9, v28, v21, v25
    v_mfma_f32_16x16x32_bf16 a[108:111], a[252:255], a[172:175], a[108:111]
    v_fma_f32 v6, -v27, v19, v6
    v_fmac_f32 v7, v27, v18
    v_mfma_f32_16x16x32_bf16 a[104:107], a[252:255], a[168:171], a[104:107]
    v_fma_f32 v8, -v29, v21, v8
    v_fmac_f32 v9, v29, v20
    v_mfma_f32_16x16x32_bf16 a[104:107], a[248:251], a[152:155], a[104:107]
    v_fmac_f32 v74, v26, v6
    v_fmac_f32 v75, v26, v7
    v_mfma_f32_16x16x32_bf16 a[100:103], a[248:251], a[148:151], a[100:103]
    v_fmac_f32 v76, v28, v8
    v_fmac_f32 v77, v28, v9
    v_mfma_f32_16x16x32_bf16 a[100:103], a[252:255], a[164:167], a[100:103]
    v_fma_f32 v74, -v27, v7, v74
    v_fmac_f32 v75, v27, v6
    v_mfma_f32_16x16x32_bf16 a[96:99], a[252:255], a[160:163], a[96:99]
    v_fma_f32 v76, -v29, v9, v76
    v_fmac_f32 v77, v29, v8
    v_mfma_f32_16x16x32_bf16 a[96:99], a[248:251], a[144:147], a[96:99]
    v_min_u32 v74, -2, v74
    v_min_u32 v75, -2, v75
    v_min_u32 v76, -2, v76
    v_min_u32 v77, -2, v77
    buffer_store_dwordx4 v[74:77], v30, s[4:7], s70 offen offset:2048 sc1
    v_cmp_eq_u32 vcc, s50, v0
    s_or_b32 s60, s76, s77
    v_lshl_add_u32 v79, v33, 10, v79
    s_min_u32 s60, s60, 1
    v_lshrrev_b32 v33, 5, v0
    s_lshl_b32 s60, s60, 28
    v_lshl_add_u32 v79, v33, 8, v79
    s_mov_b32 s56, 0xbfb8aa3b
    v_cndmask_b32 v76, v31, v16, vcc
    s_mov_b32 s57, s56
    v_or_b32 v78, s60, v76
    s_barrier
    s_add_u32 s68, s45, 65536
    s_add_u32 m0, s64, 98304
    s_nop 0
    buffer_load_dwordx4 v2, s[28:31], s68 offen offset:0  lds
    buffer_load_dwordx4 v3, s[28:31], s68 offen offset:1024  lds
    v_pk_mul_f32 v[18:19], v[144:145], s[56:57]
    v_pk_mul_f32 v[20:21], v[146:147], s[56:57]
    v_pk_mul_f32 v[22:23], v[160:161], s[56:57]
    v_pk_mul_f32 v[24:25], v[162:163], s[56:57]
    v_exp_f32 v18, v18
    v_accvgpr_read_b32 v26, a0
    v_exp_f32 v19, v19
    v_accvgpr_read_b32 v27, a1
    v_exp_f32 v20, v20
    v_accvgpr_read_b32 v28, a2
    v_exp_f32 v21, v21
    v_accvgpr_read_b32 v29, a3
    v_exp_f32 v22, v22
    v_accvgpr_read_b32 v30, a16
    v_exp_f32 v23, v23
    v_accvgpr_read_b32 v31, a17
    v_exp_f32 v24, v24
    v_accvgpr_read_b32 v32, a18
    v_exp_f32 v25, v25
    v_accvgpr_read_b32 v33, a19
    v_pk_add_f32 v[18:19], v[18:19], 1.0 op_sel_hi:[1,0]
    v_pk_add_f32 v[20:21], v[20:21], 1.0 op_sel_hi:[1,0]
    v_pk_add_f32 v[22:23], v[22:23], 1.0 op_sel_hi:[1,0]
    v_pk_add_f32 v[24:25], v[24:25], 1.0 op_sel_hi:[1,0]
    v_rcp_f32 v18, v18
    v_rcp_f32 v19, v19
    v_pk_mul_f32 v[26:27], v[26:27], v[144:145]
    v_rcp_f32 v20, v20
    v_rcp_f32 v21, v21
    v_pk_mul_f32 v[28:29], v[28:29], v[146:147]
    v_rcp_f32 v22, v22
    v_rcp_f32 v23, v23
    v_pk_mul_f32 v[30:31], v[30:31], v[160:161]
    v_rcp_f32 v24, v24
    v_rcp_f32 v25, v25
    v_pk_mul_f32 v[32:33], v[32:33], v[162:163]
    v_pk_mul_f32 v[26:27], v[26:27], v[18:19]
    v_pk_mul_f32 v[28:29], v[28:29], v[20:21]
    v_pk_mul_f32 v[30:31], v[30:31], v[22:23]
    v_pk_mul_f32 v[32:33], v[32:33], v[24:25]
    v_cvt_pk_bf16_f32 v160, v26, v27
    v_cvt_pk_bf16_f32 v161, v28, v29
    v_cvt_pk_bf16_f32 v162, v30, v31
    v_cvt_pk_bf16_f32 v163, v32, v33
    buffer_store_dwordx4 v[160:163], v1, s[4:7], s71 offen offset:0 sc1
    v_accvgpr_write_b32 a112, v160
    v_accvgpr_write_b32 a113, v161
    v_accvgpr_write_b32 a114, v162
    v_accvgpr_write_b32 a115, v163
    buffer_load_dwordx4 v4, s[28:31], s68 offen offset:2048  lds
    buffer_load_dwordx4 v5, s[28:31], s68 offen offset:3072  lds
    v_pk_mul_f32 v[18:19], v[148:149], s[56:57]
    v_pk_mul_f32 v[20:21], v[150:151], s[56:57]
    v_pk_mul_f32 v[22:23], v[164:165], s[56:57]
    v_pk_mul_f32 v[24:25], v[166:167], s[56:57]
    v_exp_f32 v18, v18
    v_accvgpr_read_b32 v26, a4
    v_exp_f32 v19, v19
    v_accvgpr_read_b32 v27, a5
    v_exp_f32 v20, v20
    v_accvgpr_read_b32 v28, a6
    v_exp_f32 v21, v21
    v_accvgpr_read_b32 v29, a7
    v_exp_f32 v22, v22
    v_accvgpr_read_b32 v30, a20
    v_exp_f32 v23, v23
    v_accvgpr_read_b32 v31, a21
    v_exp_f32 v24, v24
    v_accvgpr_read_b32 v32, a22
    v_exp_f32 v25, v25
    v_accvgpr_read_b32 v33, a23
    v_pk_add_f32 v[18:19], v[18:19], 1.0 op_sel_hi:[1,0]
    v_pk_add_f32 v[20:21], v[20:21], 1.0 op_sel_hi:[1,0]
    v_pk_add_f32 v[22:23], v[22:23], 1.0 op_sel_hi:[1,0]
    v_pk_add_f32 v[24:25], v[24:25], 1.0 op_sel_hi:[1,0]
    v_rcp_f32 v18, v18
    v_rcp_f32 v19, v19
    v_pk_mul_f32 v[26:27], v[26:27], v[148:149]
    v_rcp_f32 v20, v20
    v_rcp_f32 v21, v21
    v_pk_mul_f32 v[28:29], v[28:29], v[150:151]
    v_rcp_f32 v22, v22
    v_rcp_f32 v23, v23
    v_pk_mul_f32 v[30:31], v[30:31], v[164:165]
    v_rcp_f32 v24, v24
    v_rcp_f32 v25, v25
    v_pk_mul_f32 v[32:33], v[32:33], v[166:167]
    v_pk_mul_f32 v[26:27], v[26:27], v[18:19]
    v_pk_mul_f32 v[28:29], v[28:29], v[20:21]
    v_pk_mul_f32 v[30:31], v[30:31], v[22:23]
    v_pk_mul_f32 v[32:33], v[32:33], v[24:25]
    v_cvt_pk_bf16_f32 v164, v26, v27
    v_cvt_pk_bf16_f32 v165, v28, v29
    v_cvt_pk_bf16_f32 v166, v30, v31
    v_cvt_pk_bf16_f32 v167, v32, v33
    buffer_store_dwordx4 v[164:167], v1, s[4:7], s71 offen offset:1024 sc1
    v_accvgpr_write_b32 a116, v164
    v_accvgpr_write_b32 a117, v165
    v_accvgpr_write_b32 a118, v166
    v_accvgpr_write_b32 a119, v167
    s_add_u32 s68, s45, 98304
    s_add_u32 m0, s64, 102400
    s_nop 0
    buffer_load_dwordx4 v2, s[28:31], s68 offen offset:0  lds
    buffer_load_dwordx4 v3, s[28:31], s68 offen offset:1024  lds
    v_pk_mul_f32 v[18:19], v[152:153], s[56:57]
    v_pk_mul_f32 v[20:21], v[154:155], s[56:57]
    v_pk_mul_f32 v[22:23], v[168:169], s[56:57]
    v_pk_mul_f32 v[24:25], v[170:171], s[56:57]
    v_exp_f32 v18, v18
    v_accvgpr_read_b32 v26, a8
    v_exp_f32 v19, v19
    v_accvgpr_read_b32 v27, a9
    v_exp_f32 v20, v20
    v_accvgpr_read_b32 v28, a10
    v_exp_f32 v21, v21
    v_accvgpr_read_b32 v29, a11
    v_exp_f32 v22, v22
    v_accvgpr_read_b32 v30, a24
    v_exp_f32 v23, v23
    v_accvgpr_read_b32 v31, a25
    v_exp_f32 v24, v24
    v_accvgpr_read_b32 v32, a26
    v_exp_f32 v25, v25
    v_accvgpr_read_b32 v33, a27
    v_pk_add_f32 v[18:19], v[18:19], 1.0 op_sel_hi:[1,0]
    v_pk_add_f32 v[20:21], v[20:21], 1.0 op_sel_hi:[1,0]
    v_pk_add_f32 v[22:23], v[22:23], 1.0 op_sel_hi:[1,0]
    v_pk_add_f32 v[24:25], v[24:25], 1.0 op_sel_hi:[1,0]
    v_rcp_f32 v18, v18
    v_rcp_f32 v19, v19
    v_pk_mul_f32 v[26:27], v[26:27], v[152:153]
    v_rcp_f32 v20, v20
    v_rcp_f32 v21, v21
    v_pk_mul_f32 v[28:29], v[28:29], v[154:155]
    v_rcp_f32 v22, v22
    v_rcp_f32 v23, v23
    v_pk_mul_f32 v[30:31], v[30:31], v[168:169]
    v_rcp_f32 v24, v24
    v_rcp_f32 v25, v25
    v_pk_mul_f32 v[32:33], v[32:33], v[170:171]
    v_pk_mul_f32 v[26:27], v[26:27], v[18:19]
    v_pk_mul_f32 v[28:29], v[28:29], v[20:21]
    v_pk_mul_f32 v[30:31], v[30:31], v[22:23]
    v_pk_mul_f32 v[32:33], v[32:33], v[24:25]
    v_cvt_pk_bf16_f32 v168, v26, v27
    v_cvt_pk_bf16_f32 v169, v28, v29
    v_cvt_pk_bf16_f32 v170, v30, v31
    v_cvt_pk_bf16_f32 v171, v32, v33
    buffer_store_dwordx4 v[168:171], v1, s[4:7], s71 offen offset:2048 sc1
    v_accvgpr_write_b32 a120, v168
    v_accvgpr_write_b32 a121, v169
    v_accvgpr_write_b32 a122, v170
    v_accvgpr_write_b32 a123, v171
    buffer_load_dwordx4 v4, s[28:31], s68 offen offset:2048  lds
    buffer_load_dwordx4 v5, s[28:31], s68 offen offset:3072  lds
    v_pk_mul_f32 v[18:19], v[156:157], s[56:57]
    v_pk_mul_f32 v[20:21], v[158:159], s[56:57]
    v_pk_mul_f32 v[22:23], v[172:173], s[56:57]
    v_pk_mul_f32 v[24:25], v[174:175], s[56:57]
    v_exp_f32 v18, v18
    v_accvgpr_read_b32 v26, a12
    v_exp_f32 v19, v19
    v_accvgpr_read_b32 v27, a13
    v_exp_f32 v20, v20
    v_accvgpr_read_b32 v28, a14
    v_exp_f32 v21, v21
    v_accvgpr_read_b32 v29, a15
    v_exp_f32 v22, v22
    v_accvgpr_read_b32 v30, a28
    v_exp_f32 v23, v23
    v_accvgpr_read_b32 v31, a29
    v_exp_f32 v24, v24
    v_accvgpr_read_b32 v32, a30
    v_exp_f32 v25, v25
    v_accvgpr_read_b32 v33, a31
    v_pk_add_f32 v[18:19], v[18:19], 1.0 op_sel_hi:[1,0]
    v_pk_add_f32 v[20:21], v[20:21], 1.0 op_sel_hi:[1,0]
    v_pk_add_f32 v[22:23], v[22:23], 1.0 op_sel_hi:[1,0]
    v_pk_add_f32 v[24:25], v[24:25], 1.0 op_sel_hi:[1,0]
    v_rcp_f32 v18, v18
    v_rcp_f32 v19, v19
    v_pk_mul_f32 v[26:27], v[26:27], v[156:157]
    v_rcp_f32 v20, v20
    v_rcp_f32 v21, v21
    v_pk_mul_f32 v[28:29], v[28:29], v[158:159]
    v_rcp_f32 v22, v22
    v_rcp_f32 v23, v23
    v_pk_mul_f32 v[30:31], v[30:31], v[172:173]
    v_rcp_f32 v24, v24
    v_rcp_f32 v25, v25
    v_pk_mul_f32 v[32:33], v[32:33], v[174:175]
    v_pk_mul_f32 v[26:27], v[26:27], v[18:19]
    v_pk_mul_f32 v[28:29], v[28:29], v[20:21]
    v_pk_mul_f32 v[30:31], v[30:31], v[22:23]
    v_pk_mul_f32 v[32:33], v[32:33], v[24:25]
    v_cvt_pk_bf16_f32 v172, v26, v27
    v_cvt_pk_bf16_f32 v173, v28, v29
    v_cvt_pk_bf16_f32 v174, v30, v31
    v_cvt_pk_bf16_f32 v175, v32, v33
    buffer_store_dwordx4 v[172:175], v1, s[4:7], s71 offen offset:3072 sc1
    v_accvgpr_write_b32 a124, v172
    v_accvgpr_write_b32 a125, v173
    v_accvgpr_write_b32 a126, v174
    v_accvgpr_write_b32 a127, v175
    s_xor_b32 s71, s69, 65536
    v_pk_mul_f32 v[18:19], v[176:177], s[56:57]
    v_pk_mul_f32 v[20:21], v[178:179], s[56:57]
    v_pk_mul_f32 v[22:23], v[192:193], s[56:57]
    v_pk_mul_f32 v[24:25], v[194:195], s[56:57]
    v_exp_f32 v18, v18
    v_accvgpr_read_b32 v26, a32
    v_exp_f32 v19, v19
    v_accvgpr_read_b32 v27, a33
    v_exp_f32 v20, v20
    v_accvgpr_read_b32 v28, a34
    v_exp_f32 v21, v21
    v_accvgpr_read_b32 v29, a35
    v_exp_f32 v22, v22
    v_accvgpr_read_b32 v30, a48
    v_exp_f32 v23, v23
    v_accvgpr_read_b32 v31, a49
    v_exp_f32 v24, v24
    v_accvgpr_read_b32 v32, a50
    v_exp_f32 v25, v25
    v_accvgpr_read_b32 v33, a51
    v_pk_add_f32 v[18:19], v[18:19], 1.0 op_sel_hi:[1,0]
    v_pk_add_f32 v[20:21], v[20:21], 1.0 op_sel_hi:[1,0]
    v_pk_add_f32 v[22:23], v[22:23], 1.0 op_sel_hi:[1,0]
    v_pk_add_f32 v[24:25], v[24:25], 1.0 op_sel_hi:[1,0]
    v_rcp_f32 v18, v18
    v_rcp_f32 v19, v19
    v_pk_mul_f32 v[26:27], v[26:27], v[176:177]
    v_rcp_f32 v20, v20
    v_rcp_f32 v21, v21
    v_pk_mul_f32 v[28:29], v[28:29], v[178:179]
    v_rcp_f32 v22, v22
    v_rcp_f32 v23, v23
    v_pk_mul_f32 v[30:31], v[30:31], v[192:193]
    v_rcp_f32 v24, v24
    v_rcp_f32 v25, v25
    v_pk_mul_f32 v[32:33], v[32:33], v[194:195]
    v_pk_mul_f32 v[26:27], v[26:27], v[18:19]
    v_pk_mul_f32 v[28:29], v[28:29], v[20:21]
    v_pk_mul_f32 v[30:31], v[30:31], v[22:23]
    v_pk_mul_f32 v[32:33], v[32:33], v[24:25]
    v_cvt_pk_bf16_f32 v192, v26, v27
    v_cvt_pk_bf16_f32 v193, v28, v29
    v_cvt_pk_bf16_f32 v194, v30, v31
    v_cvt_pk_bf16_f32 v195, v32, v33
    buffer_store_dwordx4 v[192:195], v1, s[4:7], s71 offen offset:0 sc1
    v_accvgpr_write_b32 a128, v192
    v_accvgpr_write_b32 a129, v193
    v_accvgpr_write_b32 a130, v194
    v_accvgpr_write_b32 a131, v195
    v_pk_mul_f32 v[18:19], v[180:181], s[56:57]
    v_pk_mul_f32 v[20:21], v[182:183], s[56:57]
    v_pk_mul_f32 v[22:23], v[196:197], s[56:57]
    v_pk_mul_f32 v[24:25], v[198:199], s[56:57]
    v_exp_f32 v18, v18
    v_accvgpr_read_b32 v26, a36
    v_exp_f32 v19, v19
    v_accvgpr_read_b32 v27, a37
    v_exp_f32 v20, v20
    v_accvgpr_read_b32 v28, a38
    v_exp_f32 v21, v21
    v_accvgpr_read_b32 v29, a39
    v_exp_f32 v22, v22
    v_accvgpr_read_b32 v30, a52
    v_exp_f32 v23, v23
    v_accvgpr_read_b32 v31, a53
    v_exp_f32 v24, v24
    v_accvgpr_read_b32 v32, a54
    v_exp_f32 v25, v25
    v_accvgpr_read_b32 v33, a55
    v_pk_add_f32 v[18:19], v[18:19], 1.0 op_sel_hi:[1,0]
    v_pk_add_f32 v[20:21], v[20:21], 1.0 op_sel_hi:[1,0]
    v_pk_add_f32 v[22:23], v[22:23], 1.0 op_sel_hi:[1,0]
    v_pk_add_f32 v[24:25], v[24:25], 1.0 op_sel_hi:[1,0]
    v_rcp_f32 v18, v18
    v_rcp_f32 v19, v19
    v_pk_mul_f32 v[26:27], v[26:27], v[180:181]
    v_rcp_f32 v20, v20
    v_rcp_f32 v21, v21
    v_pk_mul_f32 v[28:29], v[28:29], v[182:183]
    v_rcp_f32 v22, v22
    v_rcp_f32 v23, v23
    v_pk_mul_f32 v[30:31], v[30:31], v[196:197]
    v_rcp_f32 v24, v24
    v_rcp_f32 v25, v25
    v_pk_mul_f32 v[32:33], v[32:33], v[198:199]
    v_pk_mul_f32 v[26:27], v[26:27], v[18:19]
    v_pk_mul_f32 v[28:29], v[28:29], v[20:21]
    v_pk_mul_f32 v[30:31], v[30:31], v[22:23]
    v_pk_mul_f32 v[32:33], v[32:33], v[24:25]
    v_cvt_pk_bf16_f32 v196, v26, v27
    v_cvt_pk_bf16_f32 v197, v28, v29
    v_cvt_pk_bf16_f32 v198, v30, v31
    v_cvt_pk_bf16_f32 v199, v32, v33
    buffer_store_dwordx4 v[196:199], v1, s[4:7], s71 offen offset:1024 sc1
    v_accvgpr_write_b32 a132, v196
    v_accvgpr_write_b32 a133, v197
    v_accvgpr_write_b32 a134, v198
    v_accvgpr_write_b32 a135, v199
    v_pk_mul_f32 v[18:19], v[184:185], s[56:57]
    v_pk_mul_f32 v[20:21], v[186:187], s[56:57]
    v_pk_mul_f32 v[22:23], v[200:201], s[56:57]
    v_pk_mul_f32 v[24:25], v[202:203], s[56:57]
    v_exp_f32 v18, v18
    v_accvgpr_read_b32 v26, a40
    v_exp_f32 v19, v19
    v_accvgpr_read_b32 v27, a41
    v_exp_f32 v20, v20
    v_accvgpr_read_b32 v28, a42
    v_exp_f32 v21, v21
    v_accvgpr_read_b32 v29, a43
    v_exp_f32 v22, v22
    v_accvgpr_read_b32 v30, a56
    v_exp_f32 v23, v23
    v_accvgpr_read_b32 v31, a57
    v_exp_f32 v24, v24
    v_accvgpr_read_b32 v32, a58
    v_exp_f32 v25, v25
    v_accvgpr_read_b32 v33, a59
    v_pk_add_f32 v[18:19], v[18:19], 1.0 op_sel_hi:[1,0]
    v_pk_add_f32 v[20:21], v[20:21], 1.0 op_sel_hi:[1,0]
    v_pk_add_f32 v[22:23], v[22:23], 1.0 op_sel_hi:[1,0]
    v_pk_add_f32 v[24:25], v[24:25], 1.0 op_sel_hi:[1,0]
    v_rcp_f32 v18, v18
    v_rcp_f32 v19, v19
    v_pk_mul_f32 v[26:27], v[26:27], v[184:185]
    v_rcp_f32 v20, v20
    v_rcp_f32 v21, v21
    v_pk_mul_f32 v[28:29], v[28:29], v[186:187]
    v_rcp_f32 v22, v22
    v_rcp_f32 v23, v23
    v_pk_mul_f32 v[30:31], v[30:31], v[200:201]
    v_rcp_f32 v24, v24
    v_rcp_f32 v25, v25
    v_pk_mul_f32 v[32:33], v[32:33], v[202:203]
    v_pk_mul_f32 v[26:27], v[26:27], v[18:19]
    v_pk_mul_f32 v[28:29], v[28:29], v[20:21]
    v_pk_mul_f32 v[30:31], v[30:31], v[22:23]
    v_pk_mul_f32 v[32:33], v[32:33], v[24:25]
    v_cvt_pk_bf16_f32 v200, v26, v27
    v_cvt_pk_bf16_f32 v201, v28, v29
    v_cvt_pk_bf16_f32 v202, v30, v31
    v_cvt_pk_bf16_f32 v203, v32, v33
    buffer_store_dwordx4 v[200:203], v1, s[4:7], s71 offen offset:2048 sc1
    v_accvgpr_write_b32 a136, v200
    v_accvgpr_write_b32 a137, v201
    v_accvgpr_write_b32 a138, v202
    v_accvgpr_write_b32 a139, v203
    v_pk_mul_f32 v[18:19], v[188:189], s[56:57]
    v_pk_mul_f32 v[20:21], v[190:191], s[56:57]
    v_pk_mul_f32 v[22:23], v[204:205], s[56:57]
    v_pk_mul_f32 v[24:25], v[206:207], s[56:57]
    v_exp_f32 v18, v18
    v_accvgpr_read_b32 v26, a44
    v_exp_f32 v19, v19
    v_accvgpr_read_b32 v27, a45
    v_exp_f32 v20, v20
    v_accvgpr_read_b32 v28, a46
    v_exp_f32 v21, v21
    v_accvgpr_read_b32 v29, a47
    v_exp_f32 v22, v22
    v_accvgpr_read_b32 v30, a60
    v_exp_f32 v23, v23
    v_accvgpr_read_b32 v31, a61
    v_exp_f32 v24, v24
    v_accvgpr_read_b32 v32, a62
    v_exp_f32 v25, v25
    v_accvgpr_read_b32 v33, a63
    v_pk_add_f32 v[18:19], v[18:19], 1.0 op_sel_hi:[1,0]
    v_pk_add_f32 v[20:21], v[20:21], 1.0 op_sel_hi:[1,0]
    v_pk_add_f32 v[22:23], v[22:23], 1.0 op_sel_hi:[1,0]
    v_pk_add_f32 v[24:25], v[24:25], 1.0 op_sel_hi:[1,0]
    v_rcp_f32 v18, v18
    v_rcp_f32 v19, v19
    v_pk_mul_f32 v[26:27], v[26:27], v[188:189]
    v_rcp_f32 v20, v20
    v_rcp_f32 v21, v21
    v_pk_mul_f32 v[28:29], v[28:29], v[190:191]
    v_rcp_f32 v22, v22
    v_rcp_f32 v23, v23
    v_pk_mul_f32 v[30:31], v[30:31], v[204:205]
    v_rcp_f32 v24, v24
    v_rcp_f32 v25, v25
    v_pk_mul_f32 v[32:33], v[32:33], v[206:207]
    v_pk_mul_f32 v[26:27], v[26:27], v[18:19]
    v_pk_mul_f32 v[28:29], v[28:29], v[20:21]
    v_pk_mul_f32 v[30:31], v[30:31], v[22:23]
    v_pk_mul_f32 v[32:33], v[32:33], v[24:25]
    v_cvt_pk_bf16_f32 v204, v26, v27
    v_cvt_pk_bf16_f32 v205, v28, v29
    v_cvt_pk_bf16_f32 v206, v30, v31
    v_cvt_pk_bf16_f32 v207, v32, v33
    buffer_store_dwordx4 v[204:207], v1, s[4:7], s71 offen offset:3072 sc1
    v_accvgpr_write_b32 a140, v204
    v_accvgpr_write_b32 a141, v205
    v_accvgpr_write_b32 a142, v206
    v_accvgpr_write_b32 a143, v207
    s_xor_b32 s71, s69, 131072
    v_mov_b32 v74, 1
    s_mov_b64 vcc, s[76:77]
    v_add_u32 v74, s79, v74
    s_waitcnt vmcnt(4)
    s_cbranch_vccnz FAR_1
NEAR_1:
    buffer_store_dword v74, v78, s[4:7], s73 offen
    buffer_load_dwordx4 v[144:147], v14, s[4:7], s70 offen sc1
    buffer_load_dwordx4 v[148:151], v15, s[4:7], s70 offen sc1
    v_pk_mul_f32 v[18:19], v[208:209], s[56:57]
    v_pk_mul_f32 v[20:21], v[210:211], s[56:57]
    v_pk_mul_f32 v[22:23], v[224:225], s[56:57]
    v_pk_mul_f32 v[24:25], v[226:227], s[56:57]
    v_exp_f32 v18, v18
    v_accvgpr_read_b32 v26, a64
    v_exp_f32 v19, v19
    v_accvgpr_read_b32 v27, a65
    v_exp_f32 v20, v20
    v_accvgpr_read_b32 v28, a66
    v_exp_f32 v21, v21
    v_accvgpr_read_b32 v29, a67
    v_exp_f32 v22, v22
    v_accvgpr_read_b32 v30, a80
    v_exp_f32 v23, v23
    v_accvgpr_read_b32 v31, a81
    v_exp_f32 v24, v24
    v_accvgpr_read_b32 v32, a82
    v_exp_f32 v25, v25
    v_accvgpr_read_b32 v33, a83
    v_pk_add_f32 v[18:19], v[18:19], 1.0 op_sel_hi:[1,0]
    v_pk_add_f32 v[20:21], v[20:21], 1.0 op_sel_hi:[1,0]
    v_pk_add_f32 v[22:23], v[22:23], 1.0 op_sel_hi:[1,0]
    v_pk_add_f32 v[24:25], v[24:25], 1.0 op_sel_hi:[1,0]
    v_rcp_f32 v18, v18
    v_rcp_f32 v19, v19
    v_pk_mul_f32 v[26:27], v[26:27], v[208:209]
    v_rcp_f32 v20, v20
    v_rcp_f32 v21, v21
    v_pk_mul_f32 v[28:29], v[28:29], v[210:211]
    v_rcp_f32 v22, v22
    v_rcp_f32 v23, v23
    v_pk_mul_f32 v[30:31], v[30:31], v[224:225]
    v_rcp_f32 v24, v24
    v_rcp_f32 v25, v25
    v_pk_mul_f32 v[32:33], v[32:33], v[226:227]
    v_pk_mul_f32 v[26:27], v[26:27], v[18:19]
    v_pk_mul_f32 v[28:29], v[28:29], v[20:21]
    v_pk_mul_f32 v[30:31], v[30:31], v[22:23]
    v_pk_mul_f32 v[32:33], v[32:33], v[24:25]
    v_cvt_pk_bf16_f32 v224, v26, v27
    v_cvt_pk_bf16_f32 v225, v28, v29
    v_cvt_pk_bf16_f32 v226, v30, v31
    v_cvt_pk_bf16_f32 v227, v32, v33
    buffer_store_dwordx4 v[224:227], v1, s[4:7], s71 offen offset:0 sc1
    v_accvgpr_write_b32 a144, v224
    v_accvgpr_write_b32 a145, v225
    v_accvgpr_write_b32 a146, v226
    v_accvgpr_write_b32 a147, v227
    v_pk_mul_f32 v[18:19], v[212:213], s[56:57]
    v_pk_mul_f32 v[20:21], v[214:215], s[56:57]
    v_pk_mul_f32 v[22:23], v[228:229], s[56:57]
    v_pk_mul_f32 v[24:25], v[230:231], s[56:57]
    v_exp_f32 v18, v18
    v_accvgpr_read_b32 v26, a68
    v_exp_f32 v19, v19
    v_accvgpr_read_b32 v27, a69
    v_exp_f32 v20, v20
    v_accvgpr_read_b32 v28, a70
    v_exp_f32 v21, v21
    v_accvgpr_read_b32 v29, a71
    v_exp_f32 v22, v22
    v_accvgpr_read_b32 v30, a84
    v_exp_f32 v23, v23
    v_accvgpr_read_b32 v31, a85
    v_exp_f32 v24, v24
    v_accvgpr_read_b32 v32, a86
    v_exp_f32 v25, v25
    v_accvgpr_read_b32 v33, a87
    v_pk_add_f32 v[18:19], v[18:19], 1.0 op_sel_hi:[1,0]
    v_pk_add_f32 v[20:21], v[20:21], 1.0 op_sel_hi:[1,0]
    v_pk_add_f32 v[22:23], v[22:23], 1.0 op_sel_hi:[1,0]
    v_pk_add_f32 v[24:25], v[24:25], 1.0 op_sel_hi:[1,0]
    v_rcp_f32 v18, v18
    v_rcp_f32 v19, v19
    v_pk_mul_f32 v[26:27], v[26:27], v[212:213]
    v_rcp_f32 v20, v20
    v_rcp_f32 v21, v21
    v_pk_mul_f32 v[28:29], v[28:29], v[214:215]
    v_rcp_f32 v22, v22
    v_rcp_f32 v23, v23
    v_pk_mul_f32 v[30:31], v[30:31], v[228:229]
    v_rcp_f32 v24, v24
    v_rcp_f32 v25, v25
    v_pk_mul_f32 v[32:33], v[32:33], v[230:231]
    v_pk_mul_f32 v[26:27], v[26:27], v[18:19]
    v_pk_mul_f32 v[28:29], v[28:29], v[20:21]
    v_pk_mul_f32 v[30:31], v[30:31], v[22:23]
    v_pk_mul_f32 v[32:33], v[32:33], v[24:25]
    v_cvt_pk_bf16_f32 v228, v26, v27
    v_cvt_pk_bf16_f32 v229, v28, v29
    v_cvt_pk_bf16_f32 v230, v30, v31
    v_cvt_pk_bf16_f32 v231, v32, v33
    buffer_store_dwordx4 v[228:231], v1, s[4:7], s71 offen offset:1024 sc1
    v_accvgpr_write_b32 a148, v228
    v_accvgpr_write_b32 a149, v229
    v_accvgpr_write_b32 a150, v230
    v_accvgpr_write_b32 a151, v231
    v_pk_mul_f32 v[18:19], v[216:217], s[56:57]
    v_pk_mul_f32 v[20:21], v[218:219], s[56:57]
    v_pk_mul_f32 v[22:23], v[232:233], s[56:57]
    v_pk_mul_f32 v[24:25], v[234:235], s[56:57]
    v_exp_f32 v18, v18
    v_accvgpr_read_b32 v26, a72
    v_exp_f32 v19, v19
    v_accvgpr_read_b32 v27, a73
    v_exp_f32 v20, v20
    v_accvgpr_read_b32 v28, a74
    v_exp_f32 v21, v21
    v_accvgpr_read_b32 v29, a75
    v_exp_f32 v22, v22
    v_accvgpr_read_b32 v30, a88
    v_exp_f32 v23, v23
    v_accvgpr_read_b32 v31, a89
    v_exp_f32 v24, v24
    v_accvgpr_read_b32 v32, a90
    v_exp_f32 v25, v25
    v_accvgpr_read_b32 v33, a91
    v_pk_add_f32 v[18:19], v[18:19], 1.0 op_sel_hi:[1,0]
    v_pk_add_f32 v[20:21], v[20:21], 1.0 op_sel_hi:[1,0]
    v_pk_add_f32 v[22:23], v[22:23], 1.0 op_sel_hi:[1,0]
    v_pk_add_f32 v[24:25], v[24:25], 1.0 op_sel_hi:[1,0]
    v_rcp_f32 v18, v18
    v_rcp_f32 v19, v19
    v_pk_mul_f32 v[26:27], v[26:27], v[216:217]
    v_rcp_f32 v20, v20
    v_rcp_f32 v21, v21
    v_pk_mul_f32 v[28:29], v[28:29], v[218:219]
    v_rcp_f32 v22, v22
    v_rcp_f32 v23, v23
    v_pk_mul_f32 v[30:31], v[30:31], v[232:233]
    v_rcp_f32 v24, v24
    v_rcp_f32 v25, v25
    v_pk_mul_f32 v[32:33], v[32:33], v[234:235]
    v_pk_mul_f32 v[26:27], v[26:27], v[18:19]
    v_pk_mul_f32 v[28:29], v[28:29], v[20:21]
    v_pk_mul_f32 v[30:31], v[30:31], v[22:23]
    v_pk_mul_f32 v[32:33], v[32:33], v[24:25]
    v_cvt_pk_bf16_f32 v232, v26, v27
    v_cvt_pk_bf16_f32 v233, v28, v29
    v_cvt_pk_bf16_f32 v234, v30, v31
    v_cvt_pk_bf16_f32 v235, v32, v33
    buffer_store_dwordx4 v[232:235], v1, s[4:7], s71 offen offset:2048 sc1
    v_accvgpr_write_b32 a152, v232
    v_accvgpr_write_b32 a153, v233
    v_accvgpr_write_b32 a154, v234
    v_accvgpr_write_b32 a155, v235
    v_pk_mul_f32 v[18:19], v[220:221], s[56:57]
    v_pk_mul_f32 v[20:21], v[222:223], s[56:57]
    v_pk_mul_f32 v[22:23], v[236:237], s[56:57]
    v_pk_mul_f32 v[24:25], v[238:239], s[56:57]
    v_exp_f32 v18, v18
    v_accvgpr_read_b32 v26, a76
    v_exp_f32 v19, v19
    v_accvgpr_read_b32 v27, a77
    v_exp_f32 v20, v20
    v_accvgpr_read_b32 v28, a78
    v_exp_f32 v21, v21
    v_accvgpr_read_b32 v29, a79
    v_exp_f32 v22, v22
    v_accvgpr_read_b32 v30, a92
    v_exp_f32 v23, v23
    v_accvgpr_read_b32 v31, a93
    v_exp_f32 v24, v24
    v_accvgpr_read_b32 v32, a94
    v_exp_f32 v25, v25
    v_accvgpr_read_b32 v33, a95
    v_pk_add_f32 v[18:19], v[18:19], 1.0 op_sel_hi:[1,0]
    v_pk_add_f32 v[20:21], v[20:21], 1.0 op_sel_hi:[1,0]
    v_pk_add_f32 v[22:23], v[22:23], 1.0 op_sel_hi:[1,0]
    v_pk_add_f32 v[24:25], v[24:25], 1.0 op_sel_hi:[1,0]
    v_rcp_f32 v18, v18
    v_rcp_f32 v19, v19
    v_pk_mul_f32 v[26:27], v[26:27], v[220:221]
    v_rcp_f32 v20, v20
    v_rcp_f32 v21, v21
    v_pk_mul_f32 v[28:29], v[28:29], v[222:223]
    v_rcp_f32 v22, v22
    v_rcp_f32 v23, v23
    v_pk_mul_f32 v[30:31], v[30:31], v[236:237]
    v_rcp_f32 v24, v24
    v_rcp_f32 v25, v25
    v_pk_mul_f32 v[32:33], v[32:33], v[238:239]
    v_pk_mul_f32 v[26:27], v[26:27], v[18:19]
    v_pk_mul_f32 v[28:29], v[28:29], v[20:21]
    v_pk_mul_f32 v[30:31], v[30:31], v[22:23]
    v_pk_mul_f32 v[32:33], v[32:33], v[24:25]
    v_cvt_pk_bf16_f32 v236, v26, v27
    v_cvt_pk_bf16_f32 v237, v28, v29
    v_cvt_pk_bf16_f32 v238, v30, v31
    v_cvt_pk_bf16_f32 v239, v32, v33
    buffer_store_dwordx4 v[236:239], v1, s[4:7], s71 offen offset:3072 sc1
    v_accvgpr_write_b32 a156, v236
    v_accvgpr_write_b32 a157, v237
    v_accvgpr_write_b32 a158, v238
    v_accvgpr_write_b32 a159, v239
    s_xor_b32 s71, s69, 196608
    v_mov_b32 v74, 2
    s_mov_b64 vcc, s[76:77]
    v_add_u32 v74, s79, v74
    s_waitcnt vmcnt(7)
    s_cbranch_vccnz FAR_2
NEAR_2:
    buffer_store_dword v74, v78, s[4:7], s73 offen
    v_pk_mul_f32 v[18:19], v[240:241], s[56:57]
    v_pk_mul_f32 v[20:21], v[242:243], s[56:57]
    v_pk_mul_f32 v[22:23], v[244:245], s[56:57]
    v_pk_mul_f32 v[24:25], v[246:247], s[56:57]
    v_exp_f32 v18, v18
    v_accvgpr_read_b32 v26, a96
    v_exp_f32 v19, v19
    v_accvgpr_read_b32 v27, a97
    v_exp_f32 v20, v20
    v_accvgpr_read_b32 v28, a98
    v_exp_f32 v21, v21
    v_accvgpr_read_b32 v29, a99
    v_exp_f32 v22, v22
    v_accvgpr_read_b32 v30, a100
    v_exp_f32 v23, v23
    v_accvgpr_read_b32 v31, a101
    v_exp_f32 v24, v24
    v_accvgpr_read_b32 v32, a102
    v_exp_f32 v25, v25
    v_accvgpr_read_b32 v33, a103
    v_pk_add_f32 v[18:19], v[18:19], 1.0 op_sel_hi:[1,0]
    v_pk_add_f32 v[20:21], v[20:21], 1.0 op_sel_hi:[1,0]
    v_pk_add_f32 v[22:23], v[22:23], 1.0 op_sel_hi:[1,0]
    v_pk_add_f32 v[24:25], v[24:25], 1.0 op_sel_hi:[1,0]
    v_rcp_f32 v18, v18
    v_rcp_f32 v19, v19
    v_pk_mul_f32 v[26:27], v[26:27], v[240:241]
    v_rcp_f32 v20, v20
    v_rcp_f32 v21, v21
    v_pk_mul_f32 v[28:29], v[28:29], v[242:243]
    v_rcp_f32 v22, v22
    v_rcp_f32 v23, v23
    v_pk_mul_f32 v[30:31], v[30:31], v[244:245]
    v_rcp_f32 v24, v24
    v_rcp_f32 v25, v25
    v_pk_mul_f32 v[32:33], v[32:33], v[246:247]
    v_pk_mul_f32 v[26:27], v[26:27], v[18:19]
    v_pk_mul_f32 v[28:29], v[28:29], v[20:21]
    v_pk_mul_f32 v[30:31], v[30:31], v[22:23]
    v_pk_mul_f32 v[32:33], v[32:33], v[24:25]
    v_cvt_pk_bf16_f32 v240, v26, v27
    v_cvt_pk_bf16_f32 v241, v28, v29
    v_cvt_pk_bf16_f32 v242, v30, v31
    v_cvt_pk_bf16_f32 v243, v32, v33
    buffer_load_dword v17, v16, s[4:7], s73 offen sc1
    v_permlane16_swap_b32 v240, v242
    v_permlane16_swap_b32 v241, v243
    buffer_store_dwordx4 v[240:243], v79, s[4:7], s72 offen offset:0 sc1
    v_pk_mul_f32 v[18:19], v[248:249], s[56:57]
    v_pk_mul_f32 v[20:21], v[250:251], s[56:57]
    v_pk_mul_f32 v[22:23], v[252:253], s[56:57]
    v_pk_mul_f32 v[24:25], v[254:255], s[56:57]
    v_exp_f32 v18, v18
    v_accvgpr_read_b32 v26, a104
    v_exp_f32 v19, v19
    v_accvgpr_read_b32 v27, a105
    v_exp_f32 v20, v20
    v_accvgpr_read_b32 v28, a106
    v_exp_f32 v21, v21
    v_accvgpr_read_b32 v29, a107
    v_exp_f32 v22, v22
    v_accvgpr_read_b32 v30, a108
    v_exp_f32 v23, v23
    v_accvgpr_read_b32 v31, a109
    v_exp_f32 v24, v24
    v_accvgpr_read_b32 v32, a110
    v_exp_f32 v25, v25
    v_accvgpr_read_b32 v33, a111
    v_pk_add_f32 v[18:19], v[18:19], 1.0 op_sel_hi:[1,0]
    v_pk_add_f32 v[20:21], v[20:21], 1.0 op_sel_hi:[1,0]
    v_pk_add_f32 v[22:23], v[22:23], 1.0 op_sel_hi:[1,0]
    v_pk_add_f32 v[24:25], v[24:25], 1.0 op_sel_hi:[1,0]
    v_rcp_f32 v18, v18
    v_rcp_f32 v19, v19
    v_pk_mul_f32 v[26:27], v[26:27], v[248:249]
    v_rcp_f32 v20, v20
    v_rcp_f32 v21, v21
    v_pk_mul_f32 v[28:29], v[28:29], v[250:251]
    v_rcp_f32 v22, v22
    v_rcp_f32 v23, v23
    v_pk_mul_f32 v[30:31], v[30:31], v[252:253]
    v_rcp_f32 v24, v24
    v_rcp_f32 v25, v25
    v_pk_mul_f32 v[32:33], v[32:33], v[254:255]
    v_pk_mul_f32 v[26:27], v[26:27], v[18:19]
    v_pk_mul_f32 v[28:29], v[28:29], v[20:21]
    v_pk_mul_f32 v[30:31], v[30:31], v[22:23]
    v_pk_mul_f32 v[32:33], v[32:33], v[24:25]
    v_cvt_pk_bf16_f32 v248, v26, v27
    v_cvt_pk_bf16_f32 v249, v28, v29
    v_cvt_pk_bf16_f32 v250, v30, v31
    v_cvt_pk_bf16_f32 v251, v32, v33
    s_nop 0
    v_permlane16_swap_b32 v248, v250
    v_permlane16_swap_b32 v249, v251
    buffer_store_dwordx4 v[248:251], v79, s[4:7], s72 offen offset:2048 sc1
    s_waitcnt vmcnt(8)
    v_max3_u32 v74, v144, v145, v146
    v_max3_u32 v75, v147, v148, v149
    v_max3_u32 v74, v74, v150, v151
    v_max_u32 v74, v74, v75
    v_cmp_eq_u32 vcc, -1, v74
    s_cbranch_vccnz SLOW_MB
BACK_MB:
    v_fmac_f32 v148, v42, v144
    v_fmac_f32 v149, v42, v145
    v_fmac_f32 v150, v44, v146
    v_fmac_f32 v151, v44, v147
    v_fma_f32 v148, -v43, v145, v148
    v_fmac_f32 v149, v43, v144
    v_fma_f32 v150, -v45, v147, v150
    v_fmac_f32 v151, v45, v146
    v_mov_b32 v152, v148
    v_mov_b32 v153, v149
    v_mov_b32 v154, v150
    v_mov_b32 v155, v151
    v_permlane16_swap_b32 v148, v152
    v_permlane16_swap_b32 v149, v153
    v_permlane16_swap_b32 v150, v154
    v_permlane16_swap_b32 v151, v155
    v_fmac_f32 v152, v46, v148
    v_fmac_f32 v153, v46, v149
    v_fmac_f32 v154, v48, v150
    v_fmac_f32 v155, v48, v151
    v_fma_f32 v152, -v47, v149, v152
    v_fmac_f32 v153, v47, v148
    v_fma_f32 v154, -v49, v151, v154
    v_fmac_f32 v155, v49, v150
    v_mov_b32 v148, v152
    v_mov_b32 v149, v153
    v_mov_b32 v150, v154
    v_mov_b32 v151, v155
    v_permlane32_swap_b32 v152, v148
    v_permlane32_swap_b32 v153, v149
    v_permlane32_swap_b32 v154, v150
    v_permlane32_swap_b32 v155, v151
    v_fmac_f32 v148, v50, v152
    v_fmac_f32 v149, v50, v153
    v_fmac_f32 v150, v52, v154
    v_fmac_f32 v151, v52, v155
    v_fma_f32 v148, -v51, v153, v148
    v_fmac_f32 v149, v51, v152
    v_fma_f32 v150, -v53, v155, v150
    v_fmac_f32 v151, v53, v154
    v_fmac_f32 v6, v58, v148
    v_fmac_f32 v7, v58, v149
    v_fmac_f32 v8, v60, v150
    v_fmac_f32 v9, v60, v151
    v_fma_f32 v6, -v59, v149, v6
    v_fmac_f32 v7, v59, v148
    v_fma_f32 v8, -v61, v151, v8
    v_fmac_f32 v9, v61, v150
    v_fma_f32 v176, v54, v6, v10
    v_fma_f32 v178, v54, v7, v11
    v_fma_f32 v180, v56, v8, v12
    v_fma_f32 v182, v56, v9, v13
    v_fma_f32 v176, -v55, v7, v176
    v_fmac_f32 v178, v55, v6
    v_fma_f32 v180, -v57, v9, v180
    v_fmac_f32 v182, v57, v8
    v_fma_f32 v177, v38, v176, v66
    v_fma_f32 v179, v38, v178, v68
    v_fma_f32 v181, v40, v180, v70
    v_fma_f32 v183, v40, v182, v72
    v_fma_f32 v177, -v39, v178, v177
    v_fmac_f32 v179, v39, v176
    v_fma_f32 v181, -v41, v182, v181
    v_fmac_f32 v183, v41, v180
    s_waitcnt vmcnt(2)
    v_subrev_u32 v17, s79, v17
    v_subrev_u32 v17, 1, v17
    v_cmp_lt_u32 vcc, 6, v17
    s_cbranch_vccnz SLOW_FA1
BACK_FA1:
    s_xor_b32 s46, s69, 4096
    buffer_load_dwordx4 a[0:3], v1, s[4:7], s46 offen offset:0 sc1
    v_pk_fma_f32 v[80:81], v[176:177], v[34:35], v[80:81] op_sel:[0,0,0] op_sel_hi:[1,0,1]
    v_pk_fma_f32 v[96:97], v[178:179], v[34:35], v[96:97] op_sel:[0,0,0] op_sel_hi:[1,0,1]
    v_pk_fma_f32 v[112:113], v[180:181], v[36:37], v[112:113] op_sel:[0,0,0] op_sel_hi:[1,0,1]
    v_pk_fma_f32 v[128:129], v[182:183], v[36:37], v[128:129] op_sel:[0,0,0] op_sel_hi:[1,0,1]
    v_pk_fma_f32 v[80:81], v[178:179], v[34:35], v[80:81] op_sel:[0,1,0] op_sel_hi:[1,1,1] neg_lo:[1,0,0] neg_hi:[1,0,0]
    v_pk_fma_f32 v[96:97], v[176:177], v[34:35], v[96:97] op_sel:[0,1,0] op_sel_hi:[1,1,1]
    v_pk_fma_f32 v[112:113], v[182:183], v[36:37], v[112:113] op_sel:[0,1,0] op_sel_hi:[1,1,1] neg_lo:[1,0,0] neg_hi:[1,0,0]
    v_pk_fma_f32 v[128:129], v[180:181], v[36:37], v[128:129] op_sel:[0,1,0] op_sel_hi:[1,1,1]
    buffer_load_dwordx4 a[4:7], v1, s[4:7], s46 offen offset:1024 sc1
    v_pk_fma_f32 v[82:83], v[80:81], v[34:35], v[82:83] op_sel:[0,0,0] op_sel_hi:[1,0,1]
    v_pk_fma_f32 v[98:99], v[96:97], v[34:35], v[98:99] op_sel:[0,0,0] op_sel_hi:[1,0,1]
    v_pk_fma_f32 v[114:115], v[112:113], v[36:37], v[114:115] op_sel:[0,0,0] op_sel_hi:[1,0,1]
    v_pk_fma_f32 v[130:131], v[128:129], v[36:37], v[130:131] op_sel:[0,0,0] op_sel_hi:[1,0,1]
    v_pk_fma_f32 v[82:83], v[96:97], v[34:35], v[82:83] op_sel:[0,1,0] op_sel_hi:[1,1,1] neg_lo:[1,0,0] neg_hi:[1,0,0]
    v_pk_fma_f32 v[98:99], v[80:81], v[34:35], v[98:99] op_sel:[0,1,0] op_sel_hi:[1,1,1]
    v_pk_fma_f32 v[114:115], v[128:129], v[36:37], v[114:115] op_sel:[0,1,0] op_sel_hi:[1,1,1] neg_lo:[1,0,0] neg_hi:[1,0,0]
    v_pk_fma_f32 v[130:131], v[112:113], v[36:37], v[130:131] op_sel:[0,1,0] op_sel_hi:[1,1,1]
    buffer_load_dwordx4 a[8:11], v1, s[4:7], s46 offen offset:2048 sc1
    v_pk_fma_f32 v[84:85], v[82:83], v[34:35], v[84:85] op_sel:[0,0,0] op_sel_hi:[1,0,1]
    v_pk_fma_f32 v[100:101], v[98:99], v[34:35], v[100:101] op_sel:[0,0,0] op_sel_hi:[1,0,1]
    v_pk_fma_f32 v[116:117], v[114:115], v[36:37], v[116:117] op_sel:[0,0,0] op_sel_hi:[1,0,1]
    v_pk_fma_f32 v[132:133], v[130:131], v[36:37], v[132:133] op_sel:[0,0,0] op_sel_hi:[1,0,1]
    v_pk_fma_f32 v[84:85], v[98:99], v[34:35], v[84:85] op_sel:[0,1,0] op_sel_hi:[1,1,1] neg_lo:[1,0,0] neg_hi:[1,0,0]
    v_pk_fma_f32 v[100:101], v[82:83], v[34:35], v[100:101] op_sel:[0,1,0] op_sel_hi:[1,1,1]
    v_pk_fma_f32 v[116:117], v[130:131], v[36:37], v[116:117] op_sel:[0,1,0] op_sel_hi:[1,1,1] neg_lo:[1,0,0] neg_hi:[1,0,0]
    v_pk_fma_f32 v[132:133], v[114:115], v[36:37], v[132:133] op_sel:[0,1,0] op_sel_hi:[1,1,1]
    buffer_load_dwordx4 a[12:15], v1, s[4:7], s46 offen offset:3072 sc1
    v_pk_fma_f32 v[86:87], v[84:85], v[34:35], v[86:87] op_sel:[0,0,0] op_sel_hi:[1,0,1]
    v_pk_fma_f32 v[102:103], v[100:101], v[34:35], v[102:103] op_sel:[0,0,0] op_sel_hi:[1,0,1]
    v_pk_fma_f32 v[118:119], v[116:117], v[36:37], v[118:119] op_sel:[0,0,0] op_sel_hi:[1,0,1]
    v_pk_fma_f32 v[134:135], v[132:133], v[36:37], v[134:135] op_sel:[0,0,0] op_sel_hi:[1,0,1]
    v_pk_fma_f32 v[86:87], v[100:101], v[34:35], v[86:87] op_sel:[0,1,0] op_sel_hi:[1,1,1] neg_lo:[1,0,0] neg_hi:[1,0,0]
    v_pk_fma_f32 v[102:103], v[84:85], v[34:35], v[102:103] op_sel:[0,1,0] op_sel_hi:[1,1,1]
    v_pk_fma_f32 v[118:119], v[132:133], v[36:37], v[118:119] op_sel:[0,1,0] op_sel_hi:[1,1,1] neg_lo:[1,0,0] neg_hi:[1,0,0]
    v_pk_fma_f32 v[134:135], v[116:117], v[36:37], v[134:135] op_sel:[0,1,0] op_sel_hi:[1,1,1]
    s_xor_b32 s46, s69, 16384
    buffer_load_dwordx4 a[16:19], v1, s[4:7], s46 offen offset:0 sc1
    v_pk_fma_f32 v[88:89], v[86:87], v[34:35], v[88:89] op_sel:[0,0,0] op_sel_hi:[1,0,1]
    v_pk_fma_f32 v[104:105], v[102:103], v[34:35], v[104:105] op_sel:[0,0,0] op_sel_hi:[1,0,1]
    v_pk_fma_f32 v[120:121], v[118:119], v[36:37], v[120:121] op_sel:[0,0,0] op_sel_hi:[1,0,1]
    v_pk_fma_f32 v[136:137], v[134:135], v[36:37], v[136:137] op_sel:[0,0,0] op_sel_hi:[1,0,1]
    v_pk_fma_f32 v[88:89], v[102:103], v[34:35], v[88:89] op_sel:[0,1,0] op_sel_hi:[1,1,1] neg_lo:[1,0,0] neg_hi:[1,0,0]
    v_pk_fma_f32 v[104:105], v[86:87], v[34:35], v[104:105] op_sel:[0,1,0] op_sel_hi:[1,1,1]
    v_pk_fma_f32 v[120:121], v[134:135], v[36:37], v[120:121] op_sel:[0,1,0] op_sel_hi:[1,1,1] neg_lo:[1,0,0] neg_hi:[1,0,0]
    v_pk_fma_f32 v[136:137], v[118:119], v[36:37], v[136:137] op_sel:[0,1,0] op_sel_hi:[1,1,1]
    buffer_load_dwordx4 a[20:23], v1, s[4:7], s46 offen offset:1024 sc1
    v_pk_fma_f32 v[90:91], v[88:89], v[34:35], v[90:91] op_sel:[0,0,0] op_sel_hi:[1,0,1]
    v_pk_fma_f32 v[106:107], v[104:105], v[34:35], v[106:107] op_sel:[0,0,0] op_sel_hi:[1,0,1]
    v_pk_fma_f32 v[122:123], v[120:121], v[36:37], v[122:123] op_sel:[0,0,0] op_sel_hi:[1,0,1]
    v_pk_fma_f32 v[138:139], v[136:137], v[36:37], v[138:139] op_sel:[0,0,0] op_sel_hi:[1,0,1]
    v_pk_fma_f32 v[90:91], v[104:105], v[34:35], v[90:91] op_sel:[0,1,0] op_sel_hi:[1,1,1] neg_lo:[1,0,0] neg_hi:[1,0,0]
    v_pk_fma_f32 v[106:107], v[88:89], v[34:35], v[106:107] op_sel:[0,1,0] op_sel_hi:[1,1,1]
    v_pk_fma_f32 v[122:123], v[136:137], v[36:37], v[122:123] op_sel:[0,1,0] op_sel_hi:[1,1,1] neg_lo:[1,0,0] neg_hi:[1,0,0]
    v_pk_fma_f32 v[138:139], v[120:121], v[36:37], v[138:139] op_sel:[0,1,0] op_sel_hi:[1,1,1]
    buffer_load_dwordx4 a[24:27], v1, s[4:7], s46 offen offset:2048 sc1
    v_pk_fma_f32 v[92:93], v[90:91], v[34:35], v[92:93] op_sel:[0,0,0] op_sel_hi:[1,0,1]
    v_pk_fma_f32 v[108:109], v[106:107], v[34:35], v[108:109] op_sel:[0,0,0] op_sel_hi:[1,0,1]
    v_pk_fma_f32 v[124:125], v[122:123], v[36:37], v[124:125] op_sel:[0,0,0] op_sel_hi:[1,0,1]
    v_pk_fma_f32 v[140:141], v[138:139], v[36:37], v[140:141] op_sel:[0,0,0] op_sel_hi:[1,0,1]
    v_pk_fma_f32 v[92:93], v[106:107], v[34:35], v[92:93] op_sel:[0,1,0] op_sel_hi:[1,1,1] neg_lo:[1,0,0] neg_hi:[1,0,0]
    v_pk_fma_f32 v[108:109], v[90:91], v[34:35], v[108:109] op_sel:[0,1,0] op_sel_hi:[1,1,1]
    v_pk_fma_f32 v[124:125], v[138:139], v[36:37], v[124:125] op_sel:[0,1,0] op_sel_hi:[1,1,1] neg_lo:[1,0,0] neg_hi:[1,0,0]
    v_pk_fma_f32 v[140:141], v[122:123], v[36:37], v[140:141] op_sel:[0,1,0] op_sel_hi:[1,1,1]
    buffer_load_dwordx4 a[28:31], v1, s[4:7], s46 offen offset:3072 sc1
    v_pk_fma_f32 v[94:95], v[92:93], v[34:35], v[94:95] op_sel:[0,0,0] op_sel_hi:[1,0,1]
    v_pk_fma_f32 v[110:111], v[108:109], v[34:35], v[110:111] op_sel:[0,0,0] op_sel_hi:[1,0,1]
    v_pk_fma_f32 v[126:127], v[124:125], v[36:37], v[126:127] op_sel:[0,0,0] op_sel_hi:[1,0,1]
    v_pk_fma_f32 v[142:143], v[140:141], v[36:37], v[142:143] op_sel:[0,0,0] op_sel_hi:[1,0,1]
    v_pk_fma_f32 v[94:95], v[108:109], v[34:35], v[94:95] op_sel:[0,1,0] op_sel_hi:[1,1,1] neg_lo:[1,0,0] neg_hi:[1,0,0]
    v_pk_fma_f32 v[110:111], v[92:93], v[34:35], v[110:111] op_sel:[0,1,0] op_sel_hi:[1,1,1]
    v_pk_fma_f32 v[126:127], v[140:141], v[36:37], v[126:127] op_sel:[0,1,0] op_sel_hi:[1,1,1] neg_lo:[1,0,0] neg_hi:[1,0,0]
    v_pk_fma_f32 v[142:143], v[124:125], v[36:37], v[142:143] op_sel:[0,1,0] op_sel_hi:[1,1,1]
    s_lshl_b32 s60, s16, 13
    s_add_u32 s60, s60, 131072
    v_lshrrev_b32 v12, 4, v0
    v_lshlrev_b32 v10, 1, v12
    v_xor_b32 v10, v10, v0
    v_and_b32 v10, 7, v10
    v_lshlrev_b32 v10, 4, v10
    v_and_b32 v11, 15, v0
    v_lshl_add_u32 v10, v11, 7, v10
    v_add_u32 v10, s60, v10
    v_xor_b32 v11, 16, v10
    v_bfe_u32 v13, v0, 2, 2
    v_and_b32 v6, 3, v0
    v_lshlrev_b32 v6, 1, v6
    v_xor_b32 v6, v6, v13
    v_lshlrev_b32 v6, 4, v6
    v_lshl_add_u32 v13, v12, 3, v13
    v_lshl_add_u32 v6, v13, 7, v6
    v_add_u32 v6, s60, v6
    v_xor_b32 v7, 64, v6
    v_xor_b32 v8, 16, v6
    v_xor_b32 v9, 16, v7
    v_pk_mul_f32 v[224:225], v[80:81], v[62:63] op_sel:[0,0] op_sel_hi:[1,0]
    v_pk_mul_f32 v[226:227], v[96:97], v[62:63] op_sel:[0,0] op_sel_hi:[1,0] neg_lo:[1,0] neg_hi:[1,0]
    v_pk_mul_f32 v[228:229], v[82:83], v[62:63] op_sel:[0,0] op_sel_hi:[1,0]
    v_pk_mul_f32 v[230:231], v[98:99], v[62:63] op_sel:[0,0] op_sel_hi:[1,0] neg_lo:[1,0] neg_hi:[1,0]
    v_pk_mul_f32 v[232:233], v[84:85], v[62:63] op_sel:[0,0] op_sel_hi:[1,0]
    v_pk_mul_f32 v[234:235], v[100:101], v[62:63] op_sel:[0,0] op_sel_hi:[1,0] neg_lo:[1,0] neg_hi:[1,0]
    v_pk_mul_f32 v[236:237], v[86:87], v[62:63] op_sel:[0,0] op_sel_hi:[1,0]
    v_pk_mul_f32 v[238:239], v[102:103], v[62:63] op_sel:[0,0] op_sel_hi:[1,0] neg_lo:[1,0] neg_hi:[1,0]
    s_xor_b32 s46, s69, 20480
    buffer_load_dwordx4 a[32:35], v1, s[4:7], s46 offen offset:0 sc1
    v_pk_fma_f32 v[224:225], v[96:97], v[62:63], v[224:225] op_sel:[0,1,0] op_sel_hi:[1,1,1] neg_lo:[1,0,0] neg_hi:[1,0,0]
    v_pk_fma_f32 v[226:227], v[80:81], v[62:63], v[226:227] op_sel:[0,1,0] op_sel_hi:[1,1,1] neg_lo:[1,0,0] neg_hi:[1,0,0]
    v_pk_fma_f32 v[228:229], v[98:99], v[62:63], v[228:229] op_sel:[0,1,0] op_sel_hi:[1,1,1] neg_lo:[1,0,0] neg_hi:[1,0,0]
    v_pk_fma_f32 v[230:231], v[82:83], v[62:63], v[230:231] op_sel:[0,1,0] op_sel_hi:[1,1,1] neg_lo:[1,0,0] neg_hi:[1,0,0]
    v_pk_fma_f32 v[232:233], v[100:101], v[62:63], v[232:233] op_sel:[0,1,0] op_sel_hi:[1,1,1] neg_lo:[1,0,0] neg_hi:[1,0,0]
    v_pk_fma_f32 v[234:235], v[84:85], v[62:63], v[234:235] op_sel:[0,1,0] op_sel_hi:[1,1,1] neg_lo:[1,0,0] neg_hi:[1,0,0]
    v_pk_fma_f32 v[236:237], v[102:103], v[62:63], v[236:237] op_sel:[0,1,0] op_sel_hi:[1,1,1] neg_lo:[1,0,0] neg_hi:[1,0,0]
    v_pk_fma_f32 v[238:239], v[86:87], v[62:63], v[238:239] op_sel:[0,1,0] op_sel_hi:[1,1,1] neg_lo:[1,0,0] neg_hi:[1,0,0]
    buffer_load_dwordx4 a[36:39], v1, s[4:7], s46 offen offset:1024 sc1
    v_cvt_pk_bf16_f32 v192, v224, v225
    v_cvt_pk_bf16_f32 v196, v226, v227
    v_cvt_pk_bf16_f32 v193, v228, v229
    v_cvt_pk_bf16_f32 v197, v230, v231
    v_cvt_pk_bf16_f32 v194, v232, v233
    v_cvt_pk_bf16_f32 v198, v234, v235
    v_cvt_pk_bf16_f32 v195, v236, v237
    v_cvt_pk_bf16_f32 v199, v238, v239
    buffer_load_dwordx4 a[40:43], v1, s[4:7], s46 offen offset:2048 sc1
    ds_write_b128 v10, v[192:195] offset:0
    ds_write_b128 v10, v[196:199] offset:4096
    v_pk_mul_f32 v[224:225], v[88:89], v[62:63] op_sel:[0,0] op_sel_hi:[1,0]
    v_pk_mul_f32 v[226:227], v[104:105], v[62:63] op_sel:[0,0] op_sel_hi:[1,0] neg_lo:[1,0] neg_hi:[1,0]
    v_pk_mul_f32 v[228:229], v[90:91], v[62:63] op_sel:[0,0] op_sel_hi:[1,0]
    v_pk_mul_f32 v[230:231], v[106:107], v[62:63] op_sel:[0,0] op_sel_hi:[1,0] neg_lo:[1,0] neg_hi:[1,0]
    v_pk_mul_f32 v[232:233], v[92:93], v[62:63] op_sel:[0,0] op_sel_hi:[1,0]
    v_pk_mul_f32 v[234:235], v[108:109], v[62:63] op_sel:[0,0] op_sel_hi:[1,0] neg_lo:[1,0] neg_hi:[1,0]
    v_pk_mul_f32 v[236:237], v[94:95], v[62:63] op_sel:[0,0] op_sel_hi:[1,0]
    v_pk_mul_f32 v[238:239], v[110:111], v[62:63] op_sel:[0,0] op_sel_hi:[1,0] neg_lo:[1,0] neg_hi:[1,0]
    buffer_load_dwordx4 a[44:47], v1, s[4:7], s46 offen offset:3072 sc1
    v_pk_fma_f32 v[224:225], v[104:105], v[62:63], v[224:225] op_sel:[0,1,0] op_sel_hi:[1,1,1] neg_lo:[1,0,0] neg_hi:[1,0,0]
    v_pk_fma_f32 v[226:227], v[88:89], v[62:63], v[226:227] op_sel:[0,1,0] op_sel_hi:[1,1,1] neg_lo:[1,0,0] neg_hi:[1,0,0]
    v_pk_fma_f32 v[228:229], v[106:107], v[62:63], v[228:229] op_sel:[0,1,0] op_sel_hi:[1,1,1] neg_lo:[1,0,0] neg_hi:[1,0,0]
    v_pk_fma_f32 v[230:231], v[90:91], v[62:63], v[230:231] op_sel:[0,1,0] op_sel_hi:[1,1,1] neg_lo:[1,0,0] neg_hi:[1,0,0]
    v_pk_fma_f32 v[232:233], v[108:109], v[62:63], v[232:233] op_sel:[0,1,0] op_sel_hi:[1,1,1] neg_lo:[1,0,0] neg_hi:[1,0,0]
    v_pk_fma_f32 v[234:235], v[92:93], v[62:63], v[234:235] op_sel:[0,1,0] op_sel_hi:[1,1,1] neg_lo:[1,0,0] neg_hi:[1,0,0]
    v_pk_fma_f32 v[236:237], v[110:111], v[62:63], v[236:237] op_sel:[0,1,0] op_sel_hi:[1,1,1] neg_lo:[1,0,0] neg_hi:[1,0,0]
    v_pk_fma_f32 v[238:239], v[94:95], v[62:63], v[238:239] op_sel:[0,1,0] op_sel_hi:[1,1,1] neg_lo:[1,0,0] neg_hi:[1,0,0]
    s_xor_b32 s46, s69, 32768
    buffer_load_dwordx4 a[48:51], v1, s[4:7], s46 offen offset:0 sc1
    v_cvt_pk_bf16_f32 v200, v224, v225
    v_cvt_pk_bf16_f32 v204, v226, v227
    v_cvt_pk_bf16_f32 v201, v228, v229
    v_cvt_pk_bf16_f32 v205, v230, v231
    v_cvt_pk_bf16_f32 v202, v232, v233
    v_cvt_pk_bf16_f32 v206, v234, v235
    v_cvt_pk_bf16_f32 v203, v236, v237
    v_cvt_pk_bf16_f32 v207, v238, v239
    buffer_load_dwordx4 a[52:55], v1, s[4:7], s46 offen offset:1024 sc1
    ds_write_b128 v11, v[200:203] offset:0
    ds_write_b128 v11, v[204:207] offset:4096
    v_pk_mul_f32 v[224:225], v[112:113], v[64:65] op_sel:[0,0] op_sel_hi:[1,0]
    v_pk_mul_f32 v[226:227], v[128:129], v[64:65] op_sel:[0,0] op_sel_hi:[1,0] neg_lo:[1,0] neg_hi:[1,0]
    v_pk_mul_f32 v[228:229], v[114:115], v[64:65] op_sel:[0,0] op_sel_hi:[1,0]
    v_pk_mul_f32 v[230:231], v[130:131], v[64:65] op_sel:[0,0] op_sel_hi:[1,0] neg_lo:[1,0] neg_hi:[1,0]
    v_pk_mul_f32 v[232:233], v[116:117], v[64:65] op_sel:[0,0] op_sel_hi:[1,0]
    v_pk_mul_f32 v[234:235], v[132:133], v[64:65] op_sel:[0,0] op_sel_hi:[1,0] neg_lo:[1,0] neg_hi:[1,0]
    v_pk_mul_f32 v[236:237], v[118:119], v[64:65] op_sel:[0,0] op_sel_hi:[1,0]
    v_pk_mul_f32 v[238:239], v[134:135], v[64:65] op_sel:[0,0] op_sel_hi:[1,0] neg_lo:[1,0] neg_hi:[1,0]
    buffer_load_dwordx4 a[56:59], v1, s[4:7], s46 offen offset:2048 sc1
    v_pk_fma_f32 v[224:225], v[128:129], v[64:65], v[224:225] op_sel:[0,1,0] op_sel_hi:[1,1,1] neg_lo:[1,0,0] neg_hi:[1,0,0]
    v_pk_fma_f32 v[226:227], v[112:113], v[64:65], v[226:227] op_sel:[0,1,0] op_sel_hi:[1,1,1] neg_lo:[1,0,0] neg_hi:[1,0,0]
    v_pk_fma_f32 v[228:229], v[130:131], v[64:65], v[228:229] op_sel:[0,1,0] op_sel_hi:[1,1,1] neg_lo:[1,0,0] neg_hi:[1,0,0]
    v_pk_fma_f32 v[230:231], v[114:115], v[64:65], v[230:231] op_sel:[0,1,0] op_sel_hi:[1,1,1] neg_lo:[1,0,0] neg_hi:[1,0,0]
    v_pk_fma_f32 v[232:233], v[132:133], v[64:65], v[232:233] op_sel:[0,1,0] op_sel_hi:[1,1,1] neg_lo:[1,0,0] neg_hi:[1,0,0]
    v_pk_fma_f32 v[234:235], v[116:117], v[64:65], v[234:235] op_sel:[0,1,0] op_sel_hi:[1,1,1] neg_lo:[1,0,0] neg_hi:[1,0,0]
    v_pk_fma_f32 v[236:237], v[134:135], v[64:65], v[236:237] op_sel:[0,1,0] op_sel_hi:[1,1,1] neg_lo:[1,0,0] neg_hi:[1,0,0]
    v_pk_fma_f32 v[238:239], v[118:119], v[64:65], v[238:239] op_sel:[0,1,0] op_sel_hi:[1,1,1] neg_lo:[1,0,0] neg_hi:[1,0,0]
    buffer_load_dwordx4 a[60:63], v1, s[4:7], s46 offen offset:3072 sc1
    v_cvt_pk_bf16_f32 v208, v224, v225
    v_cvt_pk_bf16_f32 v212, v226, v227
    v_cvt_pk_bf16_f32 v209, v228, v229
    v_cvt_pk_bf16_f32 v213, v230, v231
    v_cvt_pk_bf16_f32 v210, v232, v233
    v_cvt_pk_bf16_f32 v214, v234, v235
    v_cvt_pk_bf16_f32 v211, v236, v237
    v_cvt_pk_bf16_f32 v215, v238, v239
    s_xor_b32 s46, s69, 36864
    buffer_load_dwordx4 a[64:67], v1, s[4:7], s46 offen offset:0 sc1
    ds_write_b128 v10, v[208:211] offset:2048
    ds_write_b128 v10, v[212:215] offset:6144
    v_pk_mul_f32 v[224:225], v[120:121], v[64:65] op_sel:[0,0] op_sel_hi:[1,0]
    v_pk_mul_f32 v[226:227], v[136:137], v[64:65] op_sel:[0,0] op_sel_hi:[1,0] neg_lo:[1,0] neg_hi:[1,0]
    v_pk_mul_f32 v[228:229], v[122:123], v[64:65] op_sel:[0,0] op_sel_hi:[1,0]
    v_pk_mul_f32 v[230:231], v[138:139], v[64:65] op_sel:[0,0] op_sel_hi:[1,0] neg_lo:[1,0] neg_hi:[1,0]
    v_pk_mul_f32 v[232:233], v[124:125], v[64:65] op_sel:[0,0] op_sel_hi:[1,0]
    v_pk_mul_f32 v[234:235], v[140:141], v[64:65] op_sel:[0,0] op_sel_hi:[1,0] neg_lo:[1,0] neg_hi:[1,0]
    v_pk_mul_f32 v[236:237], v[126:127], v[64:65] op_sel:[0,0] op_sel_hi:[1,0]
    v_pk_mul_f32 v[238:239], v[142:143], v[64:65] op_sel:[0,0] op_sel_hi:[1,0] neg_lo:[1,0] neg_hi:[1,0]
    buffer_load_dwordx4 a[68:71], v1, s[4:7], s46 offen offset:1024 sc1
    v_pk_fma_f32 v[224:225], v[136:137], v[64:65], v[224:225] op_sel:[0,1,0] op_sel_hi:[1,1,1] neg_lo:[1,0,0] neg_hi:[1,0,0]
    v_pk_fma_f32 v[226:227], v[120:121], v[64:65], v[226:227] op_sel:[0,1,0] op_sel_hi:[1,1,1] neg_lo:[1,0,0] neg_hi:[1,0,0]
    v_pk_fma_f32 v[228:229], v[138:139], v[64:65], v[228:229] op_sel:[0,1,0] op_sel_hi:[1,1,1] neg_lo:[1,0,0] neg_hi:[1,0,0]
    v_pk_fma_f32 v[230:231], v[122:123], v[64:65], v[230:231] op_sel:[0,1,0] op_sel_hi:[1,1,1] neg_lo:[1,0,0] neg_hi:[1,0,0]
    v_pk_fma_f32 v[232:233], v[140:141], v[64:65], v[232:233] op_sel:[0,1,0] op_sel_hi:[1,1,1] neg_lo:[1,0,0] neg_hi:[1,0,0]
    v_pk_fma_f32 v[234:235], v[124:125], v[64:65], v[234:235] op_sel:[0,1,0] op_sel_hi:[1,1,1] neg_lo:[1,0,0] neg_hi:[1,0,0]
    v_pk_fma_f32 v[236:237], v[142:143], v[64:65], v[236:237] op_sel:[0,1,0] op_sel_hi:[1,1,1] neg_lo:[1,0,0] neg_hi:[1,0,0]
    v_pk_fma_f32 v[238:239], v[126:127], v[64:65], v[238:239] op_sel:[0,1,0] op_sel_hi:[1,1,1] neg_lo:[1,0,0] neg_hi:[1,0,0]
    buffer_load_dwordx4 a[72:75], v1, s[4:7], s46 offen offset:2048 sc1
    v_cvt_pk_bf16_f32 v216, v224, v225
    v_cvt_pk_bf16_f32 v220, v226, v227
    v_cvt_pk_bf16_f32 v217, v228, v229
    v_cvt_pk_bf16_f32 v221, v230, v231
    v_cvt_pk_bf16_f32 v218, v232, v233
    v_cvt_pk_bf16_f32 v222, v234, v235
    v_cvt_pk_bf16_f32 v219, v236, v237
    v_cvt_pk_bf16_f32 v223, v238, v239
    buffer_load_dwordx4 a[76:79], v1, s[4:7], s46 offen offset:3072 sc1
    ds_write_b128 v11, v[216:219] offset:2048
    ds_write_b128 v11, v[220:223] offset:6144
    v_mov_b32 v74, 3
    s_mov_b64 vcc, s[76:77]
    v_add_u32 v74, s79, v74
    s_waitcnt vmcnt(20)
    s_cbranch_vccnz FAR_3
NEAR_3:
    buffer_store_dword v74, v78, s[4:7], s73 offen
    buffer_load_dword v17, v16, s[4:7], s73 offen sc1
    v_lshrrev_b32 v66, 2, v0
    v_and_b32 v67, 7, v66
    v_lshlrev_b32 v66, 8, v66
    v_and_b32 v68, 3, v0
    v_lshl_add_u32 v66, v68, 3, v66
    v_xor_b32 v68, 0, v67
    v_lshl_add_u32 v18, v68, 5, v66
    v_xor_b32 v68, 1, v67
    v_lshl_add_u32 v19, v68, 5, v66
    v_xor_b32 v68, 2, v67
    v_lshl_add_u32 v20, v68, 5, v66
    v_xor_b32 v68, 3, v67
    v_lshl_add_u32 v21, v68, 5, v66
    v_xor_b32 v68, 4, v67
    v_lshl_add_u32 v22, v68, 5, v66
    v_xor_b32 v68, 5, v67
    v_lshl_add_u32 v23, v68, 5, v66
    v_xor_b32 v68, 6, v67
    v_lshl_add_u32 v24, v68, 5, v66
    v_xor_b32 v68, 7, v67
    v_lshl_add_u32 v25, v68, 5, v66
    s_xor_b32 s46, s69, 49152
    buffer_load_dwordx4 a[80:83], v1, s[4:7], s46 offen offset:0 sc1
    buffer_load_dwordx4 a[84:87], v1, s[4:7], s46 offen offset:1024 sc1
    buffer_load_dwordx4 a[88:91], v1, s[4:7], s46 offen offset:2048 sc1
    buffer_load_dwordx4 a[92:95], v1, s[4:7], s46 offen offset:3072 sc1
    s_barrier
    ds_read_b64_tr_b16 a[232:233], v18 offset:0
    ds_read_b64_tr_b16 a[234:235], v18 offset:4096
    ds_read_b64_tr_b16 a[236:237], v18 offset:8192
    ds_read_b64_tr_b16 a[238:239], v18 offset:12288
    ds_read_b64_tr_b16 a[240:241], v19 offset:0
    ds_read_b64_tr_b16 a[242:243], v19 offset:4096
    ds_read_b64_tr_b16 a[244:245], v19 offset:8192
    ds_read_b64_tr_b16 a[246:247], v19 offset:12288
    s_waitcnt vmcnt(22) lgkmcnt(4)
    v_mfma_f32_16x16x32_bf16 v[128:131], a[232:235], a[112:115], 0
    ds_read_b64_tr_b16 a[248:249], v20 offset:0
    ds_read_b64_tr_b16 a[250:251], v20 offset:4096
    v_mfma_f32_16x16x32_bf16 v[128:131], a[236:239], a[0:3], v[128:131]
    ds_read_b64_tr_b16 a[160:161], v6 offset:0
    ds_read_b64_tr_b16 a[162:163], v7 offset:512
    v_mfma_f32_16x16x32_bf16 v[132:135], a[236:239], a[4:7], 0
    ds_read_b64_tr_b16 a[164:165], v6 offset:8
    ds_read_b64_tr_b16 a[166:167], v7 offset:520
    v_mfma_f32_16x16x32_bf16 v[132:135], a[232:235], a[116:119], v[132:135]
    ds_read_b64_tr_b16 a[168:169], v8 offset:0
    ds_read_b64_tr_b16 a[170:171], v9 offset:512
    v_mfma_f32_16x16x32_bf16 v[136:139], a[232:235], a[120:123], 0
    ds_read_b64_tr_b16 a[252:253], v20 offset:8192
    ds_read_b64_tr_b16 a[254:255], v20 offset:12288
    v_mfma_f32_16x16x32_bf16 v[136:139], a[236:239], a[8:11], v[136:139]
    ds_read_b64_tr_b16 a[172:173], v8 offset:8
    ds_read_b64_tr_b16 a[174:175], v9 offset:520
    v_mfma_f32_16x16x32_bf16 v[140:143], a[236:239], a[12:15], 0
    ds_read_b64_tr_b16 a[96:97], v6 offset:4096
    ds_read_b64_tr_b16 a[98:99], v7 offset:4608
    v_mfma_f32_16x16x32_bf16 v[140:143], a[232:235], a[124:127], v[140:143]
    s_waitcnt lgkmcnt(14)
    ds_read_b64_tr_b16 a[100:101], v6 offset:4104
    ds_read_b64_tr_b16 a[102:103], v7 offset:4616
    v_mfma_f32_16x16x32_bf16 v[156:159], a[240:243], a[124:127], 0
    ds_read_b64_tr_b16 a[232:233], v21 offset:0
    ds_read_b64_tr_b16 a[234:235], v21 offset:4096
    v_mfma_f32_16x16x32_bf16 v[156:159], a[244:247], a[12:15], v[156:159]
    ds_read_b64_tr_b16 a[104:105], v8 offset:4096
    ds_read_b64_tr_b16 a[106:107], v9 offset:4608
    v_mfma_f32_16x16x32_bf16 v[152:155], a[244:247], a[8:11], 0
    ds_read_b64_tr_b16 a[108:109], v8 offset:4104
    ds_read_b64_tr_b16 a[110:111], v9 offset:4616
H_READ:
    v_mfma_f32_16x16x32_bf16 v[152:155], a[240:243], a[120:123], v[152:155]
    v_accvgpr_read_b32 v112, a176
    v_accvgpr_read_b32 v52, a192
    v_mfma_f32_16x16x32_bf16 v[148:151], a[240:243], a[116:119], 0
    ds_read_b64_tr_b16 a[236:237], v21 offset:8192
    ds_read_b64_tr_b16 a[238:239], v21 offset:12288
    v_mfma_f32_16x16x32_bf16 v[148:151], a[244:247], a[4:7], v[148:151]
    v_accvgpr_read_b32 v113, a177
    v_accvgpr_read_b32 v53, a193
    v_mfma_f32_16x16x32_bf16 v[144:147], a[244:247], a[0:3], 0
    v_accvgpr_read_b32 v114, a178
    v_accvgpr_read_b32 v54, a194
    v_mfma_f32_16x16x32_bf16 v[144:147], a[240:243], a[112:115], v[144:147]
    s_waitcnt lgkmcnt(14)
    v_accvgpr_read_b32 v115, a179
    v_accvgpr_read_b32 v55, a195
    v_mfma_f32_16x16x32_bf16 v[160:163], a[248:251], a[112:115], 0
    ds_read_b64_tr_b16 a[240:241], v22 offset:0
    ds_read_b64_tr_b16 a[242:243], v22 offset:4096
    v_mfma_f32_16x16x32_bf16 v[160:163], a[252:255], a[0:3], v[160:163]
    v_accvgpr_read_b32 v116, a180
    v_accvgpr_read_b32 v56, a196
    v_mfma_f32_16x16x32_bf16 v[164:167], a[252:255], a[4:7], 0
    v_accvgpr_read_b32 v117, a181
    v_accvgpr_read_b32 v57, a197
    v_mfma_f32_16x16x32_bf16 v[164:167], a[248:251], a[116:119], v[164:167]
    v_accvgpr_read_b32 v118, a182
    v_accvgpr_read_b32 v58, a198
    v_mfma_f32_16x16x32_bf16 v[168:171], a[248:251], a[120:123], 0
    ds_read_b64_tr_b16 a[244:245], v22 offset:8192
    ds_read_b64_tr_b16 a[246:247], v22 offset:12288
    v_mfma_f32_16x16x32_bf16 v[168:171], a[252:255], a[8:11], v[168:171]
    v_accvgpr_read_b32 v119, a183
    v_accvgpr_read_b32 v59, a199
    v_mfma_f32_16x16x32_bf16 v[172:175], a[252:255], a[12:15], 0
    v_accvgpr_read_b32 v120, a184
    v_accvgpr_read_b32 v60, a200
    v_mfma_f32_16x16x32_bf16 v[172:175], a[248:251], a[124:127], v[172:175]
    s_waitcnt lgkmcnt(4)
    v_accvgpr_read_b32 v121, a185
    v_accvgpr_read_b32 v61, a201
    v_mfma_f32_16x16x32_bf16 v[188:191], a[232:235], a[124:127], 0
    ds_read_b64_tr_b16 a[248:249], v23 offset:0
    ds_read_b64_tr_b16 a[250:251], v23 offset:4096
    v_mfma_f32_16x16x32_bf16 v[188:191], a[236:239], a[12:15], v[188:191]
    buffer_store_dwordx4 a[160:163], v1, s[4:7], s71 offen offset:0 sc1
    v_mfma_f32_16x16x32_bf16 v[184:187], a[236:239], a[8:11], 0
    v_accvgpr_read_b32 v122, a186
    v_accvgpr_read_b32 v62, a202
    v_mfma_f32_16x16x32_bf16 v[184:187], a[232:235], a[120:123], v[184:187]
    v_accvgpr_read_b32 v123, a187
    v_accvgpr_read_b32 v63, a203
    v_mfma_f32_16x16x32_bf16 v[180:183], a[232:235], a[116:119], 0
    ds_read_b64_tr_b16 a[252:253], v23 offset:8192
    ds_read_b64_tr_b16 a[254:255], v23 offset:12288
    v_mfma_f32_16x16x32_bf16 v[180:183], a[236:239], a[4:7], v[180:183]
    v_accvgpr_read_b32 v124, a188
    v_accvgpr_read_b32 v64, a204
    v_mfma_f32_16x16x32_bf16 v[176:179], a[236:239], a[0:3], 0
    v_accvgpr_read_b32 v125, a189
    v_accvgpr_read_b32 v65, a205
    v_mfma_f32_16x16x32_bf16 v[176:179], a[232:235], a[112:115], v[176:179]
    s_waitcnt lgkmcnt(4)
    v_accvgpr_read_b32 v126, a190
    v_accvgpr_read_b32 v66, a206
    v_mfma_f32_16x16x32_bf16 v[192:195], a[240:243], a[112:115], 0
    ds_read_b64_tr_b16 a[232:233], v24 offset:0
    ds_read_b64_tr_b16 a[234:235], v24 offset:4096
    v_mfma_f32_16x16x32_bf16 v[192:195], a[244:247], a[0:3], v[192:195]
    v_accvgpr_read_b32 v127, a191
    v_accvgpr_read_b32 v67, a207
    v_mfma_f32_16x16x32_bf16 v[196:199], a[244:247], a[4:7], 0
    v_accvgpr_read_b32 v6, a208
    v_accvgpr_read_b32 v7, a209
    v_mfma_f32_16x16x32_bf16 v[196:199], a[240:243], a[116:119], v[196:199]
    v_accvgpr_read_b32 v8, a210
    v_accvgpr_read_b32 v9, a211
PARK_FREE:
    v_mfma_f32_16x16x32_bf16 v[200:203], a[240:243], a[120:123], 0
    ds_read_b64_tr_b16 a[236:237], v24 offset:8192
    ds_read_b64_tr_b16 a[238:239], v24 offset:12288
    v_mfma_f32_16x16x32_bf16 v[200:203], a[244:247], a[8:11], v[200:203]
    v_add_u32 v26, 65536, v18
    v_add_u32 v27, 65536, v19
    v_mfma_f32_16x16x32_bf16 v[204:207], a[244:247], a[12:15], 0
    v_add_u32 v28, 65536, v20
    v_add_u32 v29, 65536, v21
    v_mfma_f32_16x16x32_bf16 v[204:207], a[240:243], a[124:127], v[204:207]
    s_waitcnt lgkmcnt(4)
    v_add_u32 v30, 65536, v22
    v_add_u32 v31, 65536, v23
    v_mfma_f32_16x16x32_bf16 v[220:223], a[248:251], a[124:127], 0
    ds_read_b64_tr_b16 a[240:241], v25 offset:0
    ds_read_b64_tr_b16 a[242:243], v25 offset:4096
    v_mfma_f32_16x16x32_bf16 v[220:223], a[252:255], a[12:15], v[220:223]
    v_add_u32 v32, 65536, v24
    v_add_u32 v33, 65536, v25
    v_mfma_f32_16x16x32_bf16 v[216:219], a[252:255], a[8:11], 0
    s_and_b32 s60, s50, 3
    v_lshrrev_b32 v68, 4, v0
    s_lshl_b32 s60, s60, 2
    v_mfma_f32_16x16x32_bf16 v[216:219], a[248:251], a[120:123], v[216:219]
    v_and_b32 v69, 15, v0
    v_xor_b32 v72, s60, v69
    v_mfma_f32_16x16x32_bf16 v[212:215], a[248:251], a[116:119], 0
    ds_read_b64_tr_b16 a[244:245], v25 offset:8192
    ds_read_b64_tr_b16 a[246:247], v25 offset:12288
    v_mfma_f32_16x16x32_bf16 v[212:215], a[252:255], a[4:7], v[212:215]
    v_add_u32 v70, 0, v68
    v_lshlrev_b32 v71, 11, v70
    v_mfma_f32_16x16x32_bf16 v[208:211], a[252:255], a[0:3], 0
    v_subrev_u32 v71, 0, v71
    v_xor_b32 v70, v70, v72
    v_mfma_f32_16x16x32_bf16 v[208:211], a[248:251], a[112:115], v[208:211]
    s_waitcnt lgkmcnt(4)
    v_lshl_add_u32 v34, v70, 4, v71
    v_add_u32 v70, 4, v68
    v_mfma_f32_16x16x32_bf16 v[224:227], a[232:235], a[112:115], 0
    ds_read_b64_tr_b16 a[248:249], v18 offset:16384
    ds_read_b64_tr_b16 a[250:251], v18 offset:20480
    v_mfma_f32_16x16x32_bf16 v[224:227], a[236:239], a[0:3], v[224:227]
    v_lshlrev_b32 v71, 11, v70
    v_subrev_u32 v71, 1024, v71
    v_mfma_f32_16x16x32_bf16 v[228:231], a[236:239], a[4:7], 0
    v_xor_b32 v70, v70, v72
    v_lshl_add_u32 v35, v70, 4, v71
    v_mfma_f32_16x16x32_bf16 v[228:231], a[232:235], a[116:119], v[228:231]
    v_add_u32 v70, 8, v68
    v_lshlrev_b32 v71, 11, v70
    v_mfma_f32_16x16x32_bf16 v[232:235], a[232:235], a[120:123], 0
    ds_read_b64_tr_b16 a[252:253], v18 offset:24576
    ds_read_b64_tr_b16 a[254:255], v18 offset:28672
    v_mfma_f32_16x16x32_bf16 v[232:235], a[236:239], a[8:11], v[232:235]
    v_subrev_u32 v71, 2048, v71
    v_xor_b32 v70, v70, v72
    v_mfma_f32_16x16x32_bf16 v[236:239], a[236:239], a[12:15], 0
    v_lshl_add_u32 v36, v70, 4, v71
    v_add_u32 v70, 12, v68
    v_mfma_f32_16x16x32_bf16 v[236:239], a[232:235], a[124:127], v[236:239]
    s_waitcnt lgkmcnt(4)
    v_lshlrev_b32 v71, 11, v70
    v_subrev_u32 v71, 3072, v71
    v_mfma_f32_16x16x32_bf16 v[252:255], a[240:243], a[124:127], 0
    ds_read_b64_tr_b16 a[232:233], v19 offset:16384
    ds_read_b64_tr_b16 a[234:235], v19 offset:20480
    v_mfma_f32_16x16x32_bf16 v[252:255], a[244:247], a[12:15], v[252:255]
    buffer_store_dwordx4 a[164:167], v1, s[4:7], s71 offen offset:1024 sc1
    v_mfma_f32_16x16x32_bf16 v[248:251], a[244:247], a[8:11], 0
    v_xor_b32 v70, v70, v72
    v_lshl_add_u32 v37, v70, 4, v71
    v_mfma_f32_16x16x32_bf16 v[248:251], a[240:243], a[120:123], v[248:251]
    v_xor_b32 v70, v68, v69
    v_lshlrev_b32 v71, 8, v69
    v_mfma_f32_16x16x32_bf16 v[244:247], a[240:243], a[116:119], 0
    ds_read_b64_tr_b16 a[236:237], v19 offset:24576
    ds_read_b64_tr_b16 a[238:239], v19 offset:28672
    v_mfma_f32_16x16x32_bf16 v[244:247], a[244:247], a[4:7], v[244:247]
    v_xor_b32 v72, 0, v70
    v_lshl_add_u32 v38, v72, 4, v71
    v_mfma_f32_16x16x32_bf16 v[240:243], a[244:247], a[0:3], 0
    v_add_u32 v42, 98304, v38
    v_xor_b32 v72, 4, v70
    v_mfma_f32_16x16x32_bf16 v[240:243], a[240:243], a[112:115], v[240:243]
    s_waitcnt vmcnt(16) lgkmcnt(4)
    v_lshl_add_u32 v39, v72, 4, v71
    v_add_u32 v43, 98304, v39
    v_mfma_f32_16x16x32_bf16 v[128:131], a[248:251], a[16:19], v[128:131]
    s_waitcnt vmcnt(6)
    ds_read_b64_tr_b16 a[240:241], v20 offset:16384
    ds_read_b64_tr_b16 a[242:243], v20 offset:20480
    v_mfma_f32_16x16x32_bf16 v[128:131], a[252:255], a[32:35], v[128:131]
    s_xor_b32 s46, s69, 53248
    v_subrev_u32 v17, s79, v17
    v_subrev_u32 v17, 2, v17
    v_mfma_f32_16x16x32_bf16 v[132:135], a[252:255], a[36:39], v[132:135]
    s_lshr_b32 s63, s2, 3
    buffer_load_dwordx4 a[0:3], v1, s[4:7], s46 offen offset:0 sc1
    v_mfma_f32_16x16x32_bf16 v[132:135], a[248:251], a[20:23], v[132:135]
    v_cmp_lt_u32 vcc, 5, v17
    s_cbranch_vccnz SLOW_FA2
BACK_FA2:
    v_mfma_f32_16x16x32_bf16 v[136:139], a[248:251], a[24:27], v[136:139]
    ds_read_b64_tr_b16 a[244:245], v20 offset:24576
    ds_read_b64_tr_b16 a[246:247], v20 offset:28672
    v_mfma_f32_16x16x32_bf16 v[136:139], a[252:255], a[40:43], v[136:139]
    v_lshlrev_b32 v47, 14, v0
    s_lshl2_add_u32 s63, s63, s16
    v_mfma_f32_16x16x32_bf16 v[140:143], a[252:255], a[44:47], v[140:143]
    s_lshl_b32 s63, s63, 7
    s_add_u32 s63, s63, H_READ-K_PC
    v_add_u32 v47, s63, v47
    v_mfma_f32_16x16x32_bf16 v[140:143], a[248:251], a[28:31], v[140:143]
    s_waitcnt lgkmcnt(4)
    v_min_u32 v47, CODE_END-K_PC-4, v47
    v_xor_b32 v72, 8, v70
    v_mfma_f32_16x16x32_bf16 v[156:159], a[232:235], a[28:31], v[156:159]
    ds_read_b64_tr_b16 a[248:249], v21 offset:16384
    ds_read_b64_tr_b16 a[250:251], v21 offset:20480
    v_mfma_f32_16x16x32_bf16 v[156:159], a[236:239], a[44:47], v[156:159]
    v_lshl_add_u32 v40, v72, 4, v71
    v_add_u32 v44, 98304, v40
    v_mfma_f32_16x16x32_bf16 v[152:155], a[236:239], a[40:43], v[152:155]
    buffer_load_dwordx4 a[4:7], v1, s[4:7], s46 offen offset:1024 sc1
    v_mfma_f32_16x16x32_bf16 v[152:155], a[232:235], a[24:27], v[152:155]
    v_xor_b32 v72, 12, v70
    v_lshl_add_u32 v41, v72, 4, v71
    v_mfma_f32_16x16x32_bf16 v[148:151], a[232:235], a[20:23], v[148:151]
    ds_read_b64_tr_b16 a[252:253], v21 offset:24576
    ds_read_b64_tr_b16 a[254:255], v21 offset:28672
    v_mfma_f32_16x16x32_bf16 v[148:151], a[236:239], a[36:39], v[148:151]
    v_add_u32 v45, 98304, v41
    v_lshrrev_b32 v70, 2, v69
    v_mfma_f32_16x16x32_bf16 v[144:147], a[236:239], a[32:35], v[144:147]
    buffer_load_dwordx4 a[8:11], v1, s[4:7], s46 offen offset:2048 sc1
    v_mfma_f32_16x16x32_bf16 v[144:147], a[232:235], a[16:19], v[144:147]
    s_waitcnt lgkmcnt(4)
    v_lshlrev_b32 v70, 4, v70
    v_and_b32 v71, 1, v69
    v_mfma_f32_16x16x32_bf16 v[160:163], a[240:243], a[16:19], v[160:163]
    ds_read_b64_tr_b16 a[232:233], v22 offset:16384
    ds_read_b64_tr_b16 a[234:235], v22 offset:20480
    v_mfma_f32_16x16x32_bf16 v[160:163], a[244:247], a[32:35], v[160:163]
    v_lshl_add_u32 v70, v71, 3, v70
    v_bfe_u32 v71, v69, 1, 1
    v_mfma_f32_16x16x32_bf16 v[164:167], a[244:247], a[36:39], v[164:167]
    buffer_load_dwordx4 a[12:15], v1, s[4:7], s46 offen offset:3072 sc1
    v_mfma_f32_16x16x32_bf16 v[164:167], a[240:243], a[20:23], v[164:167]
    v_add_u32 v70, v70, v71
    v_lshlrev_b32 v70, 11, v70
    v_mfma_f32_16x16x32_bf16 v[168:171], a[240:243], a[24:27], v[168:171]
    ds_read_b64_tr_b16 a[236:237], v22 offset:24576
    ds_read_b64_tr_b16 a[238:239], v22 offset:28672
    v_mfma_f32_16x16x32_bf16 v[168:171], a[244:247], a[40:43], v[168:171]
    s_xor_b32 s46, s69, 69632
    v_lshl_add_u32 v46, v68, 3, v70
    v_lshlrev_b32 v46, 1, v46
    v_mfma_f32_16x16x32_bf16 v[172:175], a[244:247], a[44:47], v[172:175]
    buffer_load_dwordx4 a[112:115], v1, s[4:7], s46 offen offset:0 sc1
    v_mfma_f32_16x16x32_bf16 v[172:175], a[240:243], a[28:31], v[172:175]
    s_waitcnt lgkmcnt(4)
    v_mov_b32 v51, 0
    s_lshl_b32 s61, s19, 17
    v_mfma_f32_16x16x32_bf16 v[188:191], a[248:251], a[28:31], v[188:191]
    s_add_u32 s61, s61, s51
    ds_read_b64_tr_b16 a[240:241], v23 offset:16384
    ds_read_b64_tr_b16 a[242:243], v23 offset:20480
    v_mfma_f32_16x16x32_bf16 v[188:191], a[252:255], a[44:47], v[188:191]
    s_lshl_b32 s47, s61, 1
    buffer_store_dwordx4 a[168:171], v1, s[4:7], s71 offen offset:2048 sc1
    v_mfma_f32_16x16x32_bf16 v[184:187], a[252:255], a[40:43], v[184:187]
    s_mov_b32 s54, 0xffff0000
    s_xor_b32 s57, s0, 327680
    s_xor_b32 s58, s0, 393216
    v_mfma_f32_16x16x32_bf16 v[184:187], a[248:251], a[24:27], v[184:187]
    s_xor_b32 s59, s0, 458752
ADDR_READY:
    v_permlane16_swap_b32 v112, v114
    v_permlane16_swap_b32 v113, v115
    v_mfma_f32_16x16x32_bf16 v[180:183], a[248:251], a[20:23], v[180:183]
    ds_read_b64_tr_b16 a[244:245], v23 offset:24576
    ds_read_b64_tr_b16 a[246:247], v23 offset:28672
    v_mfma_f32_16x16x32_bf16 v[180:183], a[252:255], a[36:39], v[180:183]
    v_permlane16_swap_b32 v116, v118
    v_permlane16_swap_b32 v117, v119
    v_mfma_f32_16x16x32_bf16 v[176:179], a[252:255], a[32:35], v[176:179]
    v_permlane16_swap_b32 v120, v122
    v_permlane16_swap_b32 v121, v123
    v_mfma_f32_16x16x32_bf16 v[176:179], a[248:251], a[16:19], v[176:179]
    s_waitcnt lgkmcnt(4)
    v_permlane16_swap_b32 v124, v126
    v_permlane16_swap_b32 v125, v127
    v_mfma_f32_16x16x32_bf16 v[192:195], a[232:235], a[16:19], v[192:195]
    ds_read_b64_tr_b16 a[248:249], v24 offset:16384
    ds_read_b64_tr_b16 a[250:251], v24 offset:20480
    v_mfma_f32_16x16x32_bf16 v[192:195], a[236:239], a[32:35], v[192:195]
    v_permlane16_swap_b32 v52, v54
    v_permlane16_swap_b32 v53, v55
    v_mfma_f32_16x16x32_bf16 v[196:199], a[236:239], a[36:39], v[196:199]
    buffer_load_dwordx4 a[116:119], v1, s[4:7], s46 offen offset:1024 sc1
    v_mfma_f32_16x16x32_bf16 v[196:199], a[232:235], a[20:23], v[196:199]
    v_permlane16_swap_b32 v56, v58
    v_permlane16_swap_b32 v57, v59
    v_mfma_f32_16x16x32_bf16 v[200:203], a[232:235], a[24:27], v[200:203]
    ds_read_b64_tr_b16 a[252:253], v24 offset:24576
    ds_read_b64_tr_b16 a[254:255], v24 offset:28672
    v_mfma_f32_16x16x32_bf16 v[200:203], a[236:239], a[40:43], v[200:203]
    v_permlane16_swap_b32 v60, v62
    v_permlane16_swap_b32 v61, v63
    v_mfma_f32_16x16x32_bf16 v[204:207], a[236:239], a[44:47], v[204:207]
    v_permlane16_swap_b32 v64, v66
    v_permlane16_swap_b32 v65, v67
    v_mfma_f32_16x16x32_bf16 v[204:207], a[232:235], a[28:31], v[204:207]
    s_waitcnt lgkmcnt(4)
    v_permlane32_swap_b32 v112, v114
    v_permlane32_swap_b32 v113, v115
    v_mfma_f32_16x16x32_bf16 v[220:223], a[240:243], a[28:31], v[220:223]
    ds_read_b64_tr_b16 a[232:233], v25 offset:16384
    ds_read_b64_tr_b16 a[234:235], v25 offset:20480
    v_mfma_f32_16x16x32_bf16 v[220:223], a[244:247], a[44:47], v[220:223]
    v_permlane32_swap_b32 v116, v118
    v_permlane32_swap_b32 v117, v119
    v_mfma_f32_16x16x32_bf16 v[216:219], a[244:247], a[40:43], v[216:219]
    buffer_load_dwordx4 a[120:123], v1, s[4:7], s46 offen offset:2048 sc1
    v_mfma_f32_16x16x32_bf16 v[216:219], a[240:243], a[24:27], v[216:219]
    v_permlane32_swap_b32 v120, v122
    v_permlane32_swap_b32 v121, v123
    v_mfma_f32_16x16x32_bf16 v[212:215], a[240:243], a[20:23], v[212:215]
    ds_read_b64_tr_b16 a[236:237], v25 offset:24576
    ds_read_b64_tr_b16 a[238:239], v25 offset:28672
    v_mfma_f32_16x16x32_bf16 v[212:215], a[244:247], a[36:39], v[212:215]
    v_permlane32_swap_b32 v124, v126
    v_permlane32_swap_b32 v125, v127
    v_mfma_f32_16x16x32_bf16 v[208:211], a[244:247], a[32:35], v[208:211]
    buffer_load_dwordx4 a[124:127], v1, s[4:7], s46 offen offset:3072 sc1
    v_mfma_f32_16x16x32_bf16 v[208:211], a[240:243], a[16:19], v[208:211]
    s_waitcnt lgkmcnt(4)
    v_permlane32_swap_b32 v52, v54
    v_permlane32_swap_b32 v53, v55
    v_mfma_f32_16x16x32_bf16 v[224:227], a[248:251], a[16:19], v[224:227]
    s_barrier
    ds_read_b64_tr_b16 a[240:241], v18 offset:32768
    ds_read_b64_tr_b16 a[242:243], v18 offset:36864
    v_mfma_f32_16x16x32_bf16 v[224:227], a[252:255], a[32:35], v[224:227]
    s_xor_b32 s46, s69, 81920
    v_permlane32_swap_b32 v56, v58
    v_permlane32_swap_b32 v57, v59
    v_mfma_f32_16x16x32_bf16 v[228:231], a[252:255], a[36:39], v[228:231]
    buffer_load_dwordx4 a[176:179], v1, s[4:7], s46 offen offset:0 sc1
    v_mfma_f32_16x16x32_bf16 v[228:231], a[248:251], a[20:23], v[228:231]
    v_permlane32_swap_b32 v60, v62
    v_permlane32_swap_b32 v61, v63
    v_mfma_f32_16x16x32_bf16 v[232:235], a[248:251], a[24:27], v[232:235]
    ds_read_b64_tr_b16 a[244:245], v18 offset:40960
    ds_read_b64_tr_b16 a[246:247], v18 offset:45056
    v_mfma_f32_16x16x32_bf16 v[232:235], a[252:255], a[40:43], v[232:235]
    v_permlane32_swap_b32 v64, v66
    v_permlane32_swap_b32 v65, v67
    v_mfma_f32_16x16x32_bf16 v[236:239], a[252:255], a[44:47], v[236:239]
    v_lshlrev_b32 v10, 16, v6
    v_and_b32 v11, s54, v6
    v_mfma_f32_16x16x32_bf16 v[236:239], a[248:251], a[28:31], v[236:239]
    s_waitcnt lgkmcnt(4)
    v_lshlrev_b32 v12, 16, v7
    v_and_b32 v13, s54, v7
    v_mfma_f32_16x16x32_bf16 v[252:255], a[232:235], a[28:31], v[252:255]
    ds_read_b64_tr_b16 a[248:249], v19 offset:32768
    ds_read_b64_tr_b16 a[250:251], v19 offset:36864
    v_mfma_f32_16x16x32_bf16 v[252:255], a[236:239], a[44:47], v[252:255]
    buffer_store_dwordx4 a[172:175], v1, s[4:7], s71 offen offset:3072 sc1
    v_mfma_f32_16x16x32_bf16 v[248:251], a[236:239], a[40:43], v[248:251]
    v_lshlrev_b32 v68, 16, v52
    v_and_b32 v69, s54, v52
    v_mfma_f32_16x16x32_bf16 v[248:251], a[232:235], a[24:27], v[248:251]
    v_lshlrev_b32 v70, 16, v53
    v_and_b32 v71, s54, v53
    v_mfma_f32_16x16x32_bf16 v[244:247], a[232:235], a[20:23], v[244:247]
    ds_read_b64_tr_b16 a[252:253], v19 offset:40960
    ds_read_b64_tr_b16 a[254:255], v19 offset:45056
    v_mfma_f32_16x16x32_bf16 v[244:247], a[236:239], a[36:39], v[244:247]
    v_mul_f32 v68, v68, v10
    v_mul_f32 v69, v69, v11
    v_mfma_f32_16x16x32_bf16 v[240:243], a[236:239], a[32:35], v[240:243]
    v_mul_f32 v70, v70, v12
    v_mul_f32 v71, v71, v13
    v_mfma_f32_16x16x32_bf16 v[240:243], a[232:235], a[16:19], v[240:243]
    s_waitcnt lgkmcnt(4)
    v_cvt_pk_bf16_f32 v72, v68, v69
    v_cvt_pk_bf16_f32 v73, v70, v71
    v_mfma_f32_16x16x32_bf16 v[128:131], a[240:243], a[48:51], v[128:131]
    ds_read_b64_tr_b16 a[232:233], v20 offset:32768
    ds_read_b64_tr_b16 a[234:235], v20 offset:36864
    v_mfma_f32_16x16x32_bf16 v[128:131], a[244:247], a[64:67], v[128:131]
    v_lshlrev_b32 v68, 16, v72
    v_and_b32 v69, s54, v72
    v_mfma_f32_16x16x32_bf16 v[132:135], a[244:247], a[68:71], v[132:135]
    buffer_load_dwordx4 a[180:183], v1, s[4:7], s46 offen offset:1024 sc1
    v_mfma_f32_16x16x32_bf16 v[132:135], a[240:243], a[52:55], v[132:135]
    v_lshlrev_b32 v80, 16, v112
    v_and_b32 v81, s54, v112
    v_mfma_f32_16x16x32_bf16 v[136:139], a[240:243], a[56:59], v[136:139]
    ds_read_b64_tr_b16 a[236:237], v20 offset:40960
    ds_read_b64_tr_b16 a[238:239], v20 offset:45056
    v_mfma_f32_16x16x32_bf16 v[136:139], a[244:247], a[72:75], v[136:139]
    v_lshlrev_b32 v70, 16, v73
    v_and_b32 v71, s54, v73
    v_mfma_f32_16x16x32_bf16 v[140:143], a[244:247], a[76:79], v[140:143]
    v_lshlrev_b32 v82, 16, v113
    v_and_b32 v83, s54, v113
    v_mfma_f32_16x16x32_bf16 v[140:143], a[240:243], a[60:63], v[140:143]
    s_waitcnt lgkmcnt(4)
    v_add_f32 v80, v80, v68
    v_add_f32 v81, v81, v69
    v_mfma_f32_16x16x32_bf16 v[156:159], a[248:251], a[60:63], v[156:159]
    ds_read_b64_tr_b16 a[240:241], v21 offset:32768
    ds_read_b64_tr_b16 a[242:243], v21 offset:36864
    v_mfma_f32_16x16x32_bf16 v[156:159], a[252:255], a[76:79], v[156:159]
    v_add_f32 v82, v82, v70
    v_add_f32 v83, v83, v71
    v_mfma_f32_16x16x32_bf16 v[152:155], a[252:255], a[72:75], v[152:155]
    buffer_load_dwordx4 a[184:187], v1, s[4:7], s46 offen offset:2048 sc1
    v_mfma_f32_16x16x32_bf16 v[152:155], a[248:251], a[56:59], v[152:155]
    v_lshlrev_b32 v68, 16, v56
    v_and_b32 v69, s54, v56
    v_mfma_f32_16x16x32_bf16 v[148:151], a[248:251], a[52:55], v[148:151]
    ds_read_b64_tr_b16 a[244:245], v21 offset:40960
    ds_read_b64_tr_b16 a[246:247], v21 offset:45056
    v_mfma_f32_16x16x32_bf16 v[148:151], a[252:255], a[68:71], v[148:151]
    v_lshlrev_b32 v70, 16, v57
    v_and_b32 v71, s54, v57
    v_mfma_f32_16x16x32_bf16 v[144:147], a[252:255], a[64:67], v[144:147]
    buffer_load_dwordx4 a[188:191], v1, s[4:7], s46 offen offset:3072 sc1
    v_mfma_f32_16x16x32_bf16 v[144:147], a[248:251], a[48:51], v[144:147]
    s_waitcnt lgkmcnt(4)
    v_mul_f32 v68, v68, v10
    v_mul_f32 v69, v69, v11
    v_mfma_f32_16x16x32_bf16 v[160:163], a[232:235], a[48:51], v[160:163]
    ds_read_b64_tr_b16 a[248:249], v22 offset:32768
    ds_read_b64_tr_b16 a[250:251], v22 offset:36864
    v_mfma_f32_16x16x32_bf16 v[160:163], a[236:239], a[64:67], v[160:163]
    s_xor_b32 s46, s69, 86016
    v_mul_f32 v70, v70, v12
    v_mul_f32 v71, v71, v13
    v_mfma_f32_16x16x32_bf16 v[164:167], a[236:239], a[68:71], v[164:167]
    buffer_load_dwordx4 a[192:195], v1, s[4:7], s46 offen offset:0 sc1
    v_mfma_f32_16x16x32_bf16 v[164:167], a[232:235], a[52:55], v[164:167]
    v_cvt_pk_bf16_f32 v72, v68, v69
    v_cvt_pk_bf16_f32 v73, v70, v71
    v_mfma_f32_16x16x32_bf16 v[168:171], a[232:235], a[56:59], v[168:171]
    ds_read_b64_tr_b16 a[252:253], v22 offset:40960
    ds_read_b64_tr_b16 a[254:255], v22 offset:45056
    v_mfma_f32_16x16x32_bf16 v[168:171], a[236:239], a[72:75], v[168:171]
    v_lshlrev_b32 v68, 16, v72
    v_and_b32 v69, s54, v72
    v_mfma_f32_16x16x32_bf16 v[172:175], a[236:239], a[76:79], v[172:175]
    buffer_load_dwordx4 a[196:199], v1, s[4:7], s46 offen offset:1024 sc1
    v_mfma_f32_16x16x32_bf16 v[172:175], a[232:235], a[60:63], v[172:175]
    s_waitcnt lgkmcnt(4)
    v_lshlrev_b32 v84, 16, v116
    v_and_b32 v85, s54, v116
    v_mfma_f32_16x16x32_bf16 v[188:191], a[240:243], a[60:63], v[188:191]
    s_xor_b32 s71, s69, 262144
    ds_read_b64_tr_b16 a[232:233], v23 offset:32768
    ds_read_b64_tr_b16 a[234:235], v23 offset:36864
    v_mfma_f32_16x16x32_bf16 v[188:191], a[244:247], a[76:79], v[188:191]
    buffer_store_dwordx4 a[96:99], v1, s[4:7], s71 offen offset:0 sc1
    v_mfma_f32_16x16x32_bf16 v[184:187], a[244:247], a[72:75], v[184:187]
    v_lshlrev_b32 v70, 16, v73
    v_and_b32 v71, s54, v73
    v_mfma_f32_16x16x32_bf16 v[184:187], a[240:243], a[56:59], v[184:187]
    v_lshlrev_b32 v86, 16, v117
    v_and_b32 v87, s54, v117
    v_mfma_f32_16x16x32_bf16 v[180:183], a[240:243], a[52:55], v[180:183]
    ds_read_b64_tr_b16 a[236:237], v23 offset:40960
    ds_read_b64_tr_b16 a[238:239], v23 offset:45056
    v_mfma_f32_16x16x32_bf16 v[180:183], a[244:247], a[68:71], v[180:183]
    v_add_f32 v84, v84, v68
    v_add_f32 v85, v85, v69
    v_mfma_f32_16x16x32_bf16 v[176:179], a[244:247], a[64:67], v[176:179]
    v_add_f32 v86, v86, v70
    v_add_f32 v87, v87, v71
    v_mfma_f32_16x16x32_bf16 v[176:179], a[240:243], a[48:51], v[176:179]
    s_waitcnt lgkmcnt(4)
    v_lshlrev_b32 v68, 16, v60
    v_and_b32 v69, s54, v60
    v_mfma_f32_16x16x32_bf16 v[192:195], a[248:251], a[48:51], v[192:195]
    ds_read_b64_tr_b16 a[240:241], v24 offset:32768
    ds_read_b64_tr_b16 a[242:243], v24 offset:36864
    v_mfma_f32_16x16x32_bf16 v[192:195], a[252:255], a[64:67], v[192:195]
    v_lshlrev_b32 v70, 16, v61
    v_and_b32 v71, s54, v61
    v_mfma_f32_16x16x32_bf16 v[196:199], a[252:255], a[68:71], v[196:199]
    buffer_load_dwordx4 a[200:203], v1, s[4:7], s46 offen offset:2048 sc1
    v_mfma_f32_16x16x32_bf16 v[196:199], a[248:251], a[52:55], v[196:199]
    v_mul_f32 v68, v68, v10
    v_mul_f32 v69, v69, v11
    v_mfma_f32_16x16x32_bf16 v[200:203], a[248:251], a[56:59], v[200:203]
    ds_read_b64_tr_b16 a[244:245], v24 offset:40960
    ds_read_b64_tr_b16 a[246:247], v24 offset:45056
    v_mfma_f32_16x16x32_bf16 v[200:203], a[252:255], a[72:75], v[200:203]
    v_mul_f32 v70, v70, v12
    v_mul_f32 v71, v71, v13
    v_mfma_f32_16x16x32_bf16 v[204:207], a[252:255], a[76:79], v[204:207]
    v_cvt_pk_bf16_f32 v72, v68, v69
    v_cvt_pk_bf16_f32 v73, v70, v71
    v_mfma_f32_16x16x32_bf16 v[204:207], a[248:251], a[60:63], v[204:207]
    s_waitcnt lgkmcnt(4)
    v_lshlrev_b32 v68, 16, v72
    v_and_b32 v69, s54, v72
    v_mfma_f32_16x16x32_bf16 v[220:223], a[232:235], a[60:63], v[220:223]
    ds_read_b64_tr_b16 a[248:249], v25 offset:32768
    ds_read_b64_tr_b16 a[250:251], v25 offset:36864
    v_mfma_f32_16x16x32_bf16 v[220:223], a[236:239], a[76:79], v[220:223]
    v_lshlrev_b32 v88, 16, v120
    v_and_b32 v89, s54, v120
    v_mfma_f32_16x16x32_bf16 v[216:219], a[236:239], a[72:75], v[216:219]
    buffer_load_dwordx4 a[204:207], v1, s[4:7], s46 offen offset:3072 sc1
    v_mfma_f32_16x16x32_bf16 v[216:219], a[232:235], a[56:59], v[216:219]
    v_lshlrev_b32 v70, 16, v73
    v_and_b32 v71, s54, v73
    v_mfma_f32_16x16x32_bf16 v[212:215], a[232:235], a[52:55], v[212:215]
    ds_read_b64_tr_b16 a[252:253], v25 offset:40960
    ds_read_b64_tr_b16 a[254:255], v25 offset:45056
    v_mfma_f32_16x16x32_bf16 v[212:215], a[236:239], a[68:71], v[212:215]
    s_xor_b32 s46, s69, 98304
    v_lshlrev_b32 v90, 16, v121
    v_and_b32 v91, s54, v121
    v_mfma_f32_16x16x32_bf16 v[208:211], a[236:239], a[64:67], v[208:211]
    buffer_load_dwordx4 a[208:211], v1, s[4:7], s46 offen offset:0 sc1
    v_mfma_f32_16x16x32_bf16 v[208:211], a[232:235], a[48:51], v[208:211]
    s_waitcnt lgkmcnt(4)
    v_add_f32 v88, v88, v68
    v_add_f32 v89, v89, v69
    v_mfma_f32_16x16x32_bf16 v[224:227], a[240:243], a[48:51], v[224:227]
    ds_read_b64_tr_b16 a[232:233], v18 offset:49152
    ds_read_b64_tr_b16 a[234:235], v18 offset:53248
    v_mfma_f32_16x16x32_bf16 v[224:227], a[244:247], a[64:67], v[224:227]
    v_add_f32 v90, v90, v70
    v_add_f32 v91, v91, v71
    v_mfma_f32_16x16x32_bf16 v[228:231], a[244:247], a[68:71], v[228:231]
    buffer_load_dwordx4 a[212:215], v1, s[4:7], s46 offen offset:1024 sc1
    v_mfma_f32_16x16x32_bf16 v[228:231], a[240:243], a[52:55], v[228:231]
    v_lshlrev_b32 v68, 16, v64
    v_and_b32 v69, s54, v64
    v_mfma_f32_16x16x32_bf16 v[232:235], a[240:243], a[56:59], v[232:235]
    ds_read_b64_tr_b16 a[236:237], v18 offset:57344
    ds_read_b64_tr_b16 a[238:239], v18 offset:61440
    v_mfma_f32_16x16x32_bf16 v[232:235], a[244:247], a[72:75], v[232:235]
    v_lshlrev_b32 v70, 16, v65
    v_and_b32 v71, s54, v65
    v_mfma_f32_16x16x32_bf16 v[236:239], a[244:247], a[76:79], v[236:239]
    v_mul_f32 v68, v68, v10
    v_mul_f32 v69, v69, v11
    v_mfma_f32_16x16x32_bf16 v[236:239], a[240:243], a[60:63], v[236:239]
    s_waitcnt lgkmcnt(4)
    v_mul_f32 v70, v70, v12
    v_mul_f32 v71, v71, v13
    v_mfma_f32_16x16x32_bf16 v[252:255], a[248:251], a[60:63], v[252:255]
    ds_read_b64_tr_b16 a[240:241], v19 offset:49152
    ds_read_b64_tr_b16 a[242:243], v19 offset:53248
    v_mfma_f32_16x16x32_bf16 v[252:255], a[252:255], a[76:79], v[252:255]
    buffer_store_dwordx4 a[100:103], v1, s[4:7], s71 offen offset:1024 sc1
    v_mfma_f32_16x16x32_bf16 v[248:251], a[252:255], a[72:75], v[248:251]
    v_cvt_pk_bf16_f32 v72, v68, v69
    v_cvt_pk_bf16_f32 v73, v70, v71
    v_mfma_f32_16x16x32_bf16 v[248:251], a[248:251], a[56:59], v[248:251]
    v_lshlrev_b32 v68, 16, v72
    v_and_b32 v69, s54, v72
    v_mfma_f32_16x16x32_bf16 v[244:247], a[248:251], a[52:55], v[244:247]
    ds_read_b64_tr_b16 a[244:245], v19 offset:57344
    ds_read_b64_tr_b16 a[246:247], v19 offset:61440
    v_mfma_f32_16x16x32_bf16 v[244:247], a[252:255], a[68:71], v[244:247]
    v_lshlrev_b32 v92, 16, v124
    v_and_b32 v93, s54, v124
    v_mfma_f32_16x16x32_bf16 v[240:243], a[252:255], a[64:67], v[240:243]
    v_lshlrev_b32 v70, 16, v73
    v_and_b32 v71, s54, v73
    v_mfma_f32_16x16x32_bf16 v[240:243], a[248:251], a[48:51], v[240:243]
    s_waitcnt vmcnt(18) lgkmcnt(4)
    v_lshlrev_b32 v94, 16, v125
    v_and_b32 v95, s54, v125
    v_mfma_f32_16x16x32_bf16 v[128:131], a[232:235], a[80:83], v[128:131]
    ds_read_b64_tr_b16 a[248:249], v20 offset:49152
    ds_read_b64_tr_b16 a[250:251], v20 offset:53248
    v_mfma_f32_16x16x32_bf16 v[128:131], a[236:239], a[0:3], v[128:131]
    v_add_f32 v92, v92, v68
    v_add_f32 v93, v93, v69
    v_mfma_f32_16x16x32_bf16 v[132:135], a[236:239], a[4:7], v[132:135]
    buffer_load_dwordx4 a[216:219], v1, s[4:7], s46 offen offset:2048 sc1
    v_mfma_f32_16x16x32_bf16 v[132:135], a[232:235], a[84:87], v[132:135]
    v_add_f32 v94, v94, v70
    v_add_f32 v95, v95, v71
    v_mfma_f32_16x16x32_bf16 v[136:139], a[232:235], a[88:91], v[136:139]
    ds_read_b64_tr_b16 a[252:253], v20 offset:57344
    ds_read_b64_tr_b16 a[254:255], v20 offset:61440
    v_mfma_f32_16x16x32_bf16 v[136:139], a[236:239], a[8:11], v[136:139]
    v_lshlrev_b32 v10, 16, v8
    v_and_b32 v11, s54, v8
    v_mfma_f32_16x16x32_bf16 v[140:143], a[236:239], a[12:15], v[140:143]
    v_lshlrev_b32 v12, 16, v9
    v_and_b32 v13, s54, v9
    v_mfma_f32_16x16x32_bf16 v[140:143], a[232:235], a[92:95], v[140:143]
    s_waitcnt lgkmcnt(4)
    v_lshlrev_b32 v68, 16, v54
    v_and_b32 v69, s54, v54
    v_mfma_f32_16x16x32_bf16 v[156:159], a[240:243], a[92:95], v[156:159]
    ds_read_b64_tr_b16 a[232:233], v21 offset:49152
    ds_read_b64_tr_b16 a[234:235], v21 offset:53248
    v_mfma_f32_16x16x32_bf16 v[156:159], a[244:247], a[12:15], v[156:159]
    v_lshlrev_b32 v70, 16, v55
    v_and_b32 v71, s54, v55
    v_mfma_f32_16x16x32_bf16 v[152:155], a[244:247], a[8:11], v[152:155]
    buffer_load_dwordx4 a[220:223], v1, s[4:7], s46 offen offset:3072 sc1
    v_mfma_f32_16x16x32_bf16 v[152:155], a[240:243], a[88:91], v[152:155]
    v_mul_f32 v68, v68, v10
    v_mul_f32 v69, v69, v11
    v_mfma_f32_16x16x32_bf16 v[148:151], a[240:243], a[84:87], v[148:151]
    ds_read_b64_tr_b16 a[236:237], v21 offset:57344
    ds_read_b64_tr_b16 a[238:239], v21 offset:61440
    v_mfma_f32_16x16x32_bf16 v[148:151], a[244:247], a[4:7], v[148:151]
    s_xor_b32 s46, s69, 102400
    v_mul_f32 v70, v70, v12
    v_mul_f32 v71, v71, v13
    v_mfma_f32_16x16x32_bf16 v[144:147], a[244:247], a[0:3], v[144:147]
    buffer_load_dwordx4 a[16:19], v1, s[4:7], s46 offen offset:0 sc1
    v_mfma_f32_16x16x32_bf16 v[144:147], a[240:243], a[80:83], v[144:147]
    s_waitcnt lgkmcnt(4)
    v_cvt_pk_bf16_f32 v72, v68, v69
    v_cvt_pk_bf16_f32 v73, v70, v71
    v_mfma_f32_16x16x32_bf16 v[160:163], a[248:251], a[80:83], v[160:163]
    ds_read_b64_tr_b16 a[240:241], v22 offset:49152
    ds_read_b64_tr_b16 a[242:243], v22 offset:53248
    v_mfma_f32_16x16x32_bf16 v[160:163], a[252:255], a[0:3], v[160:163]
    buffer_load_dword v17, v16, s[4:7], s73 offen sc1
    v_mfma_f32_16x16x32_bf16 v[164:167], a[252:255], a[4:7], v[164:167]
    buffer_load_dwordx4 a[20:23], v1, s[4:7], s46 offen offset:1024 sc1
    v_mfma_f32_16x16x32_bf16 v[164:167], a[248:251], a[84:87], v[164:167]
    v_lshlrev_b32 v68, 16, v72
    v_and_b32 v69, s54, v72
    v_mfma_f32_16x16x32_bf16 v[168:171], a[248:251], a[88:91], v[168:171]
    ds_read_b64_tr_b16 a[244:245], v22 offset:57344
    ds_read_b64_tr_b16 a[246:247], v22 offset:61440
    v_mfma_f32_16x16x32_bf16 v[168:171], a[252:255], a[8:11], v[168:171]
    v_lshlrev_b32 v96, 16, v114
    v_and_b32 v97, s54, v114
    v_mfma_f32_16x16x32_bf16 v[172:175], a[252:255], a[12:15], v[172:175]
    buffer_load_dwordx4 a[24:27], v1, s[4:7], s46 offen offset:2048 sc1
    v_mfma_f32_16x16x32_bf16 v[172:175], a[248:251], a[92:95], v[172:175]
    s_waitcnt lgkmcnt(4)
    v_lshlrev_b32 v70, 16, v73
    v_and_b32 v71, s54, v73
    v_mfma_f32_16x16x32_bf16 v[188:191], a[232:235], a[92:95], v[188:191]
    ds_read_b64_tr_b16 a[248:249], v23 offset:49152
    ds_read_b64_tr_b16 a[250:251], v23 offset:53248
    v_mfma_f32_16x16x32_bf16 v[188:191], a[236:239], a[12:15], v[188:191]
    buffer_store_dwordx4 a[104:107], v1, s[4:7], s71 offen offset:2048 sc1
    v_mfma_f32_16x16x32_bf16 v[184:187], a[236:239], a[8:11], v[184:187]
    v_lshlrev_b32 v98, 16, v115
    v_and_b32 v99, s54, v115
    v_mfma_f32_16x16x32_bf16 v[184:187], a[232:235], a[88:91], v[184:187]
    v_add_f32 v96, v96, v68
    v_add_f32 v97, v97, v69
    v_mfma_f32_16x16x32_bf16 v[180:183], a[232:235], a[84:87], v[180:183]
    ds_read_b64_tr_b16 a[252:253], v23 offset:57344
    ds_read_b64_tr_b16 a[254:255], v23 offset:61440
    v_mfma_f32_16x16x32_bf16 v[180:183], a[236:239], a[4:7], v[180:183]
    v_add_f32 v98, v98, v70
    v_add_f32 v99, v99, v71
    v_mfma_f32_16x16x32_bf16 v[176:179], a[236:239], a[0:3], v[176:179]
    v_lshlrev_b32 v68, 16, v58
    v_and_b32 v69, s54, v58
    v_mfma_f32_16x16x32_bf16 v[176:179], a[232:235], a[80:83], v[176:179]
    s_waitcnt lgkmcnt(4)
    v_lshlrev_b32 v70, 16, v59
    v_and_b32 v71, s54, v59
    v_mfma_f32_16x16x32_bf16 v[192:195], a[240:243], a[80:83], v[192:195]
    ds_read_b64_tr_b16 a[232:233], v24 offset:49152
    ds_read_b64_tr_b16 a[234:235], v24 offset:53248
    v_mfma_f32_16x16x32_bf16 v[192:195], a[244:247], a[0:3], v[192:195]
    v_mul_f32 v68, v68, v10
    v_mul_f32 v69, v69, v11
    v_mfma_f32_16x16x32_bf16 v[196:199], a[244:247], a[4:7], v[196:199]
    buffer_load_dwordx4 a[28:31], v1, s[4:7], s46 offen offset:3072 sc1
    v_mfma_f32_16x16x32_bf16 v[196:199], a[240:243], a[84:87], v[196:199]
    v_mul_f32 v70, v70, v12
    v_mul_f32 v71, v71, v13
    v_mfma_f32_16x16x32_bf16 v[200:203], a[240:243], a[88:91], v[200:203]
    ds_read_b64_tr_b16 a[236:237], v24 offset:57344
    ds_read_b64_tr_b16 a[238:239], v24 offset:61440
    v_mfma_f32_16x16x32_bf16 v[200:203], a[244:247], a[8:11], v[200:203]
    v_cvt_pk_bf16_f32 v72, v68, v69
    v_cvt_pk_bf16_f32 v73, v70, v71
    v_mfma_f32_16x16x32_bf16 v[204:207], a[244:247], a[12:15], v[204:207]
    v_lshlrev_b32 v68, 16, v72
    v_and_b32 v69, s54, v72
    v_mfma_f32_16x16x32_bf16 v[204:207], a[240:243], a[92:95], v[204:207]
    s_waitcnt lgkmcnt(4)
    v_lshlrev_b32 v100, 16, v118
    v_and_b32 v101, s54, v118
    v_mfma_f32_16x16x32_bf16 v[220:223], a[248:251], a[92:95], v[220:223]
    ds_read_b64_tr_b16 a[240:241], v25 offset:49152
    ds_read_b64_tr_b16 a[242:243], v25 offset:53248
    v_mfma_f32_16x16x32_bf16 v[220:223], a[252:255], a[12:15], v[220:223]
    s_xor_b32 s46, s69, 114688
    v_lshlrev_b32 v70, 16, v73
    v_and_b32 v71, s54, v73
    v_mfma_f32_16x16x32_bf16 v[216:219], a[252:255], a[8:11], v[216:219]
    buffer_load_dwordx4 a[32:35], v1, s[4:7], s46 offen offset:0 sc1
    v_mfma_f32_16x16x32_bf16 v[216:219], a[248:251], a[88:91], v[216:219]
    v_lshlrev_b32 v102, 16, v119
    v_and_b32 v103, s54, v119
    v_mfma_f32_16x16x32_bf16 v[212:215], a[248:251], a[84:87], v[212:215]
    ds_read_b64_tr_b16 a[244:245], v25 offset:57344
    ds_read_b64_tr_b16 a[246:247], v25 offset:61440
    v_mfma_f32_16x16x32_bf16 v[212:215], a[252:255], a[4:7], v[212:215]
    v_add_f32 v100, v100, v68
    v_add_f32 v101, v101, v69
    v_mfma_f32_16x16x32_bf16 v[208:211], a[252:255], a[0:3], v[208:211]
    buffer_load_dwordx4 a[36:39], v1, s[4:7], s46 offen offset:1024 sc1
    v_mfma_f32_16x16x32_bf16 v[208:211], a[248:251], a[80:83], v[208:211]
    s_waitcnt lgkmcnt(4)
    v_add_f32 v102, v102, v70
    v_add_f32 v103, v103, v71
    v_mfma_f32_16x16x32_bf16 v[224:227], a[232:235], a[80:83], v[224:227]
    s_barrier
    ds_read_b64_tr_b16 a[248:249], v26 offset:0
    ds_read_b64_tr_b16 a[250:251], v26 offset:4096
    v_mfma_f32_16x16x32_bf16 v[224:227], a[236:239], a[0:3], v[224:227]
    global_load_dword v48, v47, s[74:75]
    v_mfma_f32_16x16x32_bf16 v[228:231], a[236:239], a[4:7], v[228:231]
    buffer_load_dwordx4 a[40:43], v1, s[4:7], s46 offen offset:2048 sc1
    v_mfma_f32_16x16x32_bf16 v[228:231], a[232:235], a[84:87], v[228:231]
    v_lshlrev_b32 v68, 16, v62
    v_and_b32 v69, s54, v62
    v_mfma_f32_16x16x32_bf16 v[232:235], a[232:235], a[88:91], v[232:235]
    ds_read_b64_tr_b16 a[252:253], v26 offset:8192
    ds_read_b64_tr_b16 a[254:255], v26 offset:12288
    v_mfma_f32_16x16x32_bf16 v[232:235], a[236:239], a[8:11], v[232:235]
    v_lshlrev_b32 v70, 16, v63
    v_and_b32 v71, s54, v63
    v_mfma_f32_16x16x32_bf16 v[236:239], a[236:239], a[12:15], v[236:239]
    v_mul_f32 v68, v68, v10
    v_mul_f32 v69, v69, v11
    v_mfma_f32_16x16x32_bf16 v[236:239], a[232:235], a[92:95], v[236:239]
    s_waitcnt lgkmcnt(4)
    v_mul_f32 v70, v70, v12
    v_mul_f32 v71, v71, v13
    v_mfma_f32_16x16x32_bf16 v[252:255], a[240:243], a[92:95], v[252:255]
    ds_read_b64_tr_b16 a[232:233], v27 offset:0
    ds_read_b64_tr_b16 a[234:235], v27 offset:4096
    v_mfma_f32_16x16x32_bf16 v[252:255], a[244:247], a[12:15], v[252:255]
    buffer_store_dwordx4 a[108:111], v1, s[4:7], s71 offen offset:3072 sc1
    v_mfma_f32_16x16x32_bf16 v[248:251], a[244:247], a[8:11], v[248:251]
    v_cvt_pk_bf16_f32 v72, v68, v69
    v_cvt_pk_bf16_f32 v73, v70, v71
    v_mfma_f32_16x16x32_bf16 v[248:251], a[240:243], a[88:91], v[248:251]
    v_lshlrev_b32 v68, 16, v72
    v_and_b32 v69, s54, v72
    v_mfma_f32_16x16x32_bf16 v[244:247], a[240:243], a[84:87], v[244:247]
    ds_read_b64_tr_b16 a[236:237], v27 offset:8192
    ds_read_b64_tr_b16 a[238:239], v27 offset:12288
    v_mfma_f32_16x16x32_bf16 v[244:247], a[244:247], a[4:7], v[244:247]
    v_lshlrev_b32 v104, 16, v122
    v_and_b32 v105, s54, v122
    v_mfma_f32_16x16x32_bf16 v[240:243], a[244:247], a[0:3], v[240:243]
    v_lshlrev_b32 v70, 16, v73
    v_and_b32 v71, s54, v73
    v_mfma_f32_16x16x32_bf16 v[240:243], a[240:243], a[80:83], v[240:243]
    s_waitcnt vmcnt(26) lgkmcnt(4)
    v_lshlrev_b32 v106, 16, v123
    v_and_b32 v107, s54, v123
    v_mfma_f32_16x16x32_bf16 v[128:131], a[248:251], a[128:131], v[128:131]
    s_add_u32 s68, s65, 131072
    ds_read_b64_tr_b16 a[240:241], v28 offset:0
    ds_read_b64_tr_b16 a[242:243], v28 offset:4096
    v_mfma_f32_16x16x32_bf16 v[128:131], a[252:255], a[112:115], v[128:131]
    s_add_u32 m0, s64, 0
    v_add_f32 v104, v104, v68
    v_add_f32 v105, v105, v69
    v_mfma_f32_16x16x32_bf16 v[132:135], a[252:255], a[116:119], v[132:135]
    buffer_load_dwordx4 v2, s[28:31], s68 offen offset:0  lds
    v_mfma_f32_16x16x32_bf16 v[132:135], a[248:251], a[132:135], v[132:135]
    v_add_f32 v106, v106, v70
    v_add_f32 v107, v107, v71
    v_mfma_f32_16x16x32_bf16 v[136:139], a[248:251], a[136:139], v[136:139]
    ds_read_b64_tr_b16 a[244:245], v28 offset:8192
    ds_read_b64_tr_b16 a[246:247], v28 offset:12288
    v_mfma_f32_16x16x32_bf16 v[136:139], a[252:255], a[120:123], v[136:139]
    v_lshlrev_b32 v68, 16, v66
    v_and_b32 v69, s54, v66
    v_mfma_f32_16x16x32_bf16 v[140:143], a[252:255], a[124:127], v[140:143]
    v_lshlrev_b32 v70, 16, v67
    v_and_b32 v71, s54, v67
    v_mfma_f32_16x16x32_bf16 v[140:143], a[248:251], a[140:143], v[140:143]
    s_waitcnt lgkmcnt(4)
    v_mul_f32 v68, v68, v10
    v_mul_f32 v69, v69, v11
    v_mfma_f32_16x16x32_bf16 v[156:159], a[232:235], a[140:143], v[156:159]
    ds_read_b64_tr_b16 a[248:249], v29 offset:0
    ds_read_b64_tr_b16 a[250:251], v29 offset:4096
    v_mfma_f32_16x16x32_bf16 v[156:159], a[236:239], a[124:127], v[156:159]
    v_mul_f32 v70, v70, v12
    v_mul_f32 v71, v71, v13
    v_mfma_f32_16x16x32_bf16 v[152:155], a[236:239], a[120:123], v[152:155]
    buffer_load_dwordx4 a[44:47], v1, s[4:7], s46 offen offset:3072 sc1
    v_mfma_f32_16x16x32_bf16 v[152:155], a[232:235], a[136:139], v[152:155]
    v_cvt_pk_bf16_f32 v72, v68, v69
    v_cvt_pk_bf16_f32 v73, v70, v71
    v_mfma_f32_16x16x32_bf16 v[148:151], a[232:235], a[132:135], v[148:151]
    ds_read_b64_tr_b16 a[252:253], v29 offset:8192
    ds_read_b64_tr_b16 a[254:255], v29 offset:12288
    v_mfma_f32_16x16x32_bf16 v[148:151], a[236:239], a[116:119], v[148:151]
    s_xor_b32 s46, s69, 118784
    v_lshlrev_b32 v68, 16, v72
    v_and_b32 v69, s54, v72
    v_mfma_f32_16x16x32_bf16 v[144:147], a[236:239], a[112:115], v[144:147]
    buffer_load_dwordx4 a[48:51], v1, s[4:7], s46 offen offset:0 sc1
    v_mfma_f32_16x16x32_bf16 v[144:147], a[232:235], a[128:131], v[144:147]
    s_waitcnt lgkmcnt(4)
    v_lshlrev_b32 v108, 16, v126
    v_and_b32 v109, s54, v126
    v_mfma_f32_16x16x32_bf16 v[160:163], a[240:243], a[128:131], v[160:163]
    s_waitcnt vmcnt(12)
    ds_read_b64_tr_b16 a[232:233], v30 offset:0
    ds_read_b64_tr_b16 a[234:235], v30 offset:4096
    v_mfma_f32_16x16x32_bf16 v[160:163], a[244:247], a[112:115], v[160:163]
    v_subrev_u32 v17, s79, v17
    v_subrev_u32 v17, 3, v17
    v_mfma_f32_16x16x32_bf16 v[164:167], a[244:247], a[116:119], v[164:167]
    buffer_load_dwordx4 v3, s[28:31], s68 offen offset:1024  lds
    v_mfma_f32_16x16x32_bf16 v[164:167], a[240:243], a[132:135], v[164:167]
    v_cmp_lt_u32 vcc, 4, v17
    s_cbranch_vccnz SLOW_FA3
BACK_FA3:
    v_mfma_f32_16x16x32_bf16 v[168:171], a[240:243], a[136:139], v[168:171]
    ds_read_b64_tr_b16 a[236:237], v30 offset:8192
    ds_read_b64_tr_b16 a[238:239], v30 offset:12288
    v_mfma_f32_16x16x32_bf16 v[168:171], a[244:247], a[120:123], v[168:171]
    v_lshlrev_b32 v70, 16, v73
    v_and_b32 v71, s54, v73
    v_mfma_f32_16x16x32_bf16 v[172:175], a[244:247], a[124:127], v[172:175]
    buffer_load_dwordx4 a[52:55], v1, s[4:7], s46 offen offset:1024 sc1
    v_mfma_f32_16x16x32_bf16 v[172:175], a[240:243], a[140:143], v[172:175]
    s_waitcnt lgkmcnt(4)
    v_lshlrev_b32 v110, 16, v127
    v_and_b32 v111, s54, v127
    v_mfma_f32_16x16x32_bf16 v[188:191], a[248:251], a[140:143], v[188:191]
    ds_read_b64_tr_b16 a[240:241], v31 offset:0
    ds_read_b64_tr_b16 a[242:243], v31 offset:4096
    v_mfma_f32_16x16x32_bf16 v[188:191], a[252:255], a[124:127], v[188:191]
    v_add_f32 v108, v108, v68
    v_add_f32 v109, v109, v69
    v_mfma_f32_16x16x32_bf16 v[184:187], a[252:255], a[120:123], v[184:187]
    buffer_load_dwordx4 a[56:59], v1, s[4:7], s46 offen offset:2048 sc1
    v_mfma_f32_16x16x32_bf16 v[184:187], a[248:251], a[136:139], v[184:187]
    v_add_f32 v110, v110, v70
    v_add_f32 v111, v111, v71
BASE_READY:
    v_mfma_f32_16x16x32_bf16 v[180:183], a[248:251], a[132:135], v[180:183]
    ds_read_b64_tr_b16 a[244:245], v31 offset:8192
    ds_read_b64_tr_b16 a[246:247], v31 offset:12288
    v_mfma_f32_16x16x32_bf16 v[180:183], a[252:255], a[116:119], v[180:183]
    v_mfma_f32_16x16x32_bf16 v[176:179], a[252:255], a[112:115], v[176:179]
    buffer_load_dwordx4 a[60:63], v1, s[4:7], s46 offen offset:3072 sc1
    v_mfma_f32_16x16x32_bf16 v[176:179], a[248:251], a[128:131], v[176:179]
    s_waitcnt lgkmcnt(4)
    v_mfma_f32_16x16x32_bf16 v[192:195], a[232:235], a[128:131], v[192:195]
    ds_read_b64_tr_b16 a[248:249], v32 offset:0
    ds_read_b64_tr_b16 a[250:251], v32 offset:4096
    v_mfma_f32_16x16x32_bf16 v[192:195], a[236:239], a[112:115], v[192:195]
    v_mfma_f32_16x16x32_bf16 v[196:199], a[236:239], a[116:119], v[196:199]
    buffer_load_dwordx4 v4, s[28:31], s68 offen offset:2048  lds
    v_mfma_f32_16x16x32_bf16 v[196:199], a[232:235], a[132:135], v[196:199]
    v_mfma_f32_16x16x32_bf16 v[200:203], a[232:235], a[136:139], v[200:203]
    ds_read_b64_tr_b16 a[252:253], v32 offset:8192
    ds_read_b64_tr_b16 a[254:255], v32 offset:12288
    v_mfma_f32_16x16x32_bf16 v[200:203], a[236:239], a[120:123], v[200:203]
    v_mfma_f32_16x16x32_bf16 v[204:207], a[236:239], a[124:127], v[204:207]
    v_mfma_f32_16x16x32_bf16 v[204:207], a[232:235], a[140:143], v[204:207]
    s_waitcnt lgkmcnt(4)
    v_mfma_f32_16x16x32_bf16 v[220:223], a[240:243], a[140:143], v[220:223]
    ds_read_b64_tr_b16 a[232:233], v33 offset:0
    ds_read_b64_tr_b16 a[234:235], v33 offset:4096
    v_mfma_f32_16x16x32_bf16 v[220:223], a[244:247], a[124:127], v[220:223]
    s_xor_b32 s46, s69, 135168
    v_mfma_f32_16x16x32_bf16 v[216:219], a[244:247], a[120:123], v[216:219]
    buffer_load_dwordx4 a[64:67], v1, s[4:7], s46 offen offset:0 sc1
    v_mfma_f32_16x16x32_bf16 v[216:219], a[240:243], a[136:139], v[216:219]
    v_mfma_f32_16x16x32_bf16 v[212:215], a[240:243], a[132:135], v[212:215]
    ds_read_b64_tr_b16 a[236:237], v33 offset:8192
    ds_read_b64_tr_b16 a[238:239], v33 offset:12288
    v_mfma_f32_16x16x32_bf16 v[212:215], a[244:247], a[116:119], v[212:215]
    v_mfma_f32_16x16x32_bf16 v[208:211], a[244:247], a[112:115], v[208:211]
    buffer_load_dwordx4 a[68:71], v1, s[4:7], s46 offen offset:1024 sc1
    v_mfma_f32_16x16x32_bf16 v[208:211], a[240:243], a[128:131], v[208:211]
    s_waitcnt lgkmcnt(4)
    v_mfma_f32_16x16x32_bf16 v[224:227], a[248:251], a[128:131], v[224:227]
    ds_read_b64_tr_b16 a[240:241], v26 offset:16384
    ds_read_b64_tr_b16 a[242:243], v26 offset:20480
    v_mfma_f32_16x16x32_bf16 v[224:227], a[252:255], a[112:115], v[224:227]
    v_mfma_f32_16x16x32_bf16 v[228:231], a[252:255], a[116:119], v[228:231]
    buffer_load_dwordx4 v5, s[28:31], s68 offen offset:3072  lds
    v_mfma_f32_16x16x32_bf16 v[228:231], a[248:251], a[132:135], v[228:231]
    v_mfma_f32_16x16x32_bf16 v[232:235], a[248:251], a[136:139], v[232:235]
    ds_read_b64_tr_b16 a[244:245], v26 offset:24576
    ds_read_b64_tr_b16 a[246:247], v26 offset:28672
    v_mfma_f32_16x16x32_bf16 v[232:235], a[252:255], a[120:123], v[232:235]
    v_mfma_f32_16x16x32_bf16 v[236:239], a[252:255], a[124:127], v[236:239]
    buffer_load_dwordx4 a[72:75], v1, s[4:7], s46 offen offset:2048 sc1
    v_mfma_f32_16x16x32_bf16 v[236:239], a[248:251], a[140:143], v[236:239]
    s_waitcnt lgkmcnt(4)
    v_mfma_f32_16x16x32_bf16 v[252:255], a[232:235], a[140:143], v[252:255]
    ds_read_b64_tr_b16 a[248:249], v27 offset:16384
    ds_read_b64_tr_b16 a[250:251], v27 offset:20480
    v_mfma_f32_16x16x32_bf16 v[252:255], a[236:239], a[124:127], v[252:255]
    v_mfma_f32_16x16x32_bf16 v[248:251], a[236:239], a[120:123], v[248:251]
    buffer_load_dwordx4 a[76:79], v1, s[4:7], s46 offen offset:3072 sc1
    v_mfma_f32_16x16x32_bf16 v[248:251], a[232:235], a[136:139], v[248:251]
    v_mfma_f32_16x16x32_bf16 v[244:247], a[232:235], a[132:135], v[244:247]
    ds_read_b64_tr_b16 a[252:253], v27 offset:24576
    ds_read_b64_tr_b16 a[254:255], v27 offset:28672
    v_mfma_f32_16x16x32_bf16 v[244:247], a[236:239], a[116:119], v[244:247]
    s_xor_b32 s46, s69, 147456
    v_mfma_f32_16x16x32_bf16 v[240:243], a[236:239], a[112:115], v[240:243]
    buffer_load_dwordx4 a[0:3], v1, s[4:7], s46 offen offset:0 sc1
    v_mfma_f32_16x16x32_bf16 v[240:243], a[232:235], a[128:131], v[240:243]
    s_waitcnt lgkmcnt(4)
    v_mfma_f32_16x16x32_bf16 v[128:131], a[240:243], a[176:179], v[128:131]
    s_add_u32 s68, s65, 163840
    ds_read_b64_tr_b16 a[232:233], v28 offset:16384
    ds_read_b64_tr_b16 a[234:235], v28 offset:20480
    v_mfma_f32_16x16x32_bf16 v[128:131], a[244:247], a[192:195], v[128:131]
    s_add_u32 m0, s64, 4096
    v_mfma_f32_16x16x32_bf16 v[132:135], a[244:247], a[196:199], v[132:135]
    buffer_load_dwordx4 v2, s[28:31], s68 offen offset:0  lds
    v_mfma_f32_16x16x32_bf16 v[132:135], a[240:243], a[180:183], v[132:135]
    v_mfma_f32_16x16x32_bf16 v[136:139], a[240:243], a[184:187], v[136:139]
    ds_read_b64_tr_b16 a[236:237], v28 offset:24576
    ds_read_b64_tr_b16 a[238:239], v28 offset:28672
    v_mfma_f32_16x16x32_bf16 v[136:139], a[244:247], a[200:203], v[136:139]
    v_mfma_f32_16x16x32_bf16 v[140:143], a[244:247], a[204:207], v[140:143]
    v_mfma_f32_16x16x32_bf16 v[140:143], a[240:243], a[188:191], v[140:143]
    s_waitcnt lgkmcnt(4)
    v_mfma_f32_16x16x32_bf16 v[156:159], a[248:251], a[188:191], v[156:159]
    ds_read_b64_tr_b16 a[240:241], v29 offset:16384
    ds_read_b64_tr_b16 a[242:243], v29 offset:20480
    v_mfma_f32_16x16x32_bf16 v[156:159], a[252:255], a[204:207], v[156:159]
    v_mfma_f32_16x16x32_bf16 v[152:155], a[252:255], a[200:203], v[152:155]
    buffer_load_dwordx4 a[4:7], v1, s[4:7], s46 offen offset:1024 sc1
    v_mfma_f32_16x16x32_bf16 v[152:155], a[248:251], a[184:187], v[152:155]
    v_mfma_f32_16x16x32_bf16 v[148:151], a[248:251], a[180:183], v[148:151]
    ds_read_b64_tr_b16 a[244:245], v29 offset:24576
    ds_read_b64_tr_b16 a[246:247], v29 offset:28672
    v_mfma_f32_16x16x32_bf16 v[148:151], a[252:255], a[196:199], v[148:151]
    v_mfma_f32_16x16x32_bf16 v[144:147], a[252:255], a[192:195], v[144:147]
    buffer_load_dwordx4 a[8:11], v1, s[4:7], s46 offen offset:2048 sc1
    v_mfma_f32_16x16x32_bf16 v[144:147], a[248:251], a[176:179], v[144:147]
    s_waitcnt lgkmcnt(4)
    v_mfma_f32_16x16x32_bf16 v[160:163], a[232:235], a[176:179], v[160:163]
    ds_read_b64_tr_b16 a[248:249], v30 offset:16384
    ds_read_b64_tr_b16 a[250:251], v30 offset:20480
    v_mfma_f32_16x16x32_bf16 v[160:163], a[236:239], a[192:195], v[160:163]
    v_mfma_f32_16x16x32_bf16 v[164:167], a[236:239], a[196:199], v[164:167]
    buffer_load_dwordx4 v3, s[28:31], s68 offen offset:1024  lds
    v_mfma_f32_16x16x32_bf16 v[164:167], a[232:235], a[180:183], v[164:167]
    v_mfma_f32_16x16x32_bf16 v[168:171], a[232:235], a[184:187], v[168:171]
    ds_read_b64_tr_b16 a[252:253], v30 offset:24576
    ds_read_b64_tr_b16 a[254:255], v30 offset:28672
    v_mfma_f32_16x16x32_bf16 v[168:171], a[236:239], a[200:203], v[168:171]
    v_mfma_f32_16x16x32_bf16 v[172:175], a[236:239], a[204:207], v[172:175]
    buffer_load_dwordx4 a[12:15], v1, s[4:7], s46 offen offset:3072 sc1
    v_mfma_f32_16x16x32_bf16 v[172:175], a[232:235], a[188:191], v[172:175]
    s_waitcnt lgkmcnt(4)
    v_mfma_f32_16x16x32_bf16 v[188:191], a[240:243], a[188:191], v[188:191]
    ds_read_b64_tr_b16 a[232:233], v31 offset:16384
    ds_read_b64_tr_b16 a[234:235], v31 offset:20480
    v_mfma_f32_16x16x32_bf16 v[188:191], a[244:247], a[204:207], v[188:191]
    s_xor_b32 s46, s69, 151552
    v_mov_b32 v74, 4
    s_mov_b64 vcc, s[76:77]
    v_mfma_f32_16x16x32_bf16 v[184:187], a[244:247], a[200:203], v[184:187]
    buffer_load_dwordx4 a[80:83], v1, s[4:7], s46 offen offset:0 sc1
    v_mfma_f32_16x16x32_bf16 v[184:187], a[240:243], a[184:187], v[184:187]
    v_add_u32 v74, s79, v74
    s_waitcnt vmcnt(20)
    v_mfma_f32_16x16x32_bf16 v[180:183], a[240:243], a[180:183], v[180:183]
    s_cbranch_vccnz FAR_4
NEAR_4:
    ds_read_b64_tr_b16 a[236:237], v31 offset:24576
    ds_read_b64_tr_b16 a[238:239], v31 offset:28672
    v_mfma_f32_16x16x32_bf16 v[180:183], a[244:247], a[196:199], v[180:183]
    buffer_store_dword v74, v78, s[4:7], s73 offen
    v_mfma_f32_16x16x32_bf16 v[176:179], a[244:247], a[192:195], v[176:179]
    buffer_load_dwordx4 a[84:87], v1, s[4:7], s46 offen offset:1024 sc1
    v_mfma_f32_16x16x32_bf16 v[176:179], a[240:243], a[176:179], v[176:179]
    s_waitcnt lgkmcnt(4)
    v_subrev_u32 v75, s49, v0
    v_min_u32 v75, 1, v75
    v_mfma_f32_16x16x32_bf16 v[192:195], a[248:251], a[176:179], v[192:195]
    ds_read_b64_tr_b16 a[240:241], v32 offset:16384
    ds_read_b64_tr_b16 a[242:243], v32 offset:20480
    v_mfma_f32_16x16x32_bf16 v[192:195], a[252:255], a[192:195], v[192:195]
    v_lshl_add_u32 v75, v75, 28, v16
    v_mfma_f32_16x16x32_bf16 v[196:199], a[252:255], a[196:199], v[196:199]
    buffer_load_dwordx4 v4, s[28:31], s68 offen offset:2048  lds
    v_mfma_f32_16x16x32_bf16 v[196:199], a[248:251], a[180:183], v[196:199]
    buffer_store_dword v74, v75, s[4:7], s1 offen sc1
    v_mfma_f32_16x16x32_bf16 v[200:203], a[248:251], a[184:187], v[200:203]
    ds_read_b64_tr_b16 a[244:245], v32 offset:24576
    ds_read_b64_tr_b16 a[246:247], v32 offset:28672
    v_mfma_f32_16x16x32_bf16 v[200:203], a[252:255], a[200:203], v[200:203]
    v_mfma_f32_16x16x32_bf16 v[204:207], a[252:255], a[204:207], v[204:207]
    v_mfma_f32_16x16x32_bf16 v[204:207], a[248:251], a[188:191], v[204:207]
    s_waitcnt lgkmcnt(4)
    v_mfma_f32_16x16x32_bf16 v[220:223], a[232:235], a[188:191], v[220:223]
    ds_read_b64_tr_b16 a[248:249], v33 offset:16384
    ds_read_b64_tr_b16 a[250:251], v33 offset:20480
    v_mfma_f32_16x16x32_bf16 v[220:223], a[236:239], a[204:207], v[220:223]
    v_mfma_f32_16x16x32_bf16 v[216:219], a[236:239], a[200:203], v[216:219]
    buffer_load_dwordx4 a[88:91], v1, s[4:7], s46 offen offset:2048 sc1
    v_mfma_f32_16x16x32_bf16 v[216:219], a[232:235], a[184:187], v[216:219]
    v_mfma_f32_16x16x32_bf16 v[212:215], a[232:235], a[180:183], v[212:215]
    ds_read_b64_tr_b16 a[252:253], v33 offset:24576
    ds_read_b64_tr_b16 a[254:255], v33 offset:28672
    v_mfma_f32_16x16x32_bf16 v[212:215], a[236:239], a[196:199], v[212:215]
    v_mfma_f32_16x16x32_bf16 v[208:211], a[236:239], a[192:195], v[208:211]
    buffer_load_dwordx4 a[92:95], v1, s[4:7], s46 offen offset:3072 sc1
    v_mfma_f32_16x16x32_bf16 v[208:211], a[232:235], a[176:179], v[208:211]
    s_waitcnt lgkmcnt(4)
    v_mfma_f32_16x16x32_bf16 v[224:227], a[240:243], a[176:179], v[224:227]
    s_barrier
    ds_read_b64_tr_b16 a[232:233], v26 offset:32768
    ds_read_b64_tr_b16 a[234:235], v26 offset:36864
    v_mfma_f32_16x16x32_bf16 v[224:227], a[244:247], a[192:195], v[224:227]
    v_mfma_f32_16x16x32_bf16 v[228:231], a[244:247], a[196:199], v[228:231]
    buffer_load_dwordx4 v5, s[28:31], s68 offen offset:3072  lds
    v_mfma_f32_16x16x32_bf16 v[228:231], a[240:243], a[180:183], v[228:231]
    v_mfma_f32_16x16x32_bf16 v[232:235], a[240:243], a[184:187], v[232:235]
    ds_read_b64_tr_b16 a[236:237], v26 offset:40960
    ds_read_b64_tr_b16 a[238:239], v26 offset:45056
    v_mfma_f32_16x16x32_bf16 v[232:235], a[244:247], a[200:203], v[232:235]
    s_xor_b32 s46, s69, 163840
    v_mfma_f32_16x16x32_bf16 v[236:239], a[244:247], a[204:207], v[236:239]
    buffer_load_dwordx4 a[112:115], v1, s[4:7], s46 offen offset:0 sc1
    v_mfma_f32_16x16x32_bf16 v[236:239], a[240:243], a[188:191], v[236:239]
    s_waitcnt lgkmcnt(4)
    v_mfma_f32_16x16x32_bf16 v[252:255], a[248:251], a[188:191], v[252:255]
    ds_read_b64_tr_b16 a[240:241], v27 offset:32768
    ds_read_b64_tr_b16 a[242:243], v27 offset:36864
    v_mfma_f32_16x16x32_bf16 v[252:255], a[252:255], a[204:207], v[252:255]
    v_mfma_f32_16x16x32_bf16 v[248:251], a[252:255], a[200:203], v[248:251]
    buffer_load_dwordx4 a[116:119], v1, s[4:7], s46 offen offset:1024 sc1
    v_mfma_f32_16x16x32_bf16 v[248:251], a[248:251], a[184:187], v[248:251]
    v_mfma_f32_16x16x32_bf16 v[244:247], a[248:251], a[180:183], v[244:247]
    ds_read_b64_tr_b16 a[244:245], v27 offset:40960
    ds_read_b64_tr_b16 a[246:247], v27 offset:45056
    v_mfma_f32_16x16x32_bf16 v[244:247], a[252:255], a[196:199], v[244:247]
    v_mfma_f32_16x16x32_bf16 v[240:243], a[252:255], a[192:195], v[240:243]
    buffer_load_dwordx4 a[120:123], v1, s[4:7], s46 offen offset:2048 sc1
    v_mfma_f32_16x16x32_bf16 v[240:243], a[248:251], a[176:179], v[240:243]
    s_waitcnt lgkmcnt(4)
    v_mfma_f32_16x16x32_bf16 v[128:131], a[232:235], a[208:211], v[128:131]
    s_add_u32 s68, s45, 131072
    ds_read_b64_tr_b16 a[248:249], v28 offset:32768
    ds_read_b64_tr_b16 a[250:251], v28 offset:36864
    v_mfma_f32_16x16x32_bf16 v[128:131], a[236:239], a[16:19], v[128:131]
    s_add_u32 m0, s64, 32768
    v_mfma_f32_16x16x32_bf16 v[132:135], a[236:239], a[20:23], v[132:135]
    buffer_load_dwordx4 v2, s[28:31], s68 offen offset:0  lds
    v_mfma_f32_16x16x32_bf16 v[132:135], a[232:235], a[212:215], v[132:135]
    v_mfma_f32_16x16x32_bf16 v[136:139], a[232:235], a[216:219], v[136:139]
    ds_read_b64_tr_b16 a[252:253], v28 offset:40960
    ds_read_b64_tr_b16 a[254:255], v28 offset:45056
    v_mfma_f32_16x16x32_bf16 v[136:139], a[236:239], a[24:27], v[136:139]
    v_mfma_f32_16x16x32_bf16 v[140:143], a[236:239], a[28:31], v[140:143]
    v_mfma_f32_16x16x32_bf16 v[140:143], a[232:235], a[220:223], v[140:143]
    s_waitcnt lgkmcnt(4)
    v_mfma_f32_16x16x32_bf16 v[156:159], a[240:243], a[220:223], v[156:159]
    ds_read_b64_tr_b16 a[232:233], v29 offset:32768
    ds_read_b64_tr_b16 a[234:235], v29 offset:36864
    v_mfma_f32_16x16x32_bf16 v[156:159], a[244:247], a[28:31], v[156:159]
    v_mfma_f32_16x16x32_bf16 v[152:155], a[244:247], a[24:27], v[152:155]
    buffer_load_dwordx4 a[124:127], v1, s[4:7], s46 offen offset:3072 sc1
    v_mfma_f32_16x16x32_bf16 v[152:155], a[240:243], a[216:219], v[152:155]
    v_mfma_f32_16x16x32_bf16 v[148:151], a[240:243], a[212:215], v[148:151]
    ds_read_b64_tr_b16 a[236:237], v29 offset:40960
    ds_read_b64_tr_b16 a[238:239], v29 offset:45056
    v_mfma_f32_16x16x32_bf16 v[148:151], a[244:247], a[20:23], v[148:151]
    s_xor_b32 s46, s69, 167936
    v_mfma_f32_16x16x32_bf16 v[144:147], a[244:247], a[16:19], v[144:147]
    buffer_load_dwordx4 a[128:131], v1, s[4:7], s46 offen offset:0 sc1
    v_mfma_f32_16x16x32_bf16 v[144:147], a[240:243], a[208:211], v[144:147]
    s_waitcnt lgkmcnt(4)
    v_mfma_f32_16x16x32_bf16 v[160:163], a[248:251], a[208:211], v[160:163]
    ds_read_b64_tr_b16 a[240:241], v30 offset:32768
    ds_read_b64_tr_b16 a[242:243], v30 offset:36864
    v_mfma_f32_16x16x32_bf16 v[160:163], a[252:255], a[16:19], v[160:163]
    v_mfma_f32_16x16x32_bf16 v[164:167], a[252:255], a[20:23], v[164:167]
    buffer_load_dwordx4 v3, s[28:31], s68 offen offset:1024  lds
    v_mfma_f32_16x16x32_bf16 v[164:167], a[248:251], a[212:215], v[164:167]
    v_mfma_f32_16x16x32_bf16 v[168:171], a[248:251], a[216:219], v[168:171]
    ds_read_b64_tr_b16 a[244:245], v30 offset:40960
    ds_read_b64_tr_b16 a[246:247], v30 offset:45056
    v_mfma_f32_16x16x32_bf16 v[168:171], a[252:255], a[24:27], v[168:171]
    v_mfma_f32_16x16x32_bf16 v[172:175], a[252:255], a[28:31], v[172:175]
    buffer_load_dwordx4 a[132:135], v1, s[4:7], s46 offen offset:1024 sc1
    v_mfma_f32_16x16x32_bf16 v[172:175], a[248:251], a[220:223], v[172:175]
    s_waitcnt lgkmcnt(4)
    v_mfma_f32_16x16x32_bf16 v[188:191], a[232:235], a[220:223], v[188:191]
    ds_read_b64_tr_b16 a[248:249], v31 offset:32768
    ds_read_b64_tr_b16 a[250:251], v31 offset:36864
    v_mfma_f32_16x16x32_bf16 v[188:191], a[236:239], a[28:31], v[188:191]
    v_mfma_f32_16x16x32_bf16 v[184:187], a[236:239], a[24:27], v[184:187]
    buffer_load_dwordx4 a[136:139], v1, s[4:7], s46 offen offset:2048 sc1
    v_mfma_f32_16x16x32_bf16 v[184:187], a[232:235], a[216:219], v[184:187]
    v_mfma_f32_16x16x32_bf16 v[180:183], a[232:235], a[212:215], v[180:183]
    ds_read_b64_tr_b16 a[252:253], v31 offset:40960
    ds_read_b64_tr_b16 a[254:255], v31 offset:45056
    v_mfma_f32_16x16x32_bf16 v[180:183], a[236:239], a[20:23], v[180:183]
    v_mfma_f32_16x16x32_bf16 v[176:179], a[236:239], a[16:19], v[176:179]
    buffer_load_dwordx4 a[140:143], v1, s[4:7], s46 offen offset:3072 sc1
    v_mfma_f32_16x16x32_bf16 v[176:179], a[232:235], a[208:211], v[176:179]
    s_waitcnt lgkmcnt(4)
    v_mfma_f32_16x16x32_bf16 v[192:195], a[240:243], a[208:211], v[192:195]
    ds_read_b64_tr_b16 a[232:233], v32 offset:32768
    ds_read_b64_tr_b16 a[234:235], v32 offset:36864
    v_mfma_f32_16x16x32_bf16 v[192:195], a[244:247], a[16:19], v[192:195]
    v_mfma_f32_16x16x32_bf16 v[196:199], a[244:247], a[20:23], v[196:199]
    buffer_load_dwordx4 v4, s[28:31], s68 offen offset:2048  lds
    v_mfma_f32_16x16x32_bf16 v[196:199], a[240:243], a[212:215], v[196:199]
    v_mfma_f32_16x16x32_bf16 v[200:203], a[240:243], a[216:219], v[200:203]
    ds_read_b64_tr_b16 a[236:237], v32 offset:40960
    ds_read_b64_tr_b16 a[238:239], v32 offset:45056
    v_mfma_f32_16x16x32_bf16 v[200:203], a[244:247], a[24:27], v[200:203]
    v_mfma_f32_16x16x32_bf16 v[204:207], a[244:247], a[28:31], v[204:207]
    v_mfma_f32_16x16x32_bf16 v[204:207], a[240:243], a[220:223], v[204:207]
    s_waitcnt lgkmcnt(4)
    v_mfma_f32_16x16x32_bf16 v[220:223], a[248:251], a[220:223], v[220:223]
    ds_read_b64_tr_b16 a[240:241], v33 offset:32768
    ds_read_b64_tr_b16 a[242:243], v33 offset:36864
    v_mfma_f32_16x16x32_bf16 v[220:223], a[252:255], a[28:31], v[220:223]
    s_xor_b32 s46, s69, 180224
    v_mfma_f32_16x16x32_bf16 v[216:219], a[252:255], a[24:27], v[216:219]
    buffer_load_dwordx4 a[176:179], v1, s[4:7], s46 offen offset:0 sc1
    v_mfma_f32_16x16x32_bf16 v[216:219], a[248:251], a[216:219], v[216:219]
    v_mfma_f32_16x16x32_bf16 v[212:215], a[248:251], a[212:215], v[212:215]
    ds_read_b64_tr_b16 a[244:245], v33 offset:40960
    ds_read_b64_tr_b16 a[246:247], v33 offset:45056
    v_mfma_f32_16x16x32_bf16 v[212:215], a[252:255], a[20:23], v[212:215]
    v_mfma_f32_16x16x32_bf16 v[208:211], a[252:255], a[16:19], v[208:211]
    buffer_load_dwordx4 a[180:183], v1, s[4:7], s46 offen offset:1024 sc1
    v_mfma_f32_16x16x32_bf16 v[208:211], a[248:251], a[208:211], v[208:211]
    s_waitcnt lgkmcnt(4)
    v_mfma_f32_16x16x32_bf16 v[224:227], a[232:235], a[208:211], v[224:227]
    ds_read_b64_tr_b16 a[248:249], v26 offset:49152
    ds_read_b64_tr_b16 a[250:251], v26 offset:53248
    v_mfma_f32_16x16x32_bf16 v[224:227], a[236:239], a[16:19], v[224:227]
    v_mfma_f32_16x16x32_bf16 v[228:231], a[236:239], a[20:23], v[228:231]
    buffer_load_dwordx4 v5, s[28:31], s68 offen offset:3072  lds
    v_mfma_f32_16x16x32_bf16 v[228:231], a[232:235], a[212:215], v[228:231]
    v_mfma_f32_16x16x32_bf16 v[232:235], a[232:235], a[216:219], v[232:235]
    ds_read_b64_tr_b16 a[252:253], v26 offset:57344
    ds_read_b64_tr_b16 a[254:255], v26 offset:61440
    v_mfma_f32_16x16x32_bf16 v[232:235], a[236:239], a[24:27], v[232:235]
    v_mfma_f32_16x16x32_bf16 v[236:239], a[236:239], a[28:31], v[236:239]
    buffer_load_dwordx4 a[184:187], v1, s[4:7], s46 offen offset:2048 sc1
    v_mfma_f32_16x16x32_bf16 v[236:239], a[232:235], a[220:223], v[236:239]
    s_waitcnt lgkmcnt(4)
    v_mfma_f32_16x16x32_bf16 v[252:255], a[240:243], a[220:223], v[252:255]
    ds_read_b64_tr_b16 a[232:233], v27 offset:49152
    ds_read_b64_tr_b16 a[234:235], v27 offset:53248
    v_mfma_f32_16x16x32_bf16 v[252:255], a[244:247], a[28:31], v[252:255]
    v_mfma_f32_16x16x32_bf16 v[248:251], a[244:247], a[24:27], v[248:251]
    buffer_load_dwordx4 a[188:191], v1, s[4:7], s46 offen offset:3072 sc1
    v_mfma_f32_16x16x32_bf16 v[248:251], a[240:243], a[216:219], v[248:251]
    v_mfma_f32_16x16x32_bf16 v[244:247], a[240:243], a[212:215], v[244:247]
    ds_read_b64_tr_b16 a[236:237], v27 offset:57344
    ds_read_b64_tr_b16 a[238:239], v27 offset:61440
    v_mfma_f32_16x16x32_bf16 v[244:247], a[244:247], a[20:23], v[244:247]
    s_xor_b32 s46, s69, 184320
    v_mfma_f32_16x16x32_bf16 v[240:243], a[244:247], a[16:19], v[240:243]
    buffer_load_dwordx4 a[192:195], v1, s[4:7], s46 offen offset:0 sc1
    v_mfma_f32_16x16x32_bf16 v[240:243], a[240:243], a[208:211], v[240:243]
    s_waitcnt vmcnt(37) lgkmcnt(4)
    v_mfma_f32_16x16x32_bf16 v[128:131], a[248:251], a[32:35], v[128:131]
    s_add_u32 s68, s45, 163840
    ds_read_b64_tr_b16 a[240:241], v28 offset:49152
    ds_read_b64_tr_b16 a[242:243], v28 offset:53248
    v_mfma_f32_16x16x32_bf16 v[128:131], a[252:255], a[48:51], v[128:131]
    s_add_u32 m0, s64, 36864
    v_mfma_f32_16x16x32_bf16 v[132:135], a[252:255], a[52:55], v[132:135]
    buffer_load_dwordx4 v2, s[28:31], s68 offen offset:0  lds
    v_mfma_f32_16x16x32_bf16 v[132:135], a[248:251], a[36:39], v[132:135]
    v_mfma_f32_16x16x32_bf16 v[136:139], a[248:251], a[40:43], v[136:139]
    ds_read_b64_tr_b16 a[244:245], v28 offset:57344
    ds_read_b64_tr_b16 a[246:247], v28 offset:61440
    v_mfma_f32_16x16x32_bf16 v[136:139], a[252:255], a[56:59], v[136:139]
    v_mfma_f32_16x16x32_bf16 v[140:143], a[252:255], a[60:63], v[140:143]
    v_mfma_f32_16x16x32_bf16 v[140:143], a[248:251], a[44:47], v[140:143]
    s_waitcnt lgkmcnt(4)
    v_mfma_f32_16x16x32_bf16 v[156:159], a[232:235], a[44:47], v[156:159]
    ds_read_b64_tr_b16 a[248:249], v29 offset:49152
    ds_read_b64_tr_b16 a[250:251], v29 offset:53248
    v_mfma_f32_16x16x32_bf16 v[156:159], a[236:239], a[60:63], v[156:159]
    v_mfma_f32_16x16x32_bf16 v[152:155], a[236:239], a[56:59], v[152:155]
    buffer_load_dwordx4 a[196:199], v1, s[4:7], s46 offen offset:1024 sc1
    v_mfma_f32_16x16x32_bf16 v[152:155], a[232:235], a[40:43], v[152:155]
    v_mfma_f32_16x16x32_bf16 v[148:151], a[232:235], a[36:39], v[148:151]
    ds_read_b64_tr_b16 a[252:253], v29 offset:57344
    ds_read_b64_tr_b16 a[254:255], v29 offset:61440
    v_mfma_f32_16x16x32_bf16 v[148:151], a[236:239], a[52:55], v[148:151]
    v_mfma_f32_16x16x32_bf16 v[144:147], a[236:239], a[48:51], v[144:147]
    buffer_load_dwordx4 a[200:203], v1, s[4:7], s46 offen offset:2048 sc1
    v_mfma_f32_16x16x32_bf16 v[144:147], a[232:235], a[32:35], v[144:147]
    s_waitcnt lgkmcnt(4)
    v_mfma_f32_16x16x32_bf16 v[160:163], a[240:243], a[32:35], v[160:163]
    ds_read_b64_tr_b16 a[232:233], v30 offset:49152
    ds_read_b64_tr_b16 a[234:235], v30 offset:53248
    v_mfma_f32_16x16x32_bf16 v[160:163], a[244:247], a[48:51], v[160:163]
    v_mfma_f32_16x16x32_bf16 v[164:167], a[244:247], a[52:55], v[164:167]
    buffer_load_dwordx4 v3, s[28:31], s68 offen offset:1024  lds
    v_mfma_f32_16x16x32_bf16 v[164:167], a[240:243], a[36:39], v[164:167]
    v_mfma_f32_16x16x32_bf16 v[168:171], a[240:243], a[40:43], v[168:171]
    ds_read_b64_tr_b16 a[236:237], v30 offset:57344
    ds_read_b64_tr_b16 a[238:239], v30 offset:61440
    v_mfma_f32_16x16x32_bf16 v[168:171], a[244:247], a[56:59], v[168:171]
    v_mfma_f32_16x16x32_bf16 v[172:175], a[244:247], a[60:63], v[172:175]
    buffer_load_dwordx4 a[204:207], v1, s[4:7], s46 offen offset:3072 sc1
    v_mfma_f32_16x16x32_bf16 v[172:175], a[240:243], a[44:47], v[172:175]
    s_waitcnt lgkmcnt(4)
    v_mfma_f32_16x16x32_bf16 v[188:191], a[248:251], a[44:47], v[188:191]
    ds_read_b64_tr_b16 a[240:241], v31 offset:49152
    ds_read_b64_tr_b16 a[242:243], v31 offset:53248
    v_mfma_f32_16x16x32_bf16 v[188:191], a[252:255], a[60:63], v[188:191]
    s_xor_b32 s46, s48, 0
    v_mfma_f32_16x16x32_bf16 v[184:187], a[252:255], a[56:59], v[184:187]
    buffer_load_dwordx4 a[16:19], v1, s[4:7], s46 offen offset:0 sc1
    v_mfma_f32_16x16x32_bf16 v[184:187], a[248:251], a[40:43], v[184:187]
    v_mfma_f32_16x16x32_bf16 v[180:183], a[248:251], a[36:39], v[180:183]
    ds_read_b64_tr_b16 a[244:245], v31 offset:57344
    ds_read_b64_tr_b16 a[246:247], v31 offset:61440
    v_mfma_f32_16x16x32_bf16 v[180:183], a[252:255], a[52:55], v[180:183]
    v_mfma_f32_16x16x32_bf16 v[176:179], a[252:255], a[48:51], v[176:179]
    buffer_load_dwordx4 a[20:23], v1, s[4:7], s46 offen offset:1024 sc1
    v_mfma_f32_16x16x32_bf16 v[176:179], a[248:251], a[32:35], v[176:179]
    s_waitcnt lgkmcnt(4)
    v_mfma_f32_16x16x32_bf16 v[192:195], a[232:235], a[32:35], v[192:195]
    ds_read_b64_tr_b16 a[248:249], v32 offset:49152
    ds_read_b64_tr_b16 a[250:251], v32 offset:53248
    v_mfma_f32_16x16x32_bf16 v[192:195], a[236:239], a[48:51], v[192:195]
    v_mfma_f32_16x16x32_bf16 v[196:199], a[236:239], a[52:55], v[196:199]
    buffer_load_dwordx4 v4, s[28:31], s68 offen offset:2048  lds
    v_mfma_f32_16x16x32_bf16 v[196:199], a[232:235], a[36:39], v[196:199]
    v_mfma_f32_16x16x32_bf16 v[200:203], a[232:235], a[40:43], v[200:203]
    ds_read_b64_tr_b16 a[252:253], v32 offset:57344
    ds_read_b64_tr_b16 a[254:255], v32 offset:61440
    v_mfma_f32_16x16x32_bf16 v[200:203], a[236:239], a[56:59], v[200:203]
    v_mfma_f32_16x16x32_bf16 v[204:207], a[236:239], a[60:63], v[204:207]
    v_mfma_f32_16x16x32_bf16 v[204:207], a[232:235], a[44:47], v[204:207]
    s_waitcnt lgkmcnt(4)
    v_mfma_f32_16x16x32_bf16 v[220:223], a[240:243], a[44:47], v[220:223]
    ds_read_b64_tr_b16 a[232:233], v33 offset:49152
    ds_read_b64_tr_b16 a[234:235], v33 offset:53248
    v_mfma_f32_16x16x32_bf16 v[220:223], a[244:247], a[60:63], v[220:223]
    buffer_load_dword v17, v16, s[4:7], s73 offen sc1
    v_mfma_f32_16x16x32_bf16 v[216:219], a[244:247], a[56:59], v[216:219]
    buffer_load_dwordx4 a[24:27], v1, s[4:7], s46 offen offset:2048 sc1
    v_mfma_f32_16x16x32_bf16 v[216:219], a[240:243], a[40:43], v[216:219]
    v_mfma_f32_16x16x32_bf16 v[212:215], a[240:243], a[36:39], v[212:215]
    ds_read_b64_tr_b16 a[236:237], v33 offset:57344
    ds_read_b64_tr_b16 a[238:239], v33 offset:61440
    v_mfma_f32_16x16x32_bf16 v[212:215], a[244:247], a[52:55], v[212:215]
    v_mfma_f32_16x16x32_bf16 v[208:211], a[244:247], a[48:51], v[208:211]
    buffer_load_dwordx4 a[28:31], v1, s[4:7], s46 offen offset:3072 sc1
    v_mfma_f32_16x16x32_bf16 v[208:211], a[240:243], a[32:35], v[208:211]
    s_waitcnt vmcnt(28) lgkmcnt(4)
    v_mfma_f32_16x16x32_bf16 v[224:227], a[248:251], a[32:35], v[224:227]
    s_barrier
    ds_read_b64_tr_b16 a[240:241], v18 offset:0
    ds_read_b64_tr_b16 a[242:243], v18 offset:4096
    v_mfma_f32_16x16x32_bf16 v[224:227], a[252:255], a[48:51], v[224:227]
    v_mfma_f32_16x16x32_bf16 v[228:231], a[252:255], a[52:55], v[228:231]
    buffer_load_dwordx4 v5, s[28:31], s68 offen offset:3072  lds
    v_mfma_f32_16x16x32_bf16 v[228:231], a[248:251], a[36:39], v[228:231]
    v_mfma_f32_16x16x32_bf16 v[232:235], a[248:251], a[40:43], v[232:235]
    ds_read_b64_tr_b16 a[244:245], v18 offset:8192
    ds_read_b64_tr_b16 a[246:247], v18 offset:12288
    v_mfma_f32_16x16x32_bf16 v[232:235], a[252:255], a[56:59], v[232:235]
    s_xor_b32 s46, s48, 4096
    v_mfma_f32_16x16x32_bf16 v[236:239], a[252:255], a[60:63], v[236:239]
    buffer_load_dwordx4 a[208:211], v1, s[4:7], s46 offen offset:0 sc1
    v_mfma_f32_16x16x32_bf16 v[236:239], a[248:251], a[44:47], v[236:239]
    s_waitcnt lgkmcnt(4)
    v_mfma_f32_16x16x32_bf16 v[252:255], a[232:235], a[44:47], v[252:255]
    ds_read_b64_tr_b16 a[248:249], v19 offset:0
    ds_read_b64_tr_b16 a[250:251], v19 offset:4096
    v_mfma_f32_16x16x32_bf16 v[252:255], a[236:239], a[60:63], v[252:255]
    v_mfma_f32_16x16x32_bf16 v[248:251], a[236:239], a[56:59], v[248:251]
    buffer_load_dwordx4 a[212:215], v1, s[4:7], s46 offen offset:1024 sc1
    v_mfma_f32_16x16x32_bf16 v[248:251], a[232:235], a[40:43], v[248:251]
    v_mfma_f32_16x16x32_bf16 v[244:247], a[232:235], a[36:39], v[244:247]
    ds_read_b64_tr_b16 a[252:253], v19 offset:8192
    ds_read_b64_tr_b16 a[254:255], v19 offset:12288
    v_mfma_f32_16x16x32_bf16 v[244:247], a[236:239], a[52:55], v[244:247]
    v_mfma_f32_16x16x32_bf16 v[240:243], a[236:239], a[48:51], v[240:243]
    buffer_load_dwordx4 a[216:219], v1, s[4:7], s46 offen offset:2048 sc1
    v_mfma_f32_16x16x32_bf16 v[240:243], a[232:235], a[32:35], v[240:243]
    s_waitcnt lgkmcnt(4)
    v_mfma_f32_16x16x32_bf16 v[128:131], a[240:243], a[144:147], v[128:131]
    s_add_u32 s68, s66, 0
    ds_read_b64_tr_b16 a[232:233], v20 offset:0
    ds_read_b64_tr_b16 a[234:235], v20 offset:4096
    v_mfma_f32_16x16x32_bf16 v[128:131], a[244:247], a[64:67], v[128:131]
    s_add_u32 m0, s64, 65536
    v_mfma_f32_16x16x32_bf16 v[132:135], a[244:247], a[68:71], v[132:135]
    buffer_load_dwordx4 v2, s[28:31], s68 offen offset:0  lds
    v_mfma_f32_16x16x32_bf16 v[132:135], a[240:243], a[148:151], v[132:135]
    v_mfma_f32_16x16x32_bf16 v[136:139], a[240:243], a[152:155], v[136:139]
    ds_read_b64_tr_b16 a[236:237], v20 offset:8192
    ds_read_b64_tr_b16 a[238:239], v20 offset:12288
    v_mfma_f32_16x16x32_bf16 v[136:139], a[244:247], a[72:75], v[136:139]
    v_mfma_f32_16x16x32_bf16 v[140:143], a[244:247], a[76:79], v[140:143]
    v_mfma_f32_16x16x32_bf16 v[140:143], a[240:243], a[156:159], v[140:143]
    s_waitcnt lgkmcnt(4)
    v_mfma_f32_16x16x32_bf16 v[156:159], a[248:251], a[156:159], v[156:159]
    ds_read_b64_tr_b16 a[240:241], v21 offset:0
    ds_read_b64_tr_b16 a[242:243], v21 offset:4096
    v_mfma_f32_16x16x32_bf16 v[156:159], a[252:255], a[76:79], v[156:159]
    v_mfma_f32_16x16x32_bf16 v[152:155], a[252:255], a[72:75], v[152:155]
    buffer_load_dwordx4 a[220:223], v1, s[4:7], s46 offen offset:3072 sc1
    v_mfma_f32_16x16x32_bf16 v[152:155], a[248:251], a[152:155], v[152:155]
    v_mfma_f32_16x16x32_bf16 v[148:151], a[248:251], a[148:151], v[148:151]
    ds_read_b64_tr_b16 a[244:245], v21 offset:8192
    ds_read_b64_tr_b16 a[246:247], v21 offset:12288
    v_mfma_f32_16x16x32_bf16 v[148:151], a[252:255], a[68:71], v[148:151]
    s_xor_b32 s46, s48, 16384
    v_mfma_f32_16x16x32_bf16 v[144:147], a[252:255], a[64:67], v[144:147]
    buffer_load_dwordx4 a[32:35], v1, s[4:7], s46 offen offset:0 sc1
    v_mfma_f32_16x16x32_bf16 v[144:147], a[248:251], a[144:147], v[144:147]
    s_waitcnt lgkmcnt(4)
    v_mfma_f32_16x16x32_bf16 v[160:163], a[232:235], a[144:147], v[160:163]
    ds_read_b64_tr_b16 a[248:249], v22 offset:0
    ds_read_b64_tr_b16 a[250:251], v22 offset:4096
    v_mfma_f32_16x16x32_bf16 v[160:163], a[236:239], a[64:67], v[160:163]
    s_add_u32 s68, s66, 8192
    v_mfma_f32_16x16x32_bf16 v[164:167], a[236:239], a[68:71], v[164:167]
    buffer_load_dwordx4 v3, s[28:31], s68 offen offset:1024  lds
    v_mfma_f32_16x16x32_bf16 v[164:167], a[232:235], a[148:151], v[164:167]
    v_mfma_f32_16x16x32_bf16 v[168:171], a[232:235], a[152:155], v[168:171]
    ds_read_b64_tr_b16 a[252:253], v22 offset:8192
    ds_read_b64_tr_b16 a[254:255], v22 offset:12288
    v_mfma_f32_16x16x32_bf16 v[168:171], a[236:239], a[72:75], v[168:171]
    v_mfma_f32_16x16x32_bf16 v[172:175], a[236:239], a[76:79], v[172:175]
    buffer_load_dwordx4 a[36:39], v1, s[4:7], s46 offen offset:1024 sc1
    v_mfma_f32_16x16x32_bf16 v[172:175], a[232:235], a[156:159], v[172:175]
    s_waitcnt lgkmcnt(4)
    v_mfma_f32_16x16x32_bf16 v[188:191], a[240:243], a[156:159], v[188:191]
    ds_read_b64_tr_b16 a[232:233], v23 offset:0
    ds_read_b64_tr_b16 a[234:235], v23 offset:4096
    v_mfma_f32_16x16x32_bf16 v[188:191], a[244:247], a[76:79], v[188:191]
    v_mfma_f32_16x16x32_bf16 v[184:187], a[244:247], a[72:75], v[184:187]
    buffer_load_dwordx4 a[40:43], v1, s[4:7], s46 offen offset:2048 sc1
    v_mfma_f32_16x16x32_bf16 v[184:187], a[240:243], a[152:155], v[184:187]
    v_mfma_f32_16x16x32_bf16 v[180:183], a[240:243], a[148:151], v[180:183]
    ds_read_b64_tr_b16 a[236:237], v23 offset:8192
    ds_read_b64_tr_b16 a[238:239], v23 offset:12288
    v_mfma_f32_16x16x32_bf16 v[180:183], a[244:247], a[68:71], v[180:183]
    v_mfma_f32_16x16x32_bf16 v[176:179], a[244:247], a[64:67], v[176:179]
    buffer_load_dwordx4 a[44:47], v1, s[4:7], s46 offen offset:3072 sc1
    v_mfma_f32_16x16x32_bf16 v[176:179], a[240:243], a[144:147], v[176:179]
    s_waitcnt lgkmcnt(4)
    v_mfma_f32_16x16x32_bf16 v[192:195], a[248:251], a[144:147], v[192:195]
    ds_read_b64_tr_b16 a[240:241], v24 offset:0
    ds_read_b64_tr_b16 a[242:243], v24 offset:4096
    v_mfma_f32_16x16x32_bf16 v[192:195], a[252:255], a[64:67], v[192:195]
    s_add_u32 s68, s66, 16384
    v_mfma_f32_16x16x32_bf16 v[196:199], a[252:255], a[68:71], v[196:199]
    buffer_load_dwordx4 v4, s[28:31], s68 offen offset:2048  lds
    v_mfma_f32_16x16x32_bf16 v[196:199], a[248:251], a[148:151], v[196:199]
    v_mfma_f32_16x16x32_bf16 v[200:203], a[248:251], a[152:155], v[200:203]
    ds_read_b64_tr_b16 a[244:245], v24 offset:8192
    ds_read_b64_tr_b16 a[246:247], v24 offset:12288
    v_mfma_f32_16x16x32_bf16 v[200:203], a[252:255], a[72:75], v[200:203]
    v_mfma_f32_16x16x32_bf16 v[204:207], a[252:255], a[76:79], v[204:207]
    v_mfma_f32_16x16x32_bf16 v[204:207], a[248:251], a[156:159], v[204:207]
    s_waitcnt lgkmcnt(4)
    v_mfma_f32_16x16x32_bf16 v[220:223], a[232:235], a[156:159], v[220:223]
    s_waitcnt vmcnt(14)
    ds_read_b64_tr_b16 a[248:249], v25 offset:0
    ds_read_b64_tr_b16 a[250:251], v25 offset:4096
    v_mfma_f32_16x16x32_bf16 v[220:223], a[236:239], a[76:79], v[220:223]
    s_xor_b32 s46, s48, 20480
    v_subrev_u32 v17, s79, v17
    v_subrev_u32 v17, 4, v17
    v_mfma_f32_16x16x32_bf16 v[216:219], a[236:239], a[72:75], v[216:219]
    buffer_load_dwordx4 a[48:51], v1, s[4:7], s46 offen offset:0 sc1
    v_mfma_f32_16x16x32_bf16 v[216:219], a[232:235], a[152:155], v[216:219]
    v_cmp_lt_u32 vcc, 3, v17
    s_cbranch_vccnz SLOW_FA4
BACK_FA4:
    v_mfma_f32_16x16x32_bf16 v[212:215], a[232:235], a[148:151], v[212:215]
    ds_read_b64_tr_b16 a[252:253], v25 offset:8192
    ds_read_b64_tr_b16 a[254:255], v25 offset:12288
    v_mfma_f32_16x16x32_bf16 v[212:215], a[236:239], a[68:71], v[212:215]
    v_mfma_f32_16x16x32_bf16 v[208:211], a[236:239], a[64:67], v[208:211]
    buffer_load_dwordx4 a[52:55], v1, s[4:7], s46 offen offset:1024 sc1
    v_mfma_f32_16x16x32_bf16 v[208:211], a[232:235], a[144:147], v[208:211]
    s_waitcnt lgkmcnt(4)
    v_mfma_f32_16x16x32_bf16 v[224:227], a[240:243], a[144:147], v[224:227]
    ds_read_b64_tr_b16 a[232:233], v18 offset:16384
    ds_read_b64_tr_b16 a[234:235], v18 offset:20480
    v_mfma_f32_16x16x32_bf16 v[224:227], a[244:247], a[64:67], v[224:227]
    s_add_u32 s68, s66, 24576
    v_mfma_f32_16x16x32_bf16 v[228:231], a[244:247], a[68:71], v[228:231]
    buffer_load_dwordx4 v5, s[28:31], s68 offen offset:3072  lds
    v_mfma_f32_16x16x32_bf16 v[228:231], a[240:243], a[148:151], v[228:231]
    v_mfma_f32_16x16x32_bf16 v[232:235], a[240:243], a[152:155], v[232:235]
    ds_read_b64_tr_b16 a[236:237], v18 offset:24576
    ds_read_b64_tr_b16 a[238:239], v18 offset:28672
    v_mfma_f32_16x16x32_bf16 v[232:235], a[244:247], a[72:75], v[232:235]
    v_mfma_f32_16x16x32_bf16 v[236:239], a[244:247], a[76:79], v[236:239]
    buffer_load_dwordx4 a[56:59], v1, s[4:7], s46 offen offset:2048 sc1
    v_mfma_f32_16x16x32_bf16 v[236:239], a[240:243], a[156:159], v[236:239]
    s_waitcnt lgkmcnt(4)
    v_mfma_f32_16x16x32_bf16 v[252:255], a[248:251], a[156:159], v[252:255]
    ds_read_b64_tr_b16 a[240:241], v19 offset:16384
    ds_read_b64_tr_b16 a[242:243], v19 offset:20480
    v_mfma_f32_16x16x32_bf16 v[252:255], a[252:255], a[76:79], v[252:255]
    v_mfma_f32_16x16x32_bf16 v[248:251], a[252:255], a[72:75], v[248:251]
    buffer_load_dwordx4 a[60:63], v1, s[4:7], s46 offen offset:3072 sc1
    v_mfma_f32_16x16x32_bf16 v[248:251], a[248:251], a[152:155], v[248:251]
    v_mfma_f32_16x16x32_bf16 v[244:247], a[248:251], a[148:151], v[244:247]
    ds_read_b64_tr_b16 a[244:245], v19 offset:24576
    ds_read_b64_tr_b16 a[246:247], v19 offset:28672
    v_mfma_f32_16x16x32_bf16 v[244:247], a[252:255], a[68:71], v[244:247]
    v_mfma_f32_16x16x32_bf16 v[240:243], a[252:255], a[64:67], v[240:243]
    v_mfma_f32_16x16x32_bf16 v[240:243], a[248:251], a[144:147], v[240:243]
    s_waitcnt lgkmcnt(4)
    v_mfma_f32_16x16x32_bf16 v[128:131], a[232:235], a[0:3], v[128:131]
    s_add_u32 s68, s66, 8192
    ds_read_b64_tr_b16 a[248:249], v20 offset:16384
    ds_read_b64_tr_b16 a[250:251], v20 offset:20480
    v_mfma_f32_16x16x32_bf16 v[128:131], a[236:239], a[80:83], v[128:131]
    s_add_u32 m0, s64, 69632
    v_mfma_f32_16x16x32_bf16 v[132:135], a[236:239], a[84:87], v[132:135]
    buffer_load_dwordx4 v2, s[28:31], s68 offen offset:0  lds
    v_mfma_f32_16x16x32_bf16 v[132:135], a[232:235], a[4:7], v[132:135]
    v_mfma_f32_16x16x32_bf16 v[136:139], a[232:235], a[8:11], v[136:139]
    ds_read_b64_tr_b16 a[252:253], v20 offset:24576
    ds_read_b64_tr_b16 a[254:255], v20 offset:28672
    v_mfma_f32_16x16x32_bf16 v[136:139], a[236:239], a[88:91], v[136:139]
    s_xor_b32 s46, s69, 200704
    v_mfma_f32_16x16x32_bf16 v[140:143], a[236:239], a[92:95], v[140:143]
    buffer_load_dwordx4 a[64:67], v1, s[4:7], s46 offen offset:0 sc1
    v_mfma_f32_16x16x32_bf16 v[140:143], a[232:235], a[12:15], v[140:143]
    s_waitcnt lgkmcnt(4)
    v_mfma_f32_16x16x32_bf16 v[156:159], a[240:243], a[12:15], v[156:159]
    ds_read_b64_tr_b16 a[232:233], v21 offset:16384
    ds_read_b64_tr_b16 a[234:235], v21 offset:20480
    v_mfma_f32_16x16x32_bf16 v[156:159], a[244:247], a[92:95], v[156:159]
    v_mfma_f32_16x16x32_bf16 v[152:155], a[244:247], a[88:91], v[152:155]
    buffer_load_dwordx4 a[68:71], v1, s[4:7], s46 offen offset:1024 sc1
    v_mfma_f32_16x16x32_bf16 v[152:155], a[240:243], a[8:11], v[152:155]
    v_mfma_f32_16x16x32_bf16 v[148:151], a[240:243], a[4:7], v[148:151]
    ds_read_b64_tr_b16 a[236:237], v21 offset:24576
    ds_read_b64_tr_b16 a[238:239], v21 offset:28672
    v_mfma_f32_16x16x32_bf16 v[148:151], a[244:247], a[84:87], v[148:151]
    v_mfma_f32_16x16x32_bf16 v[144:147], a[244:247], a[80:83], v[144:147]
    buffer_load_dwordx4 a[72:75], v1, s[4:7], s46 offen offset:2048 sc1
    v_mfma_f32_16x16x32_bf16 v[144:147], a[240:243], a[0:3], v[144:147]
    s_waitcnt lgkmcnt(4)
    v_mfma_f32_16x16x32_bf16 v[160:163], a[248:251], a[0:3], v[160:163]
    ds_read_b64_tr_b16 a[240:241], v22 offset:16384
    ds_read_b64_tr_b16 a[242:243], v22 offset:20480
    v_mfma_f32_16x16x32_bf16 v[160:163], a[252:255], a[80:83], v[160:163]
    s_add_u32 s68, s66, 16384
    v_mfma_f32_16x16x32_bf16 v[164:167], a[252:255], a[84:87], v[164:167]
    buffer_load_dwordx4 v3, s[28:31], s68 offen offset:1024  lds
    v_mfma_f32_16x16x32_bf16 v[164:167], a[248:251], a[4:7], v[164:167]
    v_mfma_f32_16x16x32_bf16 v[168:171], a[248:251], a[8:11], v[168:171]
    ds_read_b64_tr_b16 a[244:245], v22 offset:24576
    ds_read_b64_tr_b16 a[246:247], v22 offset:28672
    v_mfma_f32_16x16x32_bf16 v[168:171], a[252:255], a[88:91], v[168:171]
    v_mfma_f32_16x16x32_bf16 v[172:175], a[252:255], a[92:95], v[172:175]
    buffer_load_dwordx4 a[76:79], v1, s[4:7], s46 offen offset:3072 sc1
    v_mfma_f32_16x16x32_bf16 v[172:175], a[248:251], a[12:15], v[172:175]
    s_waitcnt lgkmcnt(4)
    v_mfma_f32_16x16x32_bf16 v[188:191], a[232:235], a[12:15], v[188:191]
    ds_read_b64_tr_b16 a[248:249], v23 offset:16384
    ds_read_b64_tr_b16 a[250:251], v23 offset:20480
    v_mfma_f32_16x16x32_bf16 v[188:191], a[236:239], a[92:95], v[188:191]
    s_xor_b32 s46, s69, 212992
    v_mfma_f32_16x16x32_bf16 v[184:187], a[236:239], a[88:91], v[184:187]
    buffer_load_dwordx4 a[144:147], v1, s[4:7], s46 offen offset:0 sc1
    v_mfma_f32_16x16x32_bf16 v[184:187], a[232:235], a[8:11], v[184:187]
    v_mfma_f32_16x16x32_bf16 v[180:183], a[232:235], a[4:7], v[180:183]
    ds_read_b64_tr_b16 a[252:253], v23 offset:24576
    ds_read_b64_tr_b16 a[254:255], v23 offset:28672
    v_mfma_f32_16x16x32_bf16 v[180:183], a[236:239], a[84:87], v[180:183]
    v_mfma_f32_16x16x32_bf16 v[176:179], a[236:239], a[80:83], v[176:179]
    v_mfma_f32_16x16x32_bf16 v[176:179], a[232:235], a[0:3], v[176:179]
    s_waitcnt lgkmcnt(4)
    v_mfma_f32_16x16x32_bf16 v[192:195], a[240:243], a[0:3], v[192:195]
    ds_read_b64_tr_b16 a[232:233], v24 offset:16384
    ds_read_b64_tr_b16 a[234:235], v24 offset:20480
    v_mfma_f32_16x16x32_bf16 v[192:195], a[244:247], a[80:83], v[192:195]
    s_add_u32 s68, s66, 24576
    v_mfma_f32_16x16x32_bf16 v[196:199], a[244:247], a[84:87], v[196:199]
    buffer_load_dwordx4 v4, s[28:31], s68 offen offset:2048  lds
    v_mfma_f32_16x16x32_bf16 v[196:199], a[240:243], a[4:7], v[196:199]
    v_mfma_f32_16x16x32_bf16 v[200:203], a[240:243], a[8:11], v[200:203]
    ds_read_b64_tr_b16 a[236:237], v24 offset:24576
    ds_read_b64_tr_b16 a[238:239], v24 offset:28672
    v_mfma_f32_16x16x32_bf16 v[200:203], a[244:247], a[88:91], v[200:203]
    v_mfma_f32_16x16x32_bf16 v[204:207], a[244:247], a[92:95], v[204:207]
    buffer_load_dwordx4 a[148:151], v1, s[4:7], s46 offen offset:1024 sc1
    v_mfma_f32_16x16x32_bf16 v[204:207], a[240:243], a[12:15], v[204:207]
    s_waitcnt lgkmcnt(4)
    v_mfma_f32_16x16x32_bf16 v[220:223], a[248:251], a[12:15], v[220:223]
    ds_read_b64_tr_b16 a[240:241], v25 offset:16384
    ds_read_b64_tr_b16 a[242:243], v25 offset:20480
    v_mfma_f32_16x16x32_bf16 v[220:223], a[252:255], a[92:95], v[220:223]
    v_mfma_f32_16x16x32_bf16 v[216:219], a[252:255], a[88:91], v[216:219]
    buffer_load_dwordx4 a[152:155], v1, s[4:7], s46 offen offset:2048 sc1
    v_mfma_f32_16x16x32_bf16 v[216:219], a[248:251], a[8:11], v[216:219]
    v_mfma_f32_16x16x32_bf16 v[212:215], a[248:251], a[4:7], v[212:215]
    ds_read_b64_tr_b16 a[244:245], v25 offset:24576
    ds_read_b64_tr_b16 a[246:247], v25 offset:28672
    v_mfma_f32_16x16x32_bf16 v[212:215], a[252:255], a[84:87], v[212:215]
    v_mfma_f32_16x16x32_bf16 v[208:211], a[252:255], a[80:83], v[208:211]
    buffer_load_dwordx4 a[156:159], v1, s[4:7], s46 offen offset:3072 sc1
    v_mfma_f32_16x16x32_bf16 v[208:211], a[248:251], a[0:3], v[208:211]
    s_waitcnt vmcnt(27) lgkmcnt(4)
    v_mfma_f32_16x16x32_bf16 v[224:227], a[232:235], a[0:3], v[224:227]
    s_barrier
    ds_read_b64_tr_b16 a[248:249], v18 offset:32768
    ds_read_b64_tr_b16 a[250:251], v18 offset:36864
    v_mfma_f32_16x16x32_bf16 v[224:227], a[236:239], a[80:83], v[224:227]
    s_add_u32 s68, s66, 32768
    v_mfma_f32_16x16x32_bf16 v[228:231], a[236:239], a[84:87], v[228:231]
    buffer_load_dwordx4 v5, s[28:31], s68 offen offset:3072  lds
    v_mfma_f32_16x16x32_bf16 v[228:231], a[232:235], a[4:7], v[228:231]
    v_mfma_f32_16x16x32_bf16 v[232:235], a[232:235], a[8:11], v[232:235]
    ds_read_b64_tr_b16 a[252:253], v18 offset:40960
    ds_read_b64_tr_b16 a[254:255], v18 offset:45056
    v_mfma_f32_16x16x32_bf16 v[232:235], a[236:239], a[88:91], v[232:235]
    v_mfma_f32_16x16x32_bf16 v[236:239], a[236:239], a[92:95], v[236:239]
    v_mfma_f32_16x16x32_bf16 v[236:239], a[232:235], a[12:15], v[236:239]
    s_waitcnt lgkmcnt(4)
    v_mfma_f32_16x16x32_bf16 v[252:255], a[240:243], a[12:15], v[252:255]
    ds_read_b64_tr_b16 a[232:233], v19 offset:32768
    ds_read_b64_tr_b16 a[234:235], v19 offset:36864
    v_mfma_f32_16x16x32_bf16 v[252:255], a[244:247], a[92:95], v[252:255]
    v_mfma_f32_16x16x32_bf16 v[248:251], a[244:247], a[88:91], v[248:251]
    v_mfma_f32_16x16x32_bf16 v[248:251], a[240:243], a[8:11], v[248:251]
    v_mfma_f32_16x16x32_bf16 v[244:247], a[240:243], a[4:7], v[244:247]
    ds_read_b64_tr_b16 a[236:237], v19 offset:40960
    ds_read_b64_tr_b16 a[238:239], v19 offset:45056
    v_mfma_f32_16x16x32_bf16 v[244:247], a[244:247], a[84:87], v[244:247]
    v_mfma_f32_16x16x32_bf16 v[240:243], a[244:247], a[80:83], v[240:243]
    v_mfma_f32_16x16x32_bf16 v[240:243], a[240:243], a[0:3], v[240:243]
    s_waitcnt lgkmcnt(4)
    v_mfma_f32_16x16x32_bf16 v[128:131], a[248:251], a[112:115], v[128:131]
    s_xor_b32 s68, s67, 0
    ds_read_b64_tr_b16 a[240:241], v20 offset:32768
    ds_read_b64_tr_b16 a[242:243], v20 offset:36864
    v_mfma_f32_16x16x32_bf16 v[128:131], a[252:255], a[128:131], v[128:131]
    s_add_u32 m0, s64, 98304
    v_mfma_f32_16x16x32_bf16 v[132:135], a[252:255], a[132:135], v[132:135]
    buffer_load_dwordx4 v34, s[20:23], s68 offen offset:0  lds
    v_mfma_f32_16x16x32_bf16 v[132:135], a[248:251], a[116:119], v[132:135]
    v_mfma_f32_16x16x32_bf16 v[136:139], a[248:251], a[120:123], v[136:139]
    ds_read_b64_tr_b16 a[244:245], v20 offset:40960
    ds_read_b64_tr_b16 a[246:247], v20 offset:45056
    v_mfma_f32_16x16x32_bf16 v[136:139], a[252:255], a[136:139], v[136:139]
    s_xor_b32 s46, s69, 217088
    v_mfma_f32_16x16x32_bf16 v[140:143], a[252:255], a[140:143], v[140:143]
    buffer_load_dwordx4 a[0:3], v1, s[4:7], s46 offen offset:0 sc1
    v_mfma_f32_16x16x32_bf16 v[140:143], a[248:251], a[124:127], v[140:143]
    s_waitcnt lgkmcnt(4)
    v_mfma_f32_16x16x32_bf16 v[156:159], a[232:235], a[124:127], v[156:159]
    ds_read_b64_tr_b16 a[248:249], v21 offset:32768
    ds_read_b64_tr_b16 a[250:251], v21 offset:36864
    v_mfma_f32_16x16x32_bf16 v[156:159], a[236:239], a[140:143], v[156:159]
    v_mfma_f32_16x16x32_bf16 v[152:155], a[236:239], a[136:139], v[152:155]
    buffer_load_dwordx4 v35, s[20:23], s68 offen offset:1024  lds
    v_mfma_f32_16x16x32_bf16 v[152:155], a[232:235], a[120:123], v[152:155]
    v_mfma_f32_16x16x32_bf16 v[148:151], a[232:235], a[116:119], v[148:151]
    ds_read_b64_tr_b16 a[252:253], v21 offset:40960
    ds_read_b64_tr_b16 a[254:255], v21 offset:45056
    v_mfma_f32_16x16x32_bf16 v[148:151], a[236:239], a[132:135], v[148:151]
    v_mfma_f32_16x16x32_bf16 v[144:147], a[236:239], a[128:131], v[144:147]
    buffer_load_dwordx4 a[4:7], v1, s[4:7], s46 offen offset:1024 sc1
    v_mfma_f32_16x16x32_bf16 v[144:147], a[232:235], a[112:115], v[144:147]
    s_waitcnt lgkmcnt(4)
    v_mfma_f32_16x16x32_bf16 v[160:163], a[240:243], a[112:115], v[160:163]
    ds_read_b64_tr_b16 a[232:233], v22 offset:32768
    ds_read_b64_tr_b16 a[234:235], v22 offset:36864
    v_mfma_f32_16x16x32_bf16 v[160:163], a[244:247], a[128:131], v[160:163]
    v_mfma_f32_16x16x32_bf16 v[164:167], a[244:247], a[132:135], v[164:167]
    buffer_load_dwordx4 v36, s[20:23], s68 offen offset:2048  lds
    v_mfma_f32_16x16x32_bf16 v[164:167], a[240:243], a[116:119], v[164:167]
    v_mfma_f32_16x16x32_bf16 v[168:171], a[240:243], a[120:123], v[168:171]
    ds_read_b64_tr_b16 a[236:237], v22 offset:40960
    ds_read_b64_tr_b16 a[238:239], v22 offset:45056
    v_mfma_f32_16x16x32_bf16 v[168:171], a[244:247], a[136:139], v[168:171]
    v_mfma_f32_16x16x32_bf16 v[172:175], a[244:247], a[140:143], v[172:175]
    buffer_load_dwordx4 a[8:11], v1, s[4:7], s46 offen offset:2048 sc1
    v_mfma_f32_16x16x32_bf16 v[172:175], a[240:243], a[124:127], v[172:175]
    s_waitcnt lgkmcnt(4)
    v_mfma_f32_16x16x32_bf16 v[188:191], a[248:251], a[124:127], v[188:191]
    ds_read_b64_tr_b16 a[240:241], v23 offset:32768
    ds_read_b64_tr_b16 a[242:243], v23 offset:36864
    v_mfma_f32_16x16x32_bf16 v[188:191], a[252:255], a[140:143], v[188:191]
    v_mfma_f32_16x16x32_bf16 v[184:187], a[252:255], a[136:139], v[184:187]
    buffer_load_dwordx4 a[12:15], v1, s[4:7], s46 offen offset:3072 sc1
    v_mfma_f32_16x16x32_bf16 v[184:187], a[248:251], a[120:123], v[184:187]
    v_mfma_f32_16x16x32_bf16 v[180:183], a[248:251], a[116:119], v[180:183]
    ds_read_b64_tr_b16 a[244:245], v23 offset:40960
    ds_read_b64_tr_b16 a[246:247], v23 offset:45056
    v_mfma_f32_16x16x32_bf16 v[180:183], a[252:255], a[132:135], v[180:183]
    v_mfma_f32_16x16x32_bf16 v[176:179], a[252:255], a[128:131], v[176:179]
    v_mfma_f32_16x16x32_bf16 v[176:179], a[248:251], a[112:115], v[176:179]
    s_waitcnt lgkmcnt(4)
    v_mfma_f32_16x16x32_bf16 v[192:195], a[232:235], a[112:115], v[192:195]
    ds_read_b64_tr_b16 a[248:249], v24 offset:32768
    ds_read_b64_tr_b16 a[250:251], v24 offset:36864
    v_mfma_f32_16x16x32_bf16 v[192:195], a[236:239], a[128:131], v[192:195]
    v_mfma_f32_16x16x32_bf16 v[196:199], a[236:239], a[132:135], v[196:199]
    buffer_load_dwordx4 v37, s[20:23], s68 offen offset:3072  lds
    v_mfma_f32_16x16x32_bf16 v[196:199], a[232:235], a[116:119], v[196:199]
    v_mfma_f32_16x16x32_bf16 v[200:203], a[232:235], a[120:123], v[200:203]
    ds_read_b64_tr_b16 a[252:253], v24 offset:40960
    ds_read_b64_tr_b16 a[254:255], v24 offset:45056
    v_mfma_f32_16x16x32_bf16 v[200:203], a[236:239], a[136:139], v[200:203]
    s_xor_b32 s46, s69, 229376
    v_mfma_f32_16x16x32_bf16 v[204:207], a[236:239], a[140:143], v[204:207]
    buffer_load_dwordx4 a[80:83], v1, s[4:7], s46 offen offset:0 sc1
    v_mfma_f32_16x16x32_bf16 v[204:207], a[232:235], a[124:127], v[204:207]
    s_waitcnt lgkmcnt(4)
    v_mfma_f32_16x16x32_bf16 v[220:223], a[240:243], a[124:127], v[220:223]
    s_xor_b32 s68, s67, 32768
    ds_read_b64_tr_b16 a[232:233], v25 offset:32768
    ds_read_b64_tr_b16 a[234:235], v25 offset:36864
    v_mfma_f32_16x16x32_bf16 v[220:223], a[244:247], a[140:143], v[220:223]
    s_add_u32 m0, s64, 102400
    v_mfma_f32_16x16x32_bf16 v[216:219], a[244:247], a[136:139], v[216:219]
    buffer_load_dwordx4 v34, s[20:23], s68 offen offset:0  lds
    v_mfma_f32_16x16x32_bf16 v[216:219], a[240:243], a[120:123], v[216:219]
    v_mfma_f32_16x16x32_bf16 v[212:215], a[240:243], a[116:119], v[212:215]
    ds_read_b64_tr_b16 a[236:237], v25 offset:40960
    ds_read_b64_tr_b16 a[238:239], v25 offset:45056
    v_mfma_f32_16x16x32_bf16 v[212:215], a[244:247], a[132:135], v[212:215]
    v_mfma_f32_16x16x32_bf16 v[208:211], a[244:247], a[128:131], v[208:211]
    buffer_load_dwordx4 a[84:87], v1, s[4:7], s46 offen offset:1024 sc1
    v_mfma_f32_16x16x32_bf16 v[208:211], a[240:243], a[112:115], v[208:211]
    s_waitcnt lgkmcnt(4)
    v_mfma_f32_16x16x32_bf16 v[224:227], a[248:251], a[112:115], v[224:227]
    ds_read_b64_tr_b16 a[240:241], v18 offset:49152
    ds_read_b64_tr_b16 a[242:243], v18 offset:53248
    v_mfma_f32_16x16x32_bf16 v[224:227], a[252:255], a[128:131], v[224:227]
    v_mfma_f32_16x16x32_bf16 v[228:231], a[252:255], a[132:135], v[228:231]
    buffer_load_dwordx4 v35, s[20:23], s68 offen offset:1024  lds
    v_mfma_f32_16x16x32_bf16 v[228:231], a[248:251], a[116:119], v[228:231]
    v_mfma_f32_16x16x32_bf16 v[232:235], a[248:251], a[120:123], v[232:235]
    ds_read_b64_tr_b16 a[244:245], v18 offset:57344
    ds_read_b64_tr_b16 a[246:247], v18 offset:61440
    v_mfma_f32_16x16x32_bf16 v[232:235], a[252:255], a[136:139], v[232:235]
    v_mfma_f32_16x16x32_bf16 v[236:239], a[252:255], a[140:143], v[236:239]
    buffer_load_dwordx4 a[88:91], v1, s[4:7], s46 offen offset:2048 sc1
    v_mfma_f32_16x16x32_bf16 v[236:239], a[248:251], a[124:127], v[236:239]
    s_waitcnt lgkmcnt(4)
    v_mfma_f32_16x16x32_bf16 v[252:255], a[232:235], a[124:127], v[252:255]
    ds_read_b64_tr_b16 a[248:249], v19 offset:49152
    ds_read_b64_tr_b16 a[250:251], v19 offset:53248
    v_mfma_f32_16x16x32_bf16 v[252:255], a[236:239], a[140:143], v[252:255]
    v_mfma_f32_16x16x32_bf16 v[248:251], a[236:239], a[136:139], v[248:251]
    buffer_load_dwordx4 a[92:95], v1, s[4:7], s46 offen offset:3072 sc1
    v_mfma_f32_16x16x32_bf16 v[248:251], a[232:235], a[120:123], v[248:251]
    v_mfma_f32_16x16x32_bf16 v[244:247], a[232:235], a[116:119], v[244:247]
    ds_read_b64_tr_b16 a[252:253], v19 offset:57344
    ds_read_b64_tr_b16 a[254:255], v19 offset:61440
    v_mfma_f32_16x16x32_bf16 v[244:247], a[236:239], a[132:135], v[244:247]
    v_mfma_f32_16x16x32_bf16 v[240:243], a[236:239], a[128:131], v[240:243]
    v_mfma_f32_16x16x32_bf16 v[240:243], a[232:235], a[112:115], v[240:243]
    s_waitcnt lgkmcnt(4)
    v_mfma_f32_16x16x32_bf16 v[128:131], a[240:243], a[176:179], v[128:131]
    ds_read_b64_tr_b16 a[232:233], v20 offset:49152
    ds_read_b64_tr_b16 a[234:235], v20 offset:53248
    v_mfma_f32_16x16x32_bf16 v[128:131], a[244:247], a[192:195], v[128:131]
    v_mfma_f32_16x16x32_bf16 v[132:135], a[244:247], a[196:199], v[132:135]
    buffer_load_dwordx4 v36, s[20:23], s68 offen offset:2048  lds
    v_mfma_f32_16x16x32_bf16 v[132:135], a[240:243], a[180:183], v[132:135]
    v_mfma_f32_16x16x32_bf16 v[136:139], a[240:243], a[184:187], v[136:139]
    ds_read_b64_tr_b16 a[236:237], v20 offset:57344
    ds_read_b64_tr_b16 a[238:239], v20 offset:61440
    v_mfma_f32_16x16x32_bf16 v[136:139], a[244:247], a[200:203], v[136:139]
    s_xor_b32 s46, s69, 233472
    v_mfma_f32_16x16x32_bf16 v[140:143], a[244:247], a[204:207], v[140:143]
    buffer_load_dwordx4 a[112:115], v1, s[4:7], s46 offen offset:0 sc1
    v_mfma_f32_16x16x32_bf16 v[140:143], a[240:243], a[188:191], v[140:143]
    s_waitcnt lgkmcnt(4)
    v_mfma_f32_16x16x32_bf16 v[156:159], a[248:251], a[188:191], v[156:159]
    ds_read_b64_tr_b16 a[240:241], v21 offset:49152
    ds_read_b64_tr_b16 a[242:243], v21 offset:53248
    v_mfma_f32_16x16x32_bf16 v[156:159], a[252:255], a[204:207], v[156:159]
    v_mfma_f32_16x16x32_bf16 v[152:155], a[252:255], a[200:203], v[152:155]
    buffer_load_dwordx4 v37, s[20:23], s68 offen offset:3072  lds
    v_mfma_f32_16x16x32_bf16 v[152:155], a[248:251], a[184:187], v[152:155]
    v_mfma_f32_16x16x32_bf16 v[148:151], a[248:251], a[180:183], v[148:151]
    ds_read_b64_tr_b16 a[244:245], v21 offset:57344
    ds_read_b64_tr_b16 a[246:247], v21 offset:61440
    v_mfma_f32_16x16x32_bf16 v[148:151], a[252:255], a[196:199], v[148:151]
    v_mfma_f32_16x16x32_bf16 v[144:147], a[252:255], a[192:195], v[144:147]
    buffer_load_dwordx4 a[116:119], v1, s[4:7], s46 offen offset:1024 sc1
    v_mfma_f32_16x16x32_bf16 v[144:147], a[248:251], a[176:179], v[144:147]
    s_waitcnt lgkmcnt(4)
    v_mfma_f32_16x16x32_bf16 v[160:163], a[232:235], a[176:179], v[160:163]
    s_xor_b32 s68, s67, 256
    ds_read_b64_tr_b16 a[248:249], v22 offset:49152
    ds_read_b64_tr_b16 a[250:251], v22 offset:53248
    v_mfma_f32_16x16x32_bf16 v[160:163], a[236:239], a[192:195], v[160:163]
    s_add_u32 m0, s64, 131072
    v_mfma_f32_16x16x32_bf16 v[164:167], a[236:239], a[196:199], v[164:167]
    buffer_load_dwordx4 v34, s[24:27], s68 offen offset:0  lds
    v_mfma_f32_16x16x32_bf16 v[164:167], a[232:235], a[180:183], v[164:167]
    v_mfma_f32_16x16x32_bf16 v[168:171], a[232:235], a[184:187], v[168:171]
    ds_read_b64_tr_b16 a[252:253], v22 offset:57344
    ds_read_b64_tr_b16 a[254:255], v22 offset:61440
    v_mfma_f32_16x16x32_bf16 v[168:171], a[236:239], a[200:203], v[168:171]
    v_mfma_f32_16x16x32_bf16 v[172:175], a[236:239], a[204:207], v[172:175]
    buffer_load_dwordx4 a[120:123], v1, s[4:7], s46 offen offset:2048 sc1
    v_mfma_f32_16x16x32_bf16 v[172:175], a[232:235], a[188:191], v[172:175]
    s_waitcnt lgkmcnt(4)
    v_mfma_f32_16x16x32_bf16 v[188:191], a[240:243], a[188:191], v[188:191]
    ds_read_b64_tr_b16 a[232:233], v23 offset:49152
    ds_read_b64_tr_b16 a[234:235], v23 offset:53248
    v_mfma_f32_16x16x32_bf16 v[188:191], a[244:247], a[204:207], v[188:191]
    v_mfma_f32_16x16x32_bf16 v[184:187], a[244:247], a[200:203], v[184:187]
    buffer_load_dwordx4 a[124:127], v1, s[4:7], s46 offen offset:3072 sc1
    v_mfma_f32_16x16x32_bf16 v[184:187], a[240:243], a[184:187], v[184:187]
    v_mfma_f32_16x16x32_bf16 v[180:183], a[240:243], a[180:183], v[180:183]
    ds_read_b64_tr_b16 a[236:237], v23 offset:57344
    ds_read_b64_tr_b16 a[238:239], v23 offset:61440
    v_mfma_f32_16x16x32_bf16 v[180:183], a[244:247], a[196:199], v[180:183]
    v_mfma_f32_16x16x32_bf16 v[176:179], a[244:247], a[192:195], v[176:179]
    v_mfma_f32_16x16x32_bf16 v[176:179], a[240:243], a[176:179], v[176:179]
    s_waitcnt lgkmcnt(4)
    v_mfma_f32_16x16x32_bf16 v[192:195], a[248:251], a[176:179], v[192:195]
    ds_read_b64_tr_b16 a[240:241], v24 offset:49152
    ds_read_b64_tr_b16 a[242:243], v24 offset:53248
    v_mfma_f32_16x16x32_bf16 v[192:195], a[252:255], a[192:195], v[192:195]
    v_mfma_f32_16x16x32_bf16 v[196:199], a[252:255], a[196:199], v[196:199]
    buffer_load_dwordx4 v35, s[24:27], s68 offen offset:1024  lds
    v_mfma_f32_16x16x32_bf16 v[196:199], a[248:251], a[180:183], v[196:199]
    v_mfma_f32_16x16x32_bf16 v[200:203], a[248:251], a[184:187], v[200:203]
    ds_read_b64_tr_b16 a[244:245], v24 offset:57344
    ds_read_b64_tr_b16 a[246:247], v24 offset:61440
    v_mfma_f32_16x16x32_bf16 v[200:203], a[252:255], a[200:203], v[200:203]
    s_xor_b32 s46, s69, 245760
    v_mfma_f32_16x16x32_bf16 v[204:207], a[252:255], a[204:207], v[204:207]
    buffer_load_dwordx4 a[128:131], v1, s[4:7], s46 offen offset:0 sc1
    v_mfma_f32_16x16x32_bf16 v[204:207], a[248:251], a[188:191], v[204:207]
    s_waitcnt lgkmcnt(4)
    v_mfma_f32_16x16x32_bf16 v[220:223], a[232:235], a[188:191], v[220:223]
    ds_read_b64_tr_b16 a[248:249], v25 offset:49152
    ds_read_b64_tr_b16 a[250:251], v25 offset:53248
    v_mfma_f32_16x16x32_bf16 v[220:223], a[236:239], a[204:207], v[220:223]
    v_mfma_f32_16x16x32_bf16 v[216:219], a[236:239], a[200:203], v[216:219]
    buffer_load_dwordx4 v36, s[24:27], s68 offen offset:2048  lds
    v_mfma_f32_16x16x32_bf16 v[216:219], a[232:235], a[184:187], v[216:219]
    v_mfma_f32_16x16x32_bf16 v[212:215], a[232:235], a[180:183], v[212:215]
    ds_read_b64_tr_b16 a[252:253], v25 offset:57344
    ds_read_b64_tr_b16 a[254:255], v25 offset:61440
    v_mfma_f32_16x16x32_bf16 v[212:215], a[236:239], a[196:199], v[212:215]
    v_mfma_f32_16x16x32_bf16 v[208:211], a[236:239], a[192:195], v[208:211]
    buffer_load_dwordx4 a[132:135], v1, s[4:7], s46 offen offset:1024 sc1
    v_mfma_f32_16x16x32_bf16 v[208:211], a[232:235], a[176:179], v[208:211]
    s_waitcnt vmcnt(25) lgkmcnt(4)
    v_mfma_f32_16x16x32_bf16 v[224:227], a[240:243], a[176:179], v[224:227]
    s_barrier
    ds_read_b64_tr_b16 a[232:233], v26 offset:0
    ds_read_b64_tr_b16 a[234:235], v26 offset:4096
    v_mfma_f32_16x16x32_bf16 v[224:227], a[244:247], a[192:195], v[224:227]
    v_mfma_f32_16x16x32_bf16 v[228:231], a[244:247], a[196:199], v[228:231]
    buffer_load_dwordx4 v37, s[24:27], s68 offen offset:3072  lds
    v_mfma_f32_16x16x32_bf16 v[228:231], a[240:243], a[180:183], v[228:231]
    v_mfma_f32_16x16x32_bf16 v[232:235], a[240:243], a[184:187], v[232:235]
    ds_read_b64_tr_b16 a[236:237], v26 offset:8192
    ds_read_b64_tr_b16 a[238:239], v26 offset:12288
    v_mfma_f32_16x16x32_bf16 v[232:235], a[244:247], a[200:203], v[232:235]
    v_mfma_f32_16x16x32_bf16 v[236:239], a[244:247], a[204:207], v[236:239]
    buffer_load_dwordx4 a[136:139], v1, s[4:7], s46 offen offset:2048 sc1
    v_mfma_f32_16x16x32_bf16 v[236:239], a[240:243], a[188:191], v[236:239]
    s_waitcnt lgkmcnt(4)
    v_mfma_f32_16x16x32_bf16 v[252:255], a[248:251], a[188:191], v[252:255]
    ds_read_b64_tr_b16 a[240:241], v27 offset:0
    ds_read_b64_tr_b16 a[242:243], v27 offset:4096
    v_mfma_f32_16x16x32_bf16 v[252:255], a[252:255], a[204:207], v[252:255]
    v_mfma_f32_16x16x32_bf16 v[248:251], a[252:255], a[200:203], v[248:251]
    buffer_load_dwordx4 a[140:143], v1, s[4:7], s46 offen offset:3072 sc1
    v_mfma_f32_16x16x32_bf16 v[248:251], a[248:251], a[184:187], v[248:251]
    v_mfma_f32_16x16x32_bf16 v[244:247], a[248:251], a[180:183], v[244:247]
    ds_read_b64_tr_b16 a[244:245], v27 offset:8192
    ds_read_b64_tr_b16 a[246:247], v27 offset:12288
    v_mfma_f32_16x16x32_bf16 v[244:247], a[252:255], a[196:199], v[244:247]
    v_mfma_f32_16x16x32_bf16 v[240:243], a[252:255], a[192:195], v[240:243]
    v_mfma_f32_16x16x32_bf16 v[240:243], a[248:251], a[176:179], v[240:243]
    s_waitcnt lgkmcnt(4)
    v_mfma_f32_16x16x32_bf16 v[128:131], a[232:235], a[16:19], v[128:131]
    s_xor_b32 s68, s67, 256
    ds_read_b64_tr_b16 a[248:249], v28 offset:0
    ds_read_b64_tr_b16 a[250:251], v28 offset:4096
    v_mfma_f32_16x16x32_bf16 v[128:131], a[236:239], a[208:211], v[128:131]
    s_add_u32 m0, s64, 0
    v_mfma_f32_16x16x32_bf16 v[132:135], a[236:239], a[212:215], v[132:135]
    buffer_load_dwordx4 v34, s[20:23], s68 offen offset:0  lds
    v_mfma_f32_16x16x32_bf16 v[132:135], a[232:235], a[20:23], v[132:135]
    v_mfma_f32_16x16x32_bf16 v[136:139], a[232:235], a[24:27], v[136:139]
    ds_read_b64_tr_b16 a[252:253], v28 offset:8192
    ds_read_b64_tr_b16 a[254:255], v28 offset:12288
    v_mfma_f32_16x16x32_bf16 v[136:139], a[236:239], a[216:219], v[136:139]
    s_xor_b32 s46, s69, 249856
    v_mfma_f32_16x16x32_bf16 v[140:143], a[236:239], a[220:223], v[140:143]
    buffer_load_dwordx4 a[176:179], v1, s[4:7], s46 offen offset:0 sc1
    v_mfma_f32_16x16x32_bf16 v[140:143], a[232:235], a[28:31], v[140:143]
    s_waitcnt lgkmcnt(4)
    v_mfma_f32_16x16x32_bf16 v[156:159], a[240:243], a[28:31], v[156:159]
    ds_read_b64_tr_b16 a[232:233], v29 offset:0
    ds_read_b64_tr_b16 a[234:235], v29 offset:4096
    v_mfma_f32_16x16x32_bf16 v[156:159], a[244:247], a[220:223], v[156:159]
    v_mfma_f32_16x16x32_bf16 v[152:155], a[244:247], a[216:219], v[152:155]
    buffer_load_dwordx4 v35, s[20:23], s68 offen offset:1024  lds
    v_mfma_f32_16x16x32_bf16 v[152:155], a[240:243], a[24:27], v[152:155]
    v_mfma_f32_16x16x32_bf16 v[148:151], a[240:243], a[20:23], v[148:151]
    ds_read_b64_tr_b16 a[236:237], v29 offset:8192
    ds_read_b64_tr_b16 a[238:239], v29 offset:12288
    v_mfma_f32_16x16x32_bf16 v[148:151], a[244:247], a[212:215], v[148:151]
    v_mfma_f32_16x16x32_bf16 v[144:147], a[244:247], a[208:211], v[144:147]
    buffer_load_dwordx4 a[180:183], v1, s[4:7], s46 offen offset:1024 sc1
    v_mfma_f32_16x16x32_bf16 v[144:147], a[240:243], a[16:19], v[144:147]
    s_waitcnt lgkmcnt(4)
    v_mfma_f32_16x16x32_bf16 v[160:163], a[248:251], a[16:19], v[160:163]
    ds_read_b64_tr_b16 a[240:241], v30 offset:0
    ds_read_b64_tr_b16 a[242:243], v30 offset:4096
    v_mfma_f32_16x16x32_bf16 v[160:163], a[252:255], a[208:211], v[160:163]
    v_mfma_f32_16x16x32_bf16 v[164:167], a[252:255], a[212:215], v[164:167]
    buffer_load_dwordx4 v36, s[20:23], s68 offen offset:2048  lds
    v_mfma_f32_16x16x32_bf16 v[164:167], a[248:251], a[20:23], v[164:167]
    v_mfma_f32_16x16x32_bf16 v[168:171], a[248:251], a[24:27], v[168:171]
    ds_read_b64_tr_b16 a[244:245], v30 offset:8192
    ds_read_b64_tr_b16 a[246:247], v30 offset:12288
    v_mfma_f32_16x16x32_bf16 v[168:171], a[252:255], a[216:219], v[168:171]
    v_mfma_f32_16x16x32_bf16 v[172:175], a[252:255], a[220:223], v[172:175]
    buffer_load_dwordx4 a[184:187], v1, s[4:7], s46 offen offset:2048 sc1
    v_mfma_f32_16x16x32_bf16 v[172:175], a[248:251], a[28:31], v[172:175]
    s_waitcnt lgkmcnt(4)
    v_mfma_f32_16x16x32_bf16 v[188:191], a[232:235], a[28:31], v[188:191]
    ds_read_b64_tr_b16 a[248:249], v31 offset:0
    ds_read_b64_tr_b16 a[250:251], v31 offset:4096
    v_mfma_f32_16x16x32_bf16 v[188:191], a[236:239], a[220:223], v[188:191]
    v_mfma_f32_16x16x32_bf16 v[184:187], a[236:239], a[216:219], v[184:187]
    buffer_load_dwordx4 a[188:191], v1, s[4:7], s46 offen offset:3072 sc1
    v_mfma_f32_16x16x32_bf16 v[184:187], a[232:235], a[24:27], v[184:187]
    v_mfma_f32_16x16x32_bf16 v[180:183], a[232:235], a[20:23], v[180:183]
    ds_read_b64_tr_b16 a[252:253], v31 offset:8192
    ds_read_b64_tr_b16 a[254:255], v31 offset:12288
    v_mfma_f32_16x16x32_bf16 v[180:183], a[236:239], a[212:215], v[180:183]
    v_mfma_f32_16x16x32_bf16 v[176:179], a[236:239], a[208:211], v[176:179]
    v_mfma_f32_16x16x32_bf16 v[176:179], a[232:235], a[16:19], v[176:179]
    s_waitcnt lgkmcnt(4)
    v_mfma_f32_16x16x32_bf16 v[192:195], a[240:243], a[16:19], v[192:195]
    ds_read_b64_tr_b16 a[232:233], v32 offset:0
    ds_read_b64_tr_b16 a[234:235], v32 offset:4096
    v_mfma_f32_16x16x32_bf16 v[192:195], a[244:247], a[208:211], v[192:195]
    v_mfma_f32_16x16x32_bf16 v[196:199], a[244:247], a[212:215], v[196:199]
    buffer_load_dwordx4 v37, s[20:23], s68 offen offset:3072  lds
    v_mfma_f32_16x16x32_bf16 v[196:199], a[240:243], a[20:23], v[196:199]
    v_mfma_f32_16x16x32_bf16 v[200:203], a[240:243], a[24:27], v[200:203]
    ds_read_b64_tr_b16 a[236:237], v32 offset:8192
    ds_read_b64_tr_b16 a[238:239], v32 offset:12288
    v_mfma_f32_16x16x32_bf16 v[200:203], a[244:247], a[216:219], v[200:203]
    s_xor_b32 s46, s69, 266240
    v_mfma_f32_16x16x32_bf16 v[204:207], a[244:247], a[220:223], v[204:207]
    buffer_load_dwordx4 a[192:195], v1, s[4:7], s46 offen offset:0 sc1
    v_mfma_f32_16x16x32_bf16 v[204:207], a[240:243], a[28:31], v[204:207]
    s_waitcnt lgkmcnt(4)
    v_mfma_f32_16x16x32_bf16 v[220:223], a[248:251], a[28:31], v[220:223]
    s_xor_b32 s68, s67, 33024
    ds_read_b64_tr_b16 a[240:241], v33 offset:0
    ds_read_b64_tr_b16 a[242:243], v33 offset:4096
    v_mfma_f32_16x16x32_bf16 v[220:223], a[252:255], a[220:223], v[220:223]
    s_add_u32 m0, s64, 4096
    v_mfma_f32_16x16x32_bf16 v[216:219], a[252:255], a[216:219], v[216:219]
    buffer_load_dwordx4 v34, s[20:23], s68 offen offset:0  lds
    v_mfma_f32_16x16x32_bf16 v[216:219], a[248:251], a[24:27], v[216:219]
    v_mfma_f32_16x16x32_bf16 v[212:215], a[248:251], a[20:23], v[212:215]
    ds_read_b64_tr_b16 a[244:245], v33 offset:8192
    ds_read_b64_tr_b16 a[246:247], v33 offset:12288
    v_mfma_f32_16x16x32_bf16 v[212:215], a[252:255], a[212:215], v[212:215]
    v_mfma_f32_16x16x32_bf16 v[208:211], a[252:255], a[208:211], v[208:211]
    buffer_load_dwordx4 a[196:199], v1, s[4:7], s46 offen offset:1024 sc1
    v_mfma_f32_16x16x32_bf16 v[208:211], a[248:251], a[16:19], v[208:211]
    s_waitcnt lgkmcnt(4)
    v_mfma_f32_16x16x32_bf16 v[224:227], a[232:235], a[16:19], v[224:227]
    ds_read_b64_tr_b16 a[248:249], v26 offset:16384
    ds_read_b64_tr_b16 a[250:251], v26 offset:20480
    v_mfma_f32_16x16x32_bf16 v[224:227], a[236:239], a[208:211], v[224:227]
    v_mfma_f32_16x16x32_bf16 v[228:231], a[236:239], a[212:215], v[228:231]
    buffer_load_dwordx4 v35, s[20:23], s68 offen offset:1024  lds
    v_mfma_f32_16x16x32_bf16 v[228:231], a[232:235], a[20:23], v[228:231]
    v_mfma_f32_16x16x32_bf16 v[232:235], a[232:235], a[24:27], v[232:235]
    ds_read_b64_tr_b16 a[252:253], v26 offset:24576
    ds_read_b64_tr_b16 a[254:255], v26 offset:28672
    v_mfma_f32_16x16x32_bf16 v[232:235], a[236:239], a[216:219], v[232:235]
    v_mfma_f32_16x16x32_bf16 v[236:239], a[236:239], a[220:223], v[236:239]
    buffer_load_dwordx4 a[200:203], v1, s[4:7], s46 offen offset:2048 sc1
    v_mfma_f32_16x16x32_bf16 v[236:239], a[232:235], a[28:31], v[236:239]
    s_waitcnt lgkmcnt(4)
    v_mfma_f32_16x16x32_bf16 v[252:255], a[240:243], a[28:31], v[252:255]
    ds_read_b64_tr_b16 a[232:233], v27 offset:16384
    ds_read_b64_tr_b16 a[234:235], v27 offset:20480
    v_mfma_f32_16x16x32_bf16 v[252:255], a[244:247], a[220:223], v[252:255]
    v_mfma_f32_16x16x32_bf16 v[248:251], a[244:247], a[216:219], v[248:251]
    buffer_load_dwordx4 a[204:207], v1, s[4:7], s46 offen offset:3072 sc1
    v_mfma_f32_16x16x32_bf16 v[248:251], a[240:243], a[24:27], v[248:251]
    v_mfma_f32_16x16x32_bf16 v[244:247], a[240:243], a[20:23], v[244:247]
    ds_read_b64_tr_b16 a[236:237], v27 offset:24576
    ds_read_b64_tr_b16 a[238:239], v27 offset:28672
    v_mfma_f32_16x16x32_bf16 v[244:247], a[244:247], a[212:215], v[244:247]
    v_mfma_f32_16x16x32_bf16 v[240:243], a[244:247], a[208:211], v[240:243]
    v_mfma_f32_16x16x32_bf16 v[240:243], a[240:243], a[16:19], v[240:243]
    s_waitcnt lgkmcnt(4)
    v_mfma_f32_16x16x32_bf16 v[128:131], a[248:251], a[32:35], v[128:131]
    ds_read_b64_tr_b16 a[240:241], v28 offset:16384
    ds_read_b64_tr_b16 a[242:243], v28 offset:20480
    v_mfma_f32_16x16x32_bf16 v[128:131], a[252:255], a[48:51], v[128:131]
    v_mfma_f32_16x16x32_bf16 v[132:135], a[252:255], a[52:55], v[132:135]
    buffer_load_dwordx4 v36, s[20:23], s68 offen offset:2048  lds
    v_mfma_f32_16x16x32_bf16 v[132:135], a[248:251], a[36:39], v[132:135]
    v_mfma_f32_16x16x32_bf16 v[136:139], a[248:251], a[40:43], v[136:139]
    ds_read_b64_tr_b16 a[244:245], v28 offset:24576
    ds_read_b64_tr_b16 a[246:247], v28 offset:28672
    v_mfma_f32_16x16x32_bf16 v[136:139], a[252:255], a[56:59], v[136:139]
    s_xor_b32 s46, s69, 278528
    v_mfma_f32_16x16x32_bf16 v[140:143], a[252:255], a[60:63], v[140:143]
    buffer_load_dwordx4 a[16:19], v1, s[4:7], s46 offen offset:0 sc1
    v_mfma_f32_16x16x32_bf16 v[140:143], a[248:251], a[44:47], v[140:143]
    s_waitcnt lgkmcnt(4)
    v_mfma_f32_16x16x32_bf16 v[156:159], a[232:235], a[44:47], v[156:159]
    ds_read_b64_tr_b16 a[248:249], v29 offset:16384
    ds_read_b64_tr_b16 a[250:251], v29 offset:20480
    v_mfma_f32_16x16x32_bf16 v[156:159], a[236:239], a[60:63], v[156:159]
    v_mfma_f32_16x16x32_bf16 v[152:155], a[236:239], a[56:59], v[152:155]
    buffer_load_dwordx4 v37, s[20:23], s68 offen offset:3072  lds
    v_mfma_f32_16x16x32_bf16 v[152:155], a[232:235], a[40:43], v[152:155]
    v_mfma_f32_16x16x32_bf16 v[148:151], a[232:235], a[36:39], v[148:151]
    ds_read_b64_tr_b16 a[252:253], v29 offset:24576
    ds_read_b64_tr_b16 a[254:255], v29 offset:28672
    v_mfma_f32_16x16x32_bf16 v[148:151], a[236:239], a[52:55], v[148:151]
    v_mfma_f32_16x16x32_bf16 v[144:147], a[236:239], a[48:51], v[144:147]
    buffer_load_dwordx4 a[20:23], v1, s[4:7], s46 offen offset:1024 sc1
    v_mfma_f32_16x16x32_bf16 v[144:147], a[232:235], a[32:35], v[144:147]
    s_waitcnt lgkmcnt(4)
    v_mfma_f32_16x16x32_bf16 v[160:163], a[240:243], a[32:35], v[160:163]
    s_xor_b32 s68, s67, 33024
    ds_read_b64_tr_b16 a[232:233], v30 offset:16384
    ds_read_b64_tr_b16 a[234:235], v30 offset:20480
    v_mfma_f32_16x16x32_bf16 v[160:163], a[244:247], a[48:51], v[160:163]
    s_add_u32 m0, s64, 135168
    v_mfma_f32_16x16x32_bf16 v[164:167], a[244:247], a[52:55], v[164:167]
    buffer_load_dwordx4 v34, s[24:27], s68 offen offset:0  lds
    v_mfma_f32_16x16x32_bf16 v[164:167], a[240:243], a[36:39], v[164:167]
    v_mfma_f32_16x16x32_bf16 v[168:171], a[240:243], a[40:43], v[168:171]
    ds_read_b64_tr_b16 a[236:237], v30 offset:24576
    ds_read_b64_tr_b16 a[238:239], v30 offset:28672
    v_mfma_f32_16x16x32_bf16 v[168:171], a[244:247], a[56:59], v[168:171]
    v_mfma_f32_16x16x32_bf16 v[172:175], a[244:247], a[60:63], v[172:175]
    buffer_load_dwordx4 a[24:27], v1, s[4:7], s46 offen offset:2048 sc1
    v_mfma_f32_16x16x32_bf16 v[172:175], a[240:243], a[44:47], v[172:175]
    s_waitcnt lgkmcnt(4)
    v_mfma_f32_16x16x32_bf16 v[188:191], a[248:251], a[44:47], v[188:191]
    ds_read_b64_tr_b16 a[240:241], v31 offset:16384
    ds_read_b64_tr_b16 a[242:243], v31 offset:20480
    v_mfma_f32_16x16x32_bf16 v[188:191], a[252:255], a[60:63], v[188:191]
    v_mfma_f32_16x16x32_bf16 v[184:187], a[252:255], a[56:59], v[184:187]
    buffer_load_dwordx4 a[28:31], v1, s[4:7], s46 offen offset:3072 sc1
    v_mfma_f32_16x16x32_bf16 v[184:187], a[248:251], a[40:43], v[184:187]
    v_mfma_f32_16x16x32_bf16 v[180:183], a[248:251], a[36:39], v[180:183]
    ds_read_b64_tr_b16 a[244:245], v31 offset:24576
    ds_read_b64_tr_b16 a[246:247], v31 offset:28672
    v_mfma_f32_16x16x32_bf16 v[180:183], a[252:255], a[52:55], v[180:183]
    v_mfma_f32_16x16x32_bf16 v[176:179], a[252:255], a[48:51], v[176:179]
    v_mfma_f32_16x16x32_bf16 v[176:179], a[248:251], a[32:35], v[176:179]
    s_waitcnt lgkmcnt(4)
    v_mfma_f32_16x16x32_bf16 v[192:195], a[232:235], a[32:35], v[192:195]
    ds_read_b64_tr_b16 a[248:249], v32 offset:16384
    ds_read_b64_tr_b16 a[250:251], v32 offset:20480
    v_mfma_f32_16x16x32_bf16 v[192:195], a[236:239], a[48:51], v[192:195]
    v_mfma_f32_16x16x32_bf16 v[196:199], a[236:239], a[52:55], v[196:199]
    buffer_load_dwordx4 v35, s[24:27], s68 offen offset:1024  lds
    v_mfma_f32_16x16x32_bf16 v[196:199], a[232:235], a[36:39], v[196:199]
    v_mfma_f32_16x16x32_bf16 v[200:203], a[232:235], a[40:43], v[200:203]
    ds_read_b64_tr_b16 a[252:253], v32 offset:24576
    ds_read_b64_tr_b16 a[254:255], v32 offset:28672
    v_mfma_f32_16x16x32_bf16 v[200:203], a[236:239], a[56:59], v[200:203]
    s_xor_b32 s46, s69, 282624
    v_mfma_f32_16x16x32_bf16 v[204:207], a[236:239], a[60:63], v[204:207]
    buffer_load_dwordx4 a[208:211], v1, s[4:7], s46 offen offset:0 sc1
    v_mfma_f32_16x16x32_bf16 v[204:207], a[232:235], a[44:47], v[204:207]
    s_waitcnt lgkmcnt(4)
    v_mfma_f32_16x16x32_bf16 v[220:223], a[240:243], a[44:47], v[220:223]
    ds_read_b64_tr_b16 a[232:233], v33 offset:16384
    ds_read_b64_tr_b16 a[234:235], v33 offset:20480
    v_mfma_f32_16x16x32_bf16 v[220:223], a[244:247], a[60:63], v[220:223]
    v_mfma_f32_16x16x32_bf16 v[216:219], a[244:247], a[56:59], v[216:219]
    buffer_load_dwordx4 v36, s[24:27], s68 offen offset:2048  lds
    v_mfma_f32_16x16x32_bf16 v[216:219], a[240:243], a[40:43], v[216:219]
    v_mfma_f32_16x16x32_bf16 v[212:215], a[240:243], a[36:39], v[212:215]
    ds_read_b64_tr_b16 a[236:237], v33 offset:24576
    ds_read_b64_tr_b16 a[238:239], v33 offset:28672
    v_mfma_f32_16x16x32_bf16 v[212:215], a[244:247], a[52:55], v[212:215]
    v_mfma_f32_16x16x32_bf16 v[208:211], a[244:247], a[48:51], v[208:211]
    buffer_load_dwordx4 a[212:215], v1, s[4:7], s46 offen offset:1024 sc1
    v_mfma_f32_16x16x32_bf16 v[208:211], a[240:243], a[32:35], v[208:211]
    s_waitcnt vmcnt(36) lgkmcnt(4)
    v_mfma_f32_16x16x32_bf16 v[224:227], a[248:251], a[32:35], v[224:227]
    s_barrier
    ds_read_b128 a[240:243], v42 offset:0
    v_mfma_f32_16x16x32_bf16 v[224:227], a[252:255], a[48:51], v[224:227]
    v_mfma_f32_16x16x32_bf16 v[228:231], a[252:255], a[52:55], v[228:231]
    buffer_load_dwordx4 v37, s[24:27], s68 offen offset:3072  lds
    v_mfma_f32_16x16x32_bf16 v[228:231], a[248:251], a[36:39], v[228:231]
    v_mfma_f32_16x16x32_bf16 v[232:235], a[248:251], a[40:43], v[232:235]
    ds_read_b128 a[244:247], v43 offset:0
    v_mfma_f32_16x16x32_bf16 v[232:235], a[252:255], a[56:59], v[232:235]
    v_mfma_f32_16x16x32_bf16 v[236:239], a[252:255], a[60:63], v[236:239]
    buffer_load_dwordx4 a[216:219], v1, s[4:7], s46 offen offset:2048 sc1
    v_mfma_f32_16x16x32_bf16 v[236:239], a[248:251], a[44:47], v[236:239]
    s_waitcnt lgkmcnt(2)
    v_mfma_f32_16x16x32_bf16 v[252:255], a[232:235], a[44:47], v[252:255]
    ds_read_b128 a[248:251], v42 offset:4096
    v_mfma_f32_16x16x32_bf16 v[252:255], a[236:239], a[60:63], v[252:255]
    v_mfma_f32_16x16x32_bf16 v[248:251], a[236:239], a[56:59], v[248:251]
    buffer_load_dwordx4 a[220:223], v1, s[4:7], s46 offen offset:3072 sc1
    v_mfma_f32_16x16x32_bf16 v[248:251], a[232:235], a[40:43], v[248:251]
    v_mfma_f32_16x16x32_bf16 v[244:247], a[232:235], a[36:39], v[244:247]
    ds_read_b128 a[252:255], v43 offset:4096
    v_mfma_f32_16x16x32_bf16 v[244:247], a[236:239], a[52:55], v[244:247]
    v_mfma_f32_16x16x32_bf16 v[240:243], a[236:239], a[48:51], v[240:243]
    v_mfma_f32_16x16x32_bf16 v[240:243], a[232:235], a[32:35], v[240:243]
    s_waitcnt lgkmcnt(2)
    v_mfma_f32_16x16x32_bf16 v[128:131], a[240:243], a[160:163], v[128:131]
    s_xor_b32 s68, s67, 0
    ds_read_b128 a[232:235], v42 offset:8192
    v_mfma_f32_16x16x32_bf16 v[128:131], a[244:247], a[64:67], v[128:131]
    s_add_u32 m0, s64, 32768
    buffer_load_dwordx4 v[124:127], v51, s[4:7], s1 offen sc1
    v_mfma_f32_16x16x32_bf16 v[132:135], a[244:247], a[68:71], v[132:135]
    buffer_load_dwordx4 v34, s[24:27], s68 offen offset:0  lds
    v_mfma_f32_16x16x32_bf16 v[132:135], a[240:243], a[164:167], v[132:135]
    v_mfma_f32_16x16x32_bf16 v[136:139], a[240:243], a[168:171], v[136:139]
    ds_read_b128 a[236:239], v43 offset:8192
    v_mfma_f32_16x16x32_bf16 v[136:139], a[244:247], a[72:75], v[136:139]
    s_xor_b32 s46, s69, 294912
    v_mfma_f32_16x16x32_bf16 v[140:143], a[244:247], a[76:79], v[140:143]
    buffer_load_dwordx4 a[32:35], v1, s[4:7], s46 offen offset:0 sc1
    v_mfma_f32_16x16x32_bf16 v[140:143], a[240:243], a[172:175], v[140:143]
    s_waitcnt lgkmcnt(2)
    v_mfma_f32_16x16x32_bf16 v[156:159], a[248:251], a[172:175], v[156:159]
    ds_read_b128 a[240:243], v42 offset:12288
    v_mfma_f32_16x16x32_bf16 v[156:159], a[252:255], a[76:79], v[156:159]
    v_mfma_f32_16x16x32_bf16 v[152:155], a[252:255], a[72:75], v[152:155]
    buffer_load_dwordx4 v35, s[24:27], s68 offen offset:1024  lds
    v_mfma_f32_16x16x32_bf16 v[152:155], a[248:251], a[168:171], v[152:155]
    v_mfma_f32_16x16x32_bf16 v[148:151], a[248:251], a[164:167], v[148:151]
    ds_read_b128 a[244:247], v43 offset:12288
    v_mfma_f32_16x16x32_bf16 v[148:151], a[252:255], a[68:71], v[148:151]
    v_mfma_f32_16x16x32_bf16 v[144:147], a[252:255], a[64:67], v[144:147]
    buffer_load_dwordx4 a[36:39], v1, s[4:7], s46 offen offset:1024 sc1
    v_mfma_f32_16x16x32_bf16 v[144:147], a[248:251], a[160:163], v[144:147]
    s_waitcnt lgkmcnt(2)
    v_mfma_f32_16x16x32_bf16 v[160:163], a[232:235], a[160:163], v[160:163]
    ds_read_b128 a[248:251], v42 offset:16384
    v_mfma_f32_16x16x32_bf16 v[160:163], a[236:239], a[64:67], v[160:163]
    v_mfma_f32_16x16x32_bf16 v[164:167], a[236:239], a[68:71], v[164:167]
    buffer_load_dwordx4 v36, s[24:27], s68 offen offset:2048  lds
    v_mfma_f32_16x16x32_bf16 v[164:167], a[232:235], a[164:167], v[164:167]
    v_mfma_f32_16x16x32_bf16 v[168:171], a[232:235], a[168:171], v[168:171]
    ds_read_b128 a[252:255], v43 offset:16384
    v_mfma_f32_16x16x32_bf16 v[168:171], a[236:239], a[72:75], v[168:171]
    v_mfma_f32_16x16x32_bf16 v[172:175], a[236:239], a[76:79], v[172:175]
    buffer_load_dwordx4 a[40:43], v1, s[4:7], s46 offen offset:2048 sc1
    v_mfma_f32_16x16x32_bf16 v[172:175], a[232:235], a[172:175], v[172:175]
    s_waitcnt lgkmcnt(2)
    v_mfma_f32_16x16x32_bf16 v[188:191], a[240:243], a[172:175], v[188:191]
    ds_read_b128 a[232:235], v42 offset:20480
    v_mfma_f32_16x16x32_bf16 v[188:191], a[244:247], a[76:79], v[188:191]
    v_mfma_f32_16x16x32_bf16 v[184:187], a[244:247], a[72:75], v[184:187]
    buffer_load_dwordx4 v37, s[24:27], s68 offen offset:3072  lds
    v_mfma_f32_16x16x32_bf16 v[184:187], a[240:243], a[168:171], v[184:187]
    v_mfma_f32_16x16x32_bf16 v[180:183], a[240:243], a[164:167], v[180:183]
    ds_read_b128 a[236:239], v43 offset:20480
    v_mfma_f32_16x16x32_bf16 v[180:183], a[244:247], a[68:71], v[180:183]
    v_mfma_f32_16x16x32_bf16 v[176:179], a[244:247], a[64:67], v[176:179]
    v_mfma_f32_16x16x32_bf16 v[176:179], a[240:243], a[160:163], v[176:179]
    s_waitcnt lgkmcnt(2)
    v_mfma_f32_16x16x32_bf16 v[192:195], a[248:251], a[160:163], v[192:195]
    ds_read_b128 a[240:243], v42 offset:24576
    v_mfma_f32_16x16x32_bf16 v[192:195], a[252:255], a[64:67], v[192:195]
    v_mfma_f32_16x16x32_bf16 v[196:199], a[252:255], a[68:71], v[196:199]
    buffer_load_dwordx4 a[44:47], v1, s[4:7], s46 offen offset:3072 sc1
    v_mfma_f32_16x16x32_bf16 v[196:199], a[248:251], a[164:167], v[196:199]
    v_mfma_f32_16x16x32_bf16 v[200:203], a[248:251], a[168:171], v[200:203]
    ds_read_b128 a[244:247], v43 offset:24576
    v_mfma_f32_16x16x32_bf16 v[200:203], a[252:255], a[72:75], v[200:203]
    s_xor_b32 s46, s69, 299008
    v_mfma_f32_16x16x32_bf16 v[204:207], a[252:255], a[76:79], v[204:207]
    buffer_load_dwordx4 a[48:51], v1, s[4:7], s46 offen offset:0 sc1
    v_mfma_f32_16x16x32_bf16 v[204:207], a[248:251], a[172:175], v[204:207]
    s_waitcnt lgkmcnt(2)
    v_mfma_f32_16x16x32_bf16 v[220:223], a[232:235], a[172:175], v[220:223]
    s_xor_b32 s68, s67, 32768
    ds_read_b128 a[248:251], v42 offset:28672
    v_mfma_f32_16x16x32_bf16 v[220:223], a[236:239], a[76:79], v[220:223]
    s_add_u32 m0, s64, 36864
    v_mfma_f32_16x16x32_bf16 v[216:219], a[236:239], a[72:75], v[216:219]
    buffer_load_dwordx4 v34, s[24:27], s68 offen offset:0  lds
    v_mfma_f32_16x16x32_bf16 v[216:219], a[232:235], a[168:171], v[216:219]
    v_mfma_f32_16x16x32_bf16 v[212:215], a[232:235], a[164:167], v[212:215]
    ds_read_b128 a[252:255], v43 offset:28672
    v_mfma_f32_16x16x32_bf16 v[212:215], a[236:239], a[68:71], v[212:215]
    v_mfma_f32_16x16x32_bf16 v[208:211], a[236:239], a[64:67], v[208:211]
    buffer_load_dwordx4 a[52:55], v1, s[4:7], s46 offen offset:1024 sc1
    v_mfma_f32_16x16x32_bf16 v[208:211], a[232:235], a[160:163], v[208:211]
    s_waitcnt lgkmcnt(2)
    v_mfma_f32_16x16x32_bf16 v[224:227], a[240:243], a[160:163], v[224:227]
    ds_read_b128 a[232:235], v44 offset:8192
    v_mfma_f32_16x16x32_bf16 v[224:227], a[244:247], a[64:67], v[224:227]
    v_mfma_f32_16x16x32_bf16 v[228:231], a[244:247], a[68:71], v[228:231]
    buffer_load_dwordx4 v35, s[24:27], s68 offen offset:1024  lds
    v_mfma_f32_16x16x32_bf16 v[228:231], a[240:243], a[164:167], v[228:231]
    v_mfma_f32_16x16x32_bf16 v[232:235], a[240:243], a[168:171], v[232:235]
    ds_read_b128 a[236:239], v45 offset:8192
    v_mfma_f32_16x16x32_bf16 v[232:235], a[244:247], a[72:75], v[232:235]
    v_mfma_f32_16x16x32_bf16 v[236:239], a[244:247], a[76:79], v[236:239]
    buffer_load_dwordx4 a[56:59], v1, s[4:7], s46 offen offset:2048 sc1
    v_mfma_f32_16x16x32_bf16 v[236:239], a[240:243], a[172:175], v[236:239]
    s_waitcnt vmcnt(52) lgkmcnt(2)
    v_mfma_f32_16x16x32_bf16 v[252:255], a[248:251], a[172:175], v[252:255]
    ds_read_b128 a[240:243], v44 offset:12288
    v_mfma_f32_16x16x32_bf16 v[252:255], a[252:255], a[76:79], v[252:255]
    v_mfma_f32_16x16x32_bf16 v[248:251], a[252:255], a[72:75], v[248:251]
    buffer_load_dwordx4 v36, s[24:27], s68 offen offset:2048  lds
    v_mfma_f32_16x16x32_bf16 v[248:251], a[248:251], a[168:171], v[248:251]
    v_mfma_f32_16x16x32_bf16 v[244:247], a[248:251], a[164:167], v[244:247]
    ds_read_b128 a[244:247], v45 offset:12288
    v_mfma_f32_16x16x32_bf16 v[244:247], a[252:255], a[68:71], v[244:247]
    v_mfma_f32_16x16x32_bf16 v[240:243], a[252:255], a[64:67], v[240:243]
    v_mfma_f32_16x16x32_bf16 v[240:243], a[248:251], a[160:163], v[240:243]
    s_waitcnt vmcnt(52) lgkmcnt(2)
    v_mfma_f32_16x16x32_bf16 v[160:163], a[232:235], a[144:147], v[160:163]
    ds_read_b128 a[248:251], v44 offset:16384
    v_mfma_f32_16x16x32_bf16 v[160:163], a[236:239], a[0:3], v[160:163]
    v_mfma_f32_16x16x32_bf16 v[164:167], a[236:239], a[4:7], v[164:167]
    buffer_load_dwordx4 v37, s[24:27], s68 offen offset:3072  lds
    v_mfma_f32_16x16x32_bf16 v[164:167], a[232:235], a[148:151], v[164:167]
    v_mfma_f32_16x16x32_bf16 v[168:171], a[232:235], a[152:155], v[168:171]
    ds_read_b128 a[252:255], v45 offset:16384
    v_mfma_f32_16x16x32_bf16 v[168:171], a[236:239], a[8:11], v[168:171]
    v_mfma_f32_16x16x32_bf16 v[172:175], a[236:239], a[12:15], v[172:175]
    buffer_load_dwordx4 a[60:63], v1, s[4:7], s46 offen offset:3072 sc1
    v_mfma_f32_16x16x32_bf16 v[172:175], a[232:235], a[156:159], v[172:175]
    s_waitcnt vmcnt(52) lgkmcnt(2)
    v_mfma_f32_16x16x32_bf16 v[188:191], a[240:243], a[156:159], v[188:191]
    ds_read_b128 a[232:235], v44 offset:20480
    v_mfma_f32_16x16x32_bf16 v[188:191], a[244:247], a[12:15], v[188:191]
    s_xor_b32 s46, s69, 311296
    v_mfma_f32_16x16x32_bf16 v[184:187], a[244:247], a[8:11], v[184:187]
    buffer_load_dwordx4 a[64:67], v1, s[4:7], s46 offen offset:0 sc1
    v_mfma_f32_16x16x32_bf16 v[184:187], a[240:243], a[152:155], v[184:187]
    v_mfma_f32_16x16x32_bf16 v[180:183], a[240:243], a[148:151], v[180:183]
    ds_read_b128 a[236:239], v45 offset:20480
    v_mfma_f32_16x16x32_bf16 v[180:183], a[244:247], a[4:7], v[180:183]
    v_mfma_f32_16x16x32_bf16 v[176:179], a[244:247], a[0:3], v[176:179]
    buffer_load_dwordx4 a[68:71], v1, s[4:7], s46 offen offset:1024 sc1
    v_mfma_f32_16x16x32_bf16 v[176:179], a[240:243], a[144:147], v[176:179]
    s_waitcnt vmcnt(52) lgkmcnt(2)
    v_mfma_f32_16x16x32_bf16 v[192:195], a[248:251], a[144:147], v[192:195]
    s_waitcnt vmcnt(18)
    ds_read_b128 a[240:243], v44 offset:24576
    v_xor_b32 v124, v74, v124
    v_mfma_f32_16x16x32_bf16 v[192:195], a[252:255], a[0:3], v[192:195]
    v_xor_b32 v125, v74, v125
    v_xor_b32 v126, v74, v126
    v_mfma_f32_16x16x32_bf16 v[196:199], a[252:255], a[4:7], v[196:199]
    buffer_load_dwordx4 a[72:75], v1, s[4:7], s46 offen offset:2048 sc1
    v_mfma_f32_16x16x32_bf16 v[196:199], a[248:251], a[148:151], v[196:199]
    v_xor_b32 v127, v74, v127
    v_or3_b32 v124, v124, v125, v126
    v_mfma_f32_16x16x32_bf16 v[200:203], a[248:251], a[152:155], v[200:203]
    ds_read_b128 a[244:247], v45 offset:24576
    v_or_b32 v124, v124, v127
    v_mfma_f32_16x16x32_bf16 v[200:203], a[252:255], a[8:11], v[200:203]
    v_cmp_ne_u32 vcc, 0, v124
    s_cbranch_vccnz SLOW_FX
BACK_FX:
    v_mfma_f32_16x16x32_bf16 v[204:207], a[252:255], a[12:15], v[204:207]
    buffer_load_dwordx4 a[76:79], v1, s[4:7], s46 offen offset:3072 sc1
    v_mfma_f32_16x16x32_bf16 v[204:207], a[248:251], a[156:159], v[204:207]
    s_waitcnt lgkmcnt(2)
    v_mfma_f32_16x16x32_bf16 v[220:223], a[232:235], a[156:159], v[220:223]
    s_xor_b32 s46, s69, 315392
    ds_read_b128 a[248:251], v44 offset:28672
    v_mfma_f32_16x16x32_bf16 v[220:223], a[236:239], a[12:15], v[220:223]
    buffer_load_dwordx4 a[160:163], v1, s[4:7], s46 offen offset:0 sc1
    v_mfma_f32_16x16x32_bf16 v[216:219], a[236:239], a[8:11], v[216:219]
    v_mfma_f32_16x16x32_bf16 v[216:219], a[232:235], a[152:155], v[216:219]
    buffer_load_dwordx4 a[164:167], v1, s[4:7], s46 offen offset:1024 sc1
    v_mfma_f32_16x16x32_bf16 v[212:215], a[232:235], a[148:151], v[212:215]
    ds_read_b128 a[252:255], v45 offset:28672
    v_mfma_f32_16x16x32_bf16 v[212:215], a[236:239], a[4:7], v[212:215]
    v_mfma_f32_16x16x32_bf16 v[208:211], a[236:239], a[0:3], v[208:211]
    buffer_load_dwordx4 a[168:171], v1, s[4:7], s46 offen offset:2048 sc1
    v_mfma_f32_16x16x32_bf16 v[208:211], a[232:235], a[144:147], v[208:211]
    s_waitcnt lgkmcnt(2)
    v_mfma_f32_16x16x32_bf16 v[224:227], a[240:243], a[144:147], v[224:227]
    s_barrier
    ds_read_b128 a[232:235], v38 offset:8192
    v_mfma_f32_16x16x32_bf16 v[224:227], a[244:247], a[0:3], v[224:227]
    v_mfma_f32_16x16x32_bf16 v[228:231], a[244:247], a[4:7], v[228:231]
    buffer_load_dwordx4 a[172:175], v1, s[4:7], s46 offen offset:3072 sc1
    v_mfma_f32_16x16x32_bf16 v[228:231], a[240:243], a[148:151], v[228:231]
    v_mfma_f32_16x16x32_bf16 v[232:235], a[240:243], a[152:155], v[232:235]
    ds_read_b128 a[236:239], v39 offset:8192
    v_mfma_f32_16x16x32_bf16 v[232:235], a[244:247], a[8:11], v[232:235]
    v_mfma_f32_16x16x32_bf16 v[236:239], a[244:247], a[12:15], v[236:239]
    v_mfma_f32_16x16x32_bf16 v[236:239], a[240:243], a[156:159], v[236:239]
    s_waitcnt lgkmcnt(2)
    v_mfma_f32_16x16x32_bf16 v[252:255], a[248:251], a[156:159], v[252:255]
    ds_read_b128 a[240:243], v40 offset:8192
    v_mfma_f32_16x16x32_bf16 v[252:255], a[252:255], a[12:15], v[252:255]
    v_mfma_f32_16x16x32_bf16 v[248:251], a[252:255], a[8:11], v[248:251]
    v_mfma_f32_16x16x32_bf16 v[248:251], a[248:251], a[152:155], v[248:251]
    v_mfma_f32_16x16x32_bf16 v[244:247], a[248:251], a[148:151], v[244:247]
    ds_read_b128 a[244:247], v41 offset:8192
    v_mfma_f32_16x16x32_bf16 v[244:247], a[252:255], a[4:7], v[244:247]
    v_mfma_f32_16x16x32_bf16 v[240:243], a[252:255], a[0:3], v[240:243]
    v_mfma_f32_16x16x32_bf16 v[240:243], a[248:251], a[144:147], v[240:243]
    s_waitcnt vmcnt(9) lgkmcnt(2)
    v_mfma_f32_16x16x32_bf16 v[160:163], a[232:235], a[80:83], v[160:163]
    s_barrier
    ds_read_b128 a[248:251], v38 offset:40960
    v_mfma_f32_16x16x32_bf16 v[160:163], a[236:239], a[112:115], v[160:163]
    v_mfma_f32_16x16x32_bf16 v[164:167], a[236:239], a[116:119], v[164:167]
    v_mfma_f32_16x16x32_bf16 v[164:167], a[232:235], a[84:87], v[164:167]
    v_mfma_f32_16x16x32_bf16 v[168:171], a[232:235], a[88:91], v[168:171]
    ds_read_b128 a[252:255], v39 offset:40960
    v_mfma_f32_16x16x32_bf16 v[168:171], a[236:239], a[120:123], v[168:171]
    v_mfma_f32_16x16x32_bf16 v[172:175], a[236:239], a[124:127], v[172:175]
    v_mfma_f32_16x16x32_bf16 v[172:175], a[232:235], a[92:95], v[172:175]
    s_waitcnt lgkmcnt(2)
    v_mfma_f32_16x16x32_bf16 v[172:175], a[240:243], a[140:143], v[172:175]
    ds_read_b128 a[232:235], v40 offset:40960
    v_mfma_f32_16x16x32_bf16 v[172:175], a[244:247], a[188:191], v[172:175]
    v_mfma_f32_16x16x32_bf16 v[168:171], a[244:247], a[184:187], v[168:171]
    v_mfma_f32_16x16x32_bf16 v[168:171], a[240:243], a[136:139], v[168:171]
    v_mfma_f32_16x16x32_bf16 v[164:167], a[240:243], a[132:135], v[164:167]
    ds_read_b128 a[236:239], v41 offset:40960
    v_mfma_f32_16x16x32_bf16 v[164:167], a[244:247], a[180:183], v[164:167]
    v_mfma_f32_16x16x32_bf16 v[160:163], a[244:247], a[176:179], v[160:163]
    v_mfma_f32_16x16x32_bf16 v[160:163], a[240:243], a[128:131], v[160:163]
    s_waitcnt lgkmcnt(2)
    v_mfma_f32_16x16x32_bf16 v[160:163], a[248:251], a[96:99], v[160:163]
    s_barrier
    ds_read_b128 a[240:243], v42 offset:40960
    v_mfma_f32_16x16x32_bf16 v[160:163], a[252:255], a[192:195], v[160:163]
    v_mfma_f32_16x16x32_bf16 v[164:167], a[252:255], a[196:199], v[164:167]
    v_mfma_f32_16x16x32_bf16 v[164:167], a[248:251], a[100:103], v[164:167]
    v_mfma_f32_16x16x32_bf16 v[168:171], a[248:251], a[104:107], v[168:171]
    ds_read_b128 a[244:247], v43 offset:40960
    v_mfma_f32_16x16x32_bf16 v[168:171], a[252:255], a[200:203], v[168:171]
    v_mfma_f32_16x16x32_bf16 v[172:175], a[252:255], a[204:207], v[172:175]
    v_mfma_f32_16x16x32_bf16 v[172:175], a[248:251], a[108:111], v[172:175]
    s_waitcnt lgkmcnt(2)
    v_mfma_f32_16x16x32_bf16 v[172:175], a[232:235], a[28:31], v[172:175]
    ds_read_b128 a[248:251], v44 offset:40960
    v_mfma_f32_16x16x32_bf16 v[172:175], a[236:239], a[220:223], v[172:175]
    v_mfma_f32_16x16x32_bf16 v[168:171], a[236:239], a[216:219], v[168:171]
    v_mfma_f32_16x16x32_bf16 v[168:171], a[232:235], a[24:27], v[168:171]
    v_mfma_f32_16x16x32_bf16 v[164:167], a[232:235], a[20:23], v[164:167]
    ds_read_b128 a[252:255], v45 offset:40960
    v_mfma_f32_16x16x32_bf16 v[164:167], a[236:239], a[212:215], v[164:167]
    v_mfma_f32_16x16x32_bf16 v[160:163], a[236:239], a[208:211], v[160:163]
    v_mfma_f32_16x16x32_bf16 v[160:163], a[232:235], a[16:19], v[160:163]
    s_waitcnt vmcnt(8) lgkmcnt(2)
    v_mfma_f32_16x16x32_bf16 v[160:163], a[240:243], a[32:35], v[160:163]
    ds_read_b128 a[232:235], v38 offset:16384
    v_mfma_f32_16x16x32_bf16 v[160:163], a[244:247], a[48:51], v[160:163]
    v_mfma_f32_16x16x32_bf16 v[164:167], a[244:247], a[52:55], v[164:167]
    v_mfma_f32_16x16x32_bf16 v[164:167], a[240:243], a[36:39], v[164:167]
    v_mfma_f32_16x16x32_bf16 v[168:171], a[240:243], a[40:43], v[168:171]
    ds_read_b128 a[236:239], v39 offset:16384
    v_mfma_f32_16x16x32_bf16 v[168:171], a[244:247], a[56:59], v[168:171]
    v_mfma_f32_16x16x32_bf16 v[172:175], a[244:247], a[60:63], v[172:175]
    v_mfma_f32_16x16x32_bf16 v[172:175], a[240:243], a[44:47], v[172:175]
    s_waitcnt vmcnt(0) lgkmcnt(2)
    v_mfma_f32_16x16x32_bf16 v[172:175], a[248:251], a[76:79], v[172:175]
    ds_read_b128 a[240:243], v40 offset:16384
    v_mfma_f32_16x16x32_bf16 v[172:175], a[252:255], a[172:175], v[172:175]
    v_mfma_f32_16x16x32_bf16 v[168:171], a[252:255], a[168:171], v[168:171]
    v_mfma_f32_16x16x32_bf16 v[168:171], a[248:251], a[72:75], v[168:171]
    v_mfma_f32_16x16x32_bf16 v[164:167], a[248:251], a[68:71], v[164:167]
    s_xor_b32 s62, s0, 851968
    ds_read_b128 a[244:247], v41 offset:16384
    v_mfma_f32_16x16x32_bf16 v[164:167], a[252:255], a[164:167], v[164:167]
    v_mfma_f32_16x16x32_bf16 v[160:163], a[252:255], a[160:163], v[160:163]
    v_mfma_f32_16x16x32_bf16 v[160:163], a[248:251], a[64:67], v[160:163]
    s_waitcnt lgkmcnt(2)
    v_mfma_f32_16x16x32_bf16 v[192:195], a[232:235], a[80:83], v[192:195]
    ds_read_b128 a[248:251], v38 offset:49152
    v_mfma_f32_16x16x32_bf16 v[192:195], a[236:239], a[112:115], v[192:195]
    v_mfma_f32_16x16x32_bf16 v[196:199], a[236:239], a[116:119], v[196:199]
    v_mfma_f32_16x16x32_bf16 v[196:199], a[232:235], a[84:87], v[196:199]
    v_mfma_f32_16x16x32_bf16 v[200:203], a[232:235], a[88:91], v[200:203]
    ds_read_b128 a[252:255], v39 offset:49152
    v_cvt_pk_bf16_f32 v160, v160, v161
    v_mfma_f32_16x16x32_bf16 v[200:203], a[236:239], a[120:123], v[200:203]
    v_cvt_pk_bf16_f32 v161, v162, v163
    v_cvt_pk_bf16_f32 v162, v164, v165
    v_mfma_f32_16x16x32_bf16 v[204:207], a[236:239], a[124:127], v[204:207]
    v_cvt_pk_bf16_f32 v163, v166, v167
    v_min_u32 v160, -2, v160
    v_mfma_f32_16x16x32_bf16 v[204:207], a[232:235], a[92:95], v[204:207]
    s_waitcnt lgkmcnt(2)
    v_min_u32 v161, -2, v161
    v_min_u32 v162, -2, v162
    v_mfma_f32_16x16x32_bf16 v[204:207], a[240:243], a[140:143], v[204:207]
    ds_read_b128 a[232:235], v40 offset:49152
    v_min_u32 v163, -2, v163
    v_mfma_f32_16x16x32_bf16 v[204:207], a[244:247], a[188:191], v[204:207]
    buffer_store_dwordx4 v[160:163], v1, s[4:7], s62 offen offset:0 sc1
    v_mfma_f32_16x16x32_bf16 v[200:203], a[244:247], a[184:187], v[200:203]
    v_cvt_pk_bf16_f32 v168, v168, v169
    v_cvt_pk_bf16_f32 v169, v170, v171
    v_mfma_f32_16x16x32_bf16 v[200:203], a[240:243], a[136:139], v[200:203]
    v_cvt_pk_bf16_f32 v170, v172, v173
    v_cvt_pk_bf16_f32 v171, v174, v175
    v_mfma_f32_16x16x32_bf16 v[196:199], a[240:243], a[132:135], v[196:199]
    ds_read_b128 a[236:239], v41 offset:49152
    v_min_u32 v168, -2, v168
    v_mfma_f32_16x16x32_bf16 v[196:199], a[244:247], a[180:183], v[196:199]
    v_min_u32 v169, -2, v169
    v_min_u32 v170, -2, v170
    v_mfma_f32_16x16x32_bf16 v[192:195], a[244:247], a[176:179], v[192:195]
    v_min_u32 v171, -2, v171
    v_mfma_f32_16x16x32_bf16 v[192:195], a[240:243], a[128:131], v[192:195]
    s_waitcnt lgkmcnt(2)
    v_mfma_f32_16x16x32_bf16 v[192:195], a[248:251], a[96:99], v[192:195]
    ds_read_b128 a[240:243], v42 offset:49152
    v_mfma_f32_16x16x32_bf16 v[192:195], a[252:255], a[192:195], v[192:195]
    v_mfma_f32_16x16x32_bf16 v[196:199], a[252:255], a[196:199], v[196:199]
    v_mfma_f32_16x16x32_bf16 v[196:199], a[248:251], a[100:103], v[196:199]
    v_mfma_f32_16x16x32_bf16 v[200:203], a[248:251], a[104:107], v[200:203]
    ds_read_b128 a[244:247], v43 offset:49152
    v_mfma_f32_16x16x32_bf16 v[200:203], a[252:255], a[200:203], v[200:203]
    v_mfma_f32_16x16x32_bf16 v[204:207], a[252:255], a[204:207], v[204:207]
    v_mfma_f32_16x16x32_bf16 v[204:207], a[248:251], a[108:111], v[204:207]
    s_waitcnt lgkmcnt(2)
    v_mfma_f32_16x16x32_bf16 v[204:207], a[232:235], a[28:31], v[204:207]
    ds_read_b128 a[248:251], v44 offset:49152
    v_mfma_f32_16x16x32_bf16 v[204:207], a[236:239], a[220:223], v[204:207]
    v_mfma_f32_16x16x32_bf16 v[200:203], a[236:239], a[216:219], v[200:203]
    v_mfma_f32_16x16x32_bf16 v[200:203], a[232:235], a[24:27], v[200:203]
    v_mfma_f32_16x16x32_bf16 v[196:199], a[232:235], a[20:23], v[196:199]
    ds_read_b128 a[252:255], v45 offset:49152
    v_mfma_f32_16x16x32_bf16 v[196:199], a[236:239], a[212:215], v[196:199]
    buffer_store_dwordx4 v[168:171], v1, s[4:7], s62 offen offset:1024 sc1
SENT_2:
    v_mfma_f32_16x16x32_bf16 v[192:195], a[236:239], a[208:211], v[192:195]
    v_mfma_f32_16x16x32_bf16 v[192:195], a[232:235], a[16:19], v[192:195]
    s_waitcnt lgkmcnt(2)
    v_mfma_f32_16x16x32_bf16 v[192:195], a[240:243], a[32:35], v[192:195]
    ds_read_b128 a[232:235], v38 offset:24576
    v_mfma_f32_16x16x32_bf16 v[192:195], a[244:247], a[48:51], v[192:195]
    v_mfma_f32_16x16x32_bf16 v[196:199], a[244:247], a[52:55], v[196:199]
    v_mfma_f32_16x16x32_bf16 v[196:199], a[240:243], a[36:39], v[196:199]
    v_mfma_f32_16x16x32_bf16 v[200:203], a[240:243], a[40:43], v[200:203]
    ds_read_b128 a[236:239], v39 offset:24576
    v_mfma_f32_16x16x32_bf16 v[200:203], a[244:247], a[56:59], v[200:203]
    v_mfma_f32_16x16x32_bf16 v[204:207], a[244:247], a[60:63], v[204:207]
    v_mfma_f32_16x16x32_bf16 v[204:207], a[240:243], a[44:47], v[204:207]
    s_waitcnt lgkmcnt(2)
    v_mfma_f32_16x16x32_bf16 v[204:207], a[248:251], a[76:79], v[204:207]
    ds_read_b128 a[240:243], v40 offset:24576
    v_mfma_f32_16x16x32_bf16 v[204:207], a[252:255], a[172:175], v[204:207]
    v_mfma_f32_16x16x32_bf16 v[200:203], a[252:255], a[168:171], v[200:203]
    v_mfma_f32_16x16x32_bf16 v[200:203], a[248:251], a[72:75], v[200:203]
    v_mfma_f32_16x16x32_bf16 v[196:199], a[248:251], a[68:71], v[196:199]
    s_xor_b32 s62, s0, 1441792
    ds_read_b128 a[244:247], v41 offset:24576
    v_mfma_f32_16x16x32_bf16 v[196:199], a[252:255], a[164:167], v[196:199]
    v_mfma_f32_16x16x32_bf16 v[192:195], a[252:255], a[160:163], v[192:195]
    v_mfma_f32_16x16x32_bf16 v[192:195], a[248:251], a[64:67], v[192:195]
    s_waitcnt lgkmcnt(2)
    v_mfma_f32_16x16x32_bf16 v[224:227], a[232:235], a[80:83], v[224:227]
    ds_read_b128 a[248:251], v38 offset:57344
    v_mfma_f32_16x16x32_bf16 v[224:227], a[236:239], a[112:115], v[224:227]
    v_mfma_f32_16x16x32_bf16 v[228:231], a[236:239], a[116:119], v[228:231]
    v_mfma_f32_16x16x32_bf16 v[228:231], a[232:235], a[84:87], v[228:231]
    v_mfma_f32_16x16x32_bf16 v[232:235], a[232:235], a[88:91], v[232:235]
    ds_read_b128 a[252:255], v39 offset:57344
    v_cvt_pk_bf16_f32 v192, v192, v193
    v_mfma_f32_16x16x32_bf16 v[232:235], a[236:239], a[120:123], v[232:235]
    v_cvt_pk_bf16_f32 v193, v194, v195
    v_cvt_pk_bf16_f32 v194, v196, v197
    v_mfma_f32_16x16x32_bf16 v[236:239], a[236:239], a[124:127], v[236:239]
    v_cvt_pk_bf16_f32 v195, v198, v199
    v_min_u32 v192, -2, v192
    v_mfma_f32_16x16x32_bf16 v[236:239], a[232:235], a[92:95], v[236:239]
    s_waitcnt lgkmcnt(2)
    v_min_u32 v193, -2, v193
    v_min_u32 v194, -2, v194
    v_mfma_f32_16x16x32_bf16 v[236:239], a[240:243], a[140:143], v[236:239]
    ds_read_b128 a[232:235], v40 offset:57344
    v_min_u32 v195, -2, v195
    v_mfma_f32_16x16x32_bf16 v[236:239], a[244:247], a[188:191], v[236:239]
    buffer_store_dwordx4 v[192:195], v1, s[4:7], s62 offen offset:0 sc1
    v_mfma_f32_16x16x32_bf16 v[232:235], a[244:247], a[184:187], v[232:235]
    v_cvt_pk_bf16_f32 v200, v200, v201
    v_cvt_pk_bf16_f32 v201, v202, v203
    v_mfma_f32_16x16x32_bf16 v[232:235], a[240:243], a[136:139], v[232:235]
    v_cvt_pk_bf16_f32 v202, v204, v205
    v_cvt_pk_bf16_f32 v203, v206, v207
    v_mfma_f32_16x16x32_bf16 v[228:231], a[240:243], a[132:135], v[228:231]
    ds_read_b128 a[236:239], v41 offset:57344
    v_min_u32 v200, -2, v200
    v_mfma_f32_16x16x32_bf16 v[228:231], a[244:247], a[180:183], v[228:231]
    v_min_u32 v201, -2, v201
    v_min_u32 v202, -2, v202
    v_mfma_f32_16x16x32_bf16 v[224:227], a[244:247], a[176:179], v[224:227]
    v_min_u32 v203, -2, v203
    v_mfma_f32_16x16x32_bf16 v[224:227], a[240:243], a[128:131], v[224:227]
    s_waitcnt lgkmcnt(2)
    v_mfma_f32_16x16x32_bf16 v[224:227], a[248:251], a[96:99], v[224:227]
    ds_read_b128 a[240:243], v42 offset:57344
    v_mfma_f32_16x16x32_bf16 v[224:227], a[252:255], a[192:195], v[224:227]
    v_mfma_f32_16x16x32_bf16 v[228:231], a[252:255], a[196:199], v[228:231]
    v_mfma_f32_16x16x32_bf16 v[228:231], a[248:251], a[100:103], v[228:231]
    v_mfma_f32_16x16x32_bf16 v[232:235], a[248:251], a[104:107], v[232:235]
    ds_read_b128 a[244:247], v43 offset:57344
    v_mfma_f32_16x16x32_bf16 v[232:235], a[252:255], a[200:203], v[232:235]
    v_mfma_f32_16x16x32_bf16 v[236:239], a[252:255], a[204:207], v[236:239]
    v_mfma_f32_16x16x32_bf16 v[236:239], a[248:251], a[108:111], v[236:239]
    s_waitcnt lgkmcnt(2)
    v_mfma_f32_16x16x32_bf16 v[236:239], a[232:235], a[28:31], v[236:239]
    ds_read_b128 a[248:251], v44 offset:57344
    v_mfma_f32_16x16x32_bf16 v[236:239], a[236:239], a[220:223], v[236:239]
    v_mfma_f32_16x16x32_bf16 v[232:235], a[236:239], a[216:219], v[232:235]
    v_mfma_f32_16x16x32_bf16 v[232:235], a[232:235], a[24:27], v[232:235]
    v_mfma_f32_16x16x32_bf16 v[228:231], a[232:235], a[20:23], v[228:231]
    ds_read_b128 a[252:255], v45 offset:57344
    v_mfma_f32_16x16x32_bf16 v[228:231], a[236:239], a[212:215], v[228:231]
    buffer_store_dwordx4 v[200:203], v1, s[4:7], s62 offen offset:1024 sc1
SENT_4:
    v_mfma_f32_16x16x32_bf16 v[224:227], a[236:239], a[208:211], v[224:227]
    v_mfma_f32_16x16x32_bf16 v[224:227], a[232:235], a[16:19], v[224:227]
    s_waitcnt lgkmcnt(2)
    v_mfma_f32_16x16x32_bf16 v[224:227], a[240:243], a[32:35], v[224:227]
    ds_read_b128 a[232:235], v38 offset:12288
    v_mfma_f32_16x16x32_bf16 v[224:227], a[244:247], a[48:51], v[224:227]
    v_mfma_f32_16x16x32_bf16 v[228:231], a[244:247], a[52:55], v[228:231]
    v_mfma_f32_16x16x32_bf16 v[228:231], a[240:243], a[36:39], v[228:231]
    v_mfma_f32_16x16x32_bf16 v[232:235], a[240:243], a[40:43], v[232:235]
    ds_read_b128 a[236:239], v39 offset:12288
    v_mfma_f32_16x16x32_bf16 v[232:235], a[244:247], a[56:59], v[232:235]
    v_mfma_f32_16x16x32_bf16 v[236:239], a[244:247], a[60:63], v[236:239]
    v_mfma_f32_16x16x32_bf16 v[236:239], a[240:243], a[44:47], v[236:239]
    s_waitcnt lgkmcnt(2)
    v_mfma_f32_16x16x32_bf16 v[236:239], a[248:251], a[76:79], v[236:239]
    ds_read_b128 a[240:243], v40 offset:12288
    v_mfma_f32_16x16x32_bf16 v[236:239], a[252:255], a[172:175], v[236:239]
    buffer_load_dwordx4 v[164:167], v1, s[4:7], s57 offen offset:0 sc1
    v_mfma_f32_16x16x32_bf16 v[232:235], a[252:255], a[168:171], v[232:235]
    buffer_load_dwordx4 v[172:175], v1, s[4:7], s57 offen offset:1024 sc1
    v_mfma_f32_16x16x32_bf16 v[232:235], a[248:251], a[72:75], v[232:235]
    v_mfma_f32_16x16x32_bf16 v[228:231], a[248:251], a[68:71], v[228:231]
    s_xor_b32 s62, s0, 2031616
    ds_read_b128 a[244:247], v41 offset:12288
    v_mfma_f32_16x16x32_bf16 v[228:231], a[252:255], a[164:167], v[228:231]
    v_mfma_f32_16x16x32_bf16 v[224:227], a[252:255], a[160:163], v[224:227]
    v_mfma_f32_16x16x32_bf16 v[224:227], a[248:251], a[64:67], v[224:227]
    s_waitcnt lgkmcnt(2)
    v_mfma_f32_16x16x32_bf16 v[176:179], a[232:235], a[80:83], v[176:179]
    ds_read_b128 a[248:251], v38 offset:45056
    v_mfma_f32_16x16x32_bf16 v[176:179], a[236:239], a[112:115], v[176:179]
    v_mfma_f32_16x16x32_bf16 v[180:183], a[236:239], a[116:119], v[180:183]
    v_mfma_f32_16x16x32_bf16 v[180:183], a[232:235], a[84:87], v[180:183]
    v_mfma_f32_16x16x32_bf16 v[184:187], a[232:235], a[88:91], v[184:187]
    ds_read_b128 a[252:255], v39 offset:45056
    v_cvt_pk_bf16_f32 v224, v224, v225
    v_mfma_f32_16x16x32_bf16 v[184:187], a[236:239], a[120:123], v[184:187]
    v_cvt_pk_bf16_f32 v225, v226, v227
    v_cvt_pk_bf16_f32 v226, v228, v229
    v_mfma_f32_16x16x32_bf16 v[188:191], a[236:239], a[124:127], v[188:191]
    v_cvt_pk_bf16_f32 v227, v230, v231
    v_min_u32 v224, -2, v224
    v_mfma_f32_16x16x32_bf16 v[188:191], a[232:235], a[92:95], v[188:191]
    s_waitcnt lgkmcnt(2)
    v_min_u32 v225, -2, v225
    v_min_u32 v226, -2, v226
    v_mfma_f32_16x16x32_bf16 v[188:191], a[240:243], a[140:143], v[188:191]
    ds_read_b128 a[232:235], v40 offset:45056
    v_min_u32 v227, -2, v227
    v_mfma_f32_16x16x32_bf16 v[188:191], a[244:247], a[188:191], v[188:191]
    buffer_store_dwordx4 v[224:227], v1, s[4:7], s62 offen offset:0 sc1
    v_mfma_f32_16x16x32_bf16 v[184:187], a[244:247], a[184:187], v[184:187]
    v_cvt_pk_bf16_f32 v232, v232, v233
    v_cvt_pk_bf16_f32 v233, v234, v235
    v_mfma_f32_16x16x32_bf16 v[184:187], a[240:243], a[136:139], v[184:187]
    v_cvt_pk_bf16_f32 v234, v236, v237
    v_cvt_pk_bf16_f32 v235, v238, v239
    v_mfma_f32_16x16x32_bf16 v[180:183], a[240:243], a[132:135], v[180:183]
    ds_read_b128 a[236:239], v41 offset:45056
    v_min_u32 v232, -2, v232
    v_mfma_f32_16x16x32_bf16 v[180:183], a[244:247], a[180:183], v[180:183]
    v_min_u32 v233, -2, v233
    v_min_u32 v234, -2, v234
    v_mfma_f32_16x16x32_bf16 v[176:179], a[244:247], a[176:179], v[176:179]
    v_min_u32 v235, -2, v235
    v_mfma_f32_16x16x32_bf16 v[176:179], a[240:243], a[128:131], v[176:179]
    s_waitcnt lgkmcnt(2)
    v_mfma_f32_16x16x32_bf16 v[176:179], a[248:251], a[96:99], v[176:179]
    ds_read_b128 a[240:243], v42 offset:45056
    v_mfma_f32_16x16x32_bf16 v[176:179], a[252:255], a[192:195], v[176:179]
    v_mfma_f32_16x16x32_bf16 v[180:183], a[252:255], a[196:199], v[180:183]
    v_mfma_f32_16x16x32_bf16 v[180:183], a[248:251], a[100:103], v[180:183]
    v_mfma_f32_16x16x32_bf16 v[184:187], a[248:251], a[104:107], v[184:187]
    ds_read_b128 a[244:247], v43 offset:45056
    v_mfma_f32_16x16x32_bf16 v[184:187], a[252:255], a[200:203], v[184:187]
    v_mfma_f32_16x16x32_bf16 v[188:191], a[252:255], a[204:207], v[188:191]
    v_mfma_f32_16x16x32_bf16 v[188:191], a[248:251], a[108:111], v[188:191]
    s_waitcnt lgkmcnt(2)
    v_mfma_f32_16x16x32_bf16 v[188:191], a[232:235], a[28:31], v[188:191]
    ds_read_b128 a[248:251], v44 offset:45056
    v_mfma_f32_16x16x32_bf16 v[188:191], a[236:239], a[220:223], v[188:191]
    v_mfma_f32_16x16x32_bf16 v[184:187], a[236:239], a[216:219], v[184:187]
    v_mfma_f32_16x16x32_bf16 v[184:187], a[232:235], a[24:27], v[184:187]
    v_mfma_f32_16x16x32_bf16 v[180:183], a[232:235], a[20:23], v[180:183]
    ds_read_b128 a[252:255], v45 offset:45056
    v_mfma_f32_16x16x32_bf16 v[180:183], a[236:239], a[212:215], v[180:183]
    buffer_store_dwordx4 v[232:235], v1, s[4:7], s62 offen offset:1024 sc1
SENT_6:
    v_mfma_f32_16x16x32_bf16 v[176:179], a[236:239], a[208:211], v[176:179]
    v_mfma_f32_16x16x32_bf16 v[176:179], a[232:235], a[16:19], v[176:179]
    s_waitcnt lgkmcnt(2)
    v_mfma_f32_16x16x32_bf16 v[176:179], a[240:243], a[32:35], v[176:179]
    ds_read_b128 a[232:235], v38 offset:20480
    v_mfma_f32_16x16x32_bf16 v[176:179], a[244:247], a[48:51], v[176:179]
    v_mfma_f32_16x16x32_bf16 v[180:183], a[244:247], a[52:55], v[180:183]
    v_mfma_f32_16x16x32_bf16 v[180:183], a[240:243], a[36:39], v[180:183]
    v_mfma_f32_16x16x32_bf16 v[184:187], a[240:243], a[40:43], v[184:187]
    ds_read_b128 a[236:239], v39 offset:20480
    v_mfma_f32_16x16x32_bf16 v[184:187], a[244:247], a[56:59], v[184:187]
    v_mfma_f32_16x16x32_bf16 v[188:191], a[244:247], a[60:63], v[188:191]
    v_mfma_f32_16x16x32_bf16 v[188:191], a[240:243], a[44:47], v[188:191]
    s_waitcnt lgkmcnt(2)
    v_mfma_f32_16x16x32_bf16 v[188:191], a[248:251], a[76:79], v[188:191]
    ds_read_b128 a[240:243], v40 offset:20480
    v_mfma_f32_16x16x32_bf16 v[188:191], a[252:255], a[172:175], v[188:191]
    buffer_load_dwordx4 v[196:199], v1, s[4:7], s58 offen offset:0 sc1
    v_mfma_f32_16x16x32_bf16 v[184:187], a[252:255], a[168:171], v[184:187]
    buffer_load_dwordx4 v[204:207], v1, s[4:7], s58 offen offset:1024 sc1
    v_mfma_f32_16x16x32_bf16 v[184:187], a[248:251], a[72:75], v[184:187]
    v_mfma_f32_16x16x32_bf16 v[180:183], a[248:251], a[68:71], v[180:183]
    s_xor_b32 s62, s0, 851968
    ds_read_b128 a[244:247], v41 offset:20480
    v_mfma_f32_16x16x32_bf16 v[180:183], a[252:255], a[164:167], v[180:183]
    v_mfma_f32_16x16x32_bf16 v[176:179], a[252:255], a[160:163], v[176:179]
    v_mfma_f32_16x16x32_bf16 v[176:179], a[248:251], a[64:67], v[176:179]
    s_waitcnt lgkmcnt(2)
    v_mfma_f32_16x16x32_bf16 v[208:211], a[232:235], a[80:83], v[208:211]
    ds_read_b128 a[248:251], v38 offset:53248
    v_mfma_f32_16x16x32_bf16 v[208:211], a[236:239], a[112:115], v[208:211]
    v_mfma_f32_16x16x32_bf16 v[212:215], a[236:239], a[116:119], v[212:215]
    v_mfma_f32_16x16x32_bf16 v[212:215], a[232:235], a[84:87], v[212:215]
    v_mfma_f32_16x16x32_bf16 v[216:219], a[232:235], a[88:91], v[216:219]
    ds_read_b128 a[252:255], v39 offset:53248
    v_cvt_pk_bf16_f32 v176, v176, v177
    v_mfma_f32_16x16x32_bf16 v[216:219], a[236:239], a[120:123], v[216:219]
    v_cvt_pk_bf16_f32 v177, v178, v179
    v_cvt_pk_bf16_f32 v178, v180, v181
    v_mfma_f32_16x16x32_bf16 v[220:223], a[236:239], a[124:127], v[220:223]
    v_cvt_pk_bf16_f32 v179, v182, v183
    v_min_u32 v176, -2, v176
    v_mfma_f32_16x16x32_bf16 v[220:223], a[232:235], a[92:95], v[220:223]
    s_waitcnt lgkmcnt(2)
    v_min_u32 v177, -2, v177
    v_min_u32 v178, -2, v178
    v_mfma_f32_16x16x32_bf16 v[220:223], a[240:243], a[140:143], v[220:223]
    ds_read_b128 a[232:235], v40 offset:53248
    v_min_u32 v179, -2, v179
    v_mfma_f32_16x16x32_bf16 v[220:223], a[244:247], a[188:191], v[220:223]
    buffer_store_dwordx4 v[176:179], v1, s[4:7], s62 offen offset:2048 sc1
    v_mfma_f32_16x16x32_bf16 v[216:219], a[244:247], a[184:187], v[216:219]
    v_cvt_pk_bf16_f32 v184, v184, v185
    v_cvt_pk_bf16_f32 v185, v186, v187
    v_mfma_f32_16x16x32_bf16 v[216:219], a[240:243], a[136:139], v[216:219]
    v_cvt_pk_bf16_f32 v186, v188, v189
    v_cvt_pk_bf16_f32 v187, v190, v191
    v_mfma_f32_16x16x32_bf16 v[212:215], a[240:243], a[132:135], v[212:215]
    ds_read_b128 a[236:239], v41 offset:53248
    v_min_u32 v184, -2, v184
    v_mfma_f32_16x16x32_bf16 v[212:215], a[244:247], a[180:183], v[212:215]
    v_min_u32 v185, -2, v185
    v_min_u32 v186, -2, v186
    v_mfma_f32_16x16x32_bf16 v[208:211], a[244:247], a[176:179], v[208:211]
    v_min_u32 v187, -2, v187
    v_mfma_f32_16x16x32_bf16 v[208:211], a[240:243], a[128:131], v[208:211]
    s_waitcnt lgkmcnt(2)
    v_mfma_f32_16x16x32_bf16 v[208:211], a[248:251], a[96:99], v[208:211]
    s_waitcnt vmcnt(5)
    ds_read_b128 a[240:243], v42 offset:53248
    v_max3_u32 v68, v164, v165, v166
    v_mfma_f32_16x16x32_bf16 v[208:211], a[252:255], a[192:195], v[208:211]
    v_max3_u32 v69, v167, v172, v173
    v_max3_u32 v68, v68, v174, v175
    v_mfma_f32_16x16x32_bf16 v[212:215], a[252:255], a[196:199], v[212:215]
    v_max_u32 v68, v68, v69
    v_cmp_eq_u32 vcc, -1, v68
    v_mfma_f32_16x16x32_bf16 v[212:215], a[248:251], a[100:103], v[212:215]
    s_cbranch_vccnz SLOW_X2
BACK_X2:
    v_lshlrev_b32 v160, 16, v164
    v_and_b32 v161, s54, v164
    v_mfma_f32_16x16x32_bf16 v[216:219], a[248:251], a[104:107], v[216:219]
    ds_read_b128 a[244:247], v43 offset:53248
    v_lshlrev_b32 v162, 16, v165
    v_mfma_f32_16x16x32_bf16 v[216:219], a[252:255], a[200:203], v[216:219]
    v_and_b32 v163, s54, v165
    v_add_f32 v80, v80, v160
    v_mfma_f32_16x16x32_bf16 v[220:223], a[252:255], a[204:207], v[220:223]
    v_add_f32 v81, v81, v161
    v_add_f32 v82, v82, v162
    v_mfma_f32_16x16x32_bf16 v[220:223], a[248:251], a[108:111], v[220:223]
    s_waitcnt lgkmcnt(2)
    v_add_f32 v83, v83, v163
    v_lshlrev_b32 v160, 16, v166
    v_mfma_f32_16x16x32_bf16 v[220:223], a[232:235], a[28:31], v[220:223]
    ds_read_b128 a[248:251], v44 offset:53248
    v_and_b32 v161, s54, v166
    v_mfma_f32_16x16x32_bf16 v[220:223], a[236:239], a[220:223], v[220:223]
    v_lshlrev_b32 v162, 16, v167
    v_and_b32 v163, s54, v167
    v_mfma_f32_16x16x32_bf16 v[216:219], a[236:239], a[216:219], v[216:219]
    v_add_f32 v84, v84, v160
    v_add_f32 v85, v85, v161
    v_mfma_f32_16x16x32_bf16 v[216:219], a[232:235], a[24:27], v[216:219]
    v_add_f32 v86, v86, v162
    v_add_f32 v87, v87, v163
    v_mfma_f32_16x16x32_bf16 v[212:215], a[232:235], a[20:23], v[212:215]
    ds_read_b128 a[252:255], v45 offset:53248
    v_lshlrev_b32 v168, 16, v172
    v_mfma_f32_16x16x32_bf16 v[212:215], a[236:239], a[212:215], v[212:215]
    buffer_store_dwordx4 v[184:187], v1, s[4:7], s62 offen offset:3072 sc1
SENT_3:
    v_mfma_f32_16x16x32_bf16 v[208:211], a[236:239], a[208:211], v[208:211]
    v_and_b32 v169, s54, v172
    v_lshlrev_b32 v170, 16, v173
    v_mfma_f32_16x16x32_bf16 v[208:211], a[232:235], a[16:19], v[208:211]
    s_waitcnt lgkmcnt(2)
    v_and_b32 v171, s54, v173
    v_add_f32 v88, v88, v168
    v_mfma_f32_16x16x32_bf16 v[208:211], a[240:243], a[32:35], v[208:211]
    ds_read_b128 a[232:235], v38 offset:28672
    v_add_f32 v89, v89, v169
    v_mfma_f32_16x16x32_bf16 v[208:211], a[244:247], a[48:51], v[208:211]
    v_add_f32 v90, v90, v170
    v_add_f32 v91, v91, v171
    v_mfma_f32_16x16x32_bf16 v[212:215], a[244:247], a[52:55], v[212:215]
    v_lshlrev_b32 v168, 16, v174
    v_and_b32 v169, s54, v174
    v_mfma_f32_16x16x32_bf16 v[212:215], a[240:243], a[36:39], v[212:215]
    v_lshlrev_b32 v170, 16, v175
    v_and_b32 v171, s54, v175
    v_mfma_f32_16x16x32_bf16 v[216:219], a[240:243], a[40:43], v[216:219]
    ds_read_b128 a[236:239], v39 offset:28672
    v_add_f32 v92, v92, v168
    v_mfma_f32_16x16x32_bf16 v[216:219], a[244:247], a[56:59], v[216:219]
    v_add_f32 v93, v93, v169
    v_add_f32 v94, v94, v170
    v_mfma_f32_16x16x32_bf16 v[220:223], a[244:247], a[60:63], v[220:223]
    v_add_f32 v95, v95, v171
    v_mfma_f32_16x16x32_bf16 v[220:223], a[240:243], a[44:47], v[220:223]
    s_waitcnt lgkmcnt(2)
    v_mfma_f32_16x16x32_bf16 v[220:223], a[248:251], a[76:79], v[220:223]
    ds_read_b128 a[240:243], v40 offset:28672
    v_mfma_f32_16x16x32_bf16 v[220:223], a[252:255], a[172:175], v[220:223]
    buffer_load_dwordx4 v[228:231], v1, s[4:7], s59 offen offset:0 sc1
    v_mfma_f32_16x16x32_bf16 v[216:219], a[252:255], a[168:171], v[216:219]
    buffer_load_dwordx4 v[236:239], v1, s[4:7], s59 offen offset:1024 sc1
    v_mfma_f32_16x16x32_bf16 v[216:219], a[248:251], a[72:75], v[216:219]
    v_mfma_f32_16x16x32_bf16 v[212:215], a[248:251], a[68:71], v[212:215]
    s_xor_b32 s62, s0, 1441792
    ds_read_b128 a[244:247], v41 offset:28672
    v_mfma_f32_16x16x32_bf16 v[212:215], a[252:255], a[164:167], v[212:215]
    v_mfma_f32_16x16x32_bf16 v[208:211], a[252:255], a[160:163], v[208:211]
    v_mfma_f32_16x16x32_bf16 v[208:211], a[248:251], a[64:67], v[208:211]
    s_waitcnt lgkmcnt(2)
    v_mfma_f32_16x16x32_bf16 v[240:243], a[232:235], a[80:83], v[240:243]
    ds_read_b128 a[248:251], v38 offset:61440
    v_mfma_f32_16x16x32_bf16 v[240:243], a[236:239], a[112:115], v[240:243]
    v_mfma_f32_16x16x32_bf16 v[244:247], a[236:239], a[116:119], v[244:247]
    v_mfma_f32_16x16x32_bf16 v[244:247], a[232:235], a[84:87], v[244:247]
    v_mfma_f32_16x16x32_bf16 v[248:251], a[232:235], a[88:91], v[248:251]
    ds_read_b128 a[252:255], v39 offset:61440
    v_cvt_pk_bf16_f32 v208, v208, v209
    v_mfma_f32_16x16x32_bf16 v[248:251], a[236:239], a[120:123], v[248:251]
    v_cvt_pk_bf16_f32 v209, v210, v211
    v_cvt_pk_bf16_f32 v210, v212, v213
    v_mfma_f32_16x16x32_bf16 v[252:255], a[236:239], a[124:127], v[252:255]
    v_cvt_pk_bf16_f32 v211, v214, v215
    v_min_u32 v208, -2, v208
    v_mfma_f32_16x16x32_bf16 v[252:255], a[232:235], a[92:95], v[252:255]
    s_waitcnt lgkmcnt(2)
    v_min_u32 v209, -2, v209
    v_min_u32 v210, -2, v210
    v_mfma_f32_16x16x32_bf16 v[252:255], a[240:243], a[140:143], v[252:255]
    ds_read_b128 a[232:235], v40 offset:61440
    v_min_u32 v211, -2, v211
    v_mfma_f32_16x16x32_bf16 v[252:255], a[244:247], a[188:191], v[252:255]
    buffer_store_dwordx4 v[208:211], v1, s[4:7], s62 offen offset:2048 sc1
    v_mfma_f32_16x16x32_bf16 v[248:251], a[244:247], a[184:187], v[248:251]
    v_cvt_pk_bf16_f32 v216, v216, v217
    v_cvt_pk_bf16_f32 v217, v218, v219
    v_mfma_f32_16x16x32_bf16 v[248:251], a[240:243], a[136:139], v[248:251]
    v_cvt_pk_bf16_f32 v218, v220, v221
    v_cvt_pk_bf16_f32 v219, v222, v223
    v_mfma_f32_16x16x32_bf16 v[244:247], a[240:243], a[132:135], v[244:247]
    ds_read_b128 a[236:239], v41 offset:61440
    v_min_u32 v216, -2, v216
    v_mfma_f32_16x16x32_bf16 v[244:247], a[244:247], a[180:183], v[244:247]
    v_min_u32 v217, -2, v217
    v_min_u32 v218, -2, v218
    v_mfma_f32_16x16x32_bf16 v[240:243], a[244:247], a[176:179], v[240:243]
    v_min_u32 v219, -2, v219
    v_mfma_f32_16x16x32_bf16 v[240:243], a[240:243], a[128:131], v[240:243]
    s_waitcnt lgkmcnt(2)
    v_mfma_f32_16x16x32_bf16 v[240:243], a[248:251], a[96:99], v[240:243]
    s_waitcnt vmcnt(5)
    ds_read_b128 a[240:243], v42 offset:61440
    v_max3_u32 v68, v196, v197, v198
    v_mfma_f32_16x16x32_bf16 v[240:243], a[252:255], a[192:195], v[240:243]
    v_max3_u32 v69, v199, v204, v205
    v_max3_u32 v68, v68, v206, v207
    v_mfma_f32_16x16x32_bf16 v[244:247], a[252:255], a[196:199], v[244:247]
    v_max_u32 v68, v68, v69
    v_cmp_eq_u32 vcc, -1, v68
    v_mfma_f32_16x16x32_bf16 v[244:247], a[248:251], a[100:103], v[244:247]
    s_cbranch_vccnz SLOW_X4
BACK_X4:
    v_lshlrev_b32 v192, 16, v196
    v_and_b32 v193, s54, v196
    v_mfma_f32_16x16x32_bf16 v[248:251], a[248:251], a[104:107], v[248:251]
    ds_read_b128 a[244:247], v43 offset:61440
    v_lshlrev_b32 v194, 16, v197
    v_mfma_f32_16x16x32_bf16 v[248:251], a[252:255], a[200:203], v[248:251]
    v_and_b32 v195, s54, v197
    v_add_f32 v80, v80, v192
    v_mfma_f32_16x16x32_bf16 v[252:255], a[252:255], a[204:207], v[252:255]
    v_add_f32 v81, v81, v193
    v_add_f32 v82, v82, v194
    v_mfma_f32_16x16x32_bf16 v[252:255], a[248:251], a[108:111], v[252:255]
    s_waitcnt lgkmcnt(2)
    v_add_f32 v83, v83, v195
    v_lshlrev_b32 v192, 16, v198
    v_mfma_f32_16x16x32_bf16 v[252:255], a[232:235], a[28:31], v[252:255]
    ds_read_b128 a[248:251], v44 offset:61440
    v_and_b32 v193, s54, v198
    v_mfma_f32_16x16x32_bf16 v[252:255], a[236:239], a[220:223], v[252:255]
    v_lshlrev_b32 v194, 16, v199
    v_and_b32 v195, s54, v199
    v_mfma_f32_16x16x32_bf16 v[248:251], a[236:239], a[216:219], v[248:251]
    v_add_f32 v84, v84, v192
    v_add_f32 v85, v85, v193
    v_mfma_f32_16x16x32_bf16 v[248:251], a[232:235], a[24:27], v[248:251]
    v_add_f32 v86, v86, v194
    v_add_f32 v87, v87, v195
    v_mfma_f32_16x16x32_bf16 v[244:247], a[232:235], a[20:23], v[244:247]
    ds_read_b128 a[252:255], v45 offset:61440
    v_lshlrev_b32 v200, 16, v204
    v_mfma_f32_16x16x32_bf16 v[244:247], a[236:239], a[212:215], v[244:247]
    buffer_store_dwordx4 v[216:219], v1, s[4:7], s62 offen offset:3072 sc1
SENT_5:
    v_mfma_f32_16x16x32_bf16 v[240:243], a[236:239], a[208:211], v[240:243]
    v_and_b32 v201, s54, v204
    v_lshlrev_b32 v202, 16, v205
    v_mfma_f32_16x16x32_bf16 v[240:243], a[232:235], a[16:19], v[240:243]
    s_waitcnt lgkmcnt(2)
    v_and_b32 v203, s54, v205
    v_add_f32 v88, v88, v200
    v_mfma_f32_16x16x32_bf16 v[240:243], a[240:243], a[32:35], v[240:243]
    ds_read_b128 a[232:235], v44 offset:0
    v_add_f32 v89, v89, v201
    v_mfma_f32_16x16x32_bf16 v[240:243], a[244:247], a[48:51], v[240:243]
    v_add_f32 v90, v90, v202
    v_add_f32 v91, v91, v203
    v_mfma_f32_16x16x32_bf16 v[244:247], a[244:247], a[52:55], v[244:247]
    v_lshlrev_b32 v200, 16, v206
    v_and_b32 v201, s54, v206
    v_mfma_f32_16x16x32_bf16 v[244:247], a[240:243], a[36:39], v[244:247]
    v_lshlrev_b32 v202, 16, v207
    v_and_b32 v203, s54, v207
    v_mfma_f32_16x16x32_bf16 v[248:251], a[240:243], a[40:43], v[248:251]
    ds_read_b128 a[236:239], v45 offset:0
    v_add_f32 v92, v92, v200
    v_mfma_f32_16x16x32_bf16 v[248:251], a[244:247], a[56:59], v[248:251]
    v_add_f32 v93, v93, v201
    v_add_f32 v94, v94, v202
    v_mfma_f32_16x16x32_bf16 v[252:255], a[244:247], a[60:63], v[252:255]
    v_add_f32 v95, v95, v203
    v_mfma_f32_16x16x32_bf16 v[252:255], a[240:243], a[44:47], v[252:255]
    s_waitcnt lgkmcnt(2)
    v_mfma_f32_16x16x32_bf16 v[252:255], a[248:251], a[76:79], v[252:255]
    ds_read_b128 a[240:243], v38 offset:0
    v_mfma_f32_16x16x32_bf16 v[252:255], a[252:255], a[172:175], v[252:255]
    buffer_load_dwordx4 v[180:183], v1, s[4:7], s57 offen offset:2048 sc1
    v_mfma_f32_16x16x32_bf16 v[248:251], a[252:255], a[168:171], v[248:251]
    buffer_load_dwordx4 v[188:191], v1, s[4:7], s57 offen offset:3072 sc1
    v_mfma_f32_16x16x32_bf16 v[248:251], a[248:251], a[72:75], v[248:251]
    v_mfma_f32_16x16x32_bf16 v[244:247], a[248:251], a[68:71], v[244:247]
    s_xor_b32 s62, s0, 2031616
    ds_read_b128 a[244:247], v39 offset:0
    v_mfma_f32_16x16x32_bf16 v[244:247], a[252:255], a[164:167], v[244:247]
    v_mfma_f32_16x16x32_bf16 v[240:243], a[252:255], a[160:163], v[240:243]
    v_mfma_f32_16x16x32_bf16 v[240:243], a[248:251], a[64:67], v[240:243]
    s_waitcnt lgkmcnt(2)
    v_mfma_f32_16x16x32_bf16 v[128:131], a[232:235], a[144:147], v[128:131]
    ds_read_b128 a[248:251], v40 offset:0
    v_mfma_f32_16x16x32_bf16 v[128:131], a[236:239], a[0:3], v[128:131]
    v_mfma_f32_16x16x32_bf16 v[132:135], a[236:239], a[4:7], v[132:135]
    v_mfma_f32_16x16x32_bf16 v[132:135], a[232:235], a[148:151], v[132:135]
    v_mfma_f32_16x16x32_bf16 v[136:139], a[232:235], a[152:155], v[136:139]
    ds_read_b128 a[252:255], v41 offset:0
    v_cvt_pk_bf16_f32 v240, v240, v241
    v_mfma_f32_16x16x32_bf16 v[136:139], a[236:239], a[8:11], v[136:139]
    v_cvt_pk_bf16_f32 v241, v242, v243
    v_cvt_pk_bf16_f32 v242, v244, v245
    v_mfma_f32_16x16x32_bf16 v[140:143], a[236:239], a[12:15], v[140:143]
    v_cvt_pk_bf16_f32 v243, v246, v247
    v_min_u32 v240, -2, v240
    v_mfma_f32_16x16x32_bf16 v[140:143], a[232:235], a[156:159], v[140:143]
    s_waitcnt lgkmcnt(2)
    v_min_u32 v241, -2, v241
    v_min_u32 v242, -2, v242
    v_mfma_f32_16x16x32_bf16 v[140:143], a[240:243], a[92:95], v[140:143]
    ds_read_b128 a[232:235], v38 offset:32768
    v_min_u32 v243, -2, v243
    v_mfma_f32_16x16x32_bf16 v[140:143], a[244:247], a[124:127], v[140:143]
    buffer_store_dwordx4 v[240:243], v1, s[4:7], s62 offen offset:2048 sc1
    v_mfma_f32_16x16x32_bf16 v[136:139], a[244:247], a[120:123], v[136:139]
    v_cvt_pk_bf16_f32 v248, v248, v249
    v_cvt_pk_bf16_f32 v249, v250, v251
    v_mfma_f32_16x16x32_bf16 v[136:139], a[240:243], a[88:91], v[136:139]
    v_cvt_pk_bf16_f32 v250, v252, v253
    v_cvt_pk_bf16_f32 v251, v254, v255
    v_mfma_f32_16x16x32_bf16 v[132:135], a[240:243], a[84:87], v[132:135]
    ds_read_b128 a[236:239], v39 offset:32768
    v_min_u32 v248, -2, v248
    v_mfma_f32_16x16x32_bf16 v[132:135], a[244:247], a[116:119], v[132:135]
    v_min_u32 v249, -2, v249
    v_min_u32 v250, -2, v250
    v_mfma_f32_16x16x32_bf16 v[128:131], a[244:247], a[112:115], v[128:131]
    v_min_u32 v251, -2, v251
    v_mfma_f32_16x16x32_bf16 v[128:131], a[240:243], a[80:83], v[128:131]
    s_waitcnt lgkmcnt(2)
    buffer_store_dwordx4 v[248:251], v1, s[4:7], s62 offen offset:3072 sc1
SENT_7:
    v_mfma_f32_16x16x32_bf16 v[128:131], a[248:251], a[128:131], v[128:131]
    s_waitcnt vmcnt(6)
    ds_read_b128 a[240:243], v40 offset:32768
    v_max3_u32 v68, v228, v229, v230
    v_mfma_f32_16x16x32_bf16 v[128:131], a[252:255], a[176:179], v[128:131]
    v_max3_u32 v69, v231, v236, v237
    v_max3_u32 v68, v68, v238, v239
    v_mfma_f32_16x16x32_bf16 v[132:135], a[252:255], a[180:183], v[132:135]
    v_max_u32 v68, v68, v69
    v_cmp_eq_u32 vcc, -1, v68
    v_mfma_f32_16x16x32_bf16 v[132:135], a[248:251], a[132:135], v[132:135]
    s_cbranch_vccnz SLOW_X6
BACK_X6:
    v_lshlrev_b32 v224, 16, v228
    v_and_b32 v225, s54, v228
    v_mfma_f32_16x16x32_bf16 v[136:139], a[248:251], a[136:139], v[136:139]
    ds_read_b128 a[244:247], v41 offset:32768
    v_lshlrev_b32 v226, 16, v229
    v_mfma_f32_16x16x32_bf16 v[136:139], a[252:255], a[184:187], v[136:139]
    v_and_b32 v227, s54, v229
    v_add_f32 v80, v80, v224
    v_mfma_f32_16x16x32_bf16 v[140:143], a[252:255], a[188:191], v[140:143]
    v_add_f32 v81, v81, v225
    v_add_f32 v82, v82, v226
    v_mfma_f32_16x16x32_bf16 v[140:143], a[248:251], a[140:143], v[140:143]
    s_waitcnt lgkmcnt(2)
    v_add_f32 v83, v83, v227
    v_lshlrev_b32 v224, 16, v230
    v_mfma_f32_16x16x32_bf16 v[140:143], a[232:235], a[108:111], v[140:143]
    ds_read_b128 a[248:251], v42 offset:32768
    v_and_b32 v225, s54, v230
    v_mfma_f32_16x16x32_bf16 v[140:143], a[236:239], a[204:207], v[140:143]
    v_lshlrev_b32 v226, 16, v231
    v_and_b32 v227, s54, v231
    v_mfma_f32_16x16x32_bf16 v[136:139], a[236:239], a[200:203], v[136:139]
    v_add_f32 v84, v84, v224
    v_add_f32 v85, v85, v225
    v_mfma_f32_16x16x32_bf16 v[136:139], a[232:235], a[104:107], v[136:139]
    v_add_f32 v86, v86, v226
    v_add_f32 v87, v87, v227
    v_mfma_f32_16x16x32_bf16 v[132:135], a[232:235], a[100:103], v[132:135]
    ds_read_b128 a[252:255], v43 offset:32768
    v_lshlrev_b32 v232, 16, v236
    v_mfma_f32_16x16x32_bf16 v[132:135], a[236:239], a[196:199], v[132:135]
    v_and_b32 v233, s54, v236
    v_lshlrev_b32 v234, 16, v237
    v_mfma_f32_16x16x32_bf16 v[128:131], a[236:239], a[192:195], v[128:131]
    v_and_b32 v235, s54, v237
    v_add_f32 v88, v88, v232
    v_mfma_f32_16x16x32_bf16 v[128:131], a[232:235], a[96:99], v[128:131]
    s_waitcnt lgkmcnt(2)
    v_add_f32 v89, v89, v233
    v_add_f32 v90, v90, v234
    v_mfma_f32_16x16x32_bf16 v[128:131], a[240:243], a[16:19], v[128:131]
    ds_read_b128 a[232:235], v44 offset:32768
    v_add_f32 v91, v91, v235
    v_mfma_f32_16x16x32_bf16 v[128:131], a[244:247], a[208:211], v[128:131]
    v_lshlrev_b32 v232, 16, v238
    v_and_b32 v233, s54, v238
    v_mfma_f32_16x16x32_bf16 v[132:135], a[244:247], a[212:215], v[132:135]
    v_lshlrev_b32 v234, 16, v239
    v_and_b32 v235, s54, v239
    v_mfma_f32_16x16x32_bf16 v[132:135], a[240:243], a[20:23], v[132:135]
    v_add_f32 v92, v92, v232
    v_add_f32 v93, v93, v233
    v_mfma_f32_16x16x32_bf16 v[136:139], a[240:243], a[24:27], v[136:139]
    ds_read_b128 a[236:239], v45 offset:32768
    v_add_f32 v94, v94, v234
    v_mfma_f32_16x16x32_bf16 v[136:139], a[244:247], a[216:219], v[136:139]
    v_add_f32 v95, v95, v235
    v_mfma_f32_16x16x32_bf16 v[140:143], a[244:247], a[220:223], v[140:143]
    v_mfma_f32_16x16x32_bf16 v[140:143], a[240:243], a[28:31], v[140:143]
    s_waitcnt lgkmcnt(2)
    v_mfma_f32_16x16x32_bf16 v[140:143], a[248:251], a[44:47], v[140:143]
    ds_read_b128 a[240:243], v44 offset:4096
    v_mfma_f32_16x16x32_bf16 v[140:143], a[252:255], a[60:63], v[140:143]
    buffer_load_dwordx4 v[212:215], v1, s[4:7], s58 offen offset:2048 sc1
    v_mfma_f32_16x16x32_bf16 v[136:139], a[252:255], a[56:59], v[136:139]
    buffer_load_dwordx4 v[220:223], v1, s[4:7], s58 offen offset:3072 sc1
    v_mfma_f32_16x16x32_bf16 v[136:139], a[248:251], a[40:43], v[136:139]
    v_mfma_f32_16x16x32_bf16 v[132:135], a[248:251], a[36:39], v[132:135]
    ds_read_b128 a[244:247], v45 offset:4096
    v_mfma_f32_16x16x32_bf16 v[132:135], a[252:255], a[52:55], v[132:135]
    v_mfma_f32_16x16x32_bf16 v[128:131], a[252:255], a[48:51], v[128:131]
    v_mfma_f32_16x16x32_bf16 v[128:131], a[248:251], a[32:35], v[128:131]
    s_waitcnt lgkmcnt(2)
    v_mfma_f32_16x16x32_bf16 v[128:131], a[232:235], a[64:67], v[128:131]
    ds_read_b128 a[248:251], v38 offset:4096
    v_mfma_f32_16x16x32_bf16 v[128:131], a[236:239], a[160:163], v[128:131]
    v_mfma_f32_16x16x32_bf16 v[132:135], a[236:239], a[164:167], v[132:135]
    v_mfma_f32_16x16x32_bf16 v[132:135], a[232:235], a[68:71], v[132:135]
    v_mfma_f32_16x16x32_bf16 v[136:139], a[232:235], a[72:75], v[136:139]
    ds_read_b128 a[252:255], v39 offset:4096
    v_mfma_f32_16x16x32_bf16 v[136:139], a[236:239], a[168:171], v[136:139]
    v_mfma_f32_16x16x32_bf16 v[140:143], a[236:239], a[172:175], v[140:143]
    v_mfma_f32_16x16x32_bf16 v[140:143], a[232:235], a[76:79], v[140:143]
    s_waitcnt lgkmcnt(2)
    v_mfma_f32_16x16x32_bf16 v[156:159], a[240:243], a[156:159], v[156:159]
    ds_read_b128 a[232:235], v40 offset:4096
    v_mfma_f32_16x16x32_bf16 v[156:159], a[244:247], a[12:15], v[156:159]
    v_mfma_f32_16x16x32_bf16 v[152:155], a[244:247], a[8:11], v[152:155]
    v_mfma_f32_16x16x32_bf16 v[152:155], a[240:243], a[152:155], v[152:155]
    v_mfma_f32_16x16x32_bf16 v[148:151], a[240:243], a[148:151], v[148:151]
    ds_read_b128 a[236:239], v41 offset:4096
    v_add_f32 v128, v128, v80
    v_mfma_f32_16x16x32_bf16 v[148:151], a[244:247], a[4:7], v[148:151]
    v_add_f32 v129, v129, v81
    v_add_f32 v130, v130, v82
    v_mfma_f32_16x16x32_bf16 v[144:147], a[244:247], a[0:3], v[144:147]
    v_add_f32 v131, v131, v83
    v_mfma_f32_16x16x32_bf16 v[144:147], a[240:243], a[144:147], v[144:147]
    s_waitcnt lgkmcnt(2)
    buffer_store_dwordx4 v[128:131], v46, s[32:35], s47 offen offset:0 nt
    v_mfma_f32_16x16x32_bf16 v[144:147], a[248:251], a[80:83], v[144:147]
    s_add_u32 s47, s47, 8192
    ds_read_b128 a[240:243], v38 offset:36864
    v_add_f32 v132, v132, v84
    v_mfma_f32_16x16x32_bf16 v[144:147], a[252:255], a[112:115], v[144:147]
    v_add_f32 v133, v133, v85
    v_add_f32 v134, v134, v86
    v_mfma_f32_16x16x32_bf16 v[148:151], a[252:255], a[116:119], v[148:151]
    v_add_f32 v135, v135, v87
    v_mfma_f32_16x16x32_bf16 v[148:151], a[248:251], a[84:87], v[148:151]
    buffer_store_dwordx4 v[132:135], v46, s[32:35], s47 offen offset:0 nt
    v_mfma_f32_16x16x32_bf16 v[152:155], a[248:251], a[88:91], v[152:155]
    s_add_u32 s47, s47, 8192
    ds_read_b128 a[244:247], v39 offset:36864
    v_add_f32 v136, v136, v88
    v_mfma_f32_16x16x32_bf16 v[152:155], a[252:255], a[120:123], v[152:155]
    v_add_f32 v137, v137, v89
    v_add_f32 v138, v138, v90
    v_mfma_f32_16x16x32_bf16 v[156:159], a[252:255], a[124:127], v[156:159]
    v_add_f32 v139, v139, v91
    v_mfma_f32_16x16x32_bf16 v[156:159], a[248:251], a[92:95], v[156:159]
    s_waitcnt lgkmcnt(2)
    buffer_store_dwordx4 v[136:139], v46, s[32:35], s47 offen offset:0 nt
    v_mfma_f32_16x16x32_bf16 v[156:159], a[232:235], a[140:143], v[156:159]
    s_add_u32 s47, s47, 8192
    ds_read_b128 a[248:251], v40 offset:36864
    v_add_f32 v140, v140, v92
    v_mfma_f32_16x16x32_bf16 v[156:159], a[236:239], a[188:191], v[156:159]
    v_add_f32 v141, v141, v93
    v_add_f32 v142, v142, v94
    v_mfma_f32_16x16x32_bf16 v[152:155], a[236:239], a[184:187], v[152:155]
    v_add_f32 v143, v143, v95
    v_mfma_f32_16x16x32_bf16 v[152:155], a[232:235], a[136:139], v[152:155]
    buffer_store_dwordx4 v[140:143], v46, s[32:35], s47 offen offset:0 nt
    v_mfma_f32_16x16x32_bf16 v[148:151], a[232:235], a[132:135], v[148:151]
    s_add_u32 s47, s47, 4294942720
    ds_read_b128 a[252:255], v41 offset:36864
    s_waitcnt vmcnt(8)
    v_mfma_f32_16x16x32_bf16 v[148:151], a[236:239], a[180:183], v[148:151]
    v_max3_u32 v68, v180, v181, v182
    v_max3_u32 v69, v183, v188, v189
    v_mfma_f32_16x16x32_bf16 v[144:147], a[236:239], a[176:179], v[144:147]
    v_max3_u32 v68, v68, v190, v191
    v_max_u32 v68, v68, v69
    v_mfma_f32_16x16x32_bf16 v[144:147], a[232:235], a[128:131], v[144:147]
    s_waitcnt lgkmcnt(2)
    v_cmp_eq_u32 vcc, -1, v68
    s_cbranch_vccnz SLOW_X3
BACK_X3:
    v_mfma_f32_16x16x32_bf16 v[144:147], a[240:243], a[96:99], v[144:147]
    ds_read_b128 a[232:235], v42 offset:36864
    v_lshlrev_b32 v176, 16, v180
    v_mfma_f32_16x16x32_bf16 v[144:147], a[244:247], a[192:195], v[144:147]
    v_and_b32 v177, s54, v180
    v_lshlrev_b32 v178, 16, v181
    v_mfma_f32_16x16x32_bf16 v[148:151], a[244:247], a[196:199], v[148:151]
    v_and_b32 v179, s54, v181
    v_add_f32 v96, v96, v176
    v_mfma_f32_16x16x32_bf16 v[148:151], a[240:243], a[100:103], v[148:151]
    v_add_f32 v97, v97, v177
    v_add_f32 v98, v98, v178
    v_mfma_f32_16x16x32_bf16 v[152:155], a[240:243], a[104:107], v[152:155]
    ds_read_b128 a[236:239], v43 offset:36864
    v_add_f32 v99, v99, v179
    v_mfma_f32_16x16x32_bf16 v[152:155], a[244:247], a[200:203], v[152:155]
    v_lshlrev_b32 v176, 16, v182
    v_and_b32 v177, s54, v182
    v_mfma_f32_16x16x32_bf16 v[156:159], a[244:247], a[204:207], v[156:159]
    v_lshlrev_b32 v178, 16, v183
    v_and_b32 v179, s54, v183
    v_mfma_f32_16x16x32_bf16 v[156:159], a[240:243], a[108:111], v[156:159]
    s_waitcnt lgkmcnt(2)
    v_add_f32 v100, v100, v176
    v_add_f32 v101, v101, v177
    v_mfma_f32_16x16x32_bf16 v[156:159], a[248:251], a[28:31], v[156:159]
    ds_read_b128 a[240:243], v44 offset:36864
    v_add_f32 v102, v102, v178
    v_mfma_f32_16x16x32_bf16 v[156:159], a[252:255], a[220:223], v[156:159]
    buffer_load_dwordx4 v[244:247], v1, s[4:7], s59 offen offset:2048 sc1
    v_mfma_f32_16x16x32_bf16 v[152:155], a[252:255], a[216:219], v[152:155]
    buffer_load_dwordx4 v[252:255], v1, s[4:7], s59 offen offset:3072 sc1
    v_mfma_f32_16x16x32_bf16 v[152:155], a[248:251], a[24:27], v[152:155]
    v_add_f32 v103, v103, v179
    v_lshlrev_b32 v184, 16, v188
    v_mfma_f32_16x16x32_bf16 v[148:151], a[248:251], a[20:23], v[148:151]
    ds_read_b128 a[244:247], v45 offset:36864
    v_and_b32 v185, s54, v188
    v_mfma_f32_16x16x32_bf16 v[148:151], a[252:255], a[212:215], v[148:151]
    v_lshlrev_b32 v186, 16, v189
    v_and_b32 v187, s54, v189
    v_mfma_f32_16x16x32_bf16 v[144:147], a[252:255], a[208:211], v[144:147]
    v_add_f32 v104, v104, v184
    v_add_f32 v105, v105, v185
    v_mfma_f32_16x16x32_bf16 v[144:147], a[248:251], a[16:19], v[144:147]
    s_waitcnt lgkmcnt(2)
    v_add_f32 v106, v106, v186
    v_add_f32 v107, v107, v187
    v_mfma_f32_16x16x32_bf16 v[144:147], a[232:235], a[32:35], v[144:147]
    v_lshlrev_b32 v184, 16, v190
    v_and_b32 v185, s54, v190
    v_mfma_f32_16x16x32_bf16 v[144:147], a[236:239], a[48:51], v[144:147]
    v_lshlrev_b32 v186, 16, v191
    v_and_b32 v187, s54, v191
    v_mfma_f32_16x16x32_bf16 v[148:151], a[236:239], a[52:55], v[148:151]
    v_add_f32 v108, v108, v184
    v_add_f32 v109, v109, v185
    v_mfma_f32_16x16x32_bf16 v[148:151], a[232:235], a[36:39], v[148:151]
    v_add_f32 v110, v110, v186
    v_add_f32 v111, v111, v187
    v_mfma_f32_16x16x32_bf16 v[152:155], a[232:235], a[40:43], v[152:155]
    v_mfma_f32_16x16x32_bf16 v[152:155], a[236:239], a[56:59], v[152:155]
    v_mfma_f32_16x16x32_bf16 v[156:159], a[236:239], a[60:63], v[156:159]
    v_mfma_f32_16x16x32_bf16 v[156:159], a[232:235], a[44:47], v[156:159]
    s_waitcnt lgkmcnt(0)
    v_mfma_f32_16x16x32_bf16 v[156:159], a[240:243], a[76:79], v[156:159]
    v_mfma_f32_16x16x32_bf16 v[156:159], a[244:247], a[172:175], v[156:159]
    v_mfma_f32_16x16x32_bf16 v[152:155], a[244:247], a[168:171], v[152:155]
    v_mfma_f32_16x16x32_bf16 v[152:155], a[240:243], a[72:75], v[152:155]
    v_mfma_f32_16x16x32_bf16 v[148:151], a[240:243], a[68:71], v[148:151]
    v_mfma_f32_16x16x32_bf16 v[148:151], a[244:247], a[164:167], v[148:151]
    v_mfma_f32_16x16x32_bf16 v[144:147], a[244:247], a[160:163], v[144:147]
    v_mfma_f32_16x16x32_bf16 v[144:147], a[240:243], a[64:67], v[144:147]
    s_nop 7
    v_pk_add_f32 v[144:145], v[144:145], v[96:97]
    v_pk_add_f32 v[146:147], v[146:147], v[98:99]
    v_pk_add_f32 v[148:149], v[148:149], v[100:101]
    v_pk_add_f32 v[150:151], v[150:151], v[102:103]
    v_pk_add_f32 v[152:153], v[152:153], v[104:105]
    v_pk_add_f32 v[154:155], v[154:155], v[106:107]
    v_pk_add_f32 v[156:157], v[156:157], v[108:109]
    v_pk_add_f32 v[158:159], v[158:159], v[110:111]
    s_waitcnt vmcnt(6)
    v_max3_u32 v68, v212, v213, v214
    v_max3_u32 v69, v215, v220, v221
    v_max3_u32 v68, v68, v222, v223
    v_max_u32 v68, v68, v69
    v_cmp_eq_u32 vcc, -1, v68
    s_cbranch_vccnz SLOW_X5
BACK_X5:
    v_lshlrev_b32 v208, 16, v212
    v_and_b32 v209, s54, v212
    v_lshlrev_b32 v210, 16, v213
    v_and_b32 v211, s54, v213
    v_pk_add_f32 v[144:145], v[144:145], v[208:209]
    v_pk_add_f32 v[146:147], v[146:147], v[210:211]
    v_lshlrev_b32 v208, 16, v214
    v_and_b32 v209, s54, v214
    v_lshlrev_b32 v210, 16, v215
    v_and_b32 v211, s54, v215
    v_pk_add_f32 v[148:149], v[148:149], v[208:209]
    v_pk_add_f32 v[150:151], v[150:151], v[210:211]
    v_lshlrev_b32 v216, 16, v220
    v_and_b32 v217, s54, v220
    v_lshlrev_b32 v218, 16, v221
    v_and_b32 v219, s54, v221
    v_pk_add_f32 v[152:153], v[152:153], v[216:217]
    v_pk_add_f32 v[154:155], v[154:155], v[218:219]
    v_lshlrev_b32 v216, 16, v222
    v_and_b32 v217, s54, v222
    v_lshlrev_b32 v218, 16, v223
    v_and_b32 v219, s54, v223
    v_pk_add_f32 v[156:157], v[156:157], v[216:217]
    v_pk_add_f32 v[158:159], v[158:159], v[218:219]
    s_waitcnt vmcnt(0)
    v_max3_u32 v68, v244, v245, v246
    v_max3_u32 v69, v247, v252, v253
    v_max3_u32 v68, v68, v254, v255
    v_max_u32 v68, v68, v69
    v_cmp_eq_u32 vcc, -1, v68
    s_cbranch_vccnz SLOW_X7
BACK_X7:
    v_lshlrev_b32 v240, 16, v244
    v_and_b32 v241, s54, v244
    v_lshlrev_b32 v242, 16, v245
    v_and_b32 v243, s54, v245
    v_pk_add_f32 v[144:145], v[144:145], v[240:241]
    v_pk_add_f32 v[146:147], v[146:147], v[242:243]
    buffer_store_dwordx4 v[144:147], v46, s[32:35], s47 offen offset:64 nt
    s_add_u32 s47, s47, 8192
    v_lshlrev_b32 v240, 16, v246
    v_and_b32 v241, s54, v246
    v_lshlrev_b32 v242, 16, v247
    v_and_b32 v243, s54, v247
    v_pk_add_f32 v[148:149], v[148:149], v[240:241]
    v_pk_add_f32 v[150:151], v[150:151], v[242:243]
    buffer_store_dwordx4 v[148:151], v46, s[32:35], s47 offen offset:64 nt
    s_add_u32 s47, s47, 8192
    v_lshlrev_b32 v248, 16, v252
    v_and_b32 v249, s54, v252
    v_lshlrev_b32 v250, 16, v253
    v_and_b32 v251, s54, v253
    v_pk_add_f32 v[152:153], v[152:153], v[248:249]
    v_pk_add_f32 v[154:155], v[154:155], v[250:251]
    buffer_store_dwordx4 v[152:155], v46, s[32:35], s47 offen offset:64 nt
    s_add_u32 s47, s47, 8192
    v_lshlrev_b32 v248, 16, v254
    v_and_b32 v249, s54, v254
    v_lshlrev_b32 v250, 16, v255
    v_and_b32 v251, s54, v255
    v_pk_add_f32 v[156:157], v[156:157], v[248:249]
    v_pk_add_f32 v[158:159], v[158:159], v[250:251]
    buffer_store_dwordx4 v[156:159], v46, s[32:35], s47 offen offset:64 nt
    s_add_u32 s47, s47, 4294942720
    s_lshl2_add_u32 s60, s2, s16
    s_cmp_lg_u32 s60, 1023
    s_cbranch_scc1 K_NOTAG
    v_mov_b32 v2, s79
    v_mov_b32 v3, 29884416
    buffer_store_dword v2, v3, s[4:7], 0 offen
K_NOTAG:
K_END:
    s_endpgm
SLOW_XB:
    s_mov_b32 s78, 0x20000
LOOP_XB:
    buffer_load_dword v67, v71, s[4:7], 0 offen sc1
    s_waitcnt vmcnt(0)
    v_cmp_ne_u32 vcc, s79, v67
    s_sub_u32 s78, s78, 1
    s_cbranch_scc1 BACK_XB
    s_nop 1
    s_cbranch_vccnz LOOP_XB
    s_branch BACK_XB
SLOW_ID0:
    s_mov_b32 s3, 0x20000
LOOP_ID0:
    buffer_load_dword v68, v79, s[4:7], 0 offen sc1
    s_waitcnt vmcnt(0)
    v_subrev_u32 v68, s71, v68
    v_cmp_lt_u32 vcc, 47, v68
    s_sub_u32 s3, s3, 1
    s_cbranch_scc1 BACK_ID0
    s_nop 1
    s_cbranch_vccnz LOOP_ID0
    s_branch BACK_ID0
SLOW_MF:
    s_mov_b32 s3, 0x20000
LOOP_MF:
    buffer_load_dword v67, v66, s[4:7], 0 offen sc1
    s_waitcnt vmcnt(0)
    v_cmp_ne_u32 vcc, s79, v67
    s_sub_u32 s3, s3, 1
    s_cbranch_scc1 BACK_MF
    s_nop 1
    s_cbranch_vccnz LOOP_MF
    s_branch BACK_MF
SLOW_XN:
    s_mov_b32 s78, 0x20000
LOOP_XN:
    buffer_load_dword v192, v183, s[4:7], 0 offen sc1
    s_waitcnt vmcnt(0)
    v_cmp_ne_u32 vcc, s79, v192
    s_sub_u32 s78, s78, 1
    s_cbranch_scc1 BACK_XN
    s_nop 1
    s_cbranch_vccnz LOOP_XN
    s_branch BACK_XN
FAR_1:
    buffer_store_dword v74, v76, s[4:7], s73 offen sc1
    s_branch NEAR_1
FAR_2:
    buffer_store_dword v74, v76, s[4:7], s73 offen sc1
    s_branch NEAR_2
SLOW_MB:
    s_mov_b32 s3, 0x20000
LOOP_MB:
    buffer_load_dwordx4 v[144:147], v14, s[4:7], s70 offen sc1
    buffer_load_dwordx4 v[148:151], v15, s[4:7], s70 offen sc1
    s_waitcnt vmcnt(0)
    v_max3_u32 v74, v144, v145, v146
    v_max3_u32 v75, v147, v148, v149
    v_max3_u32 v74, v74, v150, v151
    v_max_u32 v74, v74, v75
    v_cmp_eq_u32 vcc, -1, v74
    s_sub_u32 s3, s3, 1
    s_cbranch_scc1 BACK_MB
    s_nop 1
    s_cbranch_vccnz LOOP_MB
    s_branch BACK_MB
SLOW_FA1:
    s_mov_b32 s3, 0x20000
LOOP_FA1:
    buffer_load_dword v17, v16, s[4:7], s73 offen sc1
    s_waitcnt vmcnt(0)
    v_subrev_u32 v17, s79, v17
    v_subrev_u32 v17, 1, v17
    v_cmp_lt_u32 vcc, 6, v17
    s_sub_u32 s3, s3, 1
    s_cbranch_scc1 BACK_FA1
    s_nop 1
    s_cbranch_vccnz LOOP_FA1
    s_branch BACK_FA1
FAR_3:
    buffer_store_dword v74, v76, s[4:7], s73 offen sc1
    s_branch NEAR_3
SLOW_FA2:
    s_mov_b32 s3, 0x20000
LOOP_FA2:
    buffer_load_dword v17, v16, s[4:7], s73 offen sc1
    s_waitcnt vmcnt(0)
    v_subrev_u32 v17, s79, v17
    v_subrev_u32 v17, 2, v17
    v_cmp_lt_u32 vcc, 5, v17
    s_sub_u32 s3, s3, 1
    s_cbranch_scc1 BACK_FA2
    s_nop 1
    s_cbranch_vccnz LOOP_FA2
    s_branch BACK_FA2
SLOW_FA3:
    s_mov_b32 s3, 0x20000
LOOP_FA3:
    buffer_load_dword v17, v16, s[4:7], s73 offen sc1
    s_waitcnt vmcnt(0)
    v_subrev_u32 v17, s79, v17
    v_subrev_u32 v17, 3, v17
    v_cmp_lt_u32 vcc, 4, v17
    s_sub_u32 s3, s3, 1
    s_cbranch_scc1 BACK_FA3
    s_nop 1
    s_cbranch_vccnz LOOP_FA3
    s_branch BACK_FA3
FAR_4:
    buffer_store_dword v74, v76, s[4:7], s73 offen sc1
    s_branch NEAR_4
SLOW_FA4:
    s_mov_b32 s3, 0x20000
LOOP_FA4:
    buffer_load_dword v17, v16, s[4:7], s73 offen sc1
    s_waitcnt vmcnt(0)
    v_subrev_u32 v17, s79, v17
    v_subrev_u32 v17, 4, v17
    v_cmp_lt_u32 vcc, 3, v17
    s_sub_u32 s3, s3, 1
    s_cbranch_scc1 BACK_FA4
    s_nop 1
    s_cbranch_vccnz LOOP_FA4
    s_branch BACK_FA4
SLOW_FX:
    s_mov_b32 s3, 0x20000
LOOP_FX:
    buffer_load_dwordx4 v[124:127], v51, s[4:7], s1 offen sc1
    s_waitcnt vmcnt(0)
    v_xor_b32 v124, v74, v124
    v_xor_b32 v125, v74, v125
    v_xor_b32 v126, v74, v126
    v_xor_b32 v127, v74, v127
    v_or3_b32 v124, v124, v125, v126
    v_or_b32 v124, v124, v127
    v_cmp_ne_u32 vcc, 0, v124
    s_sub_u32 s3, s3, 1
    s_cbranch_scc1 BACK_FX
    s_nop 1
    s_cbranch_vccnz LOOP_FX
    s_branch BACK_FX
SLOW_X2:
    s_mov_b32 s3, 0x20000
LOOP_X2:
    buffer_load_dwordx4 v[164:167], v1, s[4:7], s57 offen offset:0 sc1
    buffer_load_dwordx4 v[172:175], v1, s[4:7], s57 offen offset:1024 sc1
    s_waitcnt vmcnt(0)
    v_max3_u32 v68, v164, v165, v166
    v_max3_u32 v69, v167, v172, v173
    v_max3_u32 v68, v68, v174, v175
    v_max_u32 v68, v68, v69
    v_cmp_eq_u32 vcc, -1, v68
    s_sub_u32 s3, s3, 1
    s_cbranch_scc1 BACK_X2
    s_nop 1
    s_cbranch_vccnz LOOP_X2
    s_branch BACK_X2
SLOW_X4:
    s_mov_b32 s3, 0x20000
LOOP_X4:
    buffer_load_dwordx4 v[196:199], v1, s[4:7], s58 offen offset:0 sc1
    buffer_load_dwordx4 v[204:207], v1, s[4:7], s58 offen offset:1024 sc1
    s_waitcnt vmcnt(0)
    v_max3_u32 v68, v196, v197, v198
    v_max3_u32 v69, v199, v204, v205
    v_max3_u32 v68, v68, v206, v207
    v_max_u32 v68, v68, v69
    v_cmp_eq_u32 vcc, -1, v68
    s_sub_u32 s3, s3, 1
    s_cbranch_scc1 BACK_X4
    s_nop 1
    s_cbranch_vccnz LOOP_X4
    s_branch BACK_X4
SLOW_X6:
    s_mov_b32 s3, 0x20000
LOOP_X6:
    buffer_load_dwordx4 v[228:231], v1, s[4:7], s59 offen offset:0 sc1
    buffer_load_dwordx4 v[236:239], v1, s[4:7], s59 offen offset:1024 sc1
    s_waitcnt vmcnt(0)
    v_max3_u32 v68, v228, v229, v230
    v_max3_u32 v69, v231, v236, v237
    v_max3_u32 v68, v68, v238, v239
    v_max_u32 v68, v68, v69
    v_cmp_eq_u32 vcc, -1, v68
    s_sub_u32 s3, s3, 1
    s_cbranch_scc1 BACK_X6
    s_nop 1
    s_cbranch_vccnz LOOP_X6
    s_branch BACK_X6
SLOW_X3:
    s_mov_b32 s3, 0x20000
LOOP_X3:
    buffer_load_dwordx4 v[180:183], v1, s[4:7], s57 offen offset:2048 sc1
    buffer_load_dwordx4 v[188:191], v1, s[4:7], s57 offen offset:3072 sc1
    s_waitcnt vmcnt(0)
    v_max3_u32 v68, v180, v181, v182
    v_max3_u32 v69, v183, v188, v189
    v_max3_u32 v68, v68, v190, v191
    v_max_u32 v68, v68, v69
    v_cmp_eq_u32 vcc, -1, v68
    s_sub_u32 s3, s3, 1
    s_cbranch_scc1 BACK_X3
    s_nop 1
    s_cbranch_vccnz LOOP_X3
    s_branch BACK_X3
SLOW_X5:
    s_mov_b32 s3, 0x20000
LOOP_X5:
    buffer_load_dwordx4 v[212:215], v1, s[4:7], s58 offen offset:2048 sc1
    buffer_load_dwordx4 v[220:223], v1, s[4:7], s58 offen offset:3072 sc1
    s_waitcnt vmcnt(0)
    v_max3_u32 v68, v212, v213, v214
    v_max3_u32 v69, v215, v220, v221
    v_max3_u32 v68, v68, v222, v223
    v_max_u32 v68, v68, v69
    v_cmp_eq_u32 vcc, -1, v68
    s_sub_u32 s3, s3, 1
    s_cbranch_scc1 BACK_X5
    s_nop 1
    s_cbranch_vccnz LOOP_X5
    s_branch BACK_X5
SLOW_X7:
    s_mov_b32 s3, 0x20000
LOOP_X7:
    buffer_load_dwordx4 v[244:247], v1, s[4:7], s59 offen offset:2048 sc1
    buffer_load_dwordx4 v[252:255], v1, s[4:7], s59 offen offset:3072 sc1
    s_waitcnt vmcnt(0)
    v_max3_u32 v68, v244, v245, v246
    v_max3_u32 v69, v247, v252, v253
    v_max3_u32 v68, v68, v254, v255
    v_max_u32 v68, v68, v69
    v_cmp_eq_u32 vcc, -1, v68
    s_sub_u32 s3, s3, 1
    s_cbranch_scc1 BACK_X7
    s_nop 1
    s_cbranch_vccnz LOOP_X7
    s_branch BACK_X7
CODE_END:
.section .rodata,"a"
.p2align 6
.amdhsa_kernel parallel_sum__ssm_conv_s5__swiglu_ffn__prompt_kernel
  .amdhsa_next_free_vgpr 512
  .amdhsa_next_free_sgpr 102
  .amdhsa_accum_offset 256
  .amdhsa_group_segment_fixed_size 0
  .amdhsa_kernarg_size 128
  .amdhsa_user_sgpr_count 2
  .amdhsa_user_sgpr_kernarg_segment_ptr 1
  .amdhsa_system_sgpr_workgroup_id_x 1
  .amdhsa_float_denorm_mode_32 3
.end_amdhsa_kernel
```
